```python
import torch

def _softmax(x, axis=-1):
    return torch.softmax(x, dim=axis)
def _gelu(x):
    return torch.nn.functional.gelu(x, approximate="tanh")
def _silu(x):
    return torch.nn.functional.silu(x)
def _sigmoid(x):
    return torch.sigmoid(x)
def _layernorm(x, axis=-1, eps=1e-5):
    m = x.mean(dim=axis, keepdim=True)
    v = x.var(dim=axis, keepdim=True, unbiased=False)
    return (x - m) / torch.sqrt(v + eps)
def _scatter_add(tgt, idx, src, axis=0):
    return tgt.clone().index_add_(axis, idx, src)
def _segment_sum(src, seg, n):
    out = torch.zeros((n,) + src.shape[1:], dtype=src.dtype)
    return out.index_add_(0, seg, src)
def _pad(x, pw):
    flat = tuple(v for pair in reversed(pw) for v in pair)
    return torch.nn.functional.pad(x, flat)

kernel_name = 'interleave_layers__mha_block__mixer_channel_mlp__prompt'

def setup_inputs():

    _w = (lambda a: (lambda t: t.to(torch.bfloat16) if t.is_floating_point() else t)(torch.as_tensor(a)))
    def _A_setup():
        B, S, D, H = 1, 2048, 640, 32
        return {
            "x": _w((lambda *s: torch.randn(*s, dtype=torch.bfloat16) * 0.05)(B, S, D)),
            "wqkv": _w((lambda *s: torch.randn(*s, dtype=torch.bfloat16) * 0.05)(D, 3 * D)),
            "wo": _w((lambda *s: torch.randn(*s, dtype=torch.bfloat16) * 0.05)(D, D)),
        }
    _A_in = _A_setup()

    def _B_setup():
        B, S, D, F = 1, 2048, 640, 1536
        return {
            "x": _w((lambda *s: torch.randn(*s, dtype=torch.bfloat16) * 0.05)(B, S, D)),
            "w1": _w((lambda *s: torch.randn(*s, dtype=torch.bfloat16) * 3.2)(D, F) * (D ** -0.5)),
            "b1": _w((lambda *s: torch.randn(*s, dtype=torch.bfloat16) * 0.8)(F)),
            "w2": _w((lambda *s: torch.randn(*s, dtype=torch.bfloat16) * 0.4)(F, D) * (F ** -0.5)),
            "b2": _w((lambda *s: torch.randn(*s, dtype=torch.bfloat16) * 0.4)(D)),
        }
    _B_in = _B_setup()

    return {
        "A_x": _A_in["x"],
        "A_wqkv": _A_in["wqkv"],
        "A_wo": _A_in["wo"],
        "B_x": _B_in["x"],
        "B_w1": _B_in["w1"],
        "B_b1": _B_in["b1"],
        "B_w2": _B_in["w2"],
        "B_b2": _B_in["b2"],
    }

def reference(A_x, A_wqkv, A_wo, B_x, B_w1, B_b1, B_w2, B_b2):
    def _A_ref(x, wqkv, wo):
        B, S, D = x.shape
        H = 32
        Dh = D // H
        qkv = (lambda x, *d: x.permute(*d))((x @ wqkv).reshape(B, S, 3, H, Dh), 2, 0, 3, 1, 4)
        q, k, v = qkv[0], qkv[1], qkv[2]
        scores = torch.einsum("bhqd,bhkd->bhqk", q, k) * (Dh ** -0.5)
        p = _softmax(scores, axis=-1)
        o = torch.einsum("bhqk,bhkd->bhqd", p, v)
        return (lambda x, *d: x.permute(*d))(o, 0, 2, 1, 3).reshape(B, S, D) @ wo

    def _B_ref(x, w1, b1, w2, b2):
        y = _layernorm(x, axis=-1)
        h = _gelu(torch.einsum("bsd,df->bsf", y, w1) + b1)
        return torch.einsum("bsf,fd->bsd", h, w2) + b2

    x = A_x
    x = x + _A_ref(_layernorm(x, axis=-1), A_wqkv, A_wo)
    x = x + _B_ref(_layernorm(x, axis=-1), B_w1, B_b1, B_w2, B_b2)
    x = x + _A_ref(_layernorm(x, axis=-1), A_wqkv, A_wo)
    x = x + _B_ref(_layernorm(x, axis=-1), B_w1, B_b1, B_w2, B_b2)
    return x
```

```asm
; @launch kernel=qkv0_kernel grid=(240,1,1) block=(512,1,1) lds=133120
; @launch kernel=f0_kernel grid=(256,1,1) block=(512,1,1) lds=163840
.amdgcn_target "amdgcn-amd-amdhsa--gfx950"
.text
.globl qkv0_kernel
.p2align 8
.type qkv0_kernel,@function
qkv0_kernel:
  s_cmp_ge_u32 s2, 240
  s_cbranch_scc1 qkv0_kernel_end
  s_load_dwordx2 s[8:9], s[0:1], 0
  s_load_dwordx2 s[10:11], s[0:1], 8
  s_load_dwordx2 s[6:7], s[0:1], 80
  v_lshrrev_b32 v1, 6, v0
  s_nop 0
  v_readfirstlane_b32 s26, v1
  v_and_b32 v0, 63, v0
  s_and_b32 s20, s2, 7
  s_lshr_b32 s21, s2, 3
  s_cmp_ge_u32 s26, 4
  s_cbranch_scc1 qkv0_kernel_nct1
  s_getpc_b64 s[40:41]
qkv0_kernel_ct2:
  s_sub_u32 s40, s40, qkv0_kernel_ct2-qkv0_kernel
  s_subb_u32 s41, s41, 0
  s_lshl_b32 s42, s21, 2
  s_add_u32 s42, s42, s26
  s_lshl_b32 s42, s42, 10
  v_lshlrev_b32 v252, 6, v0
  v_add_u32 v252, s42, v252
  v_min_u32 v252, f0_kernel_skip-qkv0_kernel-4, v252
  v_mov_b32 v253, s41
  v_add_co_u32 v252, vcc, s40, v252
  s_nop 1
  v_addc_co_u32 v253, vcc, 0, v253, vcc
  s_mov_b64 exec, 0xffff
  global_load_dword v254, v[252:253], off
  s_mov_b64 exec, -1
qkv0_kernel_nct1:
  s_and_b32 s22, s20, 1
  s_mul_i32 s22, s22, 30
  s_add_u32 s22, s22, s21
  s_lshr_b32 s25, s22, 2
  s_and_b32 s22, s22, 3
  s_lshr_b32 s23, s20, 1
  s_lshl_b32 s23, s23, 2
  s_add_u32 s24, s23, s22
  s_cmp_lt_u32 s26, 4
  s_cbranch_scc1 qkv0_kernel_compute
  s_sub_u32 s26, s26, 4
  v_lshrrev_b32 v1, 4, v0
  v_and_b32 v2, 15, v0
  v_lshlrev_b32 v3, 2, v1
  v_xor_b32 v2, v2, v3
  v_mul_u32_u24 v1, 3840, v1
  v_lshl_add_u32 v4, v2, 4, v1
  v_add_u32 v5, 14336, v4
  v_add_u32 v6, 14336, v5
  v_add_u32 v7, 14336, v6
  v_lshrrev_b32 v1, 3, v0
  v_and_b32 v2, 7, v0
  v_lshrrev_b32 v3, 1, v1
  v_xor_b32 v2, v2, v3
  v_mul_u32_u24 v1, 1280, v1
  v_lshl_add_u32 v8, v2, 4, v1
  v_xor_b32 v2, 4, v2
  v_lshl_add_u32 v2, v2, 4, v1
  v_add_u32 v9, 9216, v2
  v_add_u32 v10, 18432, v8
  v_add_u32 v11, 27648, v2
  s_lshl_b32 s40, s25, 8
  s_mul_i32 s41, s26, 61440
  s_add_u32 s40, s40, s41
  s_lshl_b32 s42, s26, 12
  s_lshl_b32 s43, s24, 2
  s_add_u32 s43, s43, s26
  s_mul_i32 s43, s43, 40960
  s_add_u32 s44, s42, 16384
  s_waitcnt lgkmcnt(0)
  s_mov_b32 s12, s10
  s_mov_b32 s13, s11
  s_mov_b32 s14, 0x258000
  s_mov_b32 s15, 0x00020000
  s_mov_b32 s16, s8
  s_mov_b32 s17, s9
  s_mov_b32 s18, 0x280000
  s_mov_b32 s19, 0x00020000
  s_add_u32 m0, s42, 0
  s_add_u32 s45, s40, 0
  buffer_load_dwordx4 v4, s[12:15], s45 offen offset:0 lds
  buffer_load_dwordx4 v5, s[12:15], s45 offen offset:1024 lds
  buffer_load_dwordx4 v6, s[12:15], s45 offen offset:2048 lds
  buffer_load_dwordx4 v7, s[12:15], s45 offen offset:3072 lds
  s_add_u32 m0, s44, 0
  s_add_u32 s45, s43, 0
  buffer_load_dwordx4 v8, s[16:19], s45 offen offset:0 lds
  buffer_load_dwordx4 v9, s[16:19], s45 offen offset:1024 lds
  buffer_load_dwordx4 v10, s[16:19], s45 offen offset:2048 lds
  buffer_load_dwordx4 v11, s[16:19], s45 offen offset:3072 lds
  s_add_u32 m0, s42, 32768
  s_add_u32 s45, s40, 245760
  buffer_load_dwordx4 v4, s[12:15], s45 offen offset:0 lds
  buffer_load_dwordx4 v5, s[12:15], s45 offen offset:1024 lds
  buffer_load_dwordx4 v6, s[12:15], s45 offen offset:2048 lds
  buffer_load_dwordx4 v7, s[12:15], s45 offen offset:3072 lds
  s_add_u32 m0, s44, 32768
  s_add_u32 s45, s43, 128
  buffer_load_dwordx4 v8, s[16:19], s45 offen offset:0 lds
  buffer_load_dwordx4 v9, s[16:19], s45 offen offset:1024 lds
  buffer_load_dwordx4 v10, s[16:19], s45 offen offset:2048 lds
  buffer_load_dwordx4 v11, s[16:19], s45 offen offset:3072 lds
  s_waitcnt vmcnt(8)
  s_barrier
  s_add_u32 m0, s42, 65536
  s_add_u32 s45, s40, 491520
  buffer_load_dwordx4 v4, s[12:15], s45 offen offset:0 lds
  buffer_load_dwordx4 v5, s[12:15], s45 offen offset:1024 lds
  buffer_load_dwordx4 v6, s[12:15], s45 offen offset:2048 lds
  buffer_load_dwordx4 v7, s[12:15], s45 offen offset:3072 lds
  s_add_u32 m0, s44, 65536
  s_add_u32 s45, s43, 256
  buffer_load_dwordx4 v8, s[16:19], s45 offen offset:0 lds
  buffer_load_dwordx4 v9, s[16:19], s45 offen offset:1024 lds
  buffer_load_dwordx4 v10, s[16:19], s45 offen offset:2048 lds
  buffer_load_dwordx4 v11, s[16:19], s45 offen offset:3072 lds
  s_add_u32 m0, s42, 98304
  s_add_u32 s45, s40, 737280
  buffer_load_dwordx4 v4, s[12:15], s45 offen offset:0 lds
  buffer_load_dwordx4 v5, s[12:15], s45 offen offset:1024 lds
  buffer_load_dwordx4 v6, s[12:15], s45 offen offset:2048 lds
  buffer_load_dwordx4 v7, s[12:15], s45 offen offset:3072 lds
  s_add_u32 m0, s44, 98304
  s_add_u32 s45, s43, 384
  buffer_load_dwordx4 v8, s[16:19], s45 offen offset:0 lds
  buffer_load_dwordx4 v9, s[16:19], s45 offen offset:1024 lds
  buffer_load_dwordx4 v10, s[16:19], s45 offen offset:2048 lds
  buffer_load_dwordx4 v11, s[16:19], s45 offen offset:3072 lds
  s_waitcnt vmcnt(16)
  s_barrier
  s_add_u32 m0, s42, 0
  s_add_u32 s45, s40, 983040
  buffer_load_dwordx4 v4, s[12:15], s45 offen offset:0 lds
  buffer_load_dwordx4 v5, s[12:15], s45 offen offset:1024 lds
  buffer_load_dwordx4 v6, s[12:15], s45 offen offset:2048 lds
  buffer_load_dwordx4 v7, s[12:15], s45 offen offset:3072 lds
  s_add_u32 m0, s44, 0
  s_add_u32 s45, s43, 512
  buffer_load_dwordx4 v8, s[16:19], s45 offen offset:0 lds
  buffer_load_dwordx4 v9, s[16:19], s45 offen offset:1024 lds
  buffer_load_dwordx4 v10, s[16:19], s45 offen offset:2048 lds
  buffer_load_dwordx4 v11, s[16:19], s45 offen offset:3072 lds
  s_waitcnt vmcnt(16)
  s_barrier
  s_add_u32 m0, s42, 32768
  s_add_u32 s45, s40, 1228800
  buffer_load_dwordx4 v4, s[12:15], s45 offen offset:0 lds
  buffer_load_dwordx4 v5, s[12:15], s45 offen offset:1024 lds
  buffer_load_dwordx4 v6, s[12:15], s45 offen offset:2048 lds
  buffer_load_dwordx4 v7, s[12:15], s45 offen offset:3072 lds
  s_add_u32 m0, s44, 32768
  s_add_u32 s45, s43, 640
  buffer_load_dwordx4 v8, s[16:19], s45 offen offset:0 lds
  buffer_load_dwordx4 v9, s[16:19], s45 offen offset:1024 lds
  buffer_load_dwordx4 v10, s[16:19], s45 offen offset:2048 lds
  buffer_load_dwordx4 v11, s[16:19], s45 offen offset:3072 lds
  s_waitcnt vmcnt(16)
  s_barrier
  s_add_u32 m0, s42, 65536
  s_add_u32 s45, s40, 1474560
  buffer_load_dwordx4 v4, s[12:15], s45 offen offset:0 lds
  buffer_load_dwordx4 v5, s[12:15], s45 offen offset:1024 lds
  buffer_load_dwordx4 v6, s[12:15], s45 offen offset:2048 lds
  buffer_load_dwordx4 v7, s[12:15], s45 offen offset:3072 lds
  s_add_u32 m0, s44, 65536
  s_add_u32 s45, s43, 768
  buffer_load_dwordx4 v8, s[16:19], s45 offen offset:0 lds
  buffer_load_dwordx4 v9, s[16:19], s45 offen offset:1024 lds
  buffer_load_dwordx4 v10, s[16:19], s45 offen offset:2048 lds
  buffer_load_dwordx4 v11, s[16:19], s45 offen offset:3072 lds
  s_waitcnt vmcnt(16)
  s_barrier
  s_add_u32 m0, s42, 98304
  s_add_u32 s45, s40, 1720320
  buffer_load_dwordx4 v4, s[12:15], s45 offen offset:0 lds
  buffer_load_dwordx4 v5, s[12:15], s45 offen offset:1024 lds
  buffer_load_dwordx4 v6, s[12:15], s45 offen offset:2048 lds
  buffer_load_dwordx4 v7, s[12:15], s45 offen offset:3072 lds
  s_add_u32 m0, s44, 98304
  s_add_u32 s45, s43, 896
  buffer_load_dwordx4 v8, s[16:19], s45 offen offset:0 lds
  buffer_load_dwordx4 v9, s[16:19], s45 offen offset:1024 lds
  buffer_load_dwordx4 v10, s[16:19], s45 offen offset:2048 lds
  buffer_load_dwordx4 v11, s[16:19], s45 offen offset:3072 lds
  s_waitcnt vmcnt(16)
  s_barrier
  s_add_u32 m0, s42, 0
  s_add_u32 s45, s40, 1966080
  buffer_load_dwordx4 v4, s[12:15], s45 offen offset:0 lds
  buffer_load_dwordx4 v5, s[12:15], s45 offen offset:1024 lds
  buffer_load_dwordx4 v6, s[12:15], s45 offen offset:2048 lds
  buffer_load_dwordx4 v7, s[12:15], s45 offen offset:3072 lds
  s_add_u32 m0, s44, 0
  s_add_u32 s45, s43, 1024
  buffer_load_dwordx4 v8, s[16:19], s45 offen offset:0 lds
  buffer_load_dwordx4 v9, s[16:19], s45 offen offset:1024 lds
  buffer_load_dwordx4 v10, s[16:19], s45 offen offset:2048 lds
  buffer_load_dwordx4 v11, s[16:19], s45 offen offset:3072 lds
  s_waitcnt vmcnt(16)
  s_barrier
  s_add_u32 m0, s42, 32768
  s_add_u32 s45, s40, 2211840
  buffer_load_dwordx4 v4, s[12:15], s45 offen offset:0 lds
  buffer_load_dwordx4 v5, s[12:15], s45 offen offset:1024 lds
  buffer_load_dwordx4 v6, s[12:15], s45 offen offset:2048 lds
  buffer_load_dwordx4 v7, s[12:15], s45 offen offset:3072 lds
  s_add_u32 m0, s44, 32768
  s_add_u32 s45, s43, 1152
  buffer_load_dwordx4 v8, s[16:19], s45 offen offset:0 lds
  buffer_load_dwordx4 v9, s[16:19], s45 offen offset:1024 lds
  buffer_load_dwordx4 v10, s[16:19], s45 offen offset:2048 lds
  buffer_load_dwordx4 v11, s[16:19], s45 offen offset:3072 lds
  s_waitcnt vmcnt(16)
  s_barrier
  s_waitcnt vmcnt(8)
  s_barrier
  s_waitcnt vmcnt(0)
  s_barrier
  s_cmp_ge_u32 s2, 64
  s_cbranch_scc1 qkv0_kernel_zdone
  s_cmp_lg_u32 s26, 0
  s_cbranch_scc1 qkv0_kernel_zdone
  s_add_u32 s48, s6, 0x8c0000
  s_addc_u32 s49, s7, 0
  s_mov_b32 s50, 0x10000
  s_mov_b32 s51, 0x00020000
  s_lshl_b32 s45, s2, 10
  v_lshlrev_b32 v1, 4, v0
  v_mov_b32 v12, 0
  v_mov_b32 v13, 0
  v_mov_b32 v14, 0
  v_mov_b32 v15, 0
  buffer_store_dwordx4 v[12:15], v1, s[48:51], s45 offen sc1
  s_waitcnt vmcnt(0)
qkv0_kernel_zdone:
  s_add_u32 s26, s26, 4
qkv0_kernel_end:
  s_endpgm
qkv0_kernel_compute:
  s_and_b32 s27, s26, 1
  s_lshr_b32 s36, s26, 1
  v_lshrrev_b32 v17, 5, v0
  v_and_b32 v16, 31, v0
  v_lshrrev_b32 v20, 4, v0
  v_bfe_u32 v21, v0, 2, 2
  v_and_b32 v22, 3, v0
  v_lshrrev_b32 v23, 1, v20
  v_lshl_add_u32 v23, v23, 3, v21
  v_and_b32 v18, 1, v20
  v_lshlrev_b32 v18, 1, v18
  v_lshrrev_b32 v19, 1, v22
  v_add_u32 v18, v18, v19
  s_lshl_b32 s37, s27, 3
  v_add_u32 v18, s37, v18
  v_lshlrev_b32 v19, 2, v21
  v_xor_b32 v18, v18, v19
  v_lshlrev_b32 v18, 4, v18
  v_lshl_add_u32 v18, v23, 8, v18
  v_and_b32 v19, 1, v22
  v_lshl_add_u32 v2, v19, 3, v18
  v_add_u32 v3, 65536, v2
  v_xor_b32 v4, 64, v2
  v_add_u32 v5, 65536, v4
  v_bfe_u32 v18, v16, 1, 3
  v_xor_b32 v18, v18, v17
  v_lshlrev_b32 v18, 4, v18
  v_lshl_add_u32 v18, v16, 7, v18
  s_lshl_b32 s37, s36, 13
  s_lshl_b32 s38, s27, 12
  s_add_u32 s37, s37, s38
  s_add_u32 s37, s37, 16384
  v_add_u32 v192, s37, v18
  v_add_u32 v193, 65536, v192
  v_xor_b32 v194, 32, v192
  v_add_u32 v195, 65536, v194
  v_xor_b32 v196, 64, v192
  v_add_u32 v197, 65536, v196
  v_xor_b32 v198, 96, v192
  v_add_u32 v199, 65536, v198
  v_xor_b32 v200, 4096, v192
  v_add_u32 v201, 65536, v200
  v_xor_b32 v202, 4128, v192
  v_add_u32 v203, 65536, v202
  v_xor_b32 v204, 4160, v192
  v_add_u32 v205, 65536, v204
  v_xor_b32 v206, 4192, v192
  v_add_u32 v207, 65536, v206
  v_and_b32 v18, 15, v0
  v_bfe_u32 v19, v0, 4, 1
  v_cmp_eq_u32 vcc, v18, v19
  v_mov_b32 v19, 0x3f803f80
  s_nop 0
  v_cndmask_b32 v60, 0, v19, vcc
  v_mov_b32 v61, v60
  v_mov_b32 v62, v60
  v_mov_b32 v63, v60
  v_mov_b32 v48, 0
  v_mov_b32 v49, 0
  v_mov_b32 v50, 0
  v_mov_b32 v51, 0
  s_waitcnt lgkmcnt(0)
  s_cmp_ge_u32 s25, 10
  s_cbranch_scc1 qkv0_kernel_vpath
  s_mov_b32 s48, s6
  s_mov_b32 s49, s7
  s_mov_b32 s50, 0x3200000
  s_mov_b32 s51, 0x00020000
  s_cmp_lt_u32 s25, 5
  s_mov_b32 s37, 25165824
  s_cselect_b32 s37, 22020096, s37
  s_cselect_b32 s38, 0, 5
  s_movk_i32 s39, 2560
  s_cselect_b32 s39, 1280, s39
  s_lshl_b32 s40, s39, 6
  s_sub_u32 s38, s25, s38
  s_lshl_b32 s41, s38, 5
  s_mul_i32 s42, s41, 205
  s_lshr_b32 s42, s42, 10
  s_mul_i32 s54, s42, s40
  s_add_u32 s54, s54, s37
  s_lshl_b32 s41, s24, 2
  s_add_u32 s41, s41, s26
  s_mul_i32 s41, s41, s39
  s_add_u32 s54, s54, s41
  s_mov_b32 s55, s42
  s_mov_b32 s60, s38
  s_barrier
  ds_read_b128 v[160:163], v192 offset:0
  ds_read_b128 v[164:167], v200 offset:0
  ds_read_b64_tr_b16 v[128:129], v2 offset:0
  ds_read_b64_tr_b16 v[130:131], v2 offset:1024
  ds_read_b64_tr_b16 v[132:133], v4 offset:0
  ds_read_b64_tr_b16 v[134:135], v4 offset:1024
  s_waitcnt lgkmcnt(0)
  v_mfma_f32_32x32x16_bf16 v[64:79], v[128:131], v[160:163], 0
  ds_read_b128 v[168:171], v194 offset:0
  v_and_b32 v52, 0xffff0000, v160
  v_lshlrev_b32 v53, 16, v160
  v_add_f32 v48, v48, v52
  v_fmac_f32 v50, v52, v52
  v_mfma_f32_32x32x16_bf16 v[80:95], v[128:131], v[164:167], 0
  ds_read_b128 v[172:175], v202 offset:0
  v_add_f32 v49, v49, v53
  v_fmac_f32 v51, v53, v53
  v_and_b32 v54, 0xffff0000, v161
  v_lshlrev_b32 v55, 16, v161
  v_mfma_f32_16x16x32_bf16 v[32:35], v[60:63], v[128:131], 0
  ds_read_b64_tr_b16 v[136:137], v2 offset:4096
  v_add_f32 v48, v48, v54
  v_fmac_f32 v50, v54, v54
  v_add_f32 v49, v49, v55
  v_fmac_f32 v51, v55, v55
  v_mfma_f32_32x32x16_bf16 v[96:111], v[132:135], v[160:163], 0
  ds_read_b64_tr_b16 v[138:139], v2 offset:5120
  v_and_b32 v52, 0xffff0000, v162
  v_lshlrev_b32 v53, 16, v162
  v_add_f32 v48, v48, v52
  v_fmac_f32 v50, v52, v52
  v_mfma_f32_32x32x16_bf16 v[112:127], v[132:135], v[164:167], 0
  ds_read_b64_tr_b16 v[140:141], v4 offset:4096
  v_add_f32 v49, v49, v53
  v_fmac_f32 v51, v53, v53
  v_and_b32 v54, 0xffff0000, v163
  v_lshlrev_b32 v55, 16, v163
  v_mfma_f32_16x16x32_bf16 v[36:39], v[60:63], v[132:135], 0
  ds_read_b64_tr_b16 v[142:143], v4 offset:5120
  v_add_f32 v48, v48, v54
  v_fmac_f32 v50, v54, v54
  v_add_f32 v49, v49, v55
  v_fmac_f32 v51, v55, v55
  s_waitcnt lgkmcnt(0)
  v_mfma_f32_32x32x16_bf16 v[64:79], v[136:139], v[168:171], v[64:79]
  ds_read_b128 v[160:163], v196 offset:0
  v_and_b32 v52, 0xffff0000, v168
  v_lshlrev_b32 v53, 16, v168
  v_add_f32 v48, v48, v52
  v_fmac_f32 v50, v52, v52
  v_mfma_f32_32x32x16_bf16 v[80:95], v[136:139], v[172:175], v[80:95]
  ds_read_b128 v[164:167], v204 offset:0
  v_add_f32 v49, v49, v53
  v_fmac_f32 v51, v53, v53
  v_and_b32 v54, 0xffff0000, v169
  v_lshlrev_b32 v55, 16, v169
  v_mfma_f32_16x16x32_bf16 v[32:35], v[60:63], v[136:139], v[32:35]
  ds_read_b64_tr_b16 v[128:129], v2 offset:8192
  v_add_f32 v48, v48, v54
  v_fmac_f32 v50, v54, v54
  v_add_f32 v49, v49, v55
  v_fmac_f32 v51, v55, v55
  v_mfma_f32_32x32x16_bf16 v[96:111], v[140:143], v[168:171], v[96:111]
  ds_read_b64_tr_b16 v[130:131], v2 offset:9216
  v_and_b32 v52, 0xffff0000, v170
  v_lshlrev_b32 v53, 16, v170
  v_add_f32 v48, v48, v52
  v_fmac_f32 v50, v52, v52
  v_mfma_f32_32x32x16_bf16 v[112:127], v[140:143], v[172:175], v[112:127]
  ds_read_b64_tr_b16 v[132:133], v4 offset:8192
  v_add_f32 v49, v49, v53
  v_fmac_f32 v51, v53, v53
  v_and_b32 v54, 0xffff0000, v171
  v_lshlrev_b32 v55, 16, v171
  v_mfma_f32_16x16x32_bf16 v[36:39], v[60:63], v[140:143], v[36:39]
  ds_read_b64_tr_b16 v[134:135], v4 offset:9216
  v_add_f32 v48, v48, v54
  v_fmac_f32 v50, v54, v54
  v_add_f32 v49, v49, v55
  v_fmac_f32 v51, v55, v55
  s_waitcnt lgkmcnt(0)
  v_mfma_f32_32x32x16_bf16 v[64:79], v[128:131], v[160:163], v[64:79]
  ds_read_b128 v[168:171], v198 offset:0
  v_and_b32 v52, 0xffff0000, v160
  v_lshlrev_b32 v53, 16, v160
  v_add_f32 v48, v48, v52
  v_fmac_f32 v50, v52, v52
  v_mfma_f32_32x32x16_bf16 v[80:95], v[128:131], v[164:167], v[80:95]
  ds_read_b128 v[172:175], v206 offset:0
  v_add_f32 v49, v49, v53
  v_fmac_f32 v51, v53, v53
  v_and_b32 v54, 0xffff0000, v161
  v_lshlrev_b32 v55, 16, v161
  v_mfma_f32_16x16x32_bf16 v[32:35], v[60:63], v[128:131], v[32:35]
  ds_read_b64_tr_b16 v[136:137], v2 offset:12288
  v_add_f32 v48, v48, v54
  v_fmac_f32 v50, v54, v54
  v_add_f32 v49, v49, v55
  v_fmac_f32 v51, v55, v55
  v_mfma_f32_32x32x16_bf16 v[96:111], v[132:135], v[160:163], v[96:111]
  ds_read_b64_tr_b16 v[138:139], v2 offset:13312
  v_and_b32 v52, 0xffff0000, v162
  v_lshlrev_b32 v53, 16, v162
  v_add_f32 v48, v48, v52
  v_fmac_f32 v50, v52, v52
  v_mfma_f32_32x32x16_bf16 v[112:127], v[132:135], v[164:167], v[112:127]
  ds_read_b64_tr_b16 v[140:141], v4 offset:12288
  v_add_f32 v49, v49, v53
  v_fmac_f32 v51, v53, v53
  v_and_b32 v54, 0xffff0000, v163
  v_lshlrev_b32 v55, 16, v163
  v_mfma_f32_16x16x32_bf16 v[36:39], v[60:63], v[132:135], v[36:39]
  ds_read_b64_tr_b16 v[142:143], v4 offset:13312
  v_add_f32 v48, v48, v54
  v_fmac_f32 v50, v54, v54
  v_add_f32 v49, v49, v55
  v_fmac_f32 v51, v55, v55
  s_mov_b32 s44, 0x7ffff
  s_cmp_eq_u32 s60, 1
  s_cselect_b32 s44, 0xffffe, s44
  s_cmp_eq_u32 s60, 2
  s_cselect_b32 s44, 0x9ffffc, s44
  s_cmp_eq_u32 s60, 3
  s_cselect_b32 s44, 0x17fffb, s44
  s_cmp_eq_u32 s60, 4
  s_cselect_b32 s44, 0x1ffffa, s44
  v_add_u32 v18, 0, v0
  v_mul_u32_u24 v19, 205, v18
  v_lshrrev_b32 v19, 14, v19
  v_mul_u32_u24 v23, 80, v19
  v_sub_u32 v18, v18, v23
  v_mul_u32_u24 v208, s40, v19
  v_lshl_add_u32 v208, v18, 4, v208
  v_mul_u32_u24 v19, 3, v19
  v_lshrrev_b32 v18, 5, v18
  v_add_u32 v19, v19, v18
  v_bfe_u32 v19, s44, v19, 1
  v_cmp_ne_u32 vcc, 0, v19
  v_mov_b32 v23, 0x80000000
  s_nop 0
  v_cndmask_b32 v208, v23, v208, vcc
  v_add_u32 v18, 64, v0
  v_mul_u32_u24 v19, 205, v18
  v_lshrrev_b32 v19, 14, v19
  v_mul_u32_u24 v23, 80, v19
  v_sub_u32 v18, v18, v23
  v_mul_u32_u24 v209, s40, v19
  v_lshl_add_u32 v209, v18, 4, v209
  v_mul_u32_u24 v19, 3, v19
  v_lshrrev_b32 v18, 5, v18
  v_add_u32 v19, v19, v18
  v_bfe_u32 v19, s44, v19, 1
  v_cmp_ne_u32 vcc, 0, v19
  v_mov_b32 v23, 0x80000000
  s_nop 0
  v_cndmask_b32 v209, v23, v209, vcc
  v_add_u32 v18, 128, v0
  v_mul_u32_u24 v19, 205, v18
  v_lshrrev_b32 v19, 14, v19
  v_mul_u32_u24 v23, 80, v19
  v_sub_u32 v18, v18, v23
  v_mul_u32_u24 v210, s40, v19
  v_lshl_add_u32 v210, v18, 4, v210
  v_mul_u32_u24 v19, 3, v19
  v_lshrrev_b32 v18, 5, v18
  v_add_u32 v19, v19, v18
  v_bfe_u32 v19, s44, v19, 1
  v_cmp_ne_u32 vcc, 0, v19
  v_mov_b32 v23, 0x80000000
  s_nop 0
  v_cndmask_b32 v210, v23, v210, vcc
  v_add_u32 v18, 192, v0
  v_mul_u32_u24 v19, 205, v18
  v_lshrrev_b32 v19, 14, v19
  v_mul_u32_u24 v23, 80, v19
  v_sub_u32 v18, v18, v23
  v_mul_u32_u24 v211, s40, v19
  v_lshl_add_u32 v211, v18, 4, v211
  v_mul_u32_u24 v19, 3, v19
  v_lshrrev_b32 v18, 5, v18
  v_add_u32 v19, v19, v18
  v_bfe_u32 v19, s44, v19, 1
  v_cmp_ne_u32 vcc, 0, v19
  v_mov_b32 v23, 0x80000000
  s_nop 0
  v_cndmask_b32 v211, v23, v211, vcc
  v_add_u32 v18, 256, v0
  v_mul_u32_u24 v19, 205, v18
  v_lshrrev_b32 v19, 14, v19
  v_mul_u32_u24 v23, 80, v19
  v_sub_u32 v18, v18, v23
  v_mul_u32_u24 v212, s40, v19
  v_lshl_add_u32 v212, v18, 4, v212
  v_mul_u32_u24 v19, 3, v19
  v_lshrrev_b32 v18, 5, v18
  v_add_u32 v19, v19, v18
  v_bfe_u32 v19, s44, v19, 1
  v_cmp_ne_u32 vcc, 0, v19
  v_mov_b32 v23, 0x80000000
  s_nop 0
  v_cndmask_b32 v212, v23, v212, vcc
  v_add_u32 v18, 320, v0
  v_mul_u32_u24 v19, 205, v18
  v_lshrrev_b32 v19, 14, v19
  v_mul_u32_u24 v23, 80, v19
  v_sub_u32 v18, v18, v23
  v_mul_u32_u24 v213, s40, v19
  v_lshl_add_u32 v213, v18, 4, v213
  v_mul_u32_u24 v19, 3, v19
  v_lshrrev_b32 v18, 5, v18
  v_add_u32 v19, v19, v18
  v_bfe_u32 v19, s44, v19, 1
  v_cmp_ne_u32 vcc, 0, v19
  v_mov_b32 v23, 0x80000000
  s_nop 0
  v_cndmask_b32 v213, v23, v213, vcc
  v_add_u32 v18, 384, v0
  v_mul_u32_u24 v19, 205, v18
  v_lshrrev_b32 v19, 14, v19
  v_mul_u32_u24 v23, 80, v19
  v_sub_u32 v18, v18, v23
  v_mul_u32_u24 v214, s40, v19
  v_lshl_add_u32 v214, v18, 4, v214
  v_mul_u32_u24 v19, 3, v19
  v_lshrrev_b32 v18, 5, v18
  v_add_u32 v19, v19, v18
  v_bfe_u32 v19, s44, v19, 1
  v_cmp_ne_u32 vcc, 0, v19
  v_mov_b32 v23, 0x80000000
  s_nop 0
  v_cndmask_b32 v214, v23, v214, vcc
  v_add_u32 v18, 448, v0
  v_mul_u32_u24 v19, 205, v18
  v_lshrrev_b32 v19, 14, v19
  v_mul_u32_u24 v23, 80, v19
  v_sub_u32 v18, v18, v23
  v_mul_u32_u24 v215, s40, v19
  v_lshl_add_u32 v215, v18, 4, v215
  v_mul_u32_u24 v19, 3, v19
  v_lshrrev_b32 v18, 5, v18
  v_add_u32 v19, v19, v18
  v_bfe_u32 v19, s44, v19, 1
  v_cmp_ne_u32 vcc, 0, v19
  v_mov_b32 v23, 0x80000000
  s_nop 0
  v_cndmask_b32 v215, v23, v215, vcc
  v_add_u32 v18, 512, v0
  v_mul_u32_u24 v19, 205, v18
  v_lshrrev_b32 v19, 14, v19
  v_mul_u32_u24 v23, 80, v19
  v_sub_u32 v18, v18, v23
  v_mul_u32_u24 v216, s40, v19
  v_lshl_add_u32 v216, v18, 4, v216
  v_mul_u32_u24 v19, 3, v19
  v_lshrrev_b32 v18, 5, v18
  v_add_u32 v19, v19, v18
  v_bfe_u32 v19, s44, v19, 1
  v_cmp_ne_u32 vcc, 0, v19
  v_mov_b32 v23, 0x80000000
  s_nop 0
  v_cndmask_b32 v216, v23, v216, vcc
  v_add_u32 v18, 576, v0
  v_mul_u32_u24 v19, 205, v18
  v_lshrrev_b32 v19, 14, v19
  v_mul_u32_u24 v23, 80, v19
  v_sub_u32 v18, v18, v23
  v_mul_u32_u24 v217, s40, v19
  v_lshl_add_u32 v217, v18, 4, v217
  v_mul_u32_u24 v19, 3, v19
  v_lshrrev_b32 v18, 5, v18
  v_add_u32 v19, v19, v18
  v_bfe_u32 v19, s44, v19, 1
  v_cmp_ne_u32 vcc, 0, v19
  v_mov_b32 v23, 0x80000000
  s_nop 0
  v_cndmask_b32 v217, v23, v217, vcc
  s_lshl_b32 s41, s26, 14
  s_add_u32 s41, s41, 65536
  v_lshlrev_b32 v218, 4, v0
  v_add_u32 v218, s41, v218
  s_lshl_b32 s52, s36, 15
  s_add_u32 s52, s52, 65536
  s_lshl_b32 s41, s27, 14
  s_add_u32 s52, s52, s41
  s_lshl_b32 s38, s60, 5
  s_lshl_b32 s42, s27, 4
  s_add_u32 s38, s38, s42
  v_add_u32 v21, s38, v17
  v_lshlrev_b32 v22, 3, v16
  s_mov_b32 s42, 0x32104
  s_mov_b32 s43, 0x32410
  v_add_u32 v23, 0, v21
  v_mul_u32_u24 v18, 205, v23
  v_lshrrev_b32 v18, 10, v18
  v_mul_u32_u24 v19, 5, v18
  v_sub_u32 v23, v23, v19
  v_cmp_eq_u32 vcc, 19, v18
  v_mov_b32 v19, 0x43210
  v_mov_b32 v20, s42
  v_cndmask_b32 v19, v19, v20, vcc
  v_cmp_eq_u32 vcc, 25, v18
  v_mov_b32 v20, s43
  v_lshlrev_b32 v23, 2, v23
  v_cndmask_b32 v19, v19, v20, vcc
  v_bfe_u32 v23, v19, v23, 4
  v_subrev_u32 v18, s55, v18
  v_mul_u32_u24 v18, 1280, v18
  v_cmp_gt_u32 vcc, 4, v23
  v_lshrrev_b32 v19, 1, v23
  v_lshl_add_u32 v18, v19, 9, v18
  v_and_b32 v19, 1, v23
  v_lshl_add_u32 v18, v19, 3, v18
  v_cndmask_b32 v19, 0, v22, vcc
  v_add_u32 v18, v18, v22
  v_add_u32 v18, v18, v19
  v_add_u32 v24, s52, v18
  v_add_u32 v23, 2, v21
  v_mul_u32_u24 v18, 205, v23
  v_lshrrev_b32 v18, 10, v18
  v_mul_u32_u24 v19, 5, v18
  v_sub_u32 v23, v23, v19
  v_cmp_eq_u32 vcc, 19, v18
  v_mov_b32 v19, 0x43210
  v_mov_b32 v20, s42
  v_cndmask_b32 v19, v19, v20, vcc
  v_cmp_eq_u32 vcc, 25, v18
  v_mov_b32 v20, s43
  v_lshlrev_b32 v23, 2, v23
  v_cndmask_b32 v19, v19, v20, vcc
  v_bfe_u32 v23, v19, v23, 4
  v_subrev_u32 v18, s55, v18
  v_mul_u32_u24 v18, 1280, v18
  v_cmp_gt_u32 vcc, 4, v23
  v_lshrrev_b32 v19, 1, v23
  v_lshl_add_u32 v18, v19, 9, v18
  v_and_b32 v19, 1, v23
  v_lshl_add_u32 v18, v19, 3, v18
  v_cndmask_b32 v19, 0, v22, vcc
  v_add_u32 v18, v18, v22
  v_add_u32 v18, v18, v19
  v_add_u32 v25, s52, v18
  v_add_u32 v23, 4, v21
  v_mul_u32_u24 v18, 205, v23
  v_lshrrev_b32 v18, 10, v18
  v_mul_u32_u24 v19, 5, v18
  v_sub_u32 v23, v23, v19
  v_cmp_eq_u32 vcc, 19, v18
  v_mov_b32 v19, 0x43210
  v_mov_b32 v20, s42
  v_cndmask_b32 v19, v19, v20, vcc
  v_cmp_eq_u32 vcc, 25, v18
  v_mov_b32 v20, s43
  v_lshlrev_b32 v23, 2, v23
  v_cndmask_b32 v19, v19, v20, vcc
  v_bfe_u32 v23, v19, v23, 4
  v_subrev_u32 v18, s55, v18
  v_mul_u32_u24 v18, 1280, v18
  v_cmp_gt_u32 vcc, 4, v23
  v_lshrrev_b32 v19, 1, v23
  v_lshl_add_u32 v18, v19, 9, v18
  v_and_b32 v19, 1, v23
  v_lshl_add_u32 v18, v19, 3, v18
  v_cndmask_b32 v19, 0, v22, vcc
  v_add_u32 v18, v18, v22
  v_add_u32 v18, v18, v19
  v_add_u32 v26, s52, v18
  v_add_u32 v23, 6, v21
  v_mul_u32_u24 v18, 205, v23
  v_lshrrev_b32 v18, 10, v18
  v_mul_u32_u24 v19, 5, v18
  v_sub_u32 v23, v23, v19
  v_cmp_eq_u32 vcc, 19, v18
  v_mov_b32 v19, 0x43210
  v_mov_b32 v20, s42
  v_cndmask_b32 v19, v19, v20, vcc
  v_cmp_eq_u32 vcc, 25, v18
  v_mov_b32 v20, s43
  v_lshlrev_b32 v23, 2, v23
  v_cndmask_b32 v19, v19, v20, vcc
  v_bfe_u32 v23, v19, v23, 4
  v_subrev_u32 v18, s55, v18
  v_mul_u32_u24 v18, 1280, v18
  v_cmp_gt_u32 vcc, 4, v23
  v_lshrrev_b32 v19, 1, v23
  v_lshl_add_u32 v18, v19, 9, v18
  v_and_b32 v19, 1, v23
  v_lshl_add_u32 v18, v19, 3, v18
  v_cndmask_b32 v19, 0, v22, vcc
  v_add_u32 v18, v18, v22
  v_add_u32 v18, v18, v19
  v_add_u32 v27, s52, v18
  v_add_u32 v23, 8, v21
  v_mul_u32_u24 v18, 205, v23
  v_lshrrev_b32 v18, 10, v18
  v_mul_u32_u24 v19, 5, v18
  v_sub_u32 v23, v23, v19
  v_cmp_eq_u32 vcc, 19, v18
  v_mov_b32 v19, 0x43210
  v_mov_b32 v20, s42
  v_cndmask_b32 v19, v19, v20, vcc
  v_cmp_eq_u32 vcc, 25, v18
  v_mov_b32 v20, s43
  v_lshlrev_b32 v23, 2, v23
  v_cndmask_b32 v19, v19, v20, vcc
  v_bfe_u32 v23, v19, v23, 4
  v_subrev_u32 v18, s55, v18
  v_mul_u32_u24 v18, 1280, v18
  v_cmp_gt_u32 vcc, 4, v23
  v_lshrrev_b32 v19, 1, v23
  v_lshl_add_u32 v18, v19, 9, v18
  v_and_b32 v19, 1, v23
  v_lshl_add_u32 v18, v19, 3, v18
  v_cndmask_b32 v19, 0, v22, vcc
  v_add_u32 v18, v18, v22
  v_add_u32 v18, v18, v19
  v_add_u32 v28, s52, v18
  v_add_u32 v23, 10, v21
  v_mul_u32_u24 v18, 205, v23
  v_lshrrev_b32 v18, 10, v18
  v_mul_u32_u24 v19, 5, v18
  v_sub_u32 v23, v23, v19
  v_cmp_eq_u32 vcc, 19, v18
  v_mov_b32 v19, 0x43210
  v_mov_b32 v20, s42
  v_cndmask_b32 v19, v19, v20, vcc
  v_cmp_eq_u32 vcc, 25, v18
  v_mov_b32 v20, s43
  v_lshlrev_b32 v23, 2, v23
  v_cndmask_b32 v19, v19, v20, vcc
  v_bfe_u32 v23, v19, v23, 4
  v_subrev_u32 v18, s55, v18
  v_mul_u32_u24 v18, 1280, v18
  v_cmp_gt_u32 vcc, 4, v23
  v_lshrrev_b32 v19, 1, v23
  v_lshl_add_u32 v18, v19, 9, v18
  v_and_b32 v19, 1, v23
  v_lshl_add_u32 v18, v19, 3, v18
  v_cndmask_b32 v19, 0, v22, vcc
  v_add_u32 v18, v18, v22
  v_add_u32 v18, v18, v19
  v_add_u32 v29, s52, v18
  v_add_u32 v23, 12, v21
  v_mul_u32_u24 v18, 205, v23
  v_lshrrev_b32 v18, 10, v18
  v_mul_u32_u24 v19, 5, v18
  v_sub_u32 v23, v23, v19
  v_cmp_eq_u32 vcc, 19, v18
  v_mov_b32 v19, 0x43210
  v_mov_b32 v20, s42
  v_cndmask_b32 v19, v19, v20, vcc
  v_cmp_eq_u32 vcc, 25, v18
  v_mov_b32 v20, s43
  v_lshlrev_b32 v23, 2, v23
  v_cndmask_b32 v19, v19, v20, vcc
  v_bfe_u32 v23, v19, v23, 4
  v_subrev_u32 v18, s55, v18
  v_mul_u32_u24 v18, 1280, v18
  v_cmp_gt_u32 vcc, 4, v23
  v_lshrrev_b32 v19, 1, v23
  v_lshl_add_u32 v18, v19, 9, v18
  v_and_b32 v19, 1, v23
  v_lshl_add_u32 v18, v19, 3, v18
  v_cndmask_b32 v19, 0, v22, vcc
  v_add_u32 v18, v18, v22
  v_add_u32 v18, v18, v19
  v_add_u32 v30, s52, v18
  v_add_u32 v23, 14, v21
  v_mul_u32_u24 v18, 205, v23
  v_lshrrev_b32 v18, 10, v18
  v_mul_u32_u24 v19, 5, v18
  v_sub_u32 v23, v23, v19
  v_cmp_eq_u32 vcc, 19, v18
  v_mov_b32 v19, 0x43210
  v_mov_b32 v20, s42
  v_cndmask_b32 v19, v19, v20, vcc
  v_cmp_eq_u32 vcc, 25, v18
  v_mov_b32 v20, s43
  v_lshlrev_b32 v23, 2, v23
  v_cndmask_b32 v19, v19, v20, vcc
  v_bfe_u32 v23, v19, v23, 4
  v_subrev_u32 v18, s55, v18
  v_mul_u32_u24 v18, 1280, v18
  v_cmp_gt_u32 vcc, 4, v23
  v_lshrrev_b32 v19, 1, v23
  v_lshl_add_u32 v18, v19, 9, v18
  v_and_b32 v19, 1, v23
  v_lshl_add_u32 v18, v19, 3, v18
  v_cndmask_b32 v19, 0, v22, vcc
  v_add_u32 v18, v18, v22
  v_add_u32 v18, v18, v19
  v_add_u32 v31, s52, v18
  s_waitcnt lgkmcnt(0)
  s_barrier
  v_mfma_f32_32x32x16_bf16 v[64:79], v[136:139], v[168:171], v[64:79]
  ds_read_b128 v[160:163], v192 offset:32768
  v_and_b32 v52, 0xffff0000, v168
  v_lshlrev_b32 v53, 16, v168
  v_add_f32 v48, v48, v52
  v_fmac_f32 v50, v52, v52
  v_mfma_f32_32x32x16_bf16 v[80:95], v[136:139], v[172:175], v[80:95]
  ds_read_b128 v[164:167], v200 offset:32768
  v_add_f32 v49, v49, v53
  v_fmac_f32 v51, v53, v53
  v_and_b32 v54, 0xffff0000, v169
  v_lshlrev_b32 v55, 16, v169
  v_mfma_f32_16x16x32_bf16 v[32:35], v[60:63], v[136:139], v[32:35]
  ds_read_b64_tr_b16 v[128:129], v2 offset:32768
  v_add_f32 v48, v48, v54
  v_fmac_f32 v50, v54, v54
  v_add_f32 v49, v49, v55
  v_fmac_f32 v51, v55, v55
  v_mfma_f32_32x32x16_bf16 v[96:111], v[140:143], v[168:171], v[96:111]
  ds_read_b64_tr_b16 v[130:131], v2 offset:33792
  v_and_b32 v52, 0xffff0000, v170
  v_lshlrev_b32 v53, 16, v170
  v_add_f32 v48, v48, v52
  v_fmac_f32 v50, v52, v52
  v_mfma_f32_32x32x16_bf16 v[112:127], v[140:143], v[172:175], v[112:127]
  ds_read_b64_tr_b16 v[132:133], v4 offset:32768
  v_add_f32 v49, v49, v53
  v_fmac_f32 v51, v53, v53
  v_and_b32 v54, 0xffff0000, v171
  v_lshlrev_b32 v55, 16, v171
  v_mfma_f32_16x16x32_bf16 v[36:39], v[60:63], v[140:143], v[36:39]
  ds_read_b64_tr_b16 v[134:135], v4 offset:33792
  v_add_f32 v48, v48, v54
  v_fmac_f32 v50, v54, v54
  v_add_f32 v49, v49, v55
  v_fmac_f32 v51, v55, v55
  s_waitcnt lgkmcnt(0)
  v_mfma_f32_32x32x16_bf16 v[64:79], v[128:131], v[160:163], v[64:79]
  ds_read_b128 v[168:171], v194 offset:32768
  v_and_b32 v52, 0xffff0000, v160
  v_lshlrev_b32 v53, 16, v160
  v_add_f32 v48, v48, v52
  v_fmac_f32 v50, v52, v52
  v_mfma_f32_32x32x16_bf16 v[80:95], v[128:131], v[164:167], v[80:95]
  ds_read_b128 v[172:175], v202 offset:32768
  v_add_f32 v49, v49, v53
  v_fmac_f32 v51, v53, v53
  v_and_b32 v54, 0xffff0000, v161
  v_lshlrev_b32 v55, 16, v161
  v_mfma_f32_16x16x32_bf16 v[32:35], v[60:63], v[128:131], v[32:35]
  ds_read_b64_tr_b16 v[136:137], v2 offset:36864
  v_add_f32 v48, v48, v54
  v_fmac_f32 v50, v54, v54
  v_add_f32 v49, v49, v55
  v_fmac_f32 v51, v55, v55
  v_mfma_f32_32x32x16_bf16 v[96:111], v[132:135], v[160:163], v[96:111]
  ds_read_b64_tr_b16 v[138:139], v2 offset:37888
  v_and_b32 v52, 0xffff0000, v162
  v_lshlrev_b32 v53, 16, v162
  v_add_f32 v48, v48, v52
  v_fmac_f32 v50, v52, v52
  v_mfma_f32_32x32x16_bf16 v[112:127], v[132:135], v[164:167], v[112:127]
  ds_read_b64_tr_b16 v[140:141], v4 offset:36864
  v_add_f32 v49, v49, v53
  v_fmac_f32 v51, v53, v53
  v_and_b32 v54, 0xffff0000, v163
  v_lshlrev_b32 v55, 16, v163
  v_mfma_f32_16x16x32_bf16 v[36:39], v[60:63], v[132:135], v[36:39]
  ds_read_b64_tr_b16 v[142:143], v4 offset:37888
  v_add_f32 v48, v48, v54
  v_fmac_f32 v50, v54, v54
  v_add_f32 v49, v49, v55
  v_fmac_f32 v51, v55, v55
  s_waitcnt lgkmcnt(0)
  v_mfma_f32_32x32x16_bf16 v[64:79], v[136:139], v[168:171], v[64:79]
  ds_read_b128 v[160:163], v196 offset:32768
  v_and_b32 v52, 0xffff0000, v168
  v_lshlrev_b32 v53, 16, v168
  v_add_f32 v48, v48, v52
  v_fmac_f32 v50, v52, v52
  v_mfma_f32_32x32x16_bf16 v[80:95], v[136:139], v[172:175], v[80:95]
  ds_read_b128 v[164:167], v204 offset:32768
  v_add_f32 v49, v49, v53
  v_fmac_f32 v51, v53, v53
  v_and_b32 v54, 0xffff0000, v169
  v_lshlrev_b32 v55, 16, v169
  v_mfma_f32_16x16x32_bf16 v[32:35], v[60:63], v[136:139], v[32:35]
  ds_read_b64_tr_b16 v[128:129], v2 offset:40960
  v_add_f32 v48, v48, v54
  v_fmac_f32 v50, v54, v54
  v_add_f32 v49, v49, v55
  v_fmac_f32 v51, v55, v55
  v_mfma_f32_32x32x16_bf16 v[96:111], v[140:143], v[168:171], v[96:111]
  ds_read_b64_tr_b16 v[130:131], v2 offset:41984
  v_and_b32 v52, 0xffff0000, v170
  v_lshlrev_b32 v53, 16, v170
  v_add_f32 v48, v48, v52
  v_fmac_f32 v50, v52, v52
  v_mfma_f32_32x32x16_bf16 v[112:127], v[140:143], v[172:175], v[112:127]
  ds_read_b64_tr_b16 v[132:133], v4 offset:40960
  v_add_f32 v49, v49, v53
  v_fmac_f32 v51, v53, v53
  v_and_b32 v54, 0xffff0000, v171
  v_lshlrev_b32 v55, 16, v171
  v_mfma_f32_16x16x32_bf16 v[36:39], v[60:63], v[140:143], v[36:39]
  ds_read_b64_tr_b16 v[134:135], v4 offset:41984
  v_add_f32 v48, v48, v54
  v_fmac_f32 v50, v54, v54
  v_add_f32 v49, v49, v55
  v_fmac_f32 v51, v55, v55
  s_waitcnt lgkmcnt(0)
  v_mfma_f32_32x32x16_bf16 v[64:79], v[128:131], v[160:163], v[64:79]
  ds_read_b128 v[168:171], v198 offset:32768
  v_and_b32 v52, 0xffff0000, v160
  v_lshlrev_b32 v53, 16, v160
  v_add_f32 v48, v48, v52
  v_fmac_f32 v50, v52, v52
  v_mfma_f32_32x32x16_bf16 v[80:95], v[128:131], v[164:167], v[80:95]
  ds_read_b128 v[172:175], v206 offset:32768
  v_add_f32 v49, v49, v53
  v_fmac_f32 v51, v53, v53
  v_and_b32 v54, 0xffff0000, v161
  v_lshlrev_b32 v55, 16, v161
  v_mfma_f32_16x16x32_bf16 v[32:35], v[60:63], v[128:131], v[32:35]
  ds_read_b64_tr_b16 v[136:137], v2 offset:45056
  v_add_f32 v48, v48, v54
  v_fmac_f32 v50, v54, v54
  v_add_f32 v49, v49, v55
  v_fmac_f32 v51, v55, v55
  v_mfma_f32_32x32x16_bf16 v[96:111], v[132:135], v[160:163], v[96:111]
  ds_read_b64_tr_b16 v[138:139], v2 offset:46080
  v_and_b32 v52, 0xffff0000, v162
  v_lshlrev_b32 v53, 16, v162
  v_add_f32 v48, v48, v52
  v_fmac_f32 v50, v52, v52
  v_mfma_f32_32x32x16_bf16 v[112:127], v[132:135], v[164:167], v[112:127]
  ds_read_b64_tr_b16 v[140:141], v4 offset:45056
  v_add_f32 v49, v49, v53
  v_fmac_f32 v51, v53, v53
  v_and_b32 v54, 0xffff0000, v163
  v_lshlrev_b32 v55, 16, v163
  v_mfma_f32_16x16x32_bf16 v[36:39], v[60:63], v[132:135], v[36:39]
  ds_read_b64_tr_b16 v[142:143], v4 offset:46080
  v_add_f32 v48, v48, v54
  v_fmac_f32 v50, v54, v54
  v_add_f32 v49, v49, v55
  v_fmac_f32 v51, v55, v55
  s_waitcnt lgkmcnt(0)
  s_barrier
  v_mfma_f32_32x32x16_bf16 v[64:79], v[136:139], v[168:171], v[64:79]
  ds_read_b128 v[160:163], v193 offset:0
  v_and_b32 v52, 0xffff0000, v168
  v_lshlrev_b32 v53, 16, v168
  v_add_f32 v48, v48, v52
  v_fmac_f32 v50, v52, v52
  v_mfma_f32_32x32x16_bf16 v[80:95], v[136:139], v[172:175], v[80:95]
  ds_read_b128 v[164:167], v201 offset:0
  v_add_f32 v49, v49, v53
  v_fmac_f32 v51, v53, v53
  v_and_b32 v54, 0xffff0000, v169
  v_lshlrev_b32 v55, 16, v169
  v_mfma_f32_16x16x32_bf16 v[32:35], v[60:63], v[136:139], v[32:35]
  ds_read_b64_tr_b16 v[128:129], v3 offset:0
  v_add_f32 v48, v48, v54
  v_fmac_f32 v50, v54, v54
  v_add_f32 v49, v49, v55
  v_fmac_f32 v51, v55, v55
  v_mfma_f32_32x32x16_bf16 v[96:111], v[140:143], v[168:171], v[96:111]
  ds_read_b64_tr_b16 v[130:131], v3 offset:1024
  v_and_b32 v52, 0xffff0000, v170
  v_lshlrev_b32 v53, 16, v170
  v_add_f32 v48, v48, v52
  v_fmac_f32 v50, v52, v52
  v_mfma_f32_32x32x16_bf16 v[112:127], v[140:143], v[172:175], v[112:127]
  ds_read_b64_tr_b16 v[132:133], v5 offset:0
  v_add_f32 v49, v49, v53
  v_fmac_f32 v51, v53, v53
  v_and_b32 v54, 0xffff0000, v171
  v_lshlrev_b32 v55, 16, v171
  v_mfma_f32_16x16x32_bf16 v[36:39], v[60:63], v[140:143], v[36:39]
  ds_read_b64_tr_b16 v[134:135], v5 offset:1024
  v_add_f32 v48, v48, v54
  v_fmac_f32 v50, v54, v54
  v_add_f32 v49, v49, v55
  v_fmac_f32 v51, v55, v55
  s_waitcnt lgkmcnt(0)
  v_mfma_f32_32x32x16_bf16 v[64:79], v[128:131], v[160:163], v[64:79]
  ds_read_b128 v[168:171], v195 offset:0
  v_and_b32 v52, 0xffff0000, v160
  v_lshlrev_b32 v53, 16, v160
  v_add_f32 v48, v48, v52
  v_fmac_f32 v50, v52, v52
  v_mfma_f32_32x32x16_bf16 v[80:95], v[128:131], v[164:167], v[80:95]
  ds_read_b128 v[172:175], v203 offset:0
  v_add_f32 v49, v49, v53
  v_fmac_f32 v51, v53, v53
  v_and_b32 v54, 0xffff0000, v161
  v_lshlrev_b32 v55, 16, v161
  v_mfma_f32_16x16x32_bf16 v[32:35], v[60:63], v[128:131], v[32:35]
  ds_read_b64_tr_b16 v[136:137], v3 offset:4096
  v_add_f32 v48, v48, v54
  v_fmac_f32 v50, v54, v54
  v_add_f32 v49, v49, v55
  v_fmac_f32 v51, v55, v55
  v_mfma_f32_32x32x16_bf16 v[96:111], v[132:135], v[160:163], v[96:111]
  ds_read_b64_tr_b16 v[138:139], v3 offset:5120
  v_and_b32 v52, 0xffff0000, v162
  v_lshlrev_b32 v53, 16, v162
  v_add_f32 v48, v48, v52
  v_fmac_f32 v50, v52, v52
  v_mfma_f32_32x32x16_bf16 v[112:127], v[132:135], v[164:167], v[112:127]
  ds_read_b64_tr_b16 v[140:141], v5 offset:4096
  v_add_f32 v49, v49, v53
  v_fmac_f32 v51, v53, v53
  v_and_b32 v54, 0xffff0000, v163
  v_lshlrev_b32 v55, 16, v163
  v_mfma_f32_16x16x32_bf16 v[36:39], v[60:63], v[132:135], v[36:39]
  ds_read_b64_tr_b16 v[142:143], v5 offset:5120
  v_add_f32 v48, v48, v54
  v_fmac_f32 v50, v54, v54
  v_add_f32 v49, v49, v55
  v_fmac_f32 v51, v55, v55
  s_waitcnt lgkmcnt(0)
  v_mfma_f32_32x32x16_bf16 v[64:79], v[136:139], v[168:171], v[64:79]
  ds_read_b128 v[160:163], v197 offset:0
  v_and_b32 v52, 0xffff0000, v168
  v_lshlrev_b32 v53, 16, v168
  v_add_f32 v48, v48, v52
  v_fmac_f32 v50, v52, v52
  v_mfma_f32_32x32x16_bf16 v[80:95], v[136:139], v[172:175], v[80:95]
  ds_read_b128 v[164:167], v205 offset:0
  v_add_f32 v49, v49, v53
  v_fmac_f32 v51, v53, v53
  v_and_b32 v54, 0xffff0000, v169
  v_lshlrev_b32 v55, 16, v169
  v_mfma_f32_16x16x32_bf16 v[32:35], v[60:63], v[136:139], v[32:35]
  ds_read_b64_tr_b16 v[128:129], v3 offset:8192
  v_add_f32 v48, v48, v54
  v_fmac_f32 v50, v54, v54
  v_add_f32 v49, v49, v55
  v_fmac_f32 v51, v55, v55
  v_mfma_f32_32x32x16_bf16 v[96:111], v[140:143], v[168:171], v[96:111]
  ds_read_b64_tr_b16 v[130:131], v3 offset:9216
  v_and_b32 v52, 0xffff0000, v170
  v_lshlrev_b32 v53, 16, v170
  v_add_f32 v48, v48, v52
  v_fmac_f32 v50, v52, v52
  v_mfma_f32_32x32x16_bf16 v[112:127], v[140:143], v[172:175], v[112:127]
  ds_read_b64_tr_b16 v[132:133], v5 offset:8192
  v_add_f32 v49, v49, v53
  v_fmac_f32 v51, v53, v53
  v_and_b32 v54, 0xffff0000, v171
  v_lshlrev_b32 v55, 16, v171
  v_mfma_f32_16x16x32_bf16 v[36:39], v[60:63], v[140:143], v[36:39]
  ds_read_b64_tr_b16 v[134:135], v5 offset:9216
  v_add_f32 v48, v48, v54
  v_fmac_f32 v50, v54, v54
  v_add_f32 v49, v49, v55
  v_fmac_f32 v51, v55, v55
  s_waitcnt lgkmcnt(0)
  v_mfma_f32_32x32x16_bf16 v[64:79], v[128:131], v[160:163], v[64:79]
  ds_read_b128 v[168:171], v199 offset:0
  v_and_b32 v52, 0xffff0000, v160
  v_lshlrev_b32 v53, 16, v160
  v_add_f32 v48, v48, v52
  v_fmac_f32 v50, v52, v52
  v_mfma_f32_32x32x16_bf16 v[80:95], v[128:131], v[164:167], v[80:95]
  ds_read_b128 v[172:175], v207 offset:0
  v_add_f32 v49, v49, v53
  v_fmac_f32 v51, v53, v53
  v_and_b32 v54, 0xffff0000, v161
  v_lshlrev_b32 v55, 16, v161
  v_mfma_f32_16x16x32_bf16 v[32:35], v[60:63], v[128:131], v[32:35]
  ds_read_b64_tr_b16 v[136:137], v3 offset:12288
  v_add_f32 v48, v48, v54
  v_fmac_f32 v50, v54, v54
  v_add_f32 v49, v49, v55
  v_fmac_f32 v51, v55, v55
  v_mfma_f32_32x32x16_bf16 v[96:111], v[132:135], v[160:163], v[96:111]
  ds_read_b64_tr_b16 v[138:139], v3 offset:13312
  v_and_b32 v52, 0xffff0000, v162
  v_lshlrev_b32 v53, 16, v162
  v_add_f32 v48, v48, v52
  v_fmac_f32 v50, v52, v52
  v_mfma_f32_32x32x16_bf16 v[112:127], v[132:135], v[164:167], v[112:127]
  ds_read_b64_tr_b16 v[140:141], v5 offset:12288
  v_add_f32 v49, v49, v53
  v_fmac_f32 v51, v53, v53
  v_and_b32 v54, 0xffff0000, v163
  v_lshlrev_b32 v55, 16, v163
  v_mfma_f32_16x16x32_bf16 v[36:39], v[60:63], v[132:135], v[36:39]
  ds_read_b64_tr_b16 v[142:143], v5 offset:13312
  v_add_f32 v48, v48, v54
  v_fmac_f32 v50, v54, v54
  v_add_f32 v49, v49, v55
  v_fmac_f32 v51, v55, v55
  s_waitcnt lgkmcnt(0)
  s_barrier
  v_mfma_f32_32x32x16_bf16 v[64:79], v[136:139], v[168:171], v[64:79]
  ds_read_b128 v[160:163], v193 offset:32768
  v_and_b32 v52, 0xffff0000, v168
  v_lshlrev_b32 v53, 16, v168
  v_add_f32 v48, v48, v52
  v_fmac_f32 v50, v52, v52
  v_mfma_f32_32x32x16_bf16 v[80:95], v[136:139], v[172:175], v[80:95]
  ds_read_b128 v[164:167], v201 offset:32768
  v_add_f32 v49, v49, v53
  v_fmac_f32 v51, v53, v53
  v_and_b32 v54, 0xffff0000, v169
  v_lshlrev_b32 v55, 16, v169
  v_mfma_f32_16x16x32_bf16 v[32:35], v[60:63], v[136:139], v[32:35]
  ds_read_b64_tr_b16 v[128:129], v3 offset:32768
  v_add_f32 v48, v48, v54
  v_fmac_f32 v50, v54, v54
  v_add_f32 v49, v49, v55
  v_fmac_f32 v51, v55, v55
  v_mfma_f32_32x32x16_bf16 v[96:111], v[140:143], v[168:171], v[96:111]
  ds_read_b64_tr_b16 v[130:131], v3 offset:33792
  v_and_b32 v52, 0xffff0000, v170
  v_lshlrev_b32 v53, 16, v170
  v_add_f32 v48, v48, v52
  v_fmac_f32 v50, v52, v52
  v_mfma_f32_32x32x16_bf16 v[112:127], v[140:143], v[172:175], v[112:127]
  ds_read_b64_tr_b16 v[132:133], v5 offset:32768
  v_add_f32 v49, v49, v53
  v_fmac_f32 v51, v53, v53
  v_and_b32 v54, 0xffff0000, v171
  v_lshlrev_b32 v55, 16, v171
  v_mfma_f32_16x16x32_bf16 v[36:39], v[60:63], v[140:143], v[36:39]
  ds_read_b64_tr_b16 v[134:135], v5 offset:33792
  v_add_f32 v48, v48, v54
  v_fmac_f32 v50, v54, v54
  v_add_f32 v49, v49, v55
  v_fmac_f32 v51, v55, v55
  s_waitcnt lgkmcnt(0)
  v_mfma_f32_32x32x16_bf16 v[64:79], v[128:131], v[160:163], v[64:79]
  ds_read_b128 v[168:171], v195 offset:32768
  v_and_b32 v52, 0xffff0000, v160
  v_lshlrev_b32 v53, 16, v160
  v_add_f32 v48, v48, v52
  v_fmac_f32 v50, v52, v52
  v_mfma_f32_32x32x16_bf16 v[80:95], v[128:131], v[164:167], v[80:95]
  ds_read_b128 v[172:175], v203 offset:32768
  v_add_f32 v49, v49, v53
  v_fmac_f32 v51, v53, v53
  v_and_b32 v54, 0xffff0000, v161
  v_lshlrev_b32 v55, 16, v161
  v_mfma_f32_16x16x32_bf16 v[32:35], v[60:63], v[128:131], v[32:35]
  ds_read_b64_tr_b16 v[136:137], v3 offset:36864
  v_add_f32 v48, v48, v54
  v_fmac_f32 v50, v54, v54
  v_add_f32 v49, v49, v55
  v_fmac_f32 v51, v55, v55
  v_mfma_f32_32x32x16_bf16 v[96:111], v[132:135], v[160:163], v[96:111]
  ds_read_b64_tr_b16 v[138:139], v3 offset:37888
  v_and_b32 v52, 0xffff0000, v162
  v_lshlrev_b32 v53, 16, v162
  v_add_f32 v48, v48, v52
  v_fmac_f32 v50, v52, v52
  v_mfma_f32_32x32x16_bf16 v[112:127], v[132:135], v[164:167], v[112:127]
  ds_read_b64_tr_b16 v[140:141], v5 offset:36864
  v_add_f32 v49, v49, v53
  v_fmac_f32 v51, v53, v53
  v_and_b32 v54, 0xffff0000, v163
  v_lshlrev_b32 v55, 16, v163
  v_mfma_f32_16x16x32_bf16 v[36:39], v[60:63], v[132:135], v[36:39]
  ds_read_b64_tr_b16 v[142:143], v5 offset:37888
  v_add_f32 v48, v48, v54
  v_fmac_f32 v50, v54, v54
  v_add_f32 v49, v49, v55
  v_fmac_f32 v51, v55, v55
  s_waitcnt lgkmcnt(0)
  v_mfma_f32_32x32x16_bf16 v[64:79], v[136:139], v[168:171], v[64:79]
  ds_read_b128 v[160:163], v197 offset:32768
  v_and_b32 v52, 0xffff0000, v168
  v_lshlrev_b32 v53, 16, v168
  v_add_f32 v48, v48, v52
  v_fmac_f32 v50, v52, v52
  v_mfma_f32_32x32x16_bf16 v[80:95], v[136:139], v[172:175], v[80:95]
  ds_read_b128 v[164:167], v205 offset:32768
  v_add_f32 v49, v49, v53
  v_fmac_f32 v51, v53, v53
  v_and_b32 v54, 0xffff0000, v169
  v_lshlrev_b32 v55, 16, v169
  v_mfma_f32_16x16x32_bf16 v[32:35], v[60:63], v[136:139], v[32:35]
  ds_read_b64_tr_b16 v[128:129], v3 offset:40960
  v_add_f32 v48, v48, v54
  v_fmac_f32 v50, v54, v54
  v_add_f32 v49, v49, v55
  v_fmac_f32 v51, v55, v55
  v_mfma_f32_32x32x16_bf16 v[96:111], v[140:143], v[168:171], v[96:111]
  ds_read_b64_tr_b16 v[130:131], v3 offset:41984
  v_and_b32 v52, 0xffff0000, v170
  v_lshlrev_b32 v53, 16, v170
  v_add_f32 v48, v48, v52
  v_fmac_f32 v50, v52, v52
  v_mfma_f32_32x32x16_bf16 v[112:127], v[140:143], v[172:175], v[112:127]
  ds_read_b64_tr_b16 v[132:133], v5 offset:40960
  v_add_f32 v49, v49, v53
  v_fmac_f32 v51, v53, v53
  v_and_b32 v54, 0xffff0000, v171
  v_lshlrev_b32 v55, 16, v171
  v_mfma_f32_16x16x32_bf16 v[36:39], v[60:63], v[140:143], v[36:39]
  ds_read_b64_tr_b16 v[134:135], v5 offset:41984
  v_add_f32 v48, v48, v54
  v_fmac_f32 v50, v54, v54
  v_add_f32 v49, v49, v55
  v_fmac_f32 v51, v55, v55
  s_waitcnt lgkmcnt(0)
  v_mfma_f32_32x32x16_bf16 v[64:79], v[128:131], v[160:163], v[64:79]
  ds_read_b128 v[168:171], v199 offset:32768
  v_and_b32 v52, 0xffff0000, v160
  v_lshlrev_b32 v53, 16, v160
  v_add_f32 v48, v48, v52
  v_fmac_f32 v50, v52, v52
  v_mfma_f32_32x32x16_bf16 v[80:95], v[128:131], v[164:167], v[80:95]
  ds_read_b128 v[172:175], v207 offset:32768
  v_add_f32 v49, v49, v53
  v_fmac_f32 v51, v53, v53
  v_and_b32 v54, 0xffff0000, v161
  v_lshlrev_b32 v55, 16, v161
  v_mfma_f32_16x16x32_bf16 v[32:35], v[60:63], v[128:131], v[32:35]
  ds_read_b64_tr_b16 v[136:137], v3 offset:45056
  v_add_f32 v48, v48, v54
  v_fmac_f32 v50, v54, v54
  v_add_f32 v49, v49, v55
  v_fmac_f32 v51, v55, v55
  v_mfma_f32_32x32x16_bf16 v[96:111], v[132:135], v[160:163], v[96:111]
  ds_read_b64_tr_b16 v[138:139], v3 offset:46080
  v_and_b32 v52, 0xffff0000, v162
  v_lshlrev_b32 v53, 16, v162
  v_add_f32 v48, v48, v52
  v_fmac_f32 v50, v52, v52
  v_mfma_f32_32x32x16_bf16 v[112:127], v[132:135], v[164:167], v[112:127]
  ds_read_b64_tr_b16 v[140:141], v5 offset:45056
  v_add_f32 v49, v49, v53
  v_fmac_f32 v51, v53, v53
  v_and_b32 v54, 0xffff0000, v163
  v_lshlrev_b32 v55, 16, v163
  v_mfma_f32_16x16x32_bf16 v[36:39], v[60:63], v[132:135], v[36:39]
  ds_read_b64_tr_b16 v[142:143], v5 offset:46080
  v_add_f32 v48, v48, v54
  v_fmac_f32 v50, v54, v54
  v_add_f32 v49, v49, v55
  v_fmac_f32 v51, v55, v55
  s_waitcnt lgkmcnt(0)
  s_barrier
  v_mfma_f32_32x32x16_bf16 v[64:79], v[136:139], v[168:171], v[64:79]
  ds_read_b128 v[160:163], v192 offset:0
  v_and_b32 v52, 0xffff0000, v168
  v_lshlrev_b32 v53, 16, v168
  v_add_f32 v48, v48, v52
  v_fmac_f32 v50, v52, v52
  v_mfma_f32_32x32x16_bf16 v[80:95], v[136:139], v[172:175], v[80:95]
  ds_read_b128 v[164:167], v200 offset:0
  v_add_f32 v49, v49, v53
  v_fmac_f32 v51, v53, v53
  v_and_b32 v54, 0xffff0000, v169
  v_lshlrev_b32 v55, 16, v169
  v_mfma_f32_16x16x32_bf16 v[32:35], v[60:63], v[136:139], v[32:35]
  ds_read_b64_tr_b16 v[128:129], v2 offset:0
  v_add_f32 v48, v48, v54
  v_fmac_f32 v50, v54, v54
  v_add_f32 v49, v49, v55
  v_fmac_f32 v51, v55, v55
  v_mfma_f32_32x32x16_bf16 v[96:111], v[140:143], v[168:171], v[96:111]
  ds_read_b64_tr_b16 v[130:131], v2 offset:1024
  v_and_b32 v52, 0xffff0000, v170
  v_lshlrev_b32 v53, 16, v170
  v_add_f32 v48, v48, v52
  v_fmac_f32 v50, v52, v52
  v_mfma_f32_32x32x16_bf16 v[112:127], v[140:143], v[172:175], v[112:127]
  ds_read_b64_tr_b16 v[132:133], v4 offset:0
  v_add_f32 v49, v49, v53
  v_fmac_f32 v51, v53, v53
  v_and_b32 v54, 0xffff0000, v171
  v_lshlrev_b32 v55, 16, v171
  v_mfma_f32_16x16x32_bf16 v[36:39], v[60:63], v[140:143], v[36:39]
  ds_read_b64_tr_b16 v[134:135], v4 offset:1024
  v_add_f32 v48, v48, v54
  v_fmac_f32 v50, v54, v54
  v_add_f32 v49, v49, v55
  v_fmac_f32 v51, v55, v55
  s_waitcnt lgkmcnt(0)
  v_mfma_f32_32x32x16_bf16 v[64:79], v[128:131], v[160:163], v[64:79]
  ds_read_b128 v[168:171], v194 offset:0
  v_and_b32 v52, 0xffff0000, v160
  v_lshlrev_b32 v53, 16, v160
  v_add_f32 v48, v48, v52
  v_fmac_f32 v50, v52, v52
  v_mfma_f32_32x32x16_bf16 v[80:95], v[128:131], v[164:167], v[80:95]
  ds_read_b128 v[172:175], v202 offset:0
  v_add_f32 v49, v49, v53
  v_fmac_f32 v51, v53, v53
  v_and_b32 v54, 0xffff0000, v161
  v_lshlrev_b32 v55, 16, v161
  v_mfma_f32_16x16x32_bf16 v[32:35], v[60:63], v[128:131], v[32:35]
  ds_read_b64_tr_b16 v[136:137], v2 offset:4096
  v_add_f32 v48, v48, v54
  v_fmac_f32 v50, v54, v54
  v_add_f32 v49, v49, v55
  v_fmac_f32 v51, v55, v55
  v_mfma_f32_32x32x16_bf16 v[96:111], v[132:135], v[160:163], v[96:111]
  ds_read_b64_tr_b16 v[138:139], v2 offset:5120
  v_and_b32 v52, 0xffff0000, v162
  v_lshlrev_b32 v53, 16, v162
  v_add_f32 v48, v48, v52
  v_fmac_f32 v50, v52, v52
  v_mfma_f32_32x32x16_bf16 v[112:127], v[132:135], v[164:167], v[112:127]
  ds_read_b64_tr_b16 v[140:141], v4 offset:4096
  v_add_f32 v49, v49, v53
  v_fmac_f32 v51, v53, v53
  v_and_b32 v54, 0xffff0000, v163
  v_lshlrev_b32 v55, 16, v163
  v_mfma_f32_16x16x32_bf16 v[36:39], v[60:63], v[132:135], v[36:39]
  ds_read_b64_tr_b16 v[142:143], v4 offset:5120
  v_add_f32 v48, v48, v54
  v_fmac_f32 v50, v54, v54
  v_add_f32 v49, v49, v55
  v_fmac_f32 v51, v55, v55
  s_waitcnt lgkmcnt(0)
  v_mfma_f32_32x32x16_bf16 v[64:79], v[136:139], v[168:171], v[64:79]
  ds_read_b128 v[160:163], v196 offset:0
  v_and_b32 v52, 0xffff0000, v168
  v_lshlrev_b32 v53, 16, v168
  v_add_f32 v48, v48, v52
  v_fmac_f32 v50, v52, v52
  v_mfma_f32_32x32x16_bf16 v[80:95], v[136:139], v[172:175], v[80:95]
  ds_read_b128 v[164:167], v204 offset:0
  v_add_f32 v49, v49, v53
  v_fmac_f32 v51, v53, v53
  v_and_b32 v54, 0xffff0000, v169
  v_lshlrev_b32 v55, 16, v169
  v_mfma_f32_16x16x32_bf16 v[32:35], v[60:63], v[136:139], v[32:35]
  ds_read_b64_tr_b16 v[128:129], v2 offset:8192
  v_add_f32 v48, v48, v54
  v_fmac_f32 v50, v54, v54
  v_add_f32 v49, v49, v55
  v_fmac_f32 v51, v55, v55
  v_mfma_f32_32x32x16_bf16 v[96:111], v[140:143], v[168:171], v[96:111]
  ds_read_b64_tr_b16 v[130:131], v2 offset:9216
  v_and_b32 v52, 0xffff0000, v170
  v_lshlrev_b32 v53, 16, v170
  v_add_f32 v48, v48, v52
  v_fmac_f32 v50, v52, v52
  v_mfma_f32_32x32x16_bf16 v[112:127], v[140:143], v[172:175], v[112:127]
  ds_read_b64_tr_b16 v[132:133], v4 offset:8192
  v_add_f32 v49, v49, v53
  v_fmac_f32 v51, v53, v53
  v_and_b32 v54, 0xffff0000, v171
  v_lshlrev_b32 v55, 16, v171
  v_mfma_f32_16x16x32_bf16 v[36:39], v[60:63], v[140:143], v[36:39]
  ds_read_b64_tr_b16 v[134:135], v4 offset:9216
  v_add_f32 v48, v48, v54
  v_fmac_f32 v50, v54, v54
  v_add_f32 v49, v49, v55
  v_fmac_f32 v51, v55, v55
  s_waitcnt lgkmcnt(0)
  v_mfma_f32_32x32x16_bf16 v[64:79], v[128:131], v[160:163], v[64:79]
  ds_read_b128 v[168:171], v198 offset:0
  v_and_b32 v52, 0xffff0000, v160
  v_lshlrev_b32 v53, 16, v160
  v_add_f32 v48, v48, v52
  v_fmac_f32 v50, v52, v52
  v_mfma_f32_32x32x16_bf16 v[80:95], v[128:131], v[164:167], v[80:95]
  ds_read_b128 v[172:175], v206 offset:0
  v_add_f32 v49, v49, v53
  v_fmac_f32 v51, v53, v53
  v_and_b32 v54, 0xffff0000, v161
  v_lshlrev_b32 v55, 16, v161
  v_mfma_f32_16x16x32_bf16 v[32:35], v[60:63], v[128:131], v[32:35]
  ds_read_b64_tr_b16 v[136:137], v2 offset:12288
  v_add_f32 v48, v48, v54
  v_fmac_f32 v50, v54, v54
  v_add_f32 v49, v49, v55
  v_fmac_f32 v51, v55, v55
  v_mfma_f32_32x32x16_bf16 v[96:111], v[132:135], v[160:163], v[96:111]
  ds_read_b64_tr_b16 v[138:139], v2 offset:13312
  v_and_b32 v52, 0xffff0000, v162
  v_lshlrev_b32 v53, 16, v162
  v_add_f32 v48, v48, v52
  v_fmac_f32 v50, v52, v52
  v_mfma_f32_32x32x16_bf16 v[112:127], v[132:135], v[164:167], v[112:127]
  ds_read_b64_tr_b16 v[140:141], v4 offset:12288
  v_add_f32 v49, v49, v53
  v_fmac_f32 v51, v53, v53
  v_and_b32 v54, 0xffff0000, v163
  v_lshlrev_b32 v55, 16, v163
  v_mfma_f32_16x16x32_bf16 v[36:39], v[60:63], v[132:135], v[36:39]
  ds_read_b64_tr_b16 v[142:143], v4 offset:13312
  v_add_f32 v48, v48, v54
  v_fmac_f32 v50, v54, v54
  v_add_f32 v49, v49, v55
  v_fmac_f32 v51, v55, v55
  s_waitcnt lgkmcnt(0)
  s_barrier
  v_mfma_f32_32x32x16_bf16 v[64:79], v[136:139], v[168:171], v[64:79]
  ds_read_b128 v[160:163], v192 offset:32768
  v_and_b32 v52, 0xffff0000, v168
  v_lshlrev_b32 v53, 16, v168
  v_add_f32 v48, v48, v52
  v_fmac_f32 v50, v52, v52
  v_mfma_f32_32x32x16_bf16 v[80:95], v[136:139], v[172:175], v[80:95]
  ds_read_b128 v[164:167], v200 offset:32768
  v_add_f32 v49, v49, v53
  v_fmac_f32 v51, v53, v53
  v_and_b32 v54, 0xffff0000, v169
  v_lshlrev_b32 v55, 16, v169
  v_mfma_f32_16x16x32_bf16 v[32:35], v[60:63], v[136:139], v[32:35]
  ds_read_b64_tr_b16 v[128:129], v2 offset:32768
  v_add_f32 v48, v48, v54
  v_fmac_f32 v50, v54, v54
  v_add_f32 v49, v49, v55
  v_fmac_f32 v51, v55, v55
  v_mfma_f32_32x32x16_bf16 v[96:111], v[140:143], v[168:171], v[96:111]
  ds_read_b64_tr_b16 v[130:131], v2 offset:33792
  v_and_b32 v52, 0xffff0000, v170
  v_lshlrev_b32 v53, 16, v170
  v_add_f32 v48, v48, v52
  v_fmac_f32 v50, v52, v52
  v_mfma_f32_32x32x16_bf16 v[112:127], v[140:143], v[172:175], v[112:127]
  ds_read_b64_tr_b16 v[132:133], v4 offset:32768
  v_add_f32 v49, v49, v53
  v_fmac_f32 v51, v53, v53
  v_and_b32 v54, 0xffff0000, v171
  v_lshlrev_b32 v55, 16, v171
  v_mfma_f32_16x16x32_bf16 v[36:39], v[60:63], v[140:143], v[36:39]
  ds_read_b64_tr_b16 v[134:135], v4 offset:33792
  v_add_f32 v48, v48, v54
  v_fmac_f32 v50, v54, v54
  v_add_f32 v49, v49, v55
  v_fmac_f32 v51, v55, v55
  s_waitcnt lgkmcnt(0)
  v_mfma_f32_32x32x16_bf16 v[64:79], v[128:131], v[160:163], v[64:79]
  ds_read_b128 v[168:171], v194 offset:32768
  v_and_b32 v52, 0xffff0000, v160
  v_lshlrev_b32 v53, 16, v160
  v_add_f32 v48, v48, v52
  v_fmac_f32 v50, v52, v52
  v_mfma_f32_32x32x16_bf16 v[80:95], v[128:131], v[164:167], v[80:95]
  ds_read_b128 v[172:175], v202 offset:32768
  v_add_f32 v49, v49, v53
  v_fmac_f32 v51, v53, v53
  v_and_b32 v54, 0xffff0000, v161
  v_lshlrev_b32 v55, 16, v161
  v_mfma_f32_16x16x32_bf16 v[32:35], v[60:63], v[128:131], v[32:35]
  ds_read_b64_tr_b16 v[136:137], v2 offset:36864
  v_add_f32 v48, v48, v54
  v_fmac_f32 v50, v54, v54
  v_add_f32 v49, v49, v55
  v_fmac_f32 v51, v55, v55
  v_mfma_f32_32x32x16_bf16 v[96:111], v[132:135], v[160:163], v[96:111]
  ds_read_b64_tr_b16 v[138:139], v2 offset:37888
  v_and_b32 v52, 0xffff0000, v162
  v_lshlrev_b32 v53, 16, v162
  v_add_f32 v48, v48, v52
  v_fmac_f32 v50, v52, v52
  v_mfma_f32_32x32x16_bf16 v[112:127], v[132:135], v[164:167], v[112:127]
  ds_read_b64_tr_b16 v[140:141], v4 offset:36864
  v_add_f32 v49, v49, v53
  v_fmac_f32 v51, v53, v53
  v_and_b32 v54, 0xffff0000, v163
  v_lshlrev_b32 v55, 16, v163
  v_mfma_f32_16x16x32_bf16 v[36:39], v[60:63], v[132:135], v[36:39]
  ds_read_b64_tr_b16 v[142:143], v4 offset:37888
  v_add_f32 v48, v48, v54
  v_fmac_f32 v50, v54, v54
  v_add_f32 v49, v49, v55
  v_fmac_f32 v51, v55, v55
  s_waitcnt lgkmcnt(0)
  v_mfma_f32_32x32x16_bf16 v[64:79], v[136:139], v[168:171], v[64:79]
  ds_read_b128 v[160:163], v196 offset:32768
  v_and_b32 v52, 0xffff0000, v168
  v_lshlrev_b32 v53, 16, v168
  v_add_f32 v48, v48, v52
  v_fmac_f32 v50, v52, v52
  v_mfma_f32_32x32x16_bf16 v[80:95], v[136:139], v[172:175], v[80:95]
  ds_read_b128 v[164:167], v204 offset:32768
  v_add_f32 v49, v49, v53
  v_fmac_f32 v51, v53, v53
  v_and_b32 v54, 0xffff0000, v169
  v_lshlrev_b32 v55, 16, v169
  v_mfma_f32_16x16x32_bf16 v[32:35], v[60:63], v[136:139], v[32:35]
  ds_read_b64_tr_b16 v[128:129], v2 offset:40960
  v_add_f32 v48, v48, v54
  v_fmac_f32 v50, v54, v54
  v_add_f32 v49, v49, v55
  v_fmac_f32 v51, v55, v55
  v_mfma_f32_32x32x16_bf16 v[96:111], v[140:143], v[168:171], v[96:111]
  ds_read_b64_tr_b16 v[130:131], v2 offset:41984
  v_and_b32 v52, 0xffff0000, v170
  v_lshlrev_b32 v53, 16, v170
  v_add_f32 v48, v48, v52
  v_fmac_f32 v50, v52, v52
  v_mfma_f32_32x32x16_bf16 v[112:127], v[140:143], v[172:175], v[112:127]
  ds_read_b64_tr_b16 v[132:133], v4 offset:40960
  v_add_f32 v49, v49, v53
  v_fmac_f32 v51, v53, v53
  v_and_b32 v54, 0xffff0000, v171
  v_lshlrev_b32 v55, 16, v171
  v_mfma_f32_16x16x32_bf16 v[36:39], v[60:63], v[140:143], v[36:39]
  ds_read_b64_tr_b16 v[134:135], v4 offset:41984
  v_add_f32 v48, v48, v54
  v_fmac_f32 v50, v54, v54
  v_add_f32 v49, v49, v55
  v_fmac_f32 v51, v55, v55
  s_waitcnt lgkmcnt(0)
  v_mfma_f32_32x32x16_bf16 v[64:79], v[128:131], v[160:163], v[64:79]
  ds_read_b128 v[168:171], v198 offset:32768
  v_and_b32 v52, 0xffff0000, v160
  v_lshlrev_b32 v53, 16, v160
  v_add_f32 v48, v48, v52
  v_fmac_f32 v50, v52, v52
  v_mfma_f32_32x32x16_bf16 v[80:95], v[128:131], v[164:167], v[80:95]
  ds_read_b128 v[172:175], v206 offset:32768
  v_add_f32 v49, v49, v53
  v_fmac_f32 v51, v53, v53
  v_and_b32 v54, 0xffff0000, v161
  v_lshlrev_b32 v55, 16, v161
  v_mfma_f32_16x16x32_bf16 v[32:35], v[60:63], v[128:131], v[32:35]
  ds_read_b64_tr_b16 v[136:137], v2 offset:45056
  v_add_f32 v48, v48, v54
  v_fmac_f32 v50, v54, v54
  v_add_f32 v49, v49, v55
  v_fmac_f32 v51, v55, v55
  v_mfma_f32_32x32x16_bf16 v[96:111], v[132:135], v[160:163], v[96:111]
  ds_read_b64_tr_b16 v[138:139], v2 offset:46080
  v_and_b32 v52, 0xffff0000, v162
  v_lshlrev_b32 v53, 16, v162
  v_add_f32 v48, v48, v52
  v_fmac_f32 v50, v52, v52
  v_mfma_f32_32x32x16_bf16 v[112:127], v[132:135], v[164:167], v[112:127]
  ds_read_b64_tr_b16 v[140:141], v4 offset:45056
  v_add_f32 v49, v49, v53
  v_fmac_f32 v51, v53, v53
  v_and_b32 v54, 0xffff0000, v163
  v_lshlrev_b32 v55, 16, v163
  v_mfma_f32_16x16x32_bf16 v[36:39], v[60:63], v[132:135], v[36:39]
  ds_read_b64_tr_b16 v[142:143], v4 offset:46080
  v_add_f32 v48, v48, v54
  v_fmac_f32 v50, v54, v54
  v_add_f32 v49, v49, v55
  v_fmac_f32 v51, v55, v55
  s_waitcnt lgkmcnt(0)
  s_barrier
  v_mfma_f32_32x32x16_bf16 v[64:79], v[136:139], v[168:171], v[64:79]
  ds_read_b128 v[160:163], v193 offset:0
  v_and_b32 v52, 0xffff0000, v168
  v_lshlrev_b32 v53, 16, v168
  v_add_f32 v48, v48, v52
  v_fmac_f32 v50, v52, v52
  v_mfma_f32_32x32x16_bf16 v[80:95], v[136:139], v[172:175], v[80:95]
  ds_read_b128 v[164:167], v201 offset:0
  v_add_f32 v49, v49, v53
  v_fmac_f32 v51, v53, v53
  v_and_b32 v54, 0xffff0000, v169
  v_lshlrev_b32 v55, 16, v169
  v_mfma_f32_16x16x32_bf16 v[32:35], v[60:63], v[136:139], v[32:35]
  ds_read_b64_tr_b16 v[128:129], v3 offset:0
  v_add_f32 v48, v48, v54
  v_fmac_f32 v50, v54, v54
  v_add_f32 v49, v49, v55
  v_fmac_f32 v51, v55, v55
  v_mfma_f32_32x32x16_bf16 v[96:111], v[140:143], v[168:171], v[96:111]
  ds_read_b64_tr_b16 v[130:131], v3 offset:1024
  v_and_b32 v52, 0xffff0000, v170
  v_lshlrev_b32 v53, 16, v170
  v_add_f32 v48, v48, v52
  v_fmac_f32 v50, v52, v52
  v_mfma_f32_32x32x16_bf16 v[112:127], v[140:143], v[172:175], v[112:127]
  ds_read_b64_tr_b16 v[132:133], v5 offset:0
  v_add_f32 v49, v49, v53
  v_fmac_f32 v51, v53, v53
  v_and_b32 v54, 0xffff0000, v171
  v_lshlrev_b32 v55, 16, v171
  v_mfma_f32_16x16x32_bf16 v[36:39], v[60:63], v[140:143], v[36:39]
  ds_read_b64_tr_b16 v[134:135], v5 offset:1024
  v_add_f32 v48, v48, v54
  v_fmac_f32 v50, v54, v54
  v_add_f32 v49, v49, v55
  v_fmac_f32 v51, v55, v55
  s_waitcnt lgkmcnt(0)
  v_mfma_f32_32x32x16_bf16 v[64:79], v[128:131], v[160:163], v[64:79]
  ds_read_b128 v[168:171], v195 offset:0
  v_and_b32 v52, 0xffff0000, v160
  v_lshlrev_b32 v53, 16, v160
  v_add_f32 v48, v48, v52
  v_fmac_f32 v50, v52, v52
  v_mfma_f32_32x32x16_bf16 v[80:95], v[128:131], v[164:167], v[80:95]
  ds_read_b128 v[172:175], v203 offset:0
  v_add_f32 v49, v49, v53
  v_fmac_f32 v51, v53, v53
  v_and_b32 v54, 0xffff0000, v161
  v_lshlrev_b32 v55, 16, v161
  v_mfma_f32_16x16x32_bf16 v[32:35], v[60:63], v[128:131], v[32:35]
  ds_read_b64_tr_b16 v[136:137], v3 offset:4096
  v_add_f32 v48, v48, v54
  v_fmac_f32 v50, v54, v54
  v_add_f32 v49, v49, v55
  v_fmac_f32 v51, v55, v55
  v_mfma_f32_32x32x16_bf16 v[96:111], v[132:135], v[160:163], v[96:111]
  ds_read_b64_tr_b16 v[138:139], v3 offset:5120
  v_and_b32 v52, 0xffff0000, v162
  v_lshlrev_b32 v53, 16, v162
  v_add_f32 v48, v48, v52
  v_fmac_f32 v50, v52, v52
  v_mfma_f32_32x32x16_bf16 v[112:127], v[132:135], v[164:167], v[112:127]
  ds_read_b64_tr_b16 v[140:141], v5 offset:4096
  v_add_f32 v49, v49, v53
  v_fmac_f32 v51, v53, v53
  v_and_b32 v54, 0xffff0000, v163
  v_lshlrev_b32 v55, 16, v163
  v_mfma_f32_16x16x32_bf16 v[36:39], v[60:63], v[132:135], v[36:39]
  ds_read_b64_tr_b16 v[142:143], v5 offset:5120
  v_add_f32 v48, v48, v54
  v_fmac_f32 v50, v54, v54
  v_add_f32 v49, v49, v55
  v_fmac_f32 v51, v55, v55
  s_waitcnt lgkmcnt(0)
  v_mfma_f32_32x32x16_bf16 v[64:79], v[136:139], v[168:171], v[64:79]
  ds_read_b128 v[160:163], v197 offset:0
  v_and_b32 v52, 0xffff0000, v168
  v_lshlrev_b32 v53, 16, v168
  v_add_f32 v48, v48, v52
  v_fmac_f32 v50, v52, v52
  v_mfma_f32_32x32x16_bf16 v[80:95], v[136:139], v[172:175], v[80:95]
  ds_read_b128 v[164:167], v205 offset:0
  v_add_f32 v49, v49, v53
  v_fmac_f32 v51, v53, v53
  v_and_b32 v54, 0xffff0000, v169
  v_lshlrev_b32 v55, 16, v169
  v_mfma_f32_16x16x32_bf16 v[32:35], v[60:63], v[136:139], v[32:35]
  ds_read_b64_tr_b16 v[128:129], v3 offset:8192
  v_add_f32 v48, v48, v54
  v_fmac_f32 v50, v54, v54
  v_add_f32 v49, v49, v55
  v_fmac_f32 v51, v55, v55
  v_mfma_f32_32x32x16_bf16 v[96:111], v[140:143], v[168:171], v[96:111]
  ds_read_b64_tr_b16 v[130:131], v3 offset:9216
  v_and_b32 v52, 0xffff0000, v170
  v_lshlrev_b32 v53, 16, v170
  v_add_f32 v48, v48, v52
  v_fmac_f32 v50, v52, v52
  v_mfma_f32_32x32x16_bf16 v[112:127], v[140:143], v[172:175], v[112:127]
  ds_read_b64_tr_b16 v[132:133], v5 offset:8192
  v_add_f32 v49, v49, v53
  v_fmac_f32 v51, v53, v53
  v_and_b32 v54, 0xffff0000, v171
  v_lshlrev_b32 v55, 16, v171
  v_mfma_f32_16x16x32_bf16 v[36:39], v[60:63], v[140:143], v[36:39]
  ds_read_b64_tr_b16 v[134:135], v5 offset:9216
  v_add_f32 v48, v48, v54
  v_fmac_f32 v50, v54, v54
  v_add_f32 v49, v49, v55
  v_fmac_f32 v51, v55, v55
  s_waitcnt lgkmcnt(0)
  v_mfma_f32_32x32x16_bf16 v[64:79], v[128:131], v[160:163], v[64:79]
  ds_read_b128 v[168:171], v199 offset:0
  v_and_b32 v52, 0xffff0000, v160
  v_lshlrev_b32 v53, 16, v160
  v_add_f32 v48, v48, v52
  v_fmac_f32 v50, v52, v52
  v_mfma_f32_32x32x16_bf16 v[80:95], v[128:131], v[164:167], v[80:95]
  ds_read_b128 v[172:175], v207 offset:0
  v_add_f32 v49, v49, v53
  v_fmac_f32 v51, v53, v53
  v_and_b32 v54, 0xffff0000, v161
  v_lshlrev_b32 v55, 16, v161
  v_mfma_f32_16x16x32_bf16 v[32:35], v[60:63], v[128:131], v[32:35]
  ds_read_b64_tr_b16 v[136:137], v3 offset:12288
  v_add_f32 v48, v48, v54
  v_fmac_f32 v50, v54, v54
  v_add_f32 v49, v49, v55
  v_fmac_f32 v51, v55, v55
  v_mfma_f32_32x32x16_bf16 v[96:111], v[132:135], v[160:163], v[96:111]
  ds_read_b64_tr_b16 v[138:139], v3 offset:13312
  v_and_b32 v52, 0xffff0000, v162
  v_lshlrev_b32 v53, 16, v162
  v_add_f32 v48, v48, v52
  v_fmac_f32 v50, v52, v52
  v_mfma_f32_32x32x16_bf16 v[112:127], v[132:135], v[164:167], v[112:127]
  ds_read_b64_tr_b16 v[140:141], v5 offset:12288
  v_add_f32 v49, v49, v53
  v_fmac_f32 v51, v53, v53
  v_and_b32 v54, 0xffff0000, v163
  v_lshlrev_b32 v55, 16, v163
  v_mfma_f32_16x16x32_bf16 v[36:39], v[60:63], v[132:135], v[36:39]
  ds_read_b64_tr_b16 v[142:143], v5 offset:13312
  v_add_f32 v48, v48, v54
  v_fmac_f32 v50, v54, v54
  v_add_f32 v49, v49, v55
  v_fmac_f32 v51, v55, v55
  s_waitcnt lgkmcnt(0)
  s_barrier
  v_mfma_f32_32x32x16_bf16 v[64:79], v[136:139], v[168:171], v[64:79]
  ds_read_b128 v[160:163], v193 offset:32768
  v_and_b32 v52, 0xffff0000, v168
  v_lshlrev_b32 v53, 16, v168
  v_add_f32 v48, v48, v52
  v_fmac_f32 v50, v52, v52
  v_mfma_f32_32x32x16_bf16 v[80:95], v[136:139], v[172:175], v[80:95]
  ds_read_b128 v[164:167], v201 offset:32768
  v_add_f32 v49, v49, v53
  v_fmac_f32 v51, v53, v53
  v_and_b32 v54, 0xffff0000, v169
  v_lshlrev_b32 v55, 16, v169
  v_mfma_f32_16x16x32_bf16 v[32:35], v[60:63], v[136:139], v[32:35]
  ds_read_b64_tr_b16 v[128:129], v3 offset:32768
  v_add_f32 v48, v48, v54
  v_fmac_f32 v50, v54, v54
  v_add_f32 v49, v49, v55
  v_fmac_f32 v51, v55, v55
  v_mfma_f32_32x32x16_bf16 v[96:111], v[140:143], v[168:171], v[96:111]
  ds_read_b64_tr_b16 v[130:131], v3 offset:33792
  v_and_b32 v52, 0xffff0000, v170
  v_lshlrev_b32 v53, 16, v170
  v_add_f32 v48, v48, v52
  v_fmac_f32 v50, v52, v52
  v_mfma_f32_32x32x16_bf16 v[112:127], v[140:143], v[172:175], v[112:127]
  ds_read_b64_tr_b16 v[132:133], v5 offset:32768
  v_add_f32 v49, v49, v53
  v_fmac_f32 v51, v53, v53
  v_and_b32 v54, 0xffff0000, v171
  v_lshlrev_b32 v55, 16, v171
  v_mfma_f32_16x16x32_bf16 v[36:39], v[60:63], v[140:143], v[36:39]
  ds_read_b64_tr_b16 v[134:135], v5 offset:33792
  v_add_f32 v48, v48, v54
  v_fmac_f32 v50, v54, v54
  v_add_f32 v49, v49, v55
  v_fmac_f32 v51, v55, v55
  s_waitcnt lgkmcnt(0)
  v_mfma_f32_32x32x16_bf16 v[64:79], v[128:131], v[160:163], v[64:79]
  ds_read_b128 v[168:171], v195 offset:32768
  v_and_b32 v52, 0xffff0000, v160
  v_lshlrev_b32 v53, 16, v160
  v_add_f32 v48, v48, v52
  v_fmac_f32 v50, v52, v52
  v_mfma_f32_32x32x16_bf16 v[80:95], v[128:131], v[164:167], v[80:95]
  ds_read_b128 v[172:175], v203 offset:32768
  v_add_f32 v49, v49, v53
  v_fmac_f32 v51, v53, v53
  v_and_b32 v54, 0xffff0000, v161
  v_lshlrev_b32 v55, 16, v161
  v_mfma_f32_16x16x32_bf16 v[32:35], v[60:63], v[128:131], v[32:35]
  ds_read_b64_tr_b16 v[136:137], v3 offset:36864
  v_add_f32 v48, v48, v54
  v_fmac_f32 v50, v54, v54
  v_add_f32 v49, v49, v55
  v_fmac_f32 v51, v55, v55
  v_mfma_f32_32x32x16_bf16 v[96:111], v[132:135], v[160:163], v[96:111]
  ds_read_b64_tr_b16 v[138:139], v3 offset:37888
  v_and_b32 v52, 0xffff0000, v162
  v_lshlrev_b32 v53, 16, v162
  v_add_f32 v48, v48, v52
  v_fmac_f32 v50, v52, v52
  v_mfma_f32_32x32x16_bf16 v[112:127], v[132:135], v[164:167], v[112:127]
  ds_read_b64_tr_b16 v[140:141], v5 offset:36864
  v_add_f32 v49, v49, v53
  v_fmac_f32 v51, v53, v53
  v_and_b32 v54, 0xffff0000, v163
  v_lshlrev_b32 v55, 16, v163
  v_mfma_f32_16x16x32_bf16 v[36:39], v[60:63], v[132:135], v[36:39]
  ds_read_b64_tr_b16 v[142:143], v5 offset:37888
  v_add_f32 v48, v48, v54
  v_fmac_f32 v50, v54, v54
  v_add_f32 v49, v49, v55
  v_fmac_f32 v51, v55, v55
  s_waitcnt lgkmcnt(0)
  v_mfma_f32_32x32x16_bf16 v[64:79], v[136:139], v[168:171], v[64:79]
  ds_read_b128 v[160:163], v197 offset:32768
  v_and_b32 v52, 0xffff0000, v168
  v_lshlrev_b32 v53, 16, v168
  v_add_f32 v48, v48, v52
  v_fmac_f32 v50, v52, v52
  v_mfma_f32_32x32x16_bf16 v[80:95], v[136:139], v[172:175], v[80:95]
  ds_read_b128 v[164:167], v205 offset:32768
  v_add_f32 v49, v49, v53
  v_fmac_f32 v51, v53, v53
  v_and_b32 v54, 0xffff0000, v169
  v_lshlrev_b32 v55, 16, v169
  v_mfma_f32_16x16x32_bf16 v[32:35], v[60:63], v[136:139], v[32:35]
  ds_read_b64_tr_b16 v[128:129], v3 offset:40960
  v_add_f32 v48, v48, v54
  v_fmac_f32 v50, v54, v54
  v_add_f32 v49, v49, v55
  v_fmac_f32 v51, v55, v55
  v_mfma_f32_32x32x16_bf16 v[96:111], v[140:143], v[168:171], v[96:111]
  ds_read_b64_tr_b16 v[130:131], v3 offset:41984
  v_and_b32 v52, 0xffff0000, v170
  v_lshlrev_b32 v53, 16, v170
  v_add_f32 v48, v48, v52
  v_fmac_f32 v50, v52, v52
  v_mfma_f32_32x32x16_bf16 v[112:127], v[140:143], v[172:175], v[112:127]
  ds_read_b64_tr_b16 v[132:133], v5 offset:40960
  v_add_f32 v49, v49, v53
  v_fmac_f32 v51, v53, v53
  v_and_b32 v54, 0xffff0000, v171
  v_lshlrev_b32 v55, 16, v171
  v_mfma_f32_16x16x32_bf16 v[36:39], v[60:63], v[140:143], v[36:39]
  ds_read_b64_tr_b16 v[134:135], v5 offset:41984
  v_add_f32 v48, v48, v54
  v_fmac_f32 v50, v54, v54
  v_add_f32 v49, v49, v55
  v_fmac_f32 v51, v55, v55
  s_waitcnt lgkmcnt(0)
  v_mfma_f32_32x32x16_bf16 v[64:79], v[128:131], v[160:163], v[64:79]
  ds_read_b128 v[168:171], v199 offset:32768
  v_and_b32 v52, 0xffff0000, v160
  v_lshlrev_b32 v53, 16, v160
  v_add_f32 v48, v48, v52
  v_fmac_f32 v50, v52, v52
  v_mfma_f32_32x32x16_bf16 v[80:95], v[128:131], v[164:167], v[80:95]
  ds_read_b128 v[172:175], v207 offset:32768
  v_add_f32 v49, v49, v53
  v_fmac_f32 v51, v53, v53
  v_and_b32 v54, 0xffff0000, v161
  v_lshlrev_b32 v55, 16, v161
  v_mfma_f32_16x16x32_bf16 v[32:35], v[60:63], v[128:131], v[32:35]
  ds_read_b64_tr_b16 v[136:137], v3 offset:45056
  v_add_f32 v48, v48, v54
  v_fmac_f32 v50, v54, v54
  v_add_f32 v49, v49, v55
  v_fmac_f32 v51, v55, v55
  v_mfma_f32_32x32x16_bf16 v[96:111], v[132:135], v[160:163], v[96:111]
  ds_read_b64_tr_b16 v[138:139], v3 offset:46080
  v_and_b32 v52, 0xffff0000, v162
  v_lshlrev_b32 v53, 16, v162
  v_add_f32 v48, v48, v52
  v_fmac_f32 v50, v52, v52
  v_mfma_f32_32x32x16_bf16 v[112:127], v[132:135], v[164:167], v[112:127]
  ds_read_b64_tr_b16 v[140:141], v5 offset:45056
  v_add_f32 v49, v49, v53
  v_fmac_f32 v51, v53, v53
  v_and_b32 v54, 0xffff0000, v163
  v_lshlrev_b32 v55, 16, v163
  v_mfma_f32_16x16x32_bf16 v[36:39], v[60:63], v[132:135], v[36:39]
  ds_read_b64_tr_b16 v[142:143], v5 offset:46080
  v_add_f32 v48, v48, v54
  v_fmac_f32 v50, v54, v54
  v_add_f32 v49, v49, v55
  v_fmac_f32 v51, v55, v55
  s_waitcnt lgkmcnt(0)
  s_barrier
  v_mfma_f32_32x32x16_bf16 v[64:79], v[136:139], v[168:171], v[64:79]
  ds_read_b128 v[160:163], v192 offset:0
  v_and_b32 v52, 0xffff0000, v168
  v_lshlrev_b32 v53, 16, v168
  v_add_f32 v48, v48, v52
  v_fmac_f32 v50, v52, v52
  v_mfma_f32_32x32x16_bf16 v[80:95], v[136:139], v[172:175], v[80:95]
  ds_read_b128 v[164:167], v200 offset:0
  v_add_f32 v49, v49, v53
  v_fmac_f32 v51, v53, v53
  v_and_b32 v54, 0xffff0000, v169
  v_lshlrev_b32 v55, 16, v169
  v_mfma_f32_16x16x32_bf16 v[32:35], v[60:63], v[136:139], v[32:35]
  ds_read_b64_tr_b16 v[128:129], v2 offset:0
  v_add_f32 v48, v48, v54
  v_fmac_f32 v50, v54, v54
  v_add_f32 v49, v49, v55
  v_fmac_f32 v51, v55, v55
  v_mfma_f32_32x32x16_bf16 v[96:111], v[140:143], v[168:171], v[96:111]
  ds_read_b64_tr_b16 v[130:131], v2 offset:1024
  v_and_b32 v52, 0xffff0000, v170
  v_lshlrev_b32 v53, 16, v170
  v_add_f32 v48, v48, v52
  v_fmac_f32 v50, v52, v52
  v_mfma_f32_32x32x16_bf16 v[112:127], v[140:143], v[172:175], v[112:127]
  ds_read_b64_tr_b16 v[132:133], v4 offset:0
  v_add_f32 v49, v49, v53
  v_fmac_f32 v51, v53, v53
  v_and_b32 v54, 0xffff0000, v171
  v_lshlrev_b32 v55, 16, v171
  v_mfma_f32_16x16x32_bf16 v[36:39], v[60:63], v[140:143], v[36:39]
  ds_read_b64_tr_b16 v[134:135], v4 offset:1024
  v_add_f32 v48, v48, v54
  v_fmac_f32 v50, v54, v54
  v_add_f32 v49, v49, v55
  v_fmac_f32 v51, v55, v55
  s_waitcnt lgkmcnt(0)
  v_mfma_f32_32x32x16_bf16 v[64:79], v[128:131], v[160:163], v[64:79]
  ds_read_b128 v[168:171], v194 offset:0
  v_and_b32 v52, 0xffff0000, v160
  v_lshlrev_b32 v53, 16, v160
  v_add_f32 v48, v48, v52
  v_fmac_f32 v50, v52, v52
  v_mfma_f32_32x32x16_bf16 v[80:95], v[128:131], v[164:167], v[80:95]
  ds_read_b128 v[172:175], v202 offset:0
  v_add_f32 v49, v49, v53
  v_fmac_f32 v51, v53, v53
  v_and_b32 v54, 0xffff0000, v161
  v_lshlrev_b32 v55, 16, v161
  v_mfma_f32_16x16x32_bf16 v[32:35], v[60:63], v[128:131], v[32:35]
  ds_read_b64_tr_b16 v[136:137], v2 offset:4096
  v_add_f32 v48, v48, v54
  v_fmac_f32 v50, v54, v54
  v_add_f32 v49, v49, v55
  v_fmac_f32 v51, v55, v55
  v_mfma_f32_32x32x16_bf16 v[96:111], v[132:135], v[160:163], v[96:111]
  ds_read_b64_tr_b16 v[138:139], v2 offset:5120
  v_and_b32 v52, 0xffff0000, v162
  v_lshlrev_b32 v53, 16, v162
  v_add_f32 v48, v48, v52
  v_fmac_f32 v50, v52, v52
  v_mfma_f32_32x32x16_bf16 v[112:127], v[132:135], v[164:167], v[112:127]
  ds_read_b64_tr_b16 v[140:141], v4 offset:4096
  v_add_f32 v49, v49, v53
  v_fmac_f32 v51, v53, v53
  v_and_b32 v54, 0xffff0000, v163
  v_lshlrev_b32 v55, 16, v163
  v_mfma_f32_16x16x32_bf16 v[36:39], v[60:63], v[132:135], v[36:39]
  ds_read_b64_tr_b16 v[142:143], v4 offset:5120
  v_add_f32 v48, v48, v54
  v_fmac_f32 v50, v54, v54
  v_add_f32 v49, v49, v55
  v_fmac_f32 v51, v55, v55
  s_waitcnt lgkmcnt(0)
  v_mfma_f32_32x32x16_bf16 v[64:79], v[136:139], v[168:171], v[64:79]
  ds_read_b128 v[160:163], v196 offset:0
  v_and_b32 v52, 0xffff0000, v168
  v_lshlrev_b32 v53, 16, v168
  v_add_f32 v48, v48, v52
  v_fmac_f32 v50, v52, v52
  v_mfma_f32_32x32x16_bf16 v[80:95], v[136:139], v[172:175], v[80:95]
  ds_read_b128 v[164:167], v204 offset:0
  v_add_f32 v49, v49, v53
  v_fmac_f32 v51, v53, v53
  v_and_b32 v54, 0xffff0000, v169
  v_lshlrev_b32 v55, 16, v169
  v_mfma_f32_16x16x32_bf16 v[32:35], v[60:63], v[136:139], v[32:35]
  ds_read_b64_tr_b16 v[128:129], v2 offset:8192
  v_add_f32 v48, v48, v54
  v_fmac_f32 v50, v54, v54
  v_add_f32 v49, v49, v55
  v_fmac_f32 v51, v55, v55
  v_mfma_f32_32x32x16_bf16 v[96:111], v[140:143], v[168:171], v[96:111]
  ds_read_b64_tr_b16 v[130:131], v2 offset:9216
  v_and_b32 v52, 0xffff0000, v170
  v_lshlrev_b32 v53, 16, v170
  v_add_f32 v48, v48, v52
  v_fmac_f32 v50, v52, v52
  v_mfma_f32_32x32x16_bf16 v[112:127], v[140:143], v[172:175], v[112:127]
  ds_read_b64_tr_b16 v[132:133], v4 offset:8192
  v_add_f32 v49, v49, v53
  v_fmac_f32 v51, v53, v53
  v_and_b32 v54, 0xffff0000, v171
  v_lshlrev_b32 v55, 16, v171
  v_mfma_f32_16x16x32_bf16 v[36:39], v[60:63], v[140:143], v[36:39]
  ds_read_b64_tr_b16 v[134:135], v4 offset:9216
  v_add_f32 v48, v48, v54
  v_fmac_f32 v50, v54, v54
  v_add_f32 v49, v49, v55
  v_fmac_f32 v51, v55, v55
  s_waitcnt lgkmcnt(0)
  v_mfma_f32_32x32x16_bf16 v[64:79], v[128:131], v[160:163], v[64:79]
  ds_read_b128 v[168:171], v198 offset:0
  v_and_b32 v52, 0xffff0000, v160
  v_lshlrev_b32 v53, 16, v160
  v_add_f32 v48, v48, v52
  v_fmac_f32 v50, v52, v52
  v_mfma_f32_32x32x16_bf16 v[80:95], v[128:131], v[164:167], v[80:95]
  ds_read_b128 v[172:175], v206 offset:0
  v_add_f32 v49, v49, v53
  v_fmac_f32 v51, v53, v53
  v_and_b32 v54, 0xffff0000, v161
  v_lshlrev_b32 v55, 16, v161
  v_mfma_f32_16x16x32_bf16 v[32:35], v[60:63], v[128:131], v[32:35]
  ds_read_b64_tr_b16 v[136:137], v2 offset:12288
  v_add_f32 v48, v48, v54
  v_fmac_f32 v50, v54, v54
  v_add_f32 v49, v49, v55
  v_fmac_f32 v51, v55, v55
  v_mfma_f32_32x32x16_bf16 v[96:111], v[132:135], v[160:163], v[96:111]
  ds_read_b64_tr_b16 v[138:139], v2 offset:13312
  v_and_b32 v52, 0xffff0000, v162
  v_lshlrev_b32 v53, 16, v162
  v_add_f32 v48, v48, v52
  v_fmac_f32 v50, v52, v52
  v_mfma_f32_32x32x16_bf16 v[112:127], v[132:135], v[164:167], v[112:127]
  ds_read_b64_tr_b16 v[140:141], v4 offset:12288
  v_add_f32 v49, v49, v53
  v_fmac_f32 v51, v53, v53
  v_and_b32 v54, 0xffff0000, v163
  v_lshlrev_b32 v55, 16, v163
  v_mfma_f32_16x16x32_bf16 v[36:39], v[60:63], v[132:135], v[36:39]
  ds_read_b64_tr_b16 v[142:143], v4 offset:13312
  v_add_f32 v48, v48, v54
  v_fmac_f32 v50, v54, v54
  v_add_f32 v49, v49, v55
  v_fmac_f32 v51, v55, v55
  s_waitcnt lgkmcnt(0)
  s_barrier
  v_mfma_f32_32x32x16_bf16 v[64:79], v[136:139], v[168:171], v[64:79]
  ds_read_b128 v[160:163], v192 offset:32768
  v_and_b32 v52, 0xffff0000, v168
  v_lshlrev_b32 v53, 16, v168
  v_add_f32 v48, v48, v52
  v_fmac_f32 v50, v52, v52
  v_mfma_f32_32x32x16_bf16 v[80:95], v[136:139], v[172:175], v[80:95]
  ds_read_b128 v[164:167], v200 offset:32768
  v_add_f32 v49, v49, v53
  v_fmac_f32 v51, v53, v53
  v_and_b32 v54, 0xffff0000, v169
  v_lshlrev_b32 v55, 16, v169
  v_mfma_f32_16x16x32_bf16 v[32:35], v[60:63], v[136:139], v[32:35]
  ds_read_b64_tr_b16 v[128:129], v2 offset:32768
  v_add_f32 v48, v48, v54
  v_fmac_f32 v50, v54, v54
  v_add_f32 v49, v49, v55
  v_fmac_f32 v51, v55, v55
  v_mfma_f32_32x32x16_bf16 v[96:111], v[140:143], v[168:171], v[96:111]
  ds_read_b64_tr_b16 v[130:131], v2 offset:33792
  v_and_b32 v52, 0xffff0000, v170
  v_lshlrev_b32 v53, 16, v170
  v_add_f32 v48, v48, v52
  v_fmac_f32 v50, v52, v52
  v_mfma_f32_32x32x16_bf16 v[112:127], v[140:143], v[172:175], v[112:127]
  ds_read_b64_tr_b16 v[132:133], v4 offset:32768
  v_add_f32 v49, v49, v53
  v_fmac_f32 v51, v53, v53
  v_and_b32 v54, 0xffff0000, v171
  v_lshlrev_b32 v55, 16, v171
  v_mfma_f32_16x16x32_bf16 v[36:39], v[60:63], v[140:143], v[36:39]
  ds_read_b64_tr_b16 v[134:135], v4 offset:33792
  v_add_f32 v48, v48, v54
  v_fmac_f32 v50, v54, v54
  v_add_f32 v49, v49, v55
  v_fmac_f32 v51, v55, v55
  s_waitcnt lgkmcnt(0)
  v_mfma_f32_32x32x16_bf16 v[64:79], v[128:131], v[160:163], v[64:79]
  ds_read_b128 v[168:171], v194 offset:32768
  v_and_b32 v52, 0xffff0000, v160
  v_lshlrev_b32 v53, 16, v160
  v_add_f32 v48, v48, v52
  v_fmac_f32 v50, v52, v52
  v_mfma_f32_32x32x16_bf16 v[80:95], v[128:131], v[164:167], v[80:95]
  ds_read_b128 v[172:175], v202 offset:32768
  v_add_f32 v49, v49, v53
  v_fmac_f32 v51, v53, v53
  v_and_b32 v54, 0xffff0000, v161
  v_lshlrev_b32 v55, 16, v161
  v_mfma_f32_16x16x32_bf16 v[32:35], v[60:63], v[128:131], v[32:35]
  ds_read_b64_tr_b16 v[136:137], v2 offset:36864
  v_add_f32 v48, v48, v54
  v_fmac_f32 v50, v54, v54
  v_add_f32 v49, v49, v55
  v_fmac_f32 v51, v55, v55
  v_mfma_f32_32x32x16_bf16 v[96:111], v[132:135], v[160:163], v[96:111]
  ds_read_b64_tr_b16 v[138:139], v2 offset:37888
  v_and_b32 v52, 0xffff0000, v162
  v_lshlrev_b32 v53, 16, v162
  v_add_f32 v48, v48, v52
  v_fmac_f32 v50, v52, v52
  v_mfma_f32_32x32x16_bf16 v[112:127], v[132:135], v[164:167], v[112:127]
  ds_read_b64_tr_b16 v[140:141], v4 offset:36864
  v_add_f32 v49, v49, v53
  v_fmac_f32 v51, v53, v53
  v_and_b32 v54, 0xffff0000, v163
  v_lshlrev_b32 v55, 16, v163
  v_mfma_f32_16x16x32_bf16 v[36:39], v[60:63], v[132:135], v[36:39]
  ds_read_b64_tr_b16 v[142:143], v4 offset:37888
  v_add_f32 v48, v48, v54
  v_fmac_f32 v50, v54, v54
  v_add_f32 v49, v49, v55
  v_fmac_f32 v51, v55, v55
  s_waitcnt lgkmcnt(0)
  v_mfma_f32_32x32x16_bf16 v[64:79], v[136:139], v[168:171], v[64:79]
  ds_read_b128 v[160:163], v196 offset:32768
  v_and_b32 v52, 0xffff0000, v168
  v_lshlrev_b32 v53, 16, v168
  v_add_f32 v48, v48, v52
  v_fmac_f32 v50, v52, v52
  v_mfma_f32_32x32x16_bf16 v[80:95], v[136:139], v[172:175], v[80:95]
  ds_read_b128 v[164:167], v204 offset:32768
  v_add_f32 v49, v49, v53
  v_fmac_f32 v51, v53, v53
  v_and_b32 v54, 0xffff0000, v169
  v_lshlrev_b32 v55, 16, v169
  v_mfma_f32_16x16x32_bf16 v[32:35], v[60:63], v[136:139], v[32:35]
  ds_read_b64_tr_b16 v[128:129], v2 offset:40960
  v_add_f32 v48, v48, v54
  v_fmac_f32 v50, v54, v54
  v_add_f32 v49, v49, v55
  v_fmac_f32 v51, v55, v55
  v_mfma_f32_32x32x16_bf16 v[96:111], v[140:143], v[168:171], v[96:111]
  ds_read_b64_tr_b16 v[130:131], v2 offset:41984
  v_and_b32 v52, 0xffff0000, v170
  v_lshlrev_b32 v53, 16, v170
  v_add_f32 v48, v48, v52
  v_fmac_f32 v50, v52, v52
  v_mfma_f32_32x32x16_bf16 v[112:127], v[140:143], v[172:175], v[112:127]
  ds_read_b64_tr_b16 v[132:133], v4 offset:40960
  v_add_f32 v49, v49, v53
  v_fmac_f32 v51, v53, v53
  v_and_b32 v54, 0xffff0000, v171
  v_lshlrev_b32 v55, 16, v171
  v_mfma_f32_16x16x32_bf16 v[36:39], v[60:63], v[140:143], v[36:39]
  ds_read_b64_tr_b16 v[134:135], v4 offset:41984
  v_add_f32 v48, v48, v54
  v_fmac_f32 v50, v54, v54
  v_add_f32 v49, v49, v55
  v_fmac_f32 v51, v55, v55
  s_waitcnt lgkmcnt(0)
  v_mfma_f32_32x32x16_bf16 v[64:79], v[128:131], v[160:163], v[64:79]
  ds_read_b128 v[168:171], v198 offset:32768
  v_and_b32 v52, 0xffff0000, v160
  v_lshlrev_b32 v53, 16, v160
  v_add_f32 v48, v48, v52
  v_fmac_f32 v50, v52, v52
  v_mfma_f32_32x32x16_bf16 v[80:95], v[128:131], v[164:167], v[80:95]
  ds_read_b128 v[172:175], v206 offset:32768
  v_add_f32 v49, v49, v53
  v_fmac_f32 v51, v53, v53
  v_and_b32 v54, 0xffff0000, v161
  v_lshlrev_b32 v55, 16, v161
  v_mfma_f32_16x16x32_bf16 v[32:35], v[60:63], v[128:131], v[32:35]
  ds_read_b64_tr_b16 v[136:137], v2 offset:45056
  v_add_f32 v48, v48, v54
  v_fmac_f32 v50, v54, v54
  v_add_f32 v49, v49, v55
  v_fmac_f32 v51, v55, v55
  v_mfma_f32_32x32x16_bf16 v[96:111], v[132:135], v[160:163], v[96:111]
  ds_read_b64_tr_b16 v[138:139], v2 offset:46080
  v_and_b32 v52, 0xffff0000, v162
  v_lshlrev_b32 v53, 16, v162
  v_add_f32 v48, v48, v52
  v_fmac_f32 v50, v52, v52
  v_mfma_f32_32x32x16_bf16 v[112:127], v[132:135], v[164:167], v[112:127]
  ds_read_b64_tr_b16 v[140:141], v4 offset:45056
  v_add_f32 v49, v49, v53
  v_fmac_f32 v51, v53, v53
  v_and_b32 v54, 0xffff0000, v163
  v_lshlrev_b32 v55, 16, v163
  v_mfma_f32_16x16x32_bf16 v[36:39], v[60:63], v[132:135], v[36:39]
  ds_read_b64_tr_b16 v[142:143], v4 offset:46080
  v_add_f32 v48, v48, v54
  v_fmac_f32 v50, v54, v54
  v_add_f32 v49, v49, v55
  v_fmac_f32 v51, v55, v55
  s_waitcnt lgkmcnt(0)
  v_mfma_f32_32x32x16_bf16 v[64:79], v[136:139], v[168:171], v[64:79]
  v_and_b32 v52, 0xffff0000, v168
  v_lshlrev_b32 v53, 16, v168
  v_add_f32 v48, v48, v52
  v_fmac_f32 v50, v52, v52
  v_mfma_f32_32x32x16_bf16 v[80:95], v[136:139], v[172:175], v[80:95]
  v_add_f32 v49, v49, v53
  v_fmac_f32 v51, v53, v53
  v_and_b32 v54, 0xffff0000, v169
  v_lshlrev_b32 v55, 16, v169
  v_mfma_f32_16x16x32_bf16 v[32:35], v[60:63], v[136:139], v[32:35]
  v_add_f32 v48, v48, v54
  v_fmac_f32 v50, v54, v54
  v_add_f32 v49, v49, v55
  v_fmac_f32 v51, v55, v55
  v_mfma_f32_32x32x16_bf16 v[96:111], v[140:143], v[168:171], v[96:111]
  v_and_b32 v52, 0xffff0000, v170
  v_lshlrev_b32 v53, 16, v170
  v_add_f32 v48, v48, v52
  v_fmac_f32 v50, v52, v52
  v_mfma_f32_32x32x16_bf16 v[112:127], v[140:143], v[172:175], v[112:127]
  v_add_f32 v49, v49, v53
  v_fmac_f32 v51, v53, v53
  v_and_b32 v54, 0xffff0000, v171
  v_lshlrev_b32 v55, 16, v171
  v_mfma_f32_16x16x32_bf16 v[36:39], v[60:63], v[140:143], v[36:39]
  v_add_f32 v48, v48, v54
  v_fmac_f32 v50, v54, v54
  v_add_f32 v49, v49, v55
  v_fmac_f32 v51, v55, v55
  v_add_f32 v40, v48, v49
  v_add_f32 v41, v50, v51
  v_mov_b32 v42, v40
  v_mov_b32 v43, v41
  s_nop 1
  v_permlane32_swap_b32 v40, v42
  v_permlane32_swap_b32 v41, v43
  s_nop 1
  v_add_f32 v40, v40, v42
  v_add_f32 v41, v41, v43
  v_mul_f32 v40, 0x3acccccd, v40
  v_mul_f32 v41, 0x3acccccd, v41
  v_fma_f32 v41, -v40, v40, v41
  v_max_f32 v41, 0, v41
  v_add_f32 v42, 0x3727c5ac, v41
  v_rsq_f32 v42, v42
  s_cmp_lt_u32 s25, 5
  s_cselect_b32 s46, 0x3ea52b5c, 1.0
  v_mul_f32 v42, s46, v42
  v_mul_f32 v43, v42, v40
  v_cmp_eq_u32 vcc, 0, v17
  s_lshl_b32 s37, s36, 8
  s_lshl_b32 s38, s27, 7
  s_add_u32 s37, s37, s38
  s_add_u32 s37, s37, 131072
  v_lshlrev_b32 v44, 2, v16
  v_add_u32 v44, s37, v44
  v_lshl_add_u32 v44, v17, 9, v44
  v_cndmask_b32 v42, v43, v42, vcc
  ds_write_b32 v44, v42
  s_lshl_b32 s37, s27, 8
  s_add_u32 s37, s37, 132096
  v_lshlrev_b32 v45, 2, v0
  v_add_u32 v45, s37, v45
  s_mov_b64 exec, 0xffff
  ds_write_b32 v45, v32 offset:0
  ds_write_b32 v45, v33 offset:64
  ds_write_b32 v45, v36 offset:128
  ds_write_b32 v45, v37 offset:192
  s_mov_b64 exec, -1
  s_waitcnt lgkmcnt(0)
  s_barrier
  s_mul_i32 s37, s36, 256
  v_lshlrev_b32 v20, 2, v16
  v_add_u32 v20, s37, v20
  v_add_u32 v20, 131072, v20
  s_lshl_b32 s37, s27, 7
  v_xor_b32 v20, s37, v20
  v_xor_b32 v19, 128, v20
  ds_read_b32 v32, v20
  ds_read_b32 v33, v20 offset:512
  ds_read_b32 v34, v19
  ds_read_b32 v35, v19 offset:512
  v_lshlrev_b32 v21, 4, v17
  s_lshl_b32 s37, s27, 8
  v_add_u32 v21, s37, v21
  v_add_u32 v21, 132096, v21
  ds_read_b128 v[128:131], v21 offset:0
  ds_read_b128 v[132:135], v21 offset:32
  ds_read_b128 v[136:139], v21 offset:64
  ds_read_b128 v[140:143], v21 offset:96
  ds_read_b128 v[144:147], v21 offset:128
  ds_read_b128 v[148:151], v21 offset:160
  ds_read_b128 v[152:155], v21 offset:192
  ds_read_b128 v[156:159], v21 offset:224
  s_waitcnt lgkmcnt(0)
  s_nop 7
  v_pk_mul_f32 v[36:37], v[128:129], v[32:33] op_sel:[0,1] op_sel_hi:[1,1]
  v_pk_mul_f32 v[38:39], v[130:131], v[32:33] op_sel:[0,1] op_sel_hi:[1,1]
  v_pk_fma_f32 v[36:37], v[64:65], v[32:33], v[36:37] op_sel_hi:[1,0,1] neg_lo:[0,0,1] neg_hi:[0,0,1]
  v_pk_fma_f32 v[38:39], v[66:67], v[32:33], v[38:39] op_sel_hi:[1,0,1] neg_lo:[0,0,1] neg_hi:[0,0,1]
  v_cvt_pk_bf16_f32 v44, v36, v37
  v_cvt_pk_bf16_f32 v45, v38, v39
  ds_write_b64 v24, v[44:45]
  v_pk_mul_f32 v[40:41], v[128:129], v[34:35] op_sel:[0,1] op_sel_hi:[1,1]
  v_pk_mul_f32 v[42:43], v[130:131], v[34:35] op_sel:[0,1] op_sel_hi:[1,1]
  v_pk_fma_f32 v[40:41], v[80:81], v[34:35], v[40:41] op_sel_hi:[1,0,1] neg_lo:[0,0,1] neg_hi:[0,0,1]
  v_pk_fma_f32 v[42:43], v[82:83], v[34:35], v[42:43] op_sel_hi:[1,0,1] neg_lo:[0,0,1] neg_hi:[0,0,1]
  v_cvt_pk_bf16_f32 v46, v40, v41
  v_cvt_pk_bf16_f32 v47, v42, v43
  v_xor_b32 v24, 16384, v24
  ds_write_b64 v24, v[46:47]
  v_pk_mul_f32 v[36:37], v[132:133], v[32:33] op_sel:[0,1] op_sel_hi:[1,1]
  v_pk_mul_f32 v[38:39], v[134:135], v[32:33] op_sel:[0,1] op_sel_hi:[1,1]
  v_pk_fma_f32 v[36:37], v[68:69], v[32:33], v[36:37] op_sel_hi:[1,0,1] neg_lo:[0,0,1] neg_hi:[0,0,1]
  v_pk_fma_f32 v[38:39], v[70:71], v[32:33], v[38:39] op_sel_hi:[1,0,1] neg_lo:[0,0,1] neg_hi:[0,0,1]
  v_cvt_pk_bf16_f32 v48, v36, v37
  v_cvt_pk_bf16_f32 v49, v38, v39
  ds_write_b64 v25, v[48:49]
  v_pk_mul_f32 v[40:41], v[132:133], v[34:35] op_sel:[0,1] op_sel_hi:[1,1]
  v_pk_mul_f32 v[42:43], v[134:135], v[34:35] op_sel:[0,1] op_sel_hi:[1,1]
  v_pk_fma_f32 v[40:41], v[84:85], v[34:35], v[40:41] op_sel_hi:[1,0,1] neg_lo:[0,0,1] neg_hi:[0,0,1]
  v_pk_fma_f32 v[42:43], v[86:87], v[34:35], v[42:43] op_sel_hi:[1,0,1] neg_lo:[0,0,1] neg_hi:[0,0,1]
  v_cvt_pk_bf16_f32 v50, v40, v41
  v_cvt_pk_bf16_f32 v51, v42, v43
  v_xor_b32 v25, 16384, v25
  ds_write_b64 v25, v[50:51]
  v_pk_mul_f32 v[36:37], v[136:137], v[32:33] op_sel:[0,1] op_sel_hi:[1,1]
  v_pk_mul_f32 v[38:39], v[138:139], v[32:33] op_sel:[0,1] op_sel_hi:[1,1]
  v_pk_fma_f32 v[36:37], v[72:73], v[32:33], v[36:37] op_sel_hi:[1,0,1] neg_lo:[0,0,1] neg_hi:[0,0,1]
  v_pk_fma_f32 v[38:39], v[74:75], v[32:33], v[38:39] op_sel_hi:[1,0,1] neg_lo:[0,0,1] neg_hi:[0,0,1]
  v_cvt_pk_bf16_f32 v44, v36, v37
  v_cvt_pk_bf16_f32 v45, v38, v39
  ds_write_b64 v26, v[44:45]
  v_pk_mul_f32 v[40:41], v[136:137], v[34:35] op_sel:[0,1] op_sel_hi:[1,1]
  v_pk_mul_f32 v[42:43], v[138:139], v[34:35] op_sel:[0,1] op_sel_hi:[1,1]
  v_pk_fma_f32 v[40:41], v[88:89], v[34:35], v[40:41] op_sel_hi:[1,0,1] neg_lo:[0,0,1] neg_hi:[0,0,1]
  v_pk_fma_f32 v[42:43], v[90:91], v[34:35], v[42:43] op_sel_hi:[1,0,1] neg_lo:[0,0,1] neg_hi:[0,0,1]
  v_cvt_pk_bf16_f32 v46, v40, v41
  v_cvt_pk_bf16_f32 v47, v42, v43
  v_xor_b32 v26, 16384, v26
  ds_write_b64 v26, v[46:47]
  v_pk_mul_f32 v[36:37], v[140:141], v[32:33] op_sel:[0,1] op_sel_hi:[1,1]
  v_pk_mul_f32 v[38:39], v[142:143], v[32:33] op_sel:[0,1] op_sel_hi:[1,1]
  v_pk_fma_f32 v[36:37], v[76:77], v[32:33], v[36:37] op_sel_hi:[1,0,1] neg_lo:[0,0,1] neg_hi:[0,0,1]
  v_pk_fma_f32 v[38:39], v[78:79], v[32:33], v[38:39] op_sel_hi:[1,0,1] neg_lo:[0,0,1] neg_hi:[0,0,1]
  v_cvt_pk_bf16_f32 v48, v36, v37
  v_cvt_pk_bf16_f32 v49, v38, v39
  ds_write_b64 v27, v[48:49]
  v_pk_mul_f32 v[40:41], v[140:141], v[34:35] op_sel:[0,1] op_sel_hi:[1,1]
  v_pk_mul_f32 v[42:43], v[142:143], v[34:35] op_sel:[0,1] op_sel_hi:[1,1]
  v_pk_fma_f32 v[40:41], v[92:93], v[34:35], v[40:41] op_sel_hi:[1,0,1] neg_lo:[0,0,1] neg_hi:[0,0,1]
  v_pk_fma_f32 v[42:43], v[94:95], v[34:35], v[42:43] op_sel_hi:[1,0,1] neg_lo:[0,0,1] neg_hi:[0,0,1]
  v_cvt_pk_bf16_f32 v50, v40, v41
  v_cvt_pk_bf16_f32 v51, v42, v43
  v_xor_b32 v27, 16384, v27
  ds_write_b64 v27, v[50:51]
  v_pk_mul_f32 v[36:37], v[144:145], v[32:33] op_sel:[0,1] op_sel_hi:[1,1]
  v_pk_mul_f32 v[38:39], v[146:147], v[32:33] op_sel:[0,1] op_sel_hi:[1,1]
  v_pk_fma_f32 v[36:37], v[96:97], v[32:33], v[36:37] op_sel_hi:[1,0,1] neg_lo:[0,0,1] neg_hi:[0,0,1]
  v_pk_fma_f32 v[38:39], v[98:99], v[32:33], v[38:39] op_sel_hi:[1,0,1] neg_lo:[0,0,1] neg_hi:[0,0,1]
  v_cvt_pk_bf16_f32 v44, v36, v37
  v_cvt_pk_bf16_f32 v45, v38, v39
  ds_write_b64 v28, v[44:45]
  v_pk_mul_f32 v[40:41], v[144:145], v[34:35] op_sel:[0,1] op_sel_hi:[1,1]
  v_pk_mul_f32 v[42:43], v[146:147], v[34:35] op_sel:[0,1] op_sel_hi:[1,1]
  v_pk_fma_f32 v[40:41], v[112:113], v[34:35], v[40:41] op_sel_hi:[1,0,1] neg_lo:[0,0,1] neg_hi:[0,0,1]
  v_pk_fma_f32 v[42:43], v[114:115], v[34:35], v[42:43] op_sel_hi:[1,0,1] neg_lo:[0,0,1] neg_hi:[0,0,1]
  v_cvt_pk_bf16_f32 v46, v40, v41
  v_cvt_pk_bf16_f32 v47, v42, v43
  v_xor_b32 v28, 16384, v28
  ds_write_b64 v28, v[46:47]
  v_pk_mul_f32 v[36:37], v[148:149], v[32:33] op_sel:[0,1] op_sel_hi:[1,1]
  v_pk_mul_f32 v[38:39], v[150:151], v[32:33] op_sel:[0,1] op_sel_hi:[1,1]
  v_pk_fma_f32 v[36:37], v[100:101], v[32:33], v[36:37] op_sel_hi:[1,0,1] neg_lo:[0,0,1] neg_hi:[0,0,1]
  v_pk_fma_f32 v[38:39], v[102:103], v[32:33], v[38:39] op_sel_hi:[1,0,1] neg_lo:[0,0,1] neg_hi:[0,0,1]
  v_cvt_pk_bf16_f32 v48, v36, v37
  v_cvt_pk_bf16_f32 v49, v38, v39
  ds_write_b64 v29, v[48:49]
  v_pk_mul_f32 v[40:41], v[148:149], v[34:35] op_sel:[0,1] op_sel_hi:[1,1]
  v_pk_mul_f32 v[42:43], v[150:151], v[34:35] op_sel:[0,1] op_sel_hi:[1,1]
  v_pk_fma_f32 v[40:41], v[116:117], v[34:35], v[40:41] op_sel_hi:[1,0,1] neg_lo:[0,0,1] neg_hi:[0,0,1]
  v_pk_fma_f32 v[42:43], v[118:119], v[34:35], v[42:43] op_sel_hi:[1,0,1] neg_lo:[0,0,1] neg_hi:[0,0,1]
  v_cvt_pk_bf16_f32 v50, v40, v41
  v_cvt_pk_bf16_f32 v51, v42, v43
  v_xor_b32 v29, 16384, v29
  ds_write_b64 v29, v[50:51]
  v_pk_mul_f32 v[36:37], v[152:153], v[32:33] op_sel:[0,1] op_sel_hi:[1,1]
  v_pk_mul_f32 v[38:39], v[154:155], v[32:33] op_sel:[0,1] op_sel_hi:[1,1]
  v_pk_fma_f32 v[36:37], v[104:105], v[32:33], v[36:37] op_sel_hi:[1,0,1] neg_lo:[0,0,1] neg_hi:[0,0,1]
  v_pk_fma_f32 v[38:39], v[106:107], v[32:33], v[38:39] op_sel_hi:[1,0,1] neg_lo:[0,0,1] neg_hi:[0,0,1]
  v_cvt_pk_bf16_f32 v44, v36, v37
  v_cvt_pk_bf16_f32 v45, v38, v39
  ds_write_b64 v30, v[44:45]
  v_pk_mul_f32 v[40:41], v[152:153], v[34:35] op_sel:[0,1] op_sel_hi:[1,1]
  v_pk_mul_f32 v[42:43], v[154:155], v[34:35] op_sel:[0,1] op_sel_hi:[1,1]
  v_pk_fma_f32 v[40:41], v[120:121], v[34:35], v[40:41] op_sel_hi:[1,0,1] neg_lo:[0,0,1] neg_hi:[0,0,1]
  v_pk_fma_f32 v[42:43], v[122:123], v[34:35], v[42:43] op_sel_hi:[1,0,1] neg_lo:[0,0,1] neg_hi:[0,0,1]
  v_cvt_pk_bf16_f32 v46, v40, v41
  v_cvt_pk_bf16_f32 v47, v42, v43
  v_xor_b32 v30, 16384, v30
  ds_write_b64 v30, v[46:47]
  v_pk_mul_f32 v[36:37], v[156:157], v[32:33] op_sel:[0,1] op_sel_hi:[1,1]
  v_pk_mul_f32 v[38:39], v[158:159], v[32:33] op_sel:[0,1] op_sel_hi:[1,1]
  v_pk_fma_f32 v[36:37], v[108:109], v[32:33], v[36:37] op_sel_hi:[1,0,1] neg_lo:[0,0,1] neg_hi:[0,0,1]
  v_pk_fma_f32 v[38:39], v[110:111], v[32:33], v[38:39] op_sel_hi:[1,0,1] neg_lo:[0,0,1] neg_hi:[0,0,1]
  v_cvt_pk_bf16_f32 v48, v36, v37
  v_cvt_pk_bf16_f32 v49, v38, v39
  ds_write_b64 v31, v[48:49]
  v_pk_mul_f32 v[40:41], v[156:157], v[34:35] op_sel:[0,1] op_sel_hi:[1,1]
  v_pk_mul_f32 v[42:43], v[158:159], v[34:35] op_sel:[0,1] op_sel_hi:[1,1]
  v_pk_fma_f32 v[40:41], v[124:125], v[34:35], v[40:41] op_sel_hi:[1,0,1] neg_lo:[0,0,1] neg_hi:[0,0,1]
  v_pk_fma_f32 v[42:43], v[126:127], v[34:35], v[42:43] op_sel_hi:[1,0,1] neg_lo:[0,0,1] neg_hi:[0,0,1]
  v_cvt_pk_bf16_f32 v50, v40, v41
  v_cvt_pk_bf16_f32 v51, v42, v43
  v_xor_b32 v31, 16384, v31
  ds_write_b64 v31, v[50:51]
  s_waitcnt lgkmcnt(0)
  s_barrier
  ds_read_b128 v[64:67], v218 offset:0
  ds_read_b128 v[68:71], v218 offset:1024
  ds_read_b128 v[72:75], v218 offset:2048
  ds_read_b128 v[76:79], v218 offset:3072
  ds_read_b128 v[80:83], v218 offset:4096
  ds_read_b128 v[84:87], v218 offset:5120
  ds_read_b128 v[88:91], v218 offset:6144
  ds_read_b128 v[92:95], v218 offset:7168
  ds_read_b128 v[96:99], v218 offset:8192
  ds_read_b128 v[100:103], v218 offset:9216
  s_waitcnt lgkmcnt(9)
  buffer_store_dwordx4 v[64:67], v208, s[48:51], s54 offen sc1
  s_waitcnt lgkmcnt(8)
  buffer_store_dwordx4 v[68:71], v209, s[48:51], s54 offen sc1
  s_waitcnt lgkmcnt(7)
  buffer_store_dwordx4 v[72:75], v210, s[48:51], s54 offen sc1
  s_waitcnt lgkmcnt(6)
  buffer_store_dwordx4 v[76:79], v211, s[48:51], s54 offen sc1
  s_waitcnt lgkmcnt(5)
  buffer_store_dwordx4 v[80:83], v212, s[48:51], s54 offen sc1
  s_waitcnt lgkmcnt(4)
  buffer_store_dwordx4 v[84:87], v213, s[48:51], s54 offen sc1
  s_waitcnt lgkmcnt(3)
  buffer_store_dwordx4 v[88:91], v214, s[48:51], s54 offen sc1
  s_waitcnt lgkmcnt(2)
  buffer_store_dwordx4 v[92:95], v215, s[48:51], s54 offen sc1
  s_waitcnt lgkmcnt(1)
  buffer_store_dwordx4 v[96:99], v216, s[48:51], s54 offen sc1
  s_waitcnt lgkmcnt(0)
  buffer_store_dwordx4 v[100:103], v217, s[48:51], s54 offen sc1
  s_waitcnt vmcnt(0)
  s_endpgm
qkv0_kernel_vpath:
  s_mov_b32 s48, s6
  s_mov_b32 s49, s7
  s_mov_b32 s50, 0x3200000
  s_mov_b32 s51, 0x00020000
  s_sub_u32 s37, s25, 10
  s_lshl_b32 s37, s37, 7
  s_mul_i32 s55, s37, 205
  s_lshr_b32 s55, s55, 12
  s_mul_i32 s43, s55, 20
  s_sub_u32 s43, s43, s37
  s_mov_b32 s40, 163840
  s_mul_i32 s54, s55, s40
  s_lshl_b32 s41, s24, 2
  s_add_u32 s41, s41, s26
  s_mul_i32 s41, s41, 2560
  s_add_u32 s54, s54, s41
  s_add_u32 s54, s54, 25167104
  s_lshl_b32 s52, s36, 15
  s_add_u32 s52, s52, 65536
  s_lshl_b32 s41, s27, 14
  s_add_u32 s52, s52, s41
  s_lshl_b32 s38, s27, 6
  s_add_u32 s37, s37, s38
  v_add_u32 v20, s37, v16
  v_mul_u32_u24 v21, 205, v20
  v_lshrrev_b32 v21, 12, v21
  v_mul_u32_u24 v22, 20, v21
  v_sub_u32 v22, v20, v22
  v_subrev_u32 v21, s55, v21
  v_mul_u32_u24 v21, 1280, v21
  v_lshl_add_u32 v21, v22, 4, v21
  v_mul_u32_u24 v22, 320, v17
  v_add_u32 v21, v21, v22
  v_add_u32 v24, s52, v21
  v_add_u32 v20, s37, v16
  v_add_u32 v20, 32, v20
  v_mul_u32_u24 v21, 205, v20
  v_lshrrev_b32 v21, 12, v21
  v_mul_u32_u24 v22, 20, v21
  v_sub_u32 v22, v20, v22
  v_subrev_u32 v21, s55, v21
  v_mul_u32_u24 v21, 1280, v21
  v_lshl_add_u32 v21, v22, 4, v21
  v_mul_u32_u24 v22, 320, v17
  v_add_u32 v21, v21, v22
  v_add_u32 v25, s52, v21
  s_barrier
  ds_read_b128 v[160:163], v192 offset:0
  ds_read_b128 v[164:167], v200 offset:0
  ds_read_b64_tr_b16 v[128:129], v2 offset:0
  ds_read_b64_tr_b16 v[130:131], v2 offset:1024
  ds_read_b64_tr_b16 v[132:133], v4 offset:0
  ds_read_b64_tr_b16 v[134:135], v4 offset:1024
  s_waitcnt lgkmcnt(0)
  v_mfma_f32_32x32x16_bf16 v[64:79], v[160:163], v[128:131], 0
  ds_read_b128 v[168:171], v194 offset:0
  v_and_b32 v52, 0xffff0000, v160
  v_lshlrev_b32 v53, 16, v160
  v_add_f32 v48, v48, v52
  v_fmac_f32 v50, v52, v52
  v_mfma_f32_32x32x16_bf16 v[80:95], v[164:167], v[128:131], 0
  ds_read_b128 v[172:175], v202 offset:0
  v_add_f32 v49, v49, v53
  v_fmac_f32 v51, v53, v53
  v_and_b32 v54, 0xffff0000, v161
  v_lshlrev_b32 v55, 16, v161
  v_mfma_f32_16x16x32_bf16 v[32:35], v[60:63], v[128:131], 0
  ds_read_b64_tr_b16 v[136:137], v2 offset:4096
  v_add_f32 v48, v48, v54
  v_fmac_f32 v50, v54, v54
  v_add_f32 v49, v49, v55
  v_fmac_f32 v51, v55, v55
  v_mfma_f32_32x32x16_bf16 v[96:111], v[160:163], v[132:135], 0
  ds_read_b64_tr_b16 v[138:139], v2 offset:5120
  v_and_b32 v52, 0xffff0000, v162
  v_lshlrev_b32 v53, 16, v162
  v_add_f32 v48, v48, v52
  v_fmac_f32 v50, v52, v52
  v_mfma_f32_32x32x16_bf16 v[112:127], v[164:167], v[132:135], 0
  ds_read_b64_tr_b16 v[140:141], v4 offset:4096
  v_add_f32 v49, v49, v53
  v_fmac_f32 v51, v53, v53
  v_and_b32 v54, 0xffff0000, v163
  v_lshlrev_b32 v55, 16, v163
  v_mfma_f32_16x16x32_bf16 v[36:39], v[60:63], v[132:135], 0
  ds_read_b64_tr_b16 v[142:143], v4 offset:5120
  v_add_f32 v48, v48, v54
  v_fmac_f32 v50, v54, v54
  v_add_f32 v49, v49, v55
  v_fmac_f32 v51, v55, v55
  s_waitcnt lgkmcnt(0)
  v_mfma_f32_32x32x16_bf16 v[64:79], v[168:171], v[136:139], v[64:79]
  ds_read_b128 v[160:163], v196 offset:0
  v_and_b32 v52, 0xffff0000, v168
  v_lshlrev_b32 v53, 16, v168
  v_add_f32 v48, v48, v52
  v_fmac_f32 v50, v52, v52
  v_mfma_f32_32x32x16_bf16 v[80:95], v[172:175], v[136:139], v[80:95]
  ds_read_b128 v[164:167], v204 offset:0
  v_add_f32 v49, v49, v53
  v_fmac_f32 v51, v53, v53
  v_and_b32 v54, 0xffff0000, v169
  v_lshlrev_b32 v55, 16, v169
  v_mfma_f32_16x16x32_bf16 v[32:35], v[60:63], v[136:139], v[32:35]
  ds_read_b64_tr_b16 v[128:129], v2 offset:8192
  v_add_f32 v48, v48, v54
  v_fmac_f32 v50, v54, v54
  v_add_f32 v49, v49, v55
  v_fmac_f32 v51, v55, v55
  v_mfma_f32_32x32x16_bf16 v[96:111], v[168:171], v[140:143], v[96:111]
  ds_read_b64_tr_b16 v[130:131], v2 offset:9216
  v_and_b32 v52, 0xffff0000, v170
  v_lshlrev_b32 v53, 16, v170
  v_add_f32 v48, v48, v52
  v_fmac_f32 v50, v52, v52
  v_mfma_f32_32x32x16_bf16 v[112:127], v[172:175], v[140:143], v[112:127]
  ds_read_b64_tr_b16 v[132:133], v4 offset:8192
  v_add_f32 v49, v49, v53
  v_fmac_f32 v51, v53, v53
  v_and_b32 v54, 0xffff0000, v171
  v_lshlrev_b32 v55, 16, v171
  v_mfma_f32_16x16x32_bf16 v[36:39], v[60:63], v[140:143], v[36:39]
  ds_read_b64_tr_b16 v[134:135], v4 offset:9216
  v_add_f32 v48, v48, v54
  v_fmac_f32 v50, v54, v54
  v_add_f32 v49, v49, v55
  v_fmac_f32 v51, v55, v55
  s_waitcnt lgkmcnt(0)
  v_mfma_f32_32x32x16_bf16 v[64:79], v[160:163], v[128:131], v[64:79]
  ds_read_b128 v[168:171], v198 offset:0
  v_and_b32 v52, 0xffff0000, v160
  v_lshlrev_b32 v53, 16, v160
  v_add_f32 v48, v48, v52
  v_fmac_f32 v50, v52, v52
  v_mfma_f32_32x32x16_bf16 v[80:95], v[164:167], v[128:131], v[80:95]
  ds_read_b128 v[172:175], v206 offset:0
  v_add_f32 v49, v49, v53
  v_fmac_f32 v51, v53, v53
  v_and_b32 v54, 0xffff0000, v161
  v_lshlrev_b32 v55, 16, v161
  v_mfma_f32_16x16x32_bf16 v[32:35], v[60:63], v[128:131], v[32:35]
  ds_read_b64_tr_b16 v[136:137], v2 offset:12288
  v_add_f32 v48, v48, v54
  v_fmac_f32 v50, v54, v54
  v_add_f32 v49, v49, v55
  v_fmac_f32 v51, v55, v55
  v_mfma_f32_32x32x16_bf16 v[96:111], v[160:163], v[132:135], v[96:111]
  ds_read_b64_tr_b16 v[138:139], v2 offset:13312
  v_and_b32 v52, 0xffff0000, v162
  v_lshlrev_b32 v53, 16, v162
  v_add_f32 v48, v48, v52
  v_fmac_f32 v50, v52, v52
  v_mfma_f32_32x32x16_bf16 v[112:127], v[164:167], v[132:135], v[112:127]
  ds_read_b64_tr_b16 v[140:141], v4 offset:12288
  v_add_f32 v49, v49, v53
  v_fmac_f32 v51, v53, v53
  v_and_b32 v54, 0xffff0000, v163
  v_lshlrev_b32 v55, 16, v163
  v_mfma_f32_16x16x32_bf16 v[36:39], v[60:63], v[132:135], v[36:39]
  ds_read_b64_tr_b16 v[142:143], v4 offset:13312
  v_add_f32 v48, v48, v54
  v_fmac_f32 v50, v54, v54
  v_add_f32 v49, v49, v55
  v_fmac_f32 v51, v55, v55
  v_add_u32 v18, 0, v0
  v_mul_u32_u24 v19, 205, v18
  v_lshrrev_b32 v19, 14, v19
  v_mul_u32_u24 v23, 80, v19
  v_sub_u32 v18, v18, v23
  v_mul_u32_u24 v208, s40, v19
  v_lshl_add_u32 v208, v18, 4, v208
  v_mul_u32_u24 v23, 205, v18
  v_lshrrev_b32 v23, 12, v23
  v_mul_u32_u24 v23, 20, v23
  v_sub_u32 v18, v18, v23
  v_mul_u32_u24 v19, 20, v19
  v_add_u32 v19, v19, v18
  v_add_u32 v19, s43, v19
  v_cmp_gt_u32 vcc, 128, v19
  v_mov_b32 v23, 0x80000000
  s_nop 0
  v_cndmask_b32 v208, v23, v208, vcc
  v_add_u32 v18, 64, v0
  v_mul_u32_u24 v19, 205, v18
  v_lshrrev_b32 v19, 14, v19
  v_mul_u32_u24 v23, 80, v19
  v_sub_u32 v18, v18, v23
  v_mul_u32_u24 v209, s40, v19
  v_lshl_add_u32 v209, v18, 4, v209
  v_mul_u32_u24 v23, 205, v18
  v_lshrrev_b32 v23, 12, v23
  v_mul_u32_u24 v23, 20, v23
  v_sub_u32 v18, v18, v23
  v_mul_u32_u24 v19, 20, v19
  v_add_u32 v19, v19, v18
  v_add_u32 v19, s43, v19
  v_cmp_gt_u32 vcc, 128, v19
  v_mov_b32 v23, 0x80000000
  s_nop 0
  v_cndmask_b32 v209, v23, v209, vcc
  v_add_u32 v18, 128, v0
  v_mul_u32_u24 v19, 205, v18
  v_lshrrev_b32 v19, 14, v19
  v_mul_u32_u24 v23, 80, v19
  v_sub_u32 v18, v18, v23
  v_mul_u32_u24 v210, s40, v19
  v_lshl_add_u32 v210, v18, 4, v210
  v_mul_u32_u24 v23, 205, v18
  v_lshrrev_b32 v23, 12, v23
  v_mul_u32_u24 v23, 20, v23
  v_sub_u32 v18, v18, v23
  v_mul_u32_u24 v19, 20, v19
  v_add_u32 v19, v19, v18
  v_add_u32 v19, s43, v19
  v_cmp_gt_u32 vcc, 128, v19
  v_mov_b32 v23, 0x80000000
  s_nop 0
  v_cndmask_b32 v210, v23, v210, vcc
  v_add_u32 v18, 192, v0
  v_mul_u32_u24 v19, 205, v18
  v_lshrrev_b32 v19, 14, v19
  v_mul_u32_u24 v23, 80, v19
  v_sub_u32 v18, v18, v23
  v_mul_u32_u24 v211, s40, v19
  v_lshl_add_u32 v211, v18, 4, v211
  v_mul_u32_u24 v23, 205, v18
  v_lshrrev_b32 v23, 12, v23
  v_mul_u32_u24 v23, 20, v23
  v_sub_u32 v18, v18, v23
  v_mul_u32_u24 v19, 20, v19
  v_add_u32 v19, v19, v18
  v_add_u32 v19, s43, v19
  v_cmp_gt_u32 vcc, 128, v19
  v_mov_b32 v23, 0x80000000
  s_nop 0
  v_cndmask_b32 v211, v23, v211, vcc
  v_add_u32 v18, 256, v0
  v_mul_u32_u24 v19, 205, v18
  v_lshrrev_b32 v19, 14, v19
  v_mul_u32_u24 v23, 80, v19
  v_sub_u32 v18, v18, v23
  v_mul_u32_u24 v212, s40, v19
  v_lshl_add_u32 v212, v18, 4, v212
  v_mul_u32_u24 v23, 205, v18
  v_lshrrev_b32 v23, 12, v23
  v_mul_u32_u24 v23, 20, v23
  v_sub_u32 v18, v18, v23
  v_mul_u32_u24 v19, 20, v19
  v_add_u32 v19, v19, v18
  v_add_u32 v19, s43, v19
  v_cmp_gt_u32 vcc, 128, v19
  v_mov_b32 v23, 0x80000000
  s_nop 0
  v_cndmask_b32 v212, v23, v212, vcc
  v_add_u32 v18, 320, v0
  v_mul_u32_u24 v19, 205, v18
  v_lshrrev_b32 v19, 14, v19
  v_mul_u32_u24 v23, 80, v19
  v_sub_u32 v18, v18, v23
  v_mul_u32_u24 v213, s40, v19
  v_lshl_add_u32 v213, v18, 4, v213
  v_mul_u32_u24 v23, 205, v18
  v_lshrrev_b32 v23, 12, v23
  v_mul_u32_u24 v23, 20, v23
  v_sub_u32 v18, v18, v23
  v_mul_u32_u24 v19, 20, v19
  v_add_u32 v19, v19, v18
  v_add_u32 v19, s43, v19
  v_cmp_gt_u32 vcc, 128, v19
  v_mov_b32 v23, 0x80000000
  s_nop 0
  v_cndmask_b32 v213, v23, v213, vcc
  v_add_u32 v18, 384, v0
  v_mul_u32_u24 v19, 205, v18
  v_lshrrev_b32 v19, 14, v19
  v_mul_u32_u24 v23, 80, v19
  v_sub_u32 v18, v18, v23
  v_mul_u32_u24 v214, s40, v19
  v_lshl_add_u32 v214, v18, 4, v214
  v_mul_u32_u24 v23, 205, v18
  v_lshrrev_b32 v23, 12, v23
  v_mul_u32_u24 v23, 20, v23
  v_sub_u32 v18, v18, v23
  v_mul_u32_u24 v19, 20, v19
  v_add_u32 v19, v19, v18
  v_add_u32 v19, s43, v19
  v_cmp_gt_u32 vcc, 128, v19
  v_mov_b32 v23, 0x80000000
  s_nop 0
  v_cndmask_b32 v214, v23, v214, vcc
  v_add_u32 v18, 448, v0
  v_mul_u32_u24 v19, 205, v18
  v_lshrrev_b32 v19, 14, v19
  v_mul_u32_u24 v23, 80, v19
  v_sub_u32 v18, v18, v23
  v_mul_u32_u24 v215, s40, v19
  v_lshl_add_u32 v215, v18, 4, v215
  v_mul_u32_u24 v23, 205, v18
  v_lshrrev_b32 v23, 12, v23
  v_mul_u32_u24 v23, 20, v23
  v_sub_u32 v18, v18, v23
  v_mul_u32_u24 v19, 20, v19
  v_add_u32 v19, v19, v18
  v_add_u32 v19, s43, v19
  v_cmp_gt_u32 vcc, 128, v19
  v_mov_b32 v23, 0x80000000
  s_nop 0
  v_cndmask_b32 v215, v23, v215, vcc
  v_add_u32 v18, 512, v0
  v_mul_u32_u24 v19, 205, v18
  v_lshrrev_b32 v19, 14, v19
  v_mul_u32_u24 v23, 80, v19
  v_sub_u32 v18, v18, v23
  v_mul_u32_u24 v216, s40, v19
  v_lshl_add_u32 v216, v18, 4, v216
  v_mul_u32_u24 v23, 205, v18
  v_lshrrev_b32 v23, 12, v23
  v_mul_u32_u24 v23, 20, v23
  v_sub_u32 v18, v18, v23
  v_mul_u32_u24 v19, 20, v19
  v_add_u32 v19, v19, v18
  v_add_u32 v19, s43, v19
  v_cmp_gt_u32 vcc, 128, v19
  v_mov_b32 v23, 0x80000000
  s_nop 0
  v_cndmask_b32 v216, v23, v216, vcc
  v_add_u32 v18, 576, v0
  v_mul_u32_u24 v19, 205, v18
  v_lshrrev_b32 v19, 14, v19
  v_mul_u32_u24 v23, 80, v19
  v_sub_u32 v18, v18, v23
  v_mul_u32_u24 v217, s40, v19
  v_lshl_add_u32 v217, v18, 4, v217
  v_mul_u32_u24 v23, 205, v18
  v_lshrrev_b32 v23, 12, v23
  v_mul_u32_u24 v23, 20, v23
  v_sub_u32 v18, v18, v23
  v_mul_u32_u24 v19, 20, v19
  v_add_u32 v19, v19, v18
  v_add_u32 v19, s43, v19
  v_cmp_gt_u32 vcc, 128, v19
  v_mov_b32 v23, 0x80000000
  s_nop 0
  v_cndmask_b32 v217, v23, v217, vcc
  s_lshl_b32 s41, s26, 14
  s_add_u32 s41, s41, 65536
  v_lshlrev_b32 v218, 4, v0
  v_add_u32 v218, s41, v218
  s_waitcnt lgkmcnt(0)
  s_barrier
  v_mfma_f32_32x32x16_bf16 v[64:79], v[168:171], v[136:139], v[64:79]
  ds_read_b128 v[160:163], v192 offset:32768
  v_and_b32 v52, 0xffff0000, v168
  v_lshlrev_b32 v53, 16, v168
  v_add_f32 v48, v48, v52
  v_fmac_f32 v50, v52, v52
  v_mfma_f32_32x32x16_bf16 v[80:95], v[172:175], v[136:139], v[80:95]
  ds_read_b128 v[164:167], v200 offset:32768
  v_add_f32 v49, v49, v53
  v_fmac_f32 v51, v53, v53
  v_and_b32 v54, 0xffff0000, v169
  v_lshlrev_b32 v55, 16, v169
  v_mfma_f32_16x16x32_bf16 v[32:35], v[60:63], v[136:139], v[32:35]
  ds_read_b64_tr_b16 v[128:129], v2 offset:32768
  v_add_f32 v48, v48, v54
  v_fmac_f32 v50, v54, v54
  v_add_f32 v49, v49, v55
  v_fmac_f32 v51, v55, v55
  v_mfma_f32_32x32x16_bf16 v[96:111], v[168:171], v[140:143], v[96:111]
  ds_read_b64_tr_b16 v[130:131], v2 offset:33792
  v_and_b32 v52, 0xffff0000, v170
  v_lshlrev_b32 v53, 16, v170
  v_add_f32 v48, v48, v52
  v_fmac_f32 v50, v52, v52
  v_mfma_f32_32x32x16_bf16 v[112:127], v[172:175], v[140:143], v[112:127]
  ds_read_b64_tr_b16 v[132:133], v4 offset:32768
  v_add_f32 v49, v49, v53
  v_fmac_f32 v51, v53, v53
  v_and_b32 v54, 0xffff0000, v171
  v_lshlrev_b32 v55, 16, v171
  v_mfma_f32_16x16x32_bf16 v[36:39], v[60:63], v[140:143], v[36:39]
  ds_read_b64_tr_b16 v[134:135], v4 offset:33792
  v_add_f32 v48, v48, v54
  v_fmac_f32 v50, v54, v54
  v_add_f32 v49, v49, v55
  v_fmac_f32 v51, v55, v55
  s_waitcnt lgkmcnt(0)
  v_mfma_f32_32x32x16_bf16 v[64:79], v[160:163], v[128:131], v[64:79]
  ds_read_b128 v[168:171], v194 offset:32768
  v_and_b32 v52, 0xffff0000, v160
  v_lshlrev_b32 v53, 16, v160
  v_add_f32 v48, v48, v52
  v_fmac_f32 v50, v52, v52
  v_mfma_f32_32x32x16_bf16 v[80:95], v[164:167], v[128:131], v[80:95]
  ds_read_b128 v[172:175], v202 offset:32768
  v_add_f32 v49, v49, v53
  v_fmac_f32 v51, v53, v53
  v_and_b32 v54, 0xffff0000, v161
  v_lshlrev_b32 v55, 16, v161
  v_mfma_f32_16x16x32_bf16 v[32:35], v[60:63], v[128:131], v[32:35]
  ds_read_b64_tr_b16 v[136:137], v2 offset:36864
  v_add_f32 v48, v48, v54
  v_fmac_f32 v50, v54, v54
  v_add_f32 v49, v49, v55
  v_fmac_f32 v51, v55, v55
  v_mfma_f32_32x32x16_bf16 v[96:111], v[160:163], v[132:135], v[96:111]
  ds_read_b64_tr_b16 v[138:139], v2 offset:37888
  v_and_b32 v52, 0xffff0000, v162
  v_lshlrev_b32 v53, 16, v162
  v_add_f32 v48, v48, v52
  v_fmac_f32 v50, v52, v52
  v_mfma_f32_32x32x16_bf16 v[112:127], v[164:167], v[132:135], v[112:127]
  ds_read_b64_tr_b16 v[140:141], v4 offset:36864
  v_add_f32 v49, v49, v53
  v_fmac_f32 v51, v53, v53
  v_and_b32 v54, 0xffff0000, v163
  v_lshlrev_b32 v55, 16, v163
  v_mfma_f32_16x16x32_bf16 v[36:39], v[60:63], v[132:135], v[36:39]
  ds_read_b64_tr_b16 v[142:143], v4 offset:37888
  v_add_f32 v48, v48, v54
  v_fmac_f32 v50, v54, v54
  v_add_f32 v49, v49, v55
  v_fmac_f32 v51, v55, v55
  s_waitcnt lgkmcnt(0)
  v_mfma_f32_32x32x16_bf16 v[64:79], v[168:171], v[136:139], v[64:79]
  ds_read_b128 v[160:163], v196 offset:32768
  v_and_b32 v52, 0xffff0000, v168
  v_lshlrev_b32 v53, 16, v168
  v_add_f32 v48, v48, v52
  v_fmac_f32 v50, v52, v52
  v_mfma_f32_32x32x16_bf16 v[80:95], v[172:175], v[136:139], v[80:95]
  ds_read_b128 v[164:167], v204 offset:32768
  v_add_f32 v49, v49, v53
  v_fmac_f32 v51, v53, v53
  v_and_b32 v54, 0xffff0000, v169
  v_lshlrev_b32 v55, 16, v169
  v_mfma_f32_16x16x32_bf16 v[32:35], v[60:63], v[136:139], v[32:35]
  ds_read_b64_tr_b16 v[128:129], v2 offset:40960
  v_add_f32 v48, v48, v54
  v_fmac_f32 v50, v54, v54
  v_add_f32 v49, v49, v55
  v_fmac_f32 v51, v55, v55
  v_mfma_f32_32x32x16_bf16 v[96:111], v[168:171], v[140:143], v[96:111]
  ds_read_b64_tr_b16 v[130:131], v2 offset:41984
  v_and_b32 v52, 0xffff0000, v170
  v_lshlrev_b32 v53, 16, v170
  v_add_f32 v48, v48, v52
  v_fmac_f32 v50, v52, v52
  v_mfma_f32_32x32x16_bf16 v[112:127], v[172:175], v[140:143], v[112:127]
  ds_read_b64_tr_b16 v[132:133], v4 offset:40960
  v_add_f32 v49, v49, v53
  v_fmac_f32 v51, v53, v53
  v_and_b32 v54, 0xffff0000, v171
  v_lshlrev_b32 v55, 16, v171
  v_mfma_f32_16x16x32_bf16 v[36:39], v[60:63], v[140:143], v[36:39]
  ds_read_b64_tr_b16 v[134:135], v4 offset:41984
  v_add_f32 v48, v48, v54
  v_fmac_f32 v50, v54, v54
  v_add_f32 v49, v49, v55
  v_fmac_f32 v51, v55, v55
  s_waitcnt lgkmcnt(0)
  v_mfma_f32_32x32x16_bf16 v[64:79], v[160:163], v[128:131], v[64:79]
  ds_read_b128 v[168:171], v198 offset:32768
  v_and_b32 v52, 0xffff0000, v160
  v_lshlrev_b32 v53, 16, v160
  v_add_f32 v48, v48, v52
  v_fmac_f32 v50, v52, v52
  v_mfma_f32_32x32x16_bf16 v[80:95], v[164:167], v[128:131], v[80:95]
  ds_read_b128 v[172:175], v206 offset:32768
  v_add_f32 v49, v49, v53
  v_fmac_f32 v51, v53, v53
  v_and_b32 v54, 0xffff0000, v161
  v_lshlrev_b32 v55, 16, v161
  v_mfma_f32_16x16x32_bf16 v[32:35], v[60:63], v[128:131], v[32:35]
  ds_read_b64_tr_b16 v[136:137], v2 offset:45056
  v_add_f32 v48, v48, v54
  v_fmac_f32 v50, v54, v54
  v_add_f32 v49, v49, v55
  v_fmac_f32 v51, v55, v55
  v_mfma_f32_32x32x16_bf16 v[96:111], v[160:163], v[132:135], v[96:111]
  ds_read_b64_tr_b16 v[138:139], v2 offset:46080
  v_and_b32 v52, 0xffff0000, v162
  v_lshlrev_b32 v53, 16, v162
  v_add_f32 v48, v48, v52
  v_fmac_f32 v50, v52, v52
  v_mfma_f32_32x32x16_bf16 v[112:127], v[164:167], v[132:135], v[112:127]
  ds_read_b64_tr_b16 v[140:141], v4 offset:45056
  v_add_f32 v49, v49, v53
  v_fmac_f32 v51, v53, v53
  v_and_b32 v54, 0xffff0000, v163
  v_lshlrev_b32 v55, 16, v163
  v_mfma_f32_16x16x32_bf16 v[36:39], v[60:63], v[132:135], v[36:39]
  ds_read_b64_tr_b16 v[142:143], v4 offset:46080
  v_add_f32 v48, v48, v54
  v_fmac_f32 v50, v54, v54
  v_add_f32 v49, v49, v55
  v_fmac_f32 v51, v55, v55
  s_waitcnt lgkmcnt(0)
  s_barrier
  v_mfma_f32_32x32x16_bf16 v[64:79], v[168:171], v[136:139], v[64:79]
  ds_read_b128 v[160:163], v193 offset:0
  v_and_b32 v52, 0xffff0000, v168
  v_lshlrev_b32 v53, 16, v168
  v_add_f32 v48, v48, v52
  v_fmac_f32 v50, v52, v52
  v_mfma_f32_32x32x16_bf16 v[80:95], v[172:175], v[136:139], v[80:95]
  ds_read_b128 v[164:167], v201 offset:0
  v_add_f32 v49, v49, v53
  v_fmac_f32 v51, v53, v53
  v_and_b32 v54, 0xffff0000, v169
  v_lshlrev_b32 v55, 16, v169
  v_mfma_f32_16x16x32_bf16 v[32:35], v[60:63], v[136:139], v[32:35]
  ds_read_b64_tr_b16 v[128:129], v3 offset:0
  v_add_f32 v48, v48, v54
  v_fmac_f32 v50, v54, v54
  v_add_f32 v49, v49, v55
  v_fmac_f32 v51, v55, v55
  v_mfma_f32_32x32x16_bf16 v[96:111], v[168:171], v[140:143], v[96:111]
  ds_read_b64_tr_b16 v[130:131], v3 offset:1024
  v_and_b32 v52, 0xffff0000, v170
  v_lshlrev_b32 v53, 16, v170
  v_add_f32 v48, v48, v52
  v_fmac_f32 v50, v52, v52
  v_mfma_f32_32x32x16_bf16 v[112:127], v[172:175], v[140:143], v[112:127]
  ds_read_b64_tr_b16 v[132:133], v5 offset:0
  v_add_f32 v49, v49, v53
  v_fmac_f32 v51, v53, v53
  v_and_b32 v54, 0xffff0000, v171
  v_lshlrev_b32 v55, 16, v171
  v_mfma_f32_16x16x32_bf16 v[36:39], v[60:63], v[140:143], v[36:39]
  ds_read_b64_tr_b16 v[134:135], v5 offset:1024
  v_add_f32 v48, v48, v54
  v_fmac_f32 v50, v54, v54
  v_add_f32 v49, v49, v55
  v_fmac_f32 v51, v55, v55
  s_waitcnt lgkmcnt(0)
  v_mfma_f32_32x32x16_bf16 v[64:79], v[160:163], v[128:131], v[64:79]
  ds_read_b128 v[168:171], v195 offset:0
  v_and_b32 v52, 0xffff0000, v160
  v_lshlrev_b32 v53, 16, v160
  v_add_f32 v48, v48, v52
  v_fmac_f32 v50, v52, v52
  v_mfma_f32_32x32x16_bf16 v[80:95], v[164:167], v[128:131], v[80:95]
  ds_read_b128 v[172:175], v203 offset:0
  v_add_f32 v49, v49, v53
  v_fmac_f32 v51, v53, v53
  v_and_b32 v54, 0xffff0000, v161
  v_lshlrev_b32 v55, 16, v161
  v_mfma_f32_16x16x32_bf16 v[32:35], v[60:63], v[128:131], v[32:35]
  ds_read_b64_tr_b16 v[136:137], v3 offset:4096
  v_add_f32 v48, v48, v54
  v_fmac_f32 v50, v54, v54
  v_add_f32 v49, v49, v55
  v_fmac_f32 v51, v55, v55
  v_mfma_f32_32x32x16_bf16 v[96:111], v[160:163], v[132:135], v[96:111]
  ds_read_b64_tr_b16 v[138:139], v3 offset:5120
  v_and_b32 v52, 0xffff0000, v162
  v_lshlrev_b32 v53, 16, v162
  v_add_f32 v48, v48, v52
  v_fmac_f32 v50, v52, v52
  v_mfma_f32_32x32x16_bf16 v[112:127], v[164:167], v[132:135], v[112:127]
  ds_read_b64_tr_b16 v[140:141], v5 offset:4096
  v_add_f32 v49, v49, v53
  v_fmac_f32 v51, v53, v53
  v_and_b32 v54, 0xffff0000, v163
  v_lshlrev_b32 v55, 16, v163
  v_mfma_f32_16x16x32_bf16 v[36:39], v[60:63], v[132:135], v[36:39]
  ds_read_b64_tr_b16 v[142:143], v5 offset:5120
  v_add_f32 v48, v48, v54
  v_fmac_f32 v50, v54, v54
  v_add_f32 v49, v49, v55
  v_fmac_f32 v51, v55, v55
  s_waitcnt lgkmcnt(0)
  v_mfma_f32_32x32x16_bf16 v[64:79], v[168:171], v[136:139], v[64:79]
  ds_read_b128 v[160:163], v197 offset:0
  v_and_b32 v52, 0xffff0000, v168
  v_lshlrev_b32 v53, 16, v168
  v_add_f32 v48, v48, v52
  v_fmac_f32 v50, v52, v52
  v_mfma_f32_32x32x16_bf16 v[80:95], v[172:175], v[136:139], v[80:95]
  ds_read_b128 v[164:167], v205 offset:0
  v_add_f32 v49, v49, v53
  v_fmac_f32 v51, v53, v53
  v_and_b32 v54, 0xffff0000, v169
  v_lshlrev_b32 v55, 16, v169
  v_mfma_f32_16x16x32_bf16 v[32:35], v[60:63], v[136:139], v[32:35]
  ds_read_b64_tr_b16 v[128:129], v3 offset:8192
  v_add_f32 v48, v48, v54
  v_fmac_f32 v50, v54, v54
  v_add_f32 v49, v49, v55
  v_fmac_f32 v51, v55, v55
  v_mfma_f32_32x32x16_bf16 v[96:111], v[168:171], v[140:143], v[96:111]
  ds_read_b64_tr_b16 v[130:131], v3 offset:9216
  v_and_b32 v52, 0xffff0000, v170
  v_lshlrev_b32 v53, 16, v170
  v_add_f32 v48, v48, v52
  v_fmac_f32 v50, v52, v52
  v_mfma_f32_32x32x16_bf16 v[112:127], v[172:175], v[140:143], v[112:127]
  ds_read_b64_tr_b16 v[132:133], v5 offset:8192
  v_add_f32 v49, v49, v53
  v_fmac_f32 v51, v53, v53
  v_and_b32 v54, 0xffff0000, v171
  v_lshlrev_b32 v55, 16, v171
  v_mfma_f32_16x16x32_bf16 v[36:39], v[60:63], v[140:143], v[36:39]
  ds_read_b64_tr_b16 v[134:135], v5 offset:9216
  v_add_f32 v48, v48, v54
  v_fmac_f32 v50, v54, v54
  v_add_f32 v49, v49, v55
  v_fmac_f32 v51, v55, v55
  s_waitcnt lgkmcnt(0)
  v_mfma_f32_32x32x16_bf16 v[64:79], v[160:163], v[128:131], v[64:79]
  ds_read_b128 v[168:171], v199 offset:0
  v_and_b32 v52, 0xffff0000, v160
  v_lshlrev_b32 v53, 16, v160
  v_add_f32 v48, v48, v52
  v_fmac_f32 v50, v52, v52
  v_mfma_f32_32x32x16_bf16 v[80:95], v[164:167], v[128:131], v[80:95]
  ds_read_b128 v[172:175], v207 offset:0
  v_add_f32 v49, v49, v53
  v_fmac_f32 v51, v53, v53
  v_and_b32 v54, 0xffff0000, v161
  v_lshlrev_b32 v55, 16, v161
  v_mfma_f32_16x16x32_bf16 v[32:35], v[60:63], v[128:131], v[32:35]
  ds_read_b64_tr_b16 v[136:137], v3 offset:12288
  v_add_f32 v48, v48, v54
  v_fmac_f32 v50, v54, v54
  v_add_f32 v49, v49, v55
  v_fmac_f32 v51, v55, v55
  v_mfma_f32_32x32x16_bf16 v[96:111], v[160:163], v[132:135], v[96:111]
  ds_read_b64_tr_b16 v[138:139], v3 offset:13312
  v_and_b32 v52, 0xffff0000, v162
  v_lshlrev_b32 v53, 16, v162
  v_add_f32 v48, v48, v52
  v_fmac_f32 v50, v52, v52
  v_mfma_f32_32x32x16_bf16 v[112:127], v[164:167], v[132:135], v[112:127]
  ds_read_b64_tr_b16 v[140:141], v5 offset:12288
  v_add_f32 v49, v49, v53
  v_fmac_f32 v51, v53, v53
  v_and_b32 v54, 0xffff0000, v163
  v_lshlrev_b32 v55, 16, v163
  v_mfma_f32_16x16x32_bf16 v[36:39], v[60:63], v[132:135], v[36:39]
  ds_read_b64_tr_b16 v[142:143], v5 offset:13312
  v_add_f32 v48, v48, v54
  v_fmac_f32 v50, v54, v54
  v_add_f32 v49, v49, v55
  v_fmac_f32 v51, v55, v55
  s_waitcnt lgkmcnt(0)
  s_barrier
  v_mfma_f32_32x32x16_bf16 v[64:79], v[168:171], v[136:139], v[64:79]
  ds_read_b128 v[160:163], v193 offset:32768
  v_and_b32 v52, 0xffff0000, v168
  v_lshlrev_b32 v53, 16, v168
  v_add_f32 v48, v48, v52
  v_fmac_f32 v50, v52, v52
  v_mfma_f32_32x32x16_bf16 v[80:95], v[172:175], v[136:139], v[80:95]
  ds_read_b128 v[164:167], v201 offset:32768
  v_add_f32 v49, v49, v53
  v_fmac_f32 v51, v53, v53
  v_and_b32 v54, 0xffff0000, v169
  v_lshlrev_b32 v55, 16, v169
  v_mfma_f32_16x16x32_bf16 v[32:35], v[60:63], v[136:139], v[32:35]
  ds_read_b64_tr_b16 v[128:129], v3 offset:32768
  v_add_f32 v48, v48, v54
  v_fmac_f32 v50, v54, v54
  v_add_f32 v49, v49, v55
  v_fmac_f32 v51, v55, v55
  v_mfma_f32_32x32x16_bf16 v[96:111], v[168:171], v[140:143], v[96:111]
  ds_read_b64_tr_b16 v[130:131], v3 offset:33792
  v_and_b32 v52, 0xffff0000, v170
  v_lshlrev_b32 v53, 16, v170
  v_add_f32 v48, v48, v52
  v_fmac_f32 v50, v52, v52
  v_mfma_f32_32x32x16_bf16 v[112:127], v[172:175], v[140:143], v[112:127]
  ds_read_b64_tr_b16 v[132:133], v5 offset:32768
  v_add_f32 v49, v49, v53
  v_fmac_f32 v51, v53, v53
  v_and_b32 v54, 0xffff0000, v171
  v_lshlrev_b32 v55, 16, v171
  v_mfma_f32_16x16x32_bf16 v[36:39], v[60:63], v[140:143], v[36:39]
  ds_read_b64_tr_b16 v[134:135], v5 offset:33792
  v_add_f32 v48, v48, v54
  v_fmac_f32 v50, v54, v54
  v_add_f32 v49, v49, v55
  v_fmac_f32 v51, v55, v55
  s_waitcnt lgkmcnt(0)
  v_mfma_f32_32x32x16_bf16 v[64:79], v[160:163], v[128:131], v[64:79]
  ds_read_b128 v[168:171], v195 offset:32768
  v_and_b32 v52, 0xffff0000, v160
  v_lshlrev_b32 v53, 16, v160
  v_add_f32 v48, v48, v52
  v_fmac_f32 v50, v52, v52
  v_mfma_f32_32x32x16_bf16 v[80:95], v[164:167], v[128:131], v[80:95]
  ds_read_b128 v[172:175], v203 offset:32768
  v_add_f32 v49, v49, v53
  v_fmac_f32 v51, v53, v53
  v_and_b32 v54, 0xffff0000, v161
  v_lshlrev_b32 v55, 16, v161
  v_mfma_f32_16x16x32_bf16 v[32:35], v[60:63], v[128:131], v[32:35]
  ds_read_b64_tr_b16 v[136:137], v3 offset:36864
  v_add_f32 v48, v48, v54
  v_fmac_f32 v50, v54, v54
  v_add_f32 v49, v49, v55
  v_fmac_f32 v51, v55, v55
  v_mfma_f32_32x32x16_bf16 v[96:111], v[160:163], v[132:135], v[96:111]
  ds_read_b64_tr_b16 v[138:139], v3 offset:37888
  v_and_b32 v52, 0xffff0000, v162
  v_lshlrev_b32 v53, 16, v162
  v_add_f32 v48, v48, v52
  v_fmac_f32 v50, v52, v52
  v_mfma_f32_32x32x16_bf16 v[112:127], v[164:167], v[132:135], v[112:127]
  ds_read_b64_tr_b16 v[140:141], v5 offset:36864
  v_add_f32 v49, v49, v53
  v_fmac_f32 v51, v53, v53
  v_and_b32 v54, 0xffff0000, v163
  v_lshlrev_b32 v55, 16, v163
  v_mfma_f32_16x16x32_bf16 v[36:39], v[60:63], v[132:135], v[36:39]
  ds_read_b64_tr_b16 v[142:143], v5 offset:37888
  v_add_f32 v48, v48, v54
  v_fmac_f32 v50, v54, v54
  v_add_f32 v49, v49, v55
  v_fmac_f32 v51, v55, v55
  s_waitcnt lgkmcnt(0)
  v_mfma_f32_32x32x16_bf16 v[64:79], v[168:171], v[136:139], v[64:79]
  ds_read_b128 v[160:163], v197 offset:32768
  v_and_b32 v52, 0xffff0000, v168
  v_lshlrev_b32 v53, 16, v168
  v_add_f32 v48, v48, v52
  v_fmac_f32 v50, v52, v52
  v_mfma_f32_32x32x16_bf16 v[80:95], v[172:175], v[136:139], v[80:95]
  ds_read_b128 v[164:167], v205 offset:32768
  v_add_f32 v49, v49, v53
  v_fmac_f32 v51, v53, v53
  v_and_b32 v54, 0xffff0000, v169
  v_lshlrev_b32 v55, 16, v169
  v_mfma_f32_16x16x32_bf16 v[32:35], v[60:63], v[136:139], v[32:35]
  ds_read_b64_tr_b16 v[128:129], v3 offset:40960
  v_add_f32 v48, v48, v54
  v_fmac_f32 v50, v54, v54
  v_add_f32 v49, v49, v55
  v_fmac_f32 v51, v55, v55
  v_mfma_f32_32x32x16_bf16 v[96:111], v[168:171], v[140:143], v[96:111]
  ds_read_b64_tr_b16 v[130:131], v3 offset:41984
  v_and_b32 v52, 0xffff0000, v170
  v_lshlrev_b32 v53, 16, v170
  v_add_f32 v48, v48, v52
  v_fmac_f32 v50, v52, v52
  v_mfma_f32_32x32x16_bf16 v[112:127], v[172:175], v[140:143], v[112:127]
  ds_read_b64_tr_b16 v[132:133], v5 offset:40960
  v_add_f32 v49, v49, v53
  v_fmac_f32 v51, v53, v53
  v_and_b32 v54, 0xffff0000, v171
  v_lshlrev_b32 v55, 16, v171
  v_mfma_f32_16x16x32_bf16 v[36:39], v[60:63], v[140:143], v[36:39]
  ds_read_b64_tr_b16 v[134:135], v5 offset:41984
  v_add_f32 v48, v48, v54
  v_fmac_f32 v50, v54, v54
  v_add_f32 v49, v49, v55
  v_fmac_f32 v51, v55, v55
  s_waitcnt lgkmcnt(0)
  v_mfma_f32_32x32x16_bf16 v[64:79], v[160:163], v[128:131], v[64:79]
  ds_read_b128 v[168:171], v199 offset:32768
  v_and_b32 v52, 0xffff0000, v160
  v_lshlrev_b32 v53, 16, v160
  v_add_f32 v48, v48, v52
  v_fmac_f32 v50, v52, v52
  v_mfma_f32_32x32x16_bf16 v[80:95], v[164:167], v[128:131], v[80:95]
  ds_read_b128 v[172:175], v207 offset:32768
  v_add_f32 v49, v49, v53
  v_fmac_f32 v51, v53, v53
  v_and_b32 v54, 0xffff0000, v161
  v_lshlrev_b32 v55, 16, v161
  v_mfma_f32_16x16x32_bf16 v[32:35], v[60:63], v[128:131], v[32:35]
  ds_read_b64_tr_b16 v[136:137], v3 offset:45056
  v_add_f32 v48, v48, v54
  v_fmac_f32 v50, v54, v54
  v_add_f32 v49, v49, v55
  v_fmac_f32 v51, v55, v55
  v_mfma_f32_32x32x16_bf16 v[96:111], v[160:163], v[132:135], v[96:111]
  ds_read_b64_tr_b16 v[138:139], v3 offset:46080
  v_and_b32 v52, 0xffff0000, v162
  v_lshlrev_b32 v53, 16, v162
  v_add_f32 v48, v48, v52
  v_fmac_f32 v50, v52, v52
  v_mfma_f32_32x32x16_bf16 v[112:127], v[164:167], v[132:135], v[112:127]
  ds_read_b64_tr_b16 v[140:141], v5 offset:45056
  v_add_f32 v49, v49, v53
  v_fmac_f32 v51, v53, v53
  v_and_b32 v54, 0xffff0000, v163
  v_lshlrev_b32 v55, 16, v163
  v_mfma_f32_16x16x32_bf16 v[36:39], v[60:63], v[132:135], v[36:39]
  ds_read_b64_tr_b16 v[142:143], v5 offset:46080
  v_add_f32 v48, v48, v54
  v_fmac_f32 v50, v54, v54
  v_add_f32 v49, v49, v55
  v_fmac_f32 v51, v55, v55
  s_waitcnt lgkmcnt(0)
  s_barrier
  v_mfma_f32_32x32x16_bf16 v[64:79], v[168:171], v[136:139], v[64:79]
  ds_read_b128 v[160:163], v192 offset:0
  v_and_b32 v52, 0xffff0000, v168
  v_lshlrev_b32 v53, 16, v168
  v_add_f32 v48, v48, v52
  v_fmac_f32 v50, v52, v52
  v_mfma_f32_32x32x16_bf16 v[80:95], v[172:175], v[136:139], v[80:95]
  ds_read_b128 v[164:167], v200 offset:0
  v_add_f32 v49, v49, v53
  v_fmac_f32 v51, v53, v53
  v_and_b32 v54, 0xffff0000, v169
  v_lshlrev_b32 v55, 16, v169
  v_mfma_f32_16x16x32_bf16 v[32:35], v[60:63], v[136:139], v[32:35]
  ds_read_b64_tr_b16 v[128:129], v2 offset:0
  v_add_f32 v48, v48, v54
  v_fmac_f32 v50, v54, v54
  v_add_f32 v49, v49, v55
  v_fmac_f32 v51, v55, v55
  v_mfma_f32_32x32x16_bf16 v[96:111], v[168:171], v[140:143], v[96:111]
  ds_read_b64_tr_b16 v[130:131], v2 offset:1024
  v_and_b32 v52, 0xffff0000, v170
  v_lshlrev_b32 v53, 16, v170
  v_add_f32 v48, v48, v52
  v_fmac_f32 v50, v52, v52
  v_mfma_f32_32x32x16_bf16 v[112:127], v[172:175], v[140:143], v[112:127]
  ds_read_b64_tr_b16 v[132:133], v4 offset:0
  v_add_f32 v49, v49, v53
  v_fmac_f32 v51, v53, v53
  v_and_b32 v54, 0xffff0000, v171
  v_lshlrev_b32 v55, 16, v171
  v_mfma_f32_16x16x32_bf16 v[36:39], v[60:63], v[140:143], v[36:39]
  ds_read_b64_tr_b16 v[134:135], v4 offset:1024
  v_add_f32 v48, v48, v54
  v_fmac_f32 v50, v54, v54
  v_add_f32 v49, v49, v55
  v_fmac_f32 v51, v55, v55
  s_waitcnt lgkmcnt(0)
  v_mfma_f32_32x32x16_bf16 v[64:79], v[160:163], v[128:131], v[64:79]
  ds_read_b128 v[168:171], v194 offset:0
  v_and_b32 v52, 0xffff0000, v160
  v_lshlrev_b32 v53, 16, v160
  v_add_f32 v48, v48, v52
  v_fmac_f32 v50, v52, v52
  v_mfma_f32_32x32x16_bf16 v[80:95], v[164:167], v[128:131], v[80:95]
  ds_read_b128 v[172:175], v202 offset:0
  v_add_f32 v49, v49, v53
  v_fmac_f32 v51, v53, v53
  v_and_b32 v54, 0xffff0000, v161
  v_lshlrev_b32 v55, 16, v161
  v_mfma_f32_16x16x32_bf16 v[32:35], v[60:63], v[128:131], v[32:35]
  ds_read_b64_tr_b16 v[136:137], v2 offset:4096
  v_add_f32 v48, v48, v54
  v_fmac_f32 v50, v54, v54
  v_add_f32 v49, v49, v55
  v_fmac_f32 v51, v55, v55
  v_mfma_f32_32x32x16_bf16 v[96:111], v[160:163], v[132:135], v[96:111]
  ds_read_b64_tr_b16 v[138:139], v2 offset:5120
  v_and_b32 v52, 0xffff0000, v162
  v_lshlrev_b32 v53, 16, v162
  v_add_f32 v48, v48, v52
  v_fmac_f32 v50, v52, v52
  v_mfma_f32_32x32x16_bf16 v[112:127], v[164:167], v[132:135], v[112:127]
  ds_read_b64_tr_b16 v[140:141], v4 offset:4096
  v_add_f32 v49, v49, v53
  v_fmac_f32 v51, v53, v53
  v_and_b32 v54, 0xffff0000, v163
  v_lshlrev_b32 v55, 16, v163
  v_mfma_f32_16x16x32_bf16 v[36:39], v[60:63], v[132:135], v[36:39]
  ds_read_b64_tr_b16 v[142:143], v4 offset:5120
  v_add_f32 v48, v48, v54
  v_fmac_f32 v50, v54, v54
  v_add_f32 v49, v49, v55
  v_fmac_f32 v51, v55, v55
  s_waitcnt lgkmcnt(0)
  v_mfma_f32_32x32x16_bf16 v[64:79], v[168:171], v[136:139], v[64:79]
  ds_read_b128 v[160:163], v196 offset:0
  v_and_b32 v52, 0xffff0000, v168
  v_lshlrev_b32 v53, 16, v168
  v_add_f32 v48, v48, v52
  v_fmac_f32 v50, v52, v52
  v_mfma_f32_32x32x16_bf16 v[80:95], v[172:175], v[136:139], v[80:95]
  ds_read_b128 v[164:167], v204 offset:0
  v_add_f32 v49, v49, v53
  v_fmac_f32 v51, v53, v53
  v_and_b32 v54, 0xffff0000, v169
  v_lshlrev_b32 v55, 16, v169
  v_mfma_f32_16x16x32_bf16 v[32:35], v[60:63], v[136:139], v[32:35]
  ds_read_b64_tr_b16 v[128:129], v2 offset:8192
  v_add_f32 v48, v48, v54
  v_fmac_f32 v50, v54, v54
  v_add_f32 v49, v49, v55
  v_fmac_f32 v51, v55, v55
  v_mfma_f32_32x32x16_bf16 v[96:111], v[168:171], v[140:143], v[96:111]
  ds_read_b64_tr_b16 v[130:131], v2 offset:9216
  v_and_b32 v52, 0xffff0000, v170
  v_lshlrev_b32 v53, 16, v170
  v_add_f32 v48, v48, v52
  v_fmac_f32 v50, v52, v52
  v_mfma_f32_32x32x16_bf16 v[112:127], v[172:175], v[140:143], v[112:127]
  ds_read_b64_tr_b16 v[132:133], v4 offset:8192
  v_add_f32 v49, v49, v53
  v_fmac_f32 v51, v53, v53
  v_and_b32 v54, 0xffff0000, v171
  v_lshlrev_b32 v55, 16, v171
  v_mfma_f32_16x16x32_bf16 v[36:39], v[60:63], v[140:143], v[36:39]
  ds_read_b64_tr_b16 v[134:135], v4 offset:9216
  v_add_f32 v48, v48, v54
  v_fmac_f32 v50, v54, v54
  v_add_f32 v49, v49, v55
  v_fmac_f32 v51, v55, v55
  s_waitcnt lgkmcnt(0)
  v_mfma_f32_32x32x16_bf16 v[64:79], v[160:163], v[128:131], v[64:79]
  ds_read_b128 v[168:171], v198 offset:0
  v_and_b32 v52, 0xffff0000, v160
  v_lshlrev_b32 v53, 16, v160
  v_add_f32 v48, v48, v52
  v_fmac_f32 v50, v52, v52
  v_mfma_f32_32x32x16_bf16 v[80:95], v[164:167], v[128:131], v[80:95]
  ds_read_b128 v[172:175], v206 offset:0
  v_add_f32 v49, v49, v53
  v_fmac_f32 v51, v53, v53
  v_and_b32 v54, 0xffff0000, v161
  v_lshlrev_b32 v55, 16, v161
  v_mfma_f32_16x16x32_bf16 v[32:35], v[60:63], v[128:131], v[32:35]
  ds_read_b64_tr_b16 v[136:137], v2 offset:12288
  v_add_f32 v48, v48, v54
  v_fmac_f32 v50, v54, v54
  v_add_f32 v49, v49, v55
  v_fmac_f32 v51, v55, v55
  v_mfma_f32_32x32x16_bf16 v[96:111], v[160:163], v[132:135], v[96:111]
  ds_read_b64_tr_b16 v[138:139], v2 offset:13312
  v_and_b32 v52, 0xffff0000, v162
  v_lshlrev_b32 v53, 16, v162
  v_add_f32 v48, v48, v52
  v_fmac_f32 v50, v52, v52
  v_mfma_f32_32x32x16_bf16 v[112:127], v[164:167], v[132:135], v[112:127]
  ds_read_b64_tr_b16 v[140:141], v4 offset:12288
  v_add_f32 v49, v49, v53
  v_fmac_f32 v51, v53, v53
  v_and_b32 v54, 0xffff0000, v163
  v_lshlrev_b32 v55, 16, v163
  v_mfma_f32_16x16x32_bf16 v[36:39], v[60:63], v[132:135], v[36:39]
  ds_read_b64_tr_b16 v[142:143], v4 offset:13312
  v_add_f32 v48, v48, v54
  v_fmac_f32 v50, v54, v54
  v_add_f32 v49, v49, v55
  v_fmac_f32 v51, v55, v55
  s_waitcnt lgkmcnt(0)
  s_barrier
  v_mfma_f32_32x32x16_bf16 v[64:79], v[168:171], v[136:139], v[64:79]
  ds_read_b128 v[160:163], v192 offset:32768
  v_and_b32 v52, 0xffff0000, v168
  v_lshlrev_b32 v53, 16, v168
  v_add_f32 v48, v48, v52
  v_fmac_f32 v50, v52, v52
  v_mfma_f32_32x32x16_bf16 v[80:95], v[172:175], v[136:139], v[80:95]
  ds_read_b128 v[164:167], v200 offset:32768
  v_add_f32 v49, v49, v53
  v_fmac_f32 v51, v53, v53
  v_and_b32 v54, 0xffff0000, v169
  v_lshlrev_b32 v55, 16, v169
  v_mfma_f32_16x16x32_bf16 v[32:35], v[60:63], v[136:139], v[32:35]
  ds_read_b64_tr_b16 v[128:129], v2 offset:32768
  v_add_f32 v48, v48, v54
  v_fmac_f32 v50, v54, v54
  v_add_f32 v49, v49, v55
  v_fmac_f32 v51, v55, v55
  v_mfma_f32_32x32x16_bf16 v[96:111], v[168:171], v[140:143], v[96:111]
  ds_read_b64_tr_b16 v[130:131], v2 offset:33792
  v_and_b32 v52, 0xffff0000, v170
  v_lshlrev_b32 v53, 16, v170
  v_add_f32 v48, v48, v52
  v_fmac_f32 v50, v52, v52
  v_mfma_f32_32x32x16_bf16 v[112:127], v[172:175], v[140:143], v[112:127]
  ds_read_b64_tr_b16 v[132:133], v4 offset:32768
  v_add_f32 v49, v49, v53
  v_fmac_f32 v51, v53, v53
  v_and_b32 v54, 0xffff0000, v171
  v_lshlrev_b32 v55, 16, v171
  v_mfma_f32_16x16x32_bf16 v[36:39], v[60:63], v[140:143], v[36:39]
  ds_read_b64_tr_b16 v[134:135], v4 offset:33792
  v_add_f32 v48, v48, v54
  v_fmac_f32 v50, v54, v54
  v_add_f32 v49, v49, v55
  v_fmac_f32 v51, v55, v55
  s_waitcnt lgkmcnt(0)
  v_mfma_f32_32x32x16_bf16 v[64:79], v[160:163], v[128:131], v[64:79]
  ds_read_b128 v[168:171], v194 offset:32768
  v_and_b32 v52, 0xffff0000, v160
  v_lshlrev_b32 v53, 16, v160
  v_add_f32 v48, v48, v52
  v_fmac_f32 v50, v52, v52
  v_mfma_f32_32x32x16_bf16 v[80:95], v[164:167], v[128:131], v[80:95]
  ds_read_b128 v[172:175], v202 offset:32768
  v_add_f32 v49, v49, v53
  v_fmac_f32 v51, v53, v53
  v_and_b32 v54, 0xffff0000, v161
  v_lshlrev_b32 v55, 16, v161
  v_mfma_f32_16x16x32_bf16 v[32:35], v[60:63], v[128:131], v[32:35]
  ds_read_b64_tr_b16 v[136:137], v2 offset:36864
  v_add_f32 v48, v48, v54
  v_fmac_f32 v50, v54, v54
  v_add_f32 v49, v49, v55
  v_fmac_f32 v51, v55, v55
  v_mfma_f32_32x32x16_bf16 v[96:111], v[160:163], v[132:135], v[96:111]
  ds_read_b64_tr_b16 v[138:139], v2 offset:37888
  v_and_b32 v52, 0xffff0000, v162
  v_lshlrev_b32 v53, 16, v162
  v_add_f32 v48, v48, v52
  v_fmac_f32 v50, v52, v52
  v_mfma_f32_32x32x16_bf16 v[112:127], v[164:167], v[132:135], v[112:127]
  ds_read_b64_tr_b16 v[140:141], v4 offset:36864
  v_add_f32 v49, v49, v53
  v_fmac_f32 v51, v53, v53
  v_and_b32 v54, 0xffff0000, v163
  v_lshlrev_b32 v55, 16, v163
  v_mfma_f32_16x16x32_bf16 v[36:39], v[60:63], v[132:135], v[36:39]
  ds_read_b64_tr_b16 v[142:143], v4 offset:37888
  v_add_f32 v48, v48, v54
  v_fmac_f32 v50, v54, v54
  v_add_f32 v49, v49, v55
  v_fmac_f32 v51, v55, v55
  s_waitcnt lgkmcnt(0)
  v_mfma_f32_32x32x16_bf16 v[64:79], v[168:171], v[136:139], v[64:79]
  ds_read_b128 v[160:163], v196 offset:32768
  v_and_b32 v52, 0xffff0000, v168
  v_lshlrev_b32 v53, 16, v168
  v_add_f32 v48, v48, v52
  v_fmac_f32 v50, v52, v52
  v_mfma_f32_32x32x16_bf16 v[80:95], v[172:175], v[136:139], v[80:95]
  ds_read_b128 v[164:167], v204 offset:32768
  v_add_f32 v49, v49, v53
  v_fmac_f32 v51, v53, v53
  v_and_b32 v54, 0xffff0000, v169
  v_lshlrev_b32 v55, 16, v169
  v_mfma_f32_16x16x32_bf16 v[32:35], v[60:63], v[136:139], v[32:35]
  ds_read_b64_tr_b16 v[128:129], v2 offset:40960
  v_add_f32 v48, v48, v54
  v_fmac_f32 v50, v54, v54
  v_add_f32 v49, v49, v55
  v_fmac_f32 v51, v55, v55
  v_mfma_f32_32x32x16_bf16 v[96:111], v[168:171], v[140:143], v[96:111]
  ds_read_b64_tr_b16 v[130:131], v2 offset:41984
  v_and_b32 v52, 0xffff0000, v170
  v_lshlrev_b32 v53, 16, v170
  v_add_f32 v48, v48, v52
  v_fmac_f32 v50, v52, v52
  v_mfma_f32_32x32x16_bf16 v[112:127], v[172:175], v[140:143], v[112:127]
  ds_read_b64_tr_b16 v[132:133], v4 offset:40960
  v_add_f32 v49, v49, v53
  v_fmac_f32 v51, v53, v53
  v_and_b32 v54, 0xffff0000, v171
  v_lshlrev_b32 v55, 16, v171
  v_mfma_f32_16x16x32_bf16 v[36:39], v[60:63], v[140:143], v[36:39]
  ds_read_b64_tr_b16 v[134:135], v4 offset:41984
  v_add_f32 v48, v48, v54
  v_fmac_f32 v50, v54, v54
  v_add_f32 v49, v49, v55
  v_fmac_f32 v51, v55, v55
  s_waitcnt lgkmcnt(0)
  v_mfma_f32_32x32x16_bf16 v[64:79], v[160:163], v[128:131], v[64:79]
  ds_read_b128 v[168:171], v198 offset:32768
  v_and_b32 v52, 0xffff0000, v160
  v_lshlrev_b32 v53, 16, v160
  v_add_f32 v48, v48, v52
  v_fmac_f32 v50, v52, v52
  v_mfma_f32_32x32x16_bf16 v[80:95], v[164:167], v[128:131], v[80:95]
  ds_read_b128 v[172:175], v206 offset:32768
  v_add_f32 v49, v49, v53
  v_fmac_f32 v51, v53, v53
  v_and_b32 v54, 0xffff0000, v161
  v_lshlrev_b32 v55, 16, v161
  v_mfma_f32_16x16x32_bf16 v[32:35], v[60:63], v[128:131], v[32:35]
  ds_read_b64_tr_b16 v[136:137], v2 offset:45056
  v_add_f32 v48, v48, v54
  v_fmac_f32 v50, v54, v54
  v_add_f32 v49, v49, v55
  v_fmac_f32 v51, v55, v55
  v_mfma_f32_32x32x16_bf16 v[96:111], v[160:163], v[132:135], v[96:111]
  ds_read_b64_tr_b16 v[138:139], v2 offset:46080
  v_and_b32 v52, 0xffff0000, v162
  v_lshlrev_b32 v53, 16, v162
  v_add_f32 v48, v48, v52
  v_fmac_f32 v50, v52, v52
  v_mfma_f32_32x32x16_bf16 v[112:127], v[164:167], v[132:135], v[112:127]
  ds_read_b64_tr_b16 v[140:141], v4 offset:45056
  v_add_f32 v49, v49, v53
  v_fmac_f32 v51, v53, v53
  v_and_b32 v54, 0xffff0000, v163
  v_lshlrev_b32 v55, 16, v163
  v_mfma_f32_16x16x32_bf16 v[36:39], v[60:63], v[132:135], v[36:39]
  ds_read_b64_tr_b16 v[142:143], v4 offset:46080
  v_add_f32 v48, v48, v54
  v_fmac_f32 v50, v54, v54
  v_add_f32 v49, v49, v55
  v_fmac_f32 v51, v55, v55
  s_waitcnt lgkmcnt(0)
  s_barrier
  v_mfma_f32_32x32x16_bf16 v[64:79], v[168:171], v[136:139], v[64:79]
  ds_read_b128 v[160:163], v193 offset:0
  v_and_b32 v52, 0xffff0000, v168
  v_lshlrev_b32 v53, 16, v168
  v_add_f32 v48, v48, v52
  v_fmac_f32 v50, v52, v52
  v_mfma_f32_32x32x16_bf16 v[80:95], v[172:175], v[136:139], v[80:95]
  ds_read_b128 v[164:167], v201 offset:0
  v_add_f32 v49, v49, v53
  v_fmac_f32 v51, v53, v53
  v_and_b32 v54, 0xffff0000, v169
  v_lshlrev_b32 v55, 16, v169
  v_mfma_f32_16x16x32_bf16 v[32:35], v[60:63], v[136:139], v[32:35]
  ds_read_b64_tr_b16 v[128:129], v3 offset:0
  v_add_f32 v48, v48, v54
  v_fmac_f32 v50, v54, v54
  v_add_f32 v49, v49, v55
  v_fmac_f32 v51, v55, v55
  v_mfma_f32_32x32x16_bf16 v[96:111], v[168:171], v[140:143], v[96:111]
  ds_read_b64_tr_b16 v[130:131], v3 offset:1024
  v_and_b32 v52, 0xffff0000, v170
  v_lshlrev_b32 v53, 16, v170
  v_add_f32 v48, v48, v52
  v_fmac_f32 v50, v52, v52
  v_mfma_f32_32x32x16_bf16 v[112:127], v[172:175], v[140:143], v[112:127]
  ds_read_b64_tr_b16 v[132:133], v5 offset:0
  v_add_f32 v49, v49, v53
  v_fmac_f32 v51, v53, v53
  v_and_b32 v54, 0xffff0000, v171
  v_lshlrev_b32 v55, 16, v171
  v_mfma_f32_16x16x32_bf16 v[36:39], v[60:63], v[140:143], v[36:39]
  ds_read_b64_tr_b16 v[134:135], v5 offset:1024
  v_add_f32 v48, v48, v54
  v_fmac_f32 v50, v54, v54
  v_add_f32 v49, v49, v55
  v_fmac_f32 v51, v55, v55
  s_waitcnt lgkmcnt(0)
  v_mfma_f32_32x32x16_bf16 v[64:79], v[160:163], v[128:131], v[64:79]
  ds_read_b128 v[168:171], v195 offset:0
  v_and_b32 v52, 0xffff0000, v160
  v_lshlrev_b32 v53, 16, v160
  v_add_f32 v48, v48, v52
  v_fmac_f32 v50, v52, v52
  v_mfma_f32_32x32x16_bf16 v[80:95], v[164:167], v[128:131], v[80:95]
  ds_read_b128 v[172:175], v203 offset:0
  v_add_f32 v49, v49, v53
  v_fmac_f32 v51, v53, v53
  v_and_b32 v54, 0xffff0000, v161
  v_lshlrev_b32 v55, 16, v161
  v_mfma_f32_16x16x32_bf16 v[32:35], v[60:63], v[128:131], v[32:35]
  ds_read_b64_tr_b16 v[136:137], v3 offset:4096
  v_add_f32 v48, v48, v54
  v_fmac_f32 v50, v54, v54
  v_add_f32 v49, v49, v55
  v_fmac_f32 v51, v55, v55
  v_mfma_f32_32x32x16_bf16 v[96:111], v[160:163], v[132:135], v[96:111]
  ds_read_b64_tr_b16 v[138:139], v3 offset:5120
  v_and_b32 v52, 0xffff0000, v162
  v_lshlrev_b32 v53, 16, v162
  v_add_f32 v48, v48, v52
  v_fmac_f32 v50, v52, v52
  v_mfma_f32_32x32x16_bf16 v[112:127], v[164:167], v[132:135], v[112:127]
  ds_read_b64_tr_b16 v[140:141], v5 offset:4096
  v_add_f32 v49, v49, v53
  v_fmac_f32 v51, v53, v53
  v_and_b32 v54, 0xffff0000, v163
  v_lshlrev_b32 v55, 16, v163
  v_mfma_f32_16x16x32_bf16 v[36:39], v[60:63], v[132:135], v[36:39]
  ds_read_b64_tr_b16 v[142:143], v5 offset:5120
  v_add_f32 v48, v48, v54
  v_fmac_f32 v50, v54, v54
  v_add_f32 v49, v49, v55
  v_fmac_f32 v51, v55, v55
  s_waitcnt lgkmcnt(0)
  v_mfma_f32_32x32x16_bf16 v[64:79], v[168:171], v[136:139], v[64:79]
  ds_read_b128 v[160:163], v197 offset:0
  v_and_b32 v52, 0xffff0000, v168
  v_lshlrev_b32 v53, 16, v168
  v_add_f32 v48, v48, v52
  v_fmac_f32 v50, v52, v52
  v_mfma_f32_32x32x16_bf16 v[80:95], v[172:175], v[136:139], v[80:95]
  ds_read_b128 v[164:167], v205 offset:0
  v_add_f32 v49, v49, v53
  v_fmac_f32 v51, v53, v53
  v_and_b32 v54, 0xffff0000, v169
  v_lshlrev_b32 v55, 16, v169
  v_mfma_f32_16x16x32_bf16 v[32:35], v[60:63], v[136:139], v[32:35]
  ds_read_b64_tr_b16 v[128:129], v3 offset:8192
  v_add_f32 v48, v48, v54
  v_fmac_f32 v50, v54, v54
  v_add_f32 v49, v49, v55
  v_fmac_f32 v51, v55, v55
  v_mfma_f32_32x32x16_bf16 v[96:111], v[168:171], v[140:143], v[96:111]
  ds_read_b64_tr_b16 v[130:131], v3 offset:9216
  v_and_b32 v52, 0xffff0000, v170
  v_lshlrev_b32 v53, 16, v170
  v_add_f32 v48, v48, v52
  v_fmac_f32 v50, v52, v52
  v_mfma_f32_32x32x16_bf16 v[112:127], v[172:175], v[140:143], v[112:127]
  ds_read_b64_tr_b16 v[132:133], v5 offset:8192
  v_add_f32 v49, v49, v53
  v_fmac_f32 v51, v53, v53
  v_and_b32 v54, 0xffff0000, v171
  v_lshlrev_b32 v55, 16, v171
  v_mfma_f32_16x16x32_bf16 v[36:39], v[60:63], v[140:143], v[36:39]
  ds_read_b64_tr_b16 v[134:135], v5 offset:9216
  v_add_f32 v48, v48, v54
  v_fmac_f32 v50, v54, v54
  v_add_f32 v49, v49, v55
  v_fmac_f32 v51, v55, v55
  s_waitcnt lgkmcnt(0)
  v_mfma_f32_32x32x16_bf16 v[64:79], v[160:163], v[128:131], v[64:79]
  ds_read_b128 v[168:171], v199 offset:0
  v_and_b32 v52, 0xffff0000, v160
  v_lshlrev_b32 v53, 16, v160
  v_add_f32 v48, v48, v52
  v_fmac_f32 v50, v52, v52
  v_mfma_f32_32x32x16_bf16 v[80:95], v[164:167], v[128:131], v[80:95]
  ds_read_b128 v[172:175], v207 offset:0
  v_add_f32 v49, v49, v53
  v_fmac_f32 v51, v53, v53
  v_and_b32 v54, 0xffff0000, v161
  v_lshlrev_b32 v55, 16, v161
  v_mfma_f32_16x16x32_bf16 v[32:35], v[60:63], v[128:131], v[32:35]
  ds_read_b64_tr_b16 v[136:137], v3 offset:12288
  v_add_f32 v48, v48, v54
  v_fmac_f32 v50, v54, v54
  v_add_f32 v49, v49, v55
  v_fmac_f32 v51, v55, v55
  v_mfma_f32_32x32x16_bf16 v[96:111], v[160:163], v[132:135], v[96:111]
  ds_read_b64_tr_b16 v[138:139], v3 offset:13312
  v_and_b32 v52, 0xffff0000, v162
  v_lshlrev_b32 v53, 16, v162
  v_add_f32 v48, v48, v52
  v_fmac_f32 v50, v52, v52
  v_mfma_f32_32x32x16_bf16 v[112:127], v[164:167], v[132:135], v[112:127]
  ds_read_b64_tr_b16 v[140:141], v5 offset:12288
  v_add_f32 v49, v49, v53
  v_fmac_f32 v51, v53, v53
  v_and_b32 v54, 0xffff0000, v163
  v_lshlrev_b32 v55, 16, v163
  v_mfma_f32_16x16x32_bf16 v[36:39], v[60:63], v[132:135], v[36:39]
  ds_read_b64_tr_b16 v[142:143], v5 offset:13312
  v_add_f32 v48, v48, v54
  v_fmac_f32 v50, v54, v54
  v_add_f32 v49, v49, v55
  v_fmac_f32 v51, v55, v55
  s_waitcnt lgkmcnt(0)
  s_barrier
  v_mfma_f32_32x32x16_bf16 v[64:79], v[168:171], v[136:139], v[64:79]
  ds_read_b128 v[160:163], v193 offset:32768
  v_and_b32 v52, 0xffff0000, v168
  v_lshlrev_b32 v53, 16, v168
  v_add_f32 v48, v48, v52
  v_fmac_f32 v50, v52, v52
  v_mfma_f32_32x32x16_bf16 v[80:95], v[172:175], v[136:139], v[80:95]
  ds_read_b128 v[164:167], v201 offset:32768
  v_add_f32 v49, v49, v53
  v_fmac_f32 v51, v53, v53
  v_and_b32 v54, 0xffff0000, v169
  v_lshlrev_b32 v55, 16, v169
  v_mfma_f32_16x16x32_bf16 v[32:35], v[60:63], v[136:139], v[32:35]
  ds_read_b64_tr_b16 v[128:129], v3 offset:32768
  v_add_f32 v48, v48, v54
  v_fmac_f32 v50, v54, v54
  v_add_f32 v49, v49, v55
  v_fmac_f32 v51, v55, v55
  v_mfma_f32_32x32x16_bf16 v[96:111], v[168:171], v[140:143], v[96:111]
  ds_read_b64_tr_b16 v[130:131], v3 offset:33792
  v_and_b32 v52, 0xffff0000, v170
  v_lshlrev_b32 v53, 16, v170
  v_add_f32 v48, v48, v52
  v_fmac_f32 v50, v52, v52
  v_mfma_f32_32x32x16_bf16 v[112:127], v[172:175], v[140:143], v[112:127]
  ds_read_b64_tr_b16 v[132:133], v5 offset:32768
  v_add_f32 v49, v49, v53
  v_fmac_f32 v51, v53, v53
  v_and_b32 v54, 0xffff0000, v171
  v_lshlrev_b32 v55, 16, v171
  v_mfma_f32_16x16x32_bf16 v[36:39], v[60:63], v[140:143], v[36:39]
  ds_read_b64_tr_b16 v[134:135], v5 offset:33792
  v_add_f32 v48, v48, v54
  v_fmac_f32 v50, v54, v54
  v_add_f32 v49, v49, v55
  v_fmac_f32 v51, v55, v55
  s_waitcnt lgkmcnt(0)
  v_mfma_f32_32x32x16_bf16 v[64:79], v[160:163], v[128:131], v[64:79]
  ds_read_b128 v[168:171], v195 offset:32768
  v_and_b32 v52, 0xffff0000, v160
  v_lshlrev_b32 v53, 16, v160
  v_add_f32 v48, v48, v52
  v_fmac_f32 v50, v52, v52
  v_mfma_f32_32x32x16_bf16 v[80:95], v[164:167], v[128:131], v[80:95]
  ds_read_b128 v[172:175], v203 offset:32768
  v_add_f32 v49, v49, v53
  v_fmac_f32 v51, v53, v53
  v_and_b32 v54, 0xffff0000, v161
  v_lshlrev_b32 v55, 16, v161
  v_mfma_f32_16x16x32_bf16 v[32:35], v[60:63], v[128:131], v[32:35]
  ds_read_b64_tr_b16 v[136:137], v3 offset:36864
  v_add_f32 v48, v48, v54
  v_fmac_f32 v50, v54, v54
  v_add_f32 v49, v49, v55
  v_fmac_f32 v51, v55, v55
  v_mfma_f32_32x32x16_bf16 v[96:111], v[160:163], v[132:135], v[96:111]
  ds_read_b64_tr_b16 v[138:139], v3 offset:37888
  v_and_b32 v52, 0xffff0000, v162
  v_lshlrev_b32 v53, 16, v162
  v_add_f32 v48, v48, v52
  v_fmac_f32 v50, v52, v52
  v_mfma_f32_32x32x16_bf16 v[112:127], v[164:167], v[132:135], v[112:127]
  ds_read_b64_tr_b16 v[140:141], v5 offset:36864
  v_add_f32 v49, v49, v53
  v_fmac_f32 v51, v53, v53
  v_and_b32 v54, 0xffff0000, v163
  v_lshlrev_b32 v55, 16, v163
  v_mfma_f32_16x16x32_bf16 v[36:39], v[60:63], v[132:135], v[36:39]
  ds_read_b64_tr_b16 v[142:143], v5 offset:37888
  v_add_f32 v48, v48, v54
  v_fmac_f32 v50, v54, v54
  v_add_f32 v49, v49, v55
  v_fmac_f32 v51, v55, v55
  s_waitcnt lgkmcnt(0)
  v_mfma_f32_32x32x16_bf16 v[64:79], v[168:171], v[136:139], v[64:79]
  ds_read_b128 v[160:163], v197 offset:32768
  v_and_b32 v52, 0xffff0000, v168
  v_lshlrev_b32 v53, 16, v168
  v_add_f32 v48, v48, v52
  v_fmac_f32 v50, v52, v52
  v_mfma_f32_32x32x16_bf16 v[80:95], v[172:175], v[136:139], v[80:95]
  ds_read_b128 v[164:167], v205 offset:32768
  v_add_f32 v49, v49, v53
  v_fmac_f32 v51, v53, v53
  v_and_b32 v54, 0xffff0000, v169
  v_lshlrev_b32 v55, 16, v169
  v_mfma_f32_16x16x32_bf16 v[32:35], v[60:63], v[136:139], v[32:35]
  ds_read_b64_tr_b16 v[128:129], v3 offset:40960
  v_add_f32 v48, v48, v54
  v_fmac_f32 v50, v54, v54
  v_add_f32 v49, v49, v55
  v_fmac_f32 v51, v55, v55
  v_mfma_f32_32x32x16_bf16 v[96:111], v[168:171], v[140:143], v[96:111]
  ds_read_b64_tr_b16 v[130:131], v3 offset:41984
  v_and_b32 v52, 0xffff0000, v170
  v_lshlrev_b32 v53, 16, v170
  v_add_f32 v48, v48, v52
  v_fmac_f32 v50, v52, v52
  v_mfma_f32_32x32x16_bf16 v[112:127], v[172:175], v[140:143], v[112:127]
  ds_read_b64_tr_b16 v[132:133], v5 offset:40960
  v_add_f32 v49, v49, v53
  v_fmac_f32 v51, v53, v53
  v_and_b32 v54, 0xffff0000, v171
  v_lshlrev_b32 v55, 16, v171
  v_mfma_f32_16x16x32_bf16 v[36:39], v[60:63], v[140:143], v[36:39]
  ds_read_b64_tr_b16 v[134:135], v5 offset:41984
  v_add_f32 v48, v48, v54
  v_fmac_f32 v50, v54, v54
  v_add_f32 v49, v49, v55
  v_fmac_f32 v51, v55, v55
  s_waitcnt lgkmcnt(0)
  v_mfma_f32_32x32x16_bf16 v[64:79], v[160:163], v[128:131], v[64:79]
  ds_read_b128 v[168:171], v199 offset:32768
  v_and_b32 v52, 0xffff0000, v160
  v_lshlrev_b32 v53, 16, v160
  v_add_f32 v48, v48, v52
  v_fmac_f32 v50, v52, v52
  v_mfma_f32_32x32x16_bf16 v[80:95], v[164:167], v[128:131], v[80:95]
  ds_read_b128 v[172:175], v207 offset:32768
  v_add_f32 v49, v49, v53
  v_fmac_f32 v51, v53, v53
  v_and_b32 v54, 0xffff0000, v161
  v_lshlrev_b32 v55, 16, v161
  v_mfma_f32_16x16x32_bf16 v[32:35], v[60:63], v[128:131], v[32:35]
  ds_read_b64_tr_b16 v[136:137], v3 offset:45056
  v_add_f32 v48, v48, v54
  v_fmac_f32 v50, v54, v54
  v_add_f32 v49, v49, v55
  v_fmac_f32 v51, v55, v55
  v_mfma_f32_32x32x16_bf16 v[96:111], v[160:163], v[132:135], v[96:111]
  ds_read_b64_tr_b16 v[138:139], v3 offset:46080
  v_and_b32 v52, 0xffff0000, v162
  v_lshlrev_b32 v53, 16, v162
  v_add_f32 v48, v48, v52
  v_fmac_f32 v50, v52, v52
  v_mfma_f32_32x32x16_bf16 v[112:127], v[164:167], v[132:135], v[112:127]
  ds_read_b64_tr_b16 v[140:141], v5 offset:45056
  v_add_f32 v49, v49, v53
  v_fmac_f32 v51, v53, v53
  v_and_b32 v54, 0xffff0000, v163
  v_lshlrev_b32 v55, 16, v163
  v_mfma_f32_16x16x32_bf16 v[36:39], v[60:63], v[132:135], v[36:39]
  ds_read_b64_tr_b16 v[142:143], v5 offset:46080
  v_add_f32 v48, v48, v54
  v_fmac_f32 v50, v54, v54
  v_add_f32 v49, v49, v55
  v_fmac_f32 v51, v55, v55
  s_waitcnt lgkmcnt(0)
  s_barrier
  v_mfma_f32_32x32x16_bf16 v[64:79], v[168:171], v[136:139], v[64:79]
  ds_read_b128 v[160:163], v192 offset:0
  v_and_b32 v52, 0xffff0000, v168
  v_lshlrev_b32 v53, 16, v168
  v_add_f32 v48, v48, v52
  v_fmac_f32 v50, v52, v52
  v_mfma_f32_32x32x16_bf16 v[80:95], v[172:175], v[136:139], v[80:95]
  ds_read_b128 v[164:167], v200 offset:0
  v_add_f32 v49, v49, v53
  v_fmac_f32 v51, v53, v53
  v_and_b32 v54, 0xffff0000, v169
  v_lshlrev_b32 v55, 16, v169
  v_mfma_f32_16x16x32_bf16 v[32:35], v[60:63], v[136:139], v[32:35]
  ds_read_b64_tr_b16 v[128:129], v2 offset:0
  v_add_f32 v48, v48, v54
  v_fmac_f32 v50, v54, v54
  v_add_f32 v49, v49, v55
  v_fmac_f32 v51, v55, v55
  v_mfma_f32_32x32x16_bf16 v[96:111], v[168:171], v[140:143], v[96:111]
  ds_read_b64_tr_b16 v[130:131], v2 offset:1024
  v_and_b32 v52, 0xffff0000, v170
  v_lshlrev_b32 v53, 16, v170
  v_add_f32 v48, v48, v52
  v_fmac_f32 v50, v52, v52
  v_mfma_f32_32x32x16_bf16 v[112:127], v[172:175], v[140:143], v[112:127]
  ds_read_b64_tr_b16 v[132:133], v4 offset:0
  v_add_f32 v49, v49, v53
  v_fmac_f32 v51, v53, v53
  v_and_b32 v54, 0xffff0000, v171
  v_lshlrev_b32 v55, 16, v171
  v_mfma_f32_16x16x32_bf16 v[36:39], v[60:63], v[140:143], v[36:39]
  ds_read_b64_tr_b16 v[134:135], v4 offset:1024
  v_add_f32 v48, v48, v54
  v_fmac_f32 v50, v54, v54
  v_add_f32 v49, v49, v55
  v_fmac_f32 v51, v55, v55
  s_waitcnt lgkmcnt(0)
  v_mfma_f32_32x32x16_bf16 v[64:79], v[160:163], v[128:131], v[64:79]
  ds_read_b128 v[168:171], v194 offset:0
  v_and_b32 v52, 0xffff0000, v160
  v_lshlrev_b32 v53, 16, v160
  v_add_f32 v48, v48, v52
  v_fmac_f32 v50, v52, v52
  v_mfma_f32_32x32x16_bf16 v[80:95], v[164:167], v[128:131], v[80:95]
  ds_read_b128 v[172:175], v202 offset:0
  v_add_f32 v49, v49, v53
  v_fmac_f32 v51, v53, v53
  v_and_b32 v54, 0xffff0000, v161
  v_lshlrev_b32 v55, 16, v161
  v_mfma_f32_16x16x32_bf16 v[32:35], v[60:63], v[128:131], v[32:35]
  ds_read_b64_tr_b16 v[136:137], v2 offset:4096
  v_add_f32 v48, v48, v54
  v_fmac_f32 v50, v54, v54
  v_add_f32 v49, v49, v55
  v_fmac_f32 v51, v55, v55
  v_mfma_f32_32x32x16_bf16 v[96:111], v[160:163], v[132:135], v[96:111]
  ds_read_b64_tr_b16 v[138:139], v2 offset:5120
  v_and_b32 v52, 0xffff0000, v162
  v_lshlrev_b32 v53, 16, v162
  v_add_f32 v48, v48, v52
  v_fmac_f32 v50, v52, v52
  v_mfma_f32_32x32x16_bf16 v[112:127], v[164:167], v[132:135], v[112:127]
  ds_read_b64_tr_b16 v[140:141], v4 offset:4096
  v_add_f32 v49, v49, v53
  v_fmac_f32 v51, v53, v53
  v_and_b32 v54, 0xffff0000, v163
  v_lshlrev_b32 v55, 16, v163
  v_mfma_f32_16x16x32_bf16 v[36:39], v[60:63], v[132:135], v[36:39]
  ds_read_b64_tr_b16 v[142:143], v4 offset:5120
  v_add_f32 v48, v48, v54
  v_fmac_f32 v50, v54, v54
  v_add_f32 v49, v49, v55
  v_fmac_f32 v51, v55, v55
  s_waitcnt lgkmcnt(0)
  v_mfma_f32_32x32x16_bf16 v[64:79], v[168:171], v[136:139], v[64:79]
  ds_read_b128 v[160:163], v196 offset:0
  v_and_b32 v52, 0xffff0000, v168
  v_lshlrev_b32 v53, 16, v168
  v_add_f32 v48, v48, v52
  v_fmac_f32 v50, v52, v52
  v_mfma_f32_32x32x16_bf16 v[80:95], v[172:175], v[136:139], v[80:95]
  ds_read_b128 v[164:167], v204 offset:0
  v_add_f32 v49, v49, v53
  v_fmac_f32 v51, v53, v53
  v_and_b32 v54, 0xffff0000, v169
  v_lshlrev_b32 v55, 16, v169
  v_mfma_f32_16x16x32_bf16 v[32:35], v[60:63], v[136:139], v[32:35]
  ds_read_b64_tr_b16 v[128:129], v2 offset:8192
  v_add_f32 v48, v48, v54
  v_fmac_f32 v50, v54, v54
  v_add_f32 v49, v49, v55
  v_fmac_f32 v51, v55, v55
  v_mfma_f32_32x32x16_bf16 v[96:111], v[168:171], v[140:143], v[96:111]
  ds_read_b64_tr_b16 v[130:131], v2 offset:9216
  v_and_b32 v52, 0xffff0000, v170
  v_lshlrev_b32 v53, 16, v170
  v_add_f32 v48, v48, v52
  v_fmac_f32 v50, v52, v52
  v_mfma_f32_32x32x16_bf16 v[112:127], v[172:175], v[140:143], v[112:127]
  ds_read_b64_tr_b16 v[132:133], v4 offset:8192
  v_add_f32 v49, v49, v53
  v_fmac_f32 v51, v53, v53
  v_and_b32 v54, 0xffff0000, v171
  v_lshlrev_b32 v55, 16, v171
  v_mfma_f32_16x16x32_bf16 v[36:39], v[60:63], v[140:143], v[36:39]
  ds_read_b64_tr_b16 v[134:135], v4 offset:9216
  v_add_f32 v48, v48, v54
  v_fmac_f32 v50, v54, v54
  v_add_f32 v49, v49, v55
  v_fmac_f32 v51, v55, v55
  s_waitcnt lgkmcnt(0)
  v_mfma_f32_32x32x16_bf16 v[64:79], v[160:163], v[128:131], v[64:79]
  ds_read_b128 v[168:171], v198 offset:0
  v_and_b32 v52, 0xffff0000, v160
  v_lshlrev_b32 v53, 16, v160
  v_add_f32 v48, v48, v52
  v_fmac_f32 v50, v52, v52
  v_mfma_f32_32x32x16_bf16 v[80:95], v[164:167], v[128:131], v[80:95]
  ds_read_b128 v[172:175], v206 offset:0
  v_add_f32 v49, v49, v53
  v_fmac_f32 v51, v53, v53
  v_and_b32 v54, 0xffff0000, v161
  v_lshlrev_b32 v55, 16, v161
  v_mfma_f32_16x16x32_bf16 v[32:35], v[60:63], v[128:131], v[32:35]
  ds_read_b64_tr_b16 v[136:137], v2 offset:12288
  v_add_f32 v48, v48, v54
  v_fmac_f32 v50, v54, v54
  v_add_f32 v49, v49, v55
  v_fmac_f32 v51, v55, v55
  v_mfma_f32_32x32x16_bf16 v[96:111], v[160:163], v[132:135], v[96:111]
  ds_read_b64_tr_b16 v[138:139], v2 offset:13312
  v_and_b32 v52, 0xffff0000, v162
  v_lshlrev_b32 v53, 16, v162
  v_add_f32 v48, v48, v52
  v_fmac_f32 v50, v52, v52
  v_mfma_f32_32x32x16_bf16 v[112:127], v[164:167], v[132:135], v[112:127]
  ds_read_b64_tr_b16 v[140:141], v4 offset:12288
  v_add_f32 v49, v49, v53
  v_fmac_f32 v51, v53, v53
  v_and_b32 v54, 0xffff0000, v163
  v_lshlrev_b32 v55, 16, v163
  v_mfma_f32_16x16x32_bf16 v[36:39], v[60:63], v[132:135], v[36:39]
  ds_read_b64_tr_b16 v[142:143], v4 offset:13312
  v_add_f32 v48, v48, v54
  v_fmac_f32 v50, v54, v54
  v_add_f32 v49, v49, v55
  v_fmac_f32 v51, v55, v55
  s_waitcnt lgkmcnt(0)
  s_barrier
  v_mfma_f32_32x32x16_bf16 v[64:79], v[168:171], v[136:139], v[64:79]
  ds_read_b128 v[160:163], v192 offset:32768
  v_and_b32 v52, 0xffff0000, v168
  v_lshlrev_b32 v53, 16, v168
  v_add_f32 v48, v48, v52
  v_fmac_f32 v50, v52, v52
  v_mfma_f32_32x32x16_bf16 v[80:95], v[172:175], v[136:139], v[80:95]
  ds_read_b128 v[164:167], v200 offset:32768
  v_add_f32 v49, v49, v53
  v_fmac_f32 v51, v53, v53
  v_and_b32 v54, 0xffff0000, v169
  v_lshlrev_b32 v55, 16, v169
  v_mfma_f32_16x16x32_bf16 v[32:35], v[60:63], v[136:139], v[32:35]
  ds_read_b64_tr_b16 v[128:129], v2 offset:32768
  v_add_f32 v48, v48, v54
  v_fmac_f32 v50, v54, v54
  v_add_f32 v49, v49, v55
  v_fmac_f32 v51, v55, v55
  v_mfma_f32_32x32x16_bf16 v[96:111], v[168:171], v[140:143], v[96:111]
  ds_read_b64_tr_b16 v[130:131], v2 offset:33792
  v_and_b32 v52, 0xffff0000, v170
  v_lshlrev_b32 v53, 16, v170
  v_add_f32 v48, v48, v52
  v_fmac_f32 v50, v52, v52
  v_mfma_f32_32x32x16_bf16 v[112:127], v[172:175], v[140:143], v[112:127]
  ds_read_b64_tr_b16 v[132:133], v4 offset:32768
  v_add_f32 v49, v49, v53
  v_fmac_f32 v51, v53, v53
  v_and_b32 v54, 0xffff0000, v171
  v_lshlrev_b32 v55, 16, v171
  v_mfma_f32_16x16x32_bf16 v[36:39], v[60:63], v[140:143], v[36:39]
  ds_read_b64_tr_b16 v[134:135], v4 offset:33792
  v_add_f32 v48, v48, v54
  v_fmac_f32 v50, v54, v54
  v_add_f32 v49, v49, v55
  v_fmac_f32 v51, v55, v55
  s_waitcnt lgkmcnt(0)
  v_mfma_f32_32x32x16_bf16 v[64:79], v[160:163], v[128:131], v[64:79]
  ds_read_b128 v[168:171], v194 offset:32768
  v_and_b32 v52, 0xffff0000, v160
  v_lshlrev_b32 v53, 16, v160
  v_add_f32 v48, v48, v52
  v_fmac_f32 v50, v52, v52
  v_mfma_f32_32x32x16_bf16 v[80:95], v[164:167], v[128:131], v[80:95]
  ds_read_b128 v[172:175], v202 offset:32768
  v_add_f32 v49, v49, v53
  v_fmac_f32 v51, v53, v53
  v_and_b32 v54, 0xffff0000, v161
  v_lshlrev_b32 v55, 16, v161
  v_mfma_f32_16x16x32_bf16 v[32:35], v[60:63], v[128:131], v[32:35]
  ds_read_b64_tr_b16 v[136:137], v2 offset:36864
  v_add_f32 v48, v48, v54
  v_fmac_f32 v50, v54, v54
  v_add_f32 v49, v49, v55
  v_fmac_f32 v51, v55, v55
  v_mfma_f32_32x32x16_bf16 v[96:111], v[160:163], v[132:135], v[96:111]
  ds_read_b64_tr_b16 v[138:139], v2 offset:37888
  v_and_b32 v52, 0xffff0000, v162
  v_lshlrev_b32 v53, 16, v162
  v_add_f32 v48, v48, v52
  v_fmac_f32 v50, v52, v52
  v_mfma_f32_32x32x16_bf16 v[112:127], v[164:167], v[132:135], v[112:127]
  ds_read_b64_tr_b16 v[140:141], v4 offset:36864
  v_add_f32 v49, v49, v53
  v_fmac_f32 v51, v53, v53
  v_and_b32 v54, 0xffff0000, v163
  v_lshlrev_b32 v55, 16, v163
  v_mfma_f32_16x16x32_bf16 v[36:39], v[60:63], v[132:135], v[36:39]
  ds_read_b64_tr_b16 v[142:143], v4 offset:37888
  v_add_f32 v48, v48, v54
  v_fmac_f32 v50, v54, v54
  v_add_f32 v49, v49, v55
  v_fmac_f32 v51, v55, v55
  s_waitcnt lgkmcnt(0)
  v_mfma_f32_32x32x16_bf16 v[64:79], v[168:171], v[136:139], v[64:79]
  ds_read_b128 v[160:163], v196 offset:32768
  v_and_b32 v52, 0xffff0000, v168
  v_lshlrev_b32 v53, 16, v168
  v_add_f32 v48, v48, v52
  v_fmac_f32 v50, v52, v52
  v_mfma_f32_32x32x16_bf16 v[80:95], v[172:175], v[136:139], v[80:95]
  ds_read_b128 v[164:167], v204 offset:32768
  v_add_f32 v49, v49, v53
  v_fmac_f32 v51, v53, v53
  v_and_b32 v54, 0xffff0000, v169
  v_lshlrev_b32 v55, 16, v169
  v_mfma_f32_16x16x32_bf16 v[32:35], v[60:63], v[136:139], v[32:35]
  ds_read_b64_tr_b16 v[128:129], v2 offset:40960
  v_add_f32 v48, v48, v54
  v_fmac_f32 v50, v54, v54
  v_add_f32 v49, v49, v55
  v_fmac_f32 v51, v55, v55
  v_mfma_f32_32x32x16_bf16 v[96:111], v[168:171], v[140:143], v[96:111]
  ds_read_b64_tr_b16 v[130:131], v2 offset:41984
  v_and_b32 v52, 0xffff0000, v170
  v_lshlrev_b32 v53, 16, v170
  v_add_f32 v48, v48, v52
  v_fmac_f32 v50, v52, v52
  v_mfma_f32_32x32x16_bf16 v[112:127], v[172:175], v[140:143], v[112:127]
  ds_read_b64_tr_b16 v[132:133], v4 offset:40960
  v_add_f32 v49, v49, v53
  v_fmac_f32 v51, v53, v53
  v_and_b32 v54, 0xffff0000, v171
  v_lshlrev_b32 v55, 16, v171
  v_mfma_f32_16x16x32_bf16 v[36:39], v[60:63], v[140:143], v[36:39]
  ds_read_b64_tr_b16 v[134:135], v4 offset:41984
  v_add_f32 v48, v48, v54
  v_fmac_f32 v50, v54, v54
  v_add_f32 v49, v49, v55
  v_fmac_f32 v51, v55, v55
  s_waitcnt lgkmcnt(0)
  v_mfma_f32_32x32x16_bf16 v[64:79], v[160:163], v[128:131], v[64:79]
  ds_read_b128 v[168:171], v198 offset:32768
  v_and_b32 v52, 0xffff0000, v160
  v_lshlrev_b32 v53, 16, v160
  v_add_f32 v48, v48, v52
  v_fmac_f32 v50, v52, v52
  v_mfma_f32_32x32x16_bf16 v[80:95], v[164:167], v[128:131], v[80:95]
  ds_read_b128 v[172:175], v206 offset:32768
  v_add_f32 v49, v49, v53
  v_fmac_f32 v51, v53, v53
  v_and_b32 v54, 0xffff0000, v161
  v_lshlrev_b32 v55, 16, v161
  v_mfma_f32_16x16x32_bf16 v[32:35], v[60:63], v[128:131], v[32:35]
  ds_read_b64_tr_b16 v[136:137], v2 offset:45056
  v_add_f32 v48, v48, v54
  v_fmac_f32 v50, v54, v54
  v_add_f32 v49, v49, v55
  v_fmac_f32 v51, v55, v55
  v_mfma_f32_32x32x16_bf16 v[96:111], v[160:163], v[132:135], v[96:111]
  ds_read_b64_tr_b16 v[138:139], v2 offset:46080
  v_and_b32 v52, 0xffff0000, v162
  v_lshlrev_b32 v53, 16, v162
  v_add_f32 v48, v48, v52
  v_fmac_f32 v50, v52, v52
  v_mfma_f32_32x32x16_bf16 v[112:127], v[164:167], v[132:135], v[112:127]
  ds_read_b64_tr_b16 v[140:141], v4 offset:45056
  v_add_f32 v49, v49, v53
  v_fmac_f32 v51, v53, v53
  v_and_b32 v54, 0xffff0000, v163
  v_lshlrev_b32 v55, 16, v163
  v_mfma_f32_16x16x32_bf16 v[36:39], v[60:63], v[132:135], v[36:39]
  ds_read_b64_tr_b16 v[142:143], v4 offset:46080
  v_add_f32 v48, v48, v54
  v_fmac_f32 v50, v54, v54
  v_add_f32 v49, v49, v55
  v_fmac_f32 v51, v55, v55
  s_waitcnt lgkmcnt(0)
  v_mfma_f32_32x32x16_bf16 v[64:79], v[168:171], v[136:139], v[64:79]
  v_and_b32 v52, 0xffff0000, v168
  v_lshlrev_b32 v53, 16, v168
  v_add_f32 v48, v48, v52
  v_fmac_f32 v50, v52, v52
  v_mfma_f32_32x32x16_bf16 v[80:95], v[172:175], v[136:139], v[80:95]
  v_add_f32 v49, v49, v53
  v_fmac_f32 v51, v53, v53
  v_and_b32 v54, 0xffff0000, v169
  v_lshlrev_b32 v55, 16, v169
  v_mfma_f32_16x16x32_bf16 v[32:35], v[60:63], v[136:139], v[32:35]
  v_add_f32 v48, v48, v54
  v_fmac_f32 v50, v54, v54
  v_add_f32 v49, v49, v55
  v_fmac_f32 v51, v55, v55
  v_mfma_f32_32x32x16_bf16 v[96:111], v[168:171], v[140:143], v[96:111]
  v_and_b32 v52, 0xffff0000, v170
  v_lshlrev_b32 v53, 16, v170
  v_add_f32 v48, v48, v52
  v_fmac_f32 v50, v52, v52
  v_mfma_f32_32x32x16_bf16 v[112:127], v[172:175], v[140:143], v[112:127]
  v_add_f32 v49, v49, v53
  v_fmac_f32 v51, v53, v53
  v_and_b32 v54, 0xffff0000, v171
  v_lshlrev_b32 v55, 16, v171
  v_mfma_f32_16x16x32_bf16 v[36:39], v[60:63], v[140:143], v[36:39]
  v_add_f32 v48, v48, v54
  v_fmac_f32 v50, v54, v54
  v_add_f32 v49, v49, v55
  v_fmac_f32 v51, v55, v55
  v_add_f32 v40, v48, v49
  v_add_f32 v41, v50, v51
  v_mov_b32 v42, v40
  v_mov_b32 v43, v41
  s_nop 1
  v_permlane32_swap_b32 v40, v42
  v_permlane32_swap_b32 v41, v43
  s_nop 1
  v_add_f32 v40, v40, v42
  v_add_f32 v41, v41, v43
  v_mul_f32 v40, 0x3acccccd, v40
  v_mul_f32 v41, 0x3acccccd, v41
  v_fma_f32 v41, -v40, v40, v41
  v_max_f32 v41, 0, v41
  v_add_f32 v42, 0x3727c5ac, v41
  v_rsq_f32 v42, v42
  s_cmp_lt_u32 s25, 5
  s_cselect_b32 s46, 0x3ea52b5c, 1.0
  v_mul_f32 v42, s46, v42
  v_mul_f32 v43, v42, v40
  v_cmp_eq_u32 vcc, 0, v17
  s_lshl_b32 s37, s36, 8
  s_lshl_b32 s38, s27, 7
  s_add_u32 s37, s37, s38
  s_add_u32 s37, s37, 131072
  v_lshlrev_b32 v44, 2, v16
  v_add_u32 v44, s37, v44
  v_lshl_add_u32 v44, v17, 9, v44
  v_cndmask_b32 v42, v43, v42, vcc
  ds_write_b32 v44, v42
  s_lshl_b32 s37, s27, 8
  s_add_u32 s37, s37, 132096
  v_lshlrev_b32 v45, 2, v0
  v_add_u32 v45, s37, v45
  s_mov_b64 exec, 0xffff
  ds_write_b32 v45, v32 offset:0
  ds_write_b32 v45, v33 offset:64
  ds_write_b32 v45, v36 offset:128
  ds_write_b32 v45, v37 offset:192
  s_mov_b64 exec, -1
  s_waitcnt lgkmcnt(0)
  s_barrier
  s_lshl_b32 s37, s36, 8
  v_lshlrev_b32 v20, 4, v17
  v_add_u32 v20, s37, v20
  v_add_u32 v20, 131072, v20
  s_lshl_b32 s37, s27, 7
  v_xor_b32 v20, s37, v20
  v_xor_b32 v19, 128, v20
  ds_read_b128 v[128:131], v20 offset:0
  ds_read_b128 v[132:135], v20 offset:32
  ds_read_b128 v[136:139], v20 offset:64
  ds_read_b128 v[140:143], v20 offset:96
  ds_read_b128 v[144:147], v19 offset:0
  ds_read_b128 v[148:151], v19 offset:32
  ds_read_b128 v[152:155], v19 offset:64
  ds_read_b128 v[156:159], v19 offset:96
  v_lshlrev_b32 v21, 2, v16
  s_lshl_b32 s37, s27, 8
  v_add_u32 v21, s37, v21
  v_add_u32 v21, 132096, v21
  s_waitcnt lgkmcnt(4)
  ds_read_b128 v[160:163], v20 offset:512
  ds_read_b128 v[164:167], v20 offset:544
  ds_read_b128 v[168:171], v20 offset:576
  ds_read_b128 v[172:175], v20 offset:608
  ds_read_b128 v[176:179], v19 offset:512
  ds_read_b128 v[180:183], v19 offset:544
  ds_read_b128 v[184:187], v19 offset:576
  ds_read_b128 v[188:191], v19 offset:608
  ds_read_b32 v32, v21
  ds_read_b32 v34, v21 offset:128
  s_waitcnt lgkmcnt(0)
  s_nop 7
  v_pk_mul_f32 v[36:37], v[160:161], v[32:33] op_sel_hi:[1,0]
  v_pk_mul_f32 v[38:39], v[162:163], v[32:33] op_sel_hi:[1,0]
  v_pk_fma_f32 v[36:37], v[64:65], v[128:129], v[36:37] neg_lo:[0,0,1] neg_hi:[0,0,1]
  v_pk_fma_f32 v[38:39], v[66:67], v[130:131], v[38:39] neg_lo:[0,0,1] neg_hi:[0,0,1]
  v_cvt_pk_bf16_f32 v44, v36, v37
  v_cvt_pk_bf16_f32 v45, v38, v39
  v_pk_mul_f32 v[40:41], v[164:165], v[32:33] op_sel_hi:[1,0]
  v_pk_mul_f32 v[42:43], v[166:167], v[32:33] op_sel_hi:[1,0]
  v_pk_fma_f32 v[40:41], v[68:69], v[132:133], v[40:41] neg_lo:[0,0,1] neg_hi:[0,0,1]
  v_pk_fma_f32 v[42:43], v[70:71], v[134:135], v[42:43] neg_lo:[0,0,1] neg_hi:[0,0,1]
  v_cvt_pk_bf16_f32 v46, v40, v41
  v_cvt_pk_bf16_f32 v47, v42, v43
  s_nop 1
  v_permlane32_swap_b32 v44, v46
  v_permlane32_swap_b32 v45, v47
  s_nop 1
  ds_write_b128 v24, v[44:47] offset:0
  v_pk_mul_f32 v[36:37], v[168:169], v[32:33] op_sel_hi:[1,0]
  v_pk_mul_f32 v[38:39], v[170:171], v[32:33] op_sel_hi:[1,0]
  v_pk_fma_f32 v[36:37], v[72:73], v[136:137], v[36:37] neg_lo:[0,0,1] neg_hi:[0,0,1]
  v_pk_fma_f32 v[38:39], v[74:75], v[138:139], v[38:39] neg_lo:[0,0,1] neg_hi:[0,0,1]
  v_cvt_pk_bf16_f32 v48, v36, v37
  v_cvt_pk_bf16_f32 v49, v38, v39
  v_pk_mul_f32 v[40:41], v[172:173], v[32:33] op_sel_hi:[1,0]
  v_pk_mul_f32 v[42:43], v[174:175], v[32:33] op_sel_hi:[1,0]
  v_pk_fma_f32 v[40:41], v[76:77], v[140:141], v[40:41] neg_lo:[0,0,1] neg_hi:[0,0,1]
  v_pk_fma_f32 v[42:43], v[78:79], v[142:143], v[42:43] neg_lo:[0,0,1] neg_hi:[0,0,1]
  v_cvt_pk_bf16_f32 v50, v40, v41
  v_cvt_pk_bf16_f32 v51, v42, v43
  s_nop 1
  v_permlane32_swap_b32 v48, v50
  v_permlane32_swap_b32 v49, v51
  s_nop 1
  ds_write_b128 v24, v[48:51] offset:640
  v_pk_mul_f32 v[36:37], v[176:177], v[32:33] op_sel_hi:[1,0]
  v_pk_mul_f32 v[38:39], v[178:179], v[32:33] op_sel_hi:[1,0]
  v_pk_fma_f32 v[36:37], v[80:81], v[144:145], v[36:37] neg_lo:[0,0,1] neg_hi:[0,0,1]
  v_pk_fma_f32 v[38:39], v[82:83], v[146:147], v[38:39] neg_lo:[0,0,1] neg_hi:[0,0,1]
  v_cvt_pk_bf16_f32 v44, v36, v37
  v_cvt_pk_bf16_f32 v45, v38, v39
  v_pk_mul_f32 v[40:41], v[180:181], v[32:33] op_sel_hi:[1,0]
  v_pk_mul_f32 v[42:43], v[182:183], v[32:33] op_sel_hi:[1,0]
  v_pk_fma_f32 v[40:41], v[84:85], v[148:149], v[40:41] neg_lo:[0,0,1] neg_hi:[0,0,1]
  v_pk_fma_f32 v[42:43], v[86:87], v[150:151], v[42:43] neg_lo:[0,0,1] neg_hi:[0,0,1]
  v_cvt_pk_bf16_f32 v46, v40, v41
  v_cvt_pk_bf16_f32 v47, v42, v43
  s_nop 1
  v_permlane32_swap_b32 v44, v46
  v_permlane32_swap_b32 v45, v47
  s_nop 1
  v_xor_b32 v24, 16384, v24
  ds_write_b128 v24, v[44:47] offset:0
  v_pk_mul_f32 v[36:37], v[184:185], v[32:33] op_sel_hi:[1,0]
  v_pk_mul_f32 v[38:39], v[186:187], v[32:33] op_sel_hi:[1,0]
  v_pk_fma_f32 v[36:37], v[88:89], v[152:153], v[36:37] neg_lo:[0,0,1] neg_hi:[0,0,1]
  v_pk_fma_f32 v[38:39], v[90:91], v[154:155], v[38:39] neg_lo:[0,0,1] neg_hi:[0,0,1]
  v_cvt_pk_bf16_f32 v48, v36, v37
  v_cvt_pk_bf16_f32 v49, v38, v39
  v_pk_mul_f32 v[40:41], v[188:189], v[32:33] op_sel_hi:[1,0]
  v_pk_mul_f32 v[42:43], v[190:191], v[32:33] op_sel_hi:[1,0]
  v_pk_fma_f32 v[40:41], v[92:93], v[156:157], v[40:41] neg_lo:[0,0,1] neg_hi:[0,0,1]
  v_pk_fma_f32 v[42:43], v[94:95], v[158:159], v[42:43] neg_lo:[0,0,1] neg_hi:[0,0,1]
  v_cvt_pk_bf16_f32 v50, v40, v41
  v_cvt_pk_bf16_f32 v51, v42, v43
  s_nop 1
  v_permlane32_swap_b32 v48, v50
  v_permlane32_swap_b32 v49, v51
  s_nop 1
  ds_write_b128 v24, v[48:51] offset:640
  v_pk_mul_f32 v[36:37], v[160:161], v[34:35] op_sel_hi:[1,0]
  v_pk_mul_f32 v[38:39], v[162:163], v[34:35] op_sel_hi:[1,0]
  v_pk_fma_f32 v[36:37], v[96:97], v[128:129], v[36:37] neg_lo:[0,0,1] neg_hi:[0,0,1]
  v_pk_fma_f32 v[38:39], v[98:99], v[130:131], v[38:39] neg_lo:[0,0,1] neg_hi:[0,0,1]
  v_cvt_pk_bf16_f32 v44, v36, v37
  v_cvt_pk_bf16_f32 v45, v38, v39
  v_pk_mul_f32 v[40:41], v[164:165], v[34:35] op_sel_hi:[1,0]
  v_pk_mul_f32 v[42:43], v[166:167], v[34:35] op_sel_hi:[1,0]
  v_pk_fma_f32 v[40:41], v[100:101], v[132:133], v[40:41] neg_lo:[0,0,1] neg_hi:[0,0,1]
  v_pk_fma_f32 v[42:43], v[102:103], v[134:135], v[42:43] neg_lo:[0,0,1] neg_hi:[0,0,1]
  v_cvt_pk_bf16_f32 v46, v40, v41
  v_cvt_pk_bf16_f32 v47, v42, v43
  s_nop 1
  v_permlane32_swap_b32 v44, v46
  v_permlane32_swap_b32 v45, v47
  s_nop 1
  ds_write_b128 v25, v[44:47] offset:0
  v_pk_mul_f32 v[36:37], v[168:169], v[34:35] op_sel_hi:[1,0]
  v_pk_mul_f32 v[38:39], v[170:171], v[34:35] op_sel_hi:[1,0]
  v_pk_fma_f32 v[36:37], v[104:105], v[136:137], v[36:37] neg_lo:[0,0,1] neg_hi:[0,0,1]
  v_pk_fma_f32 v[38:39], v[106:107], v[138:139], v[38:39] neg_lo:[0,0,1] neg_hi:[0,0,1]
  v_cvt_pk_bf16_f32 v48, v36, v37
  v_cvt_pk_bf16_f32 v49, v38, v39
  v_pk_mul_f32 v[40:41], v[172:173], v[34:35] op_sel_hi:[1,0]
  v_pk_mul_f32 v[42:43], v[174:175], v[34:35] op_sel_hi:[1,0]
  v_pk_fma_f32 v[40:41], v[108:109], v[140:141], v[40:41] neg_lo:[0,0,1] neg_hi:[0,0,1]
  v_pk_fma_f32 v[42:43], v[110:111], v[142:143], v[42:43] neg_lo:[0,0,1] neg_hi:[0,0,1]
  v_cvt_pk_bf16_f32 v50, v40, v41
  v_cvt_pk_bf16_f32 v51, v42, v43
  s_nop 1
  v_permlane32_swap_b32 v48, v50
  v_permlane32_swap_b32 v49, v51
  s_nop 1
  ds_write_b128 v25, v[48:51] offset:640
  v_pk_mul_f32 v[36:37], v[176:177], v[34:35] op_sel_hi:[1,0]
  v_pk_mul_f32 v[38:39], v[178:179], v[34:35] op_sel_hi:[1,0]
  v_pk_fma_f32 v[36:37], v[112:113], v[144:145], v[36:37] neg_lo:[0,0,1] neg_hi:[0,0,1]
  v_pk_fma_f32 v[38:39], v[114:115], v[146:147], v[38:39] neg_lo:[0,0,1] neg_hi:[0,0,1]
  v_cvt_pk_bf16_f32 v44, v36, v37
  v_cvt_pk_bf16_f32 v45, v38, v39
  v_pk_mul_f32 v[40:41], v[180:181], v[34:35] op_sel_hi:[1,0]
  v_pk_mul_f32 v[42:43], v[182:183], v[34:35] op_sel_hi:[1,0]
  v_pk_fma_f32 v[40:41], v[116:117], v[148:149], v[40:41] neg_lo:[0,0,1] neg_hi:[0,0,1]
  v_pk_fma_f32 v[42:43], v[118:119], v[150:151], v[42:43] neg_lo:[0,0,1] neg_hi:[0,0,1]
  v_cvt_pk_bf16_f32 v46, v40, v41
  v_cvt_pk_bf16_f32 v47, v42, v43
  s_nop 1
  v_permlane32_swap_b32 v44, v46
  v_permlane32_swap_b32 v45, v47
  s_nop 1
  v_xor_b32 v25, 16384, v25
  ds_write_b128 v25, v[44:47] offset:0
  v_pk_mul_f32 v[36:37], v[184:185], v[34:35] op_sel_hi:[1,0]
  v_pk_mul_f32 v[38:39], v[186:187], v[34:35] op_sel_hi:[1,0]
  v_pk_fma_f32 v[36:37], v[120:121], v[152:153], v[36:37] neg_lo:[0,0,1] neg_hi:[0,0,1]
  v_pk_fma_f32 v[38:39], v[122:123], v[154:155], v[38:39] neg_lo:[0,0,1] neg_hi:[0,0,1]
  v_cvt_pk_bf16_f32 v48, v36, v37
  v_cvt_pk_bf16_f32 v49, v38, v39
  v_pk_mul_f32 v[40:41], v[188:189], v[34:35] op_sel_hi:[1,0]
  v_pk_mul_f32 v[42:43], v[190:191], v[34:35] op_sel_hi:[1,0]
  v_pk_fma_f32 v[40:41], v[124:125], v[156:157], v[40:41] neg_lo:[0,0,1] neg_hi:[0,0,1]
  v_pk_fma_f32 v[42:43], v[126:127], v[158:159], v[42:43] neg_lo:[0,0,1] neg_hi:[0,0,1]
  v_cvt_pk_bf16_f32 v50, v40, v41
  v_cvt_pk_bf16_f32 v51, v42, v43
  s_nop 1
  v_permlane32_swap_b32 v48, v50
  v_permlane32_swap_b32 v49, v51
  s_nop 1
  ds_write_b128 v25, v[48:51] offset:640
  s_waitcnt lgkmcnt(0)
  s_barrier
  ds_read_b128 v[64:67], v218 offset:0
  ds_read_b128 v[68:71], v218 offset:1024
  ds_read_b128 v[72:75], v218 offset:2048
  ds_read_b128 v[76:79], v218 offset:3072
  ds_read_b128 v[80:83], v218 offset:4096
  ds_read_b128 v[84:87], v218 offset:5120
  ds_read_b128 v[88:91], v218 offset:6144
  ds_read_b128 v[92:95], v218 offset:7168
  ds_read_b128 v[96:99], v218 offset:8192
  ds_read_b128 v[100:103], v218 offset:9216
  s_waitcnt lgkmcnt(9)
  buffer_store_dwordx4 v[64:67], v208, s[48:51], s54 offen sc1
  s_waitcnt lgkmcnt(8)
  buffer_store_dwordx4 v[68:71], v209, s[48:51], s54 offen sc1
  s_waitcnt lgkmcnt(7)
  buffer_store_dwordx4 v[72:75], v210, s[48:51], s54 offen sc1
  s_waitcnt lgkmcnt(6)
  buffer_store_dwordx4 v[76:79], v211, s[48:51], s54 offen sc1
  s_waitcnt lgkmcnt(5)
  buffer_store_dwordx4 v[80:83], v212, s[48:51], s54 offen sc1
  s_waitcnt lgkmcnt(4)
  buffer_store_dwordx4 v[84:87], v213, s[48:51], s54 offen sc1
  s_waitcnt lgkmcnt(3)
  buffer_store_dwordx4 v[88:91], v214, s[48:51], s54 offen sc1
  s_waitcnt lgkmcnt(2)
  buffer_store_dwordx4 v[92:95], v215, s[48:51], s54 offen sc1
  s_waitcnt lgkmcnt(1)
  buffer_store_dwordx4 v[96:99], v216, s[48:51], s54 offen sc1
  s_waitcnt lgkmcnt(0)
  buffer_store_dwordx4 v[100:103], v217, s[48:51], s54 offen sc1
  s_waitcnt vmcnt(0)
  s_endpgm
.globl f0_kernel
.p2align 8
.type f0_kernel,@function
f0_kernel:
  s_cmp_ge_u32 s2, 256
  s_cbranch_scc1 f0_kernel_fin
  s_load_dwordx2 s[6:7], s[0:1], 80
  v_lshrrev_b32 v1, 6, v0
  s_nop 0
  v_readfirstlane_b32 s64, v1
  v_and_b32 v0, 63, v0
f0_kernel_p0_entry:
  s_mov_b32 s26, s64
  s_and_b32 s20, s2, 7
  s_lshr_b32 s21, s2, 3
  s_mov_b32 s24, s21
  v_lshlrev_b32 v4, 4, v0
  s_and_b32 s33, s26, 3
  s_cmp_ge_u32 s26, 4
  s_cbranch_scc1 f0_kernel_p0_nct1
  s_getpc_b64 s[40:41]
f0_kernel_p0_ct2:
  s_sub_u32 s40, s40, f0_kernel_p0_ct2-f0_kernel
  s_subb_u32 s41, s41, 0
  s_lshl_b32 s42, s21, 2
  s_add_u32 s42, s42, s33
  s_lshl_b32 s42, s42, 10
  v_lshlrev_b32 v252, 6, v0
  v_add_u32 v252, s42, v252
  v_min_u32 v252, f0_kernel_skip-f0_kernel-4, v252
  v_mov_b32 v253, s41
  v_add_co_u32 v252, vcc, s40, v252
  s_nop 1
  v_addc_co_u32 v253, vcc, 0, v253, vcc
  s_mov_b64 exec, 0xffff
  global_load_dword v254, v[252:253], off
  s_mov_b64 exec, -1
f0_kernel_p0_nct1:
  s_mul_i32 s50, s24, 163840
  s_add_u32 s50, s50, 25165824
  s_lshl_b32 s25, s20, 3
  s_lshl_b32 s23, s33, 1
  s_add_u32 s25, s25, s23
  s_lshl_b32 s27, s24, 6
  s_add_u32 s27, s27, s25
  s_mul_i32 s27, s27, 1280
  s_add_u32 s27, s27, 22020096
  s_add_u32 s28, s27, 1280
  s_cmp_lt_u32 s26, 4
  s_cbranch_scc1 f0_kernel_p0_compute
  s_lshl_b32 s29, s33, 12
  s_waitcnt lgkmcnt(0)
  s_mov_b32 s12, s6
  s_mov_b32 s13, s7
  s_mov_b32 s14, 0x3200000
  s_mov_b32 s15, 0x00020000
  s_add_u32 s32, s50, s29
  s_cmp_lg_u32 s26, 4
  s_cbranch_scc1 f0_kernel_p0_nopub
  s_getreg_b32 s66, hwreg(HW_REG_XCC_ID, 0, 4)
  s_mul_i32 s65, s66, s66
  s_lshl_b32 s65, s65, 16
  s_lshl_b32 s66, s66, 6
  s_add_u32 s65, s65, s66
  s_add_u32 s65, s65, 1
  s_and_b32 s66, s2, 7
  s_lshl_b32 s66, s66, 7
  s_add_u32 s66, s66, 9216000
  s_mov_b64 exec, 1
  v_mov_b32 v10, s65
  buffer_atomic_add v10, off, s[12:15], s66 sc1
  s_mov_b64 exec, -1
f0_kernel_p0_nopub:
  s_add_u32 m0, s29, 0
  s_add_u32 s31, s32, 0
  buffer_load_dwordx4 v4, s[12:15], s31 offen offset:0 lds
  buffer_load_dwordx4 v4, s[12:15], s31 offen offset:1024 lds
  buffer_load_dwordx4 v4, s[12:15], s31 offen offset:2048 lds
  buffer_load_dwordx4 v4, s[12:15], s31 offen offset:3072 lds
  s_waitcnt vmcnt(0)
  s_barrier
  s_add_u32 m0, s29, 16384
  s_add_u32 s31, s32, 16384
  buffer_load_dwordx4 v4, s[12:15], s31 offen offset:0 lds
  buffer_load_dwordx4 v4, s[12:15], s31 offen offset:1024 lds
  buffer_load_dwordx4 v4, s[12:15], s31 offen offset:2048 lds
  buffer_load_dwordx4 v4, s[12:15], s31 offen offset:3072 lds
  s_add_u32 m0, s29, 32768
  s_add_u32 s31, s32, 32768
  buffer_load_dwordx4 v4, s[12:15], s31 offen offset:0 lds
  buffer_load_dwordx4 v4, s[12:15], s31 offen offset:1024 lds
  buffer_load_dwordx4 v4, s[12:15], s31 offen offset:2048 lds
  buffer_load_dwordx4 v4, s[12:15], s31 offen offset:3072 lds
  s_add_u32 m0, s29, 49152
  s_add_u32 s31, s32, 49152
  buffer_load_dwordx4 v4, s[12:15], s31 offen offset:0 lds
  buffer_load_dwordx4 v4, s[12:15], s31 offen offset:1024 lds
  buffer_load_dwordx4 v4, s[12:15], s31 offen offset:2048 lds
  buffer_load_dwordx4 v4, s[12:15], s31 offen offset:3072 lds
  s_waitcnt vmcnt(8)
  s_barrier
  s_add_u32 m0, s29, 65536
  s_add_u32 s31, s32, 65536
  buffer_load_dwordx4 v4, s[12:15], s31 offen offset:0 lds
  buffer_load_dwordx4 v4, s[12:15], s31 offen offset:1024 lds
  buffer_load_dwordx4 v4, s[12:15], s31 offen offset:2048 lds
  buffer_load_dwordx4 v4, s[12:15], s31 offen offset:3072 lds
  s_add_u32 m0, s29, 81920
  s_add_u32 s31, s32, 81920
  buffer_load_dwordx4 v4, s[12:15], s31 offen offset:0 lds
  buffer_load_dwordx4 v4, s[12:15], s31 offen offset:1024 lds
  buffer_load_dwordx4 v4, s[12:15], s31 offen offset:2048 lds
  buffer_load_dwordx4 v4, s[12:15], s31 offen offset:3072 lds
  s_waitcnt vmcnt(8)
  s_barrier
  s_add_u32 m0, s29, 98304
  s_add_u32 s31, s32, 98304
  buffer_load_dwordx4 v4, s[12:15], s31 offen offset:0 lds
  buffer_load_dwordx4 v4, s[12:15], s31 offen offset:1024 lds
  buffer_load_dwordx4 v4, s[12:15], s31 offen offset:2048 lds
  buffer_load_dwordx4 v4, s[12:15], s31 offen offset:3072 lds
  s_add_u32 m0, s29, 114688
  s_add_u32 s31, s32, 114688
  buffer_load_dwordx4 v4, s[12:15], s31 offen offset:0 lds
  buffer_load_dwordx4 v4, s[12:15], s31 offen offset:1024 lds
  buffer_load_dwordx4 v4, s[12:15], s31 offen offset:2048 lds
  buffer_load_dwordx4 v4, s[12:15], s31 offen offset:3072 lds
  s_add_u32 m0, s29, 131072
  s_add_u32 s31, s32, 131072
  buffer_load_dwordx4 v4, s[12:15], s31 offen offset:0 lds
  buffer_load_dwordx4 v4, s[12:15], s31 offen offset:1024 lds
  buffer_load_dwordx4 v4, s[12:15], s31 offen offset:2048 lds
  buffer_load_dwordx4 v4, s[12:15], s31 offen offset:3072 lds
  s_add_u32 m0, s29, 147456
  s_add_u32 s31, s32, 147456
  buffer_load_dwordx4 v4, s[12:15], s31 offen offset:0 lds
  buffer_load_dwordx4 v4, s[12:15], s31 offen offset:1024 lds
  buffer_load_dwordx4 v4, s[12:15], s31 offen offset:2048 lds
  buffer_load_dwordx4 v4, s[12:15], s31 offen offset:3072 lds
  v_and_b32 v5, 31, v0
  v_lshlrev_b32 v6, 3, v5
  v_mov_b32 v12, 0
  v_mov_b32 v13, 0
  v_mov_b32 v14, 0
  v_mov_b32 v15, 0
  buffer_load_dwordx4 v[8:11], v4, s[12:15], s27 offen
  buffer_load_dwordx4 v[28:31], v4, s[12:15], s28 offen
  s_mov_b64 exec, 0xffffffff
  buffer_load_dwordx2 v[12:13], v6, s[12:15], s27 offen offset:1024
  buffer_load_dwordx2 v[14:15], v6, s[12:15], s28 offen offset:1024
  s_mov_b64 exec, -1
  v_and_b32 v5, 31, v0
  v_and_b32 v6, 0x13, v5
  v_and_b32 v7, 4, v5
  v_lshl_or_b32 v6, v7, 1, v6
  v_and_b32 v7, 8, v5
  v_lshrrev_b32 v7, 1, v7
  v_or_b32 v6, v6, v7
  v_lshrrev_b32 v7, 5, v0
  v_lshlrev_b32 v1, 9, v7
  v_lshl_add_u32 v1, v6, 4, v1
  v_lshlrev_b32 v2, 3, v6
  v_add_u32 v2, 1024, v2
  v_mul_u32_u24 v3, 320, v7
  v_lshl_add_u32 v3, v5, 4, v3
  v_add_u32 v3, 1280, v3
  v_cmp_eq_u32 vcc, 20, v5
  v_mov_b32 v7, 0x3f803f80
  s_mov_b32 s34, 0x000fffff
  s_mov_b32 s35, 0x000fffff
  v_cndmask_b32 v32, 0, v7, vcc
  v_mov_b32 v33, v32
  v_mov_b32 v34, v32
  v_mov_b32 v35, v32
  v_mov_b32 v36, v32
  v_mov_b32 v37, v32
  v_mov_b32 v38, v32
  v_mov_b32 v39, v32
  v_mov_b32 v40, v32
  v_mov_b32 v41, v32
  v_mov_b32 v42, v32
  v_mov_b32 v43, v32
  v_mov_b32 v44, v32
  v_mov_b32 v45, v32
  v_mov_b32 v46, v32
  v_mov_b32 v47, v32
  v_mov_b32 v96, 0
  v_mov_b32 v97, 0
  v_mov_b32 v98, 0
  v_mov_b32 v99, 0
  v_mov_b32 v100, 0
  v_mov_b32 v101, 0
  v_mov_b32 v102, 0
  v_mov_b32 v103, 0
  v_mov_b32 v104, 0
  v_mov_b32 v105, 0
  v_mov_b32 v106, 0
  v_mov_b32 v107, 0
  v_mov_b32 v108, 0
  v_mov_b32 v109, 0
  v_mov_b32 v110, 0
  v_mov_b32 v111, 0
  v_mov_b32 v112, 0
  v_mov_b32 v113, 0
  v_mov_b32 v114, 0
  v_mov_b32 v115, 0
  v_mov_b32 v116, 0
  v_mov_b32 v117, 0
  v_mov_b32 v118, 0
  v_mov_b32 v119, 0
  v_mov_b32 v120, 0
  v_mov_b32 v121, 0
  v_mov_b32 v122, 0
  v_mov_b32 v123, 0
  v_mov_b32 v124, 0
  v_mov_b32 v125, 0
  v_mov_b32 v126, 0
  v_mov_b32 v127, 0
  v_mov_b32 v84, 0
  v_mov_b32 v85, 0
  v_mov_b32 v86, 0
  v_mov_b32 v87, 0
  v_add_u32 v1, 143360, v1
  v_add_u32 v2, 143360, v2
  v_add_u32 v3, 143360, v3
  s_waitcnt vmcnt(0)
  s_barrier
  s_setprio 3
  s_lshl_b32 s52, s2, 2
  s_add_u32 s52, s52, s33
  s_cmp_ge_u32 s52, 880
  s_cbranch_scc1 f0_kernel_p0_rp_done
  s_load_dwordx2 s[54:55], s[0:1], 8
  s_load_dwordx2 s[56:57], s[0:1], 16
  s_load_dwordx2 s[58:59], s[0:1], 32
  s_load_dwordx2 s[60:61], s[0:1], 48
  s_waitcnt lgkmcnt(0)
  s_cmp_ge_u32 s52, 640
  s_cbranch_scc1 f0_kernel_p0_rp_w2
  s_cmp_ge_u32 s52, 540
  s_cbranch_scc1 f0_kernel_p0_rp_wo
  s_cmp_ge_u32 s52, 300
  s_cbranch_scc1 f0_kernel_p0_rp_w1
f0_kernel_p0_rp_wq:
  s_sub_u32 s52, s52, 0
  s_mov_b32 s64, s54
  s_mov_b32 s65, s55
  s_mov_b32 s66, 0x258000
  s_mov_b32 s67, 0x00020000
  s_mov_b32 s53, 3840
  s_mov_b32 s54, 512
  s_mov_b32 s55, 128
  s_mov_b32 s56, 163840
  s_mov_b32 s57, 0
  s_mul_i32 s58, s52, 2185
  s_lshr_b32 s58, s58, 16
  s_mul_i32 s59, s58, 30
  s_sub_u32 s59, s52, s59
  s_mov_b32 s60, 0x800000
  s_mov_b32 s61, 7680
  s_branch f0_kernel_p0_rp_go
f0_kernel_p0_rp_w1:
  s_sub_u32 s52, s52, 300
  s_mov_b32 s64, s58
  s_mov_b32 s65, s59
  s_mov_b32 s66, 0x1e0000
  s_mov_b32 s67, 0x00020000
  s_mov_b32 s53, 3072
  s_mov_b32 s54, 683
  s_mov_b32 s55, 96
  s_mov_b32 s56, 122880
  s_mov_b32 s57, 3145728
  s_mul_i32 s58, s52, 2731
  s_lshr_b32 s58, s58, 16
  s_mul_i32 s59, s58, 24
  s_sub_u32 s59, s52, s59
  s_mov_b32 s60, 0x820000
  s_mov_b32 s61, 6144
  s_branch f0_kernel_p0_rp_go
f0_kernel_p0_rp_wo:
  s_sub_u32 s52, s52, 540
  s_mov_b32 s64, s56
  s_mov_b32 s65, s57
  s_mov_b32 s66, 0xc8000
  s_mov_b32 s67, 0x00020000
  s_mov_b32 s53, 1280
  s_mov_b32 s54, 820
  s_mov_b32 s55, 80
  s_mov_b32 s56, 102400
  s_mov_b32 s57, 5242880
  s_mul_i32 s58, s52, 6554
  s_lshr_b32 s58, s58, 16
  s_mul_i32 s59, s58, 10
  s_sub_u32 s59, s52, s59
  s_mov_b32 s60, 0xffffffff
  s_mov_b32 s61, 0
  s_branch f0_kernel_p0_rp_go
f0_kernel_p0_rp_w2:
  s_sub_u32 s52, s52, 640
  s_mov_b32 s64, s60
  s_mov_b32 s65, s61
  s_mov_b32 s66, 0x1e0000
  s_mov_b32 s67, 0x00020000
  s_mov_b32 s53, 1280
  s_mov_b32 s54, 820
  s_mov_b32 s55, 80
  s_mov_b32 s56, 245760
  s_mov_b32 s57, 6291456
  s_mul_i32 s58, s52, 6554
  s_lshr_b32 s58, s58, 16
  s_mul_i32 s59, s58, 10
  s_sub_u32 s59, s52, s59
  s_mov_b32 s60, 0xffffffff
  s_mov_b32 s61, 0
  s_branch f0_kernel_p0_rp_go
f0_kernel_p0_rp_go:
  v_lshrrev_b32 v4, 3, v0
  v_and_b32 v5, 7, v0
  v_bfe_u32 v6, v0, 4, 1
  v_lshlrev_b32 v6, 2, v6
  v_xor_b32 v5, v5, v6
  v_mul_lo_u32 v4, v4, s53
  v_lshl_add_u32 v129, v5, 4, v4
  s_lshl_b32 s62, s58, 6
  s_mul_i32 s62, s62, s53
  s_lshl_b32 s63, s59, 7
  s_add_u32 s52, s62, s63
  s_mul_i32 s69, s33, 8192
  s_sub_u32 s69, 44288, s69
  v_bfe_u32 v6, v0, 2, 2
  v_lshrrev_b32 v7, 4, v0
  v_lshlrev_b32 v7, 1, v7
  v_bfe_u32 v5, v0, 1, 1
  v_add_u32 v7, v7, v5
  v_lshrrev_b32 v5, 1, v6
  v_lshlrev_b32 v5, 2, v5
  v_xor_b32 v7, v7, v5
  v_lshlrev_b32 v7, 4, v7
  v_lshl_add_u32 v7, v6, 7, v7
  v_and_b32 v5, 1, v0
  v_lshl_add_u32 v7, v5, 3, v7
  v_add_u32 v128, s69, v7
  s_lshl_b32 s53, s53, 3
  s_add_u32 m0, s69, 0
  s_nop 0
  buffer_load_dwordx4 v129, s[64:67], s52 offen lds
  s_add_u32 m0, s69, 1024
  s_add_u32 s52, s52, s53
  buffer_load_dwordx4 v129, s[64:67], s52 offen lds
  s_add_u32 m0, s69, 2048
  s_add_u32 s52, s52, s53
  buffer_load_dwordx4 v129, s[64:67], s52 offen lds
  s_add_u32 m0, s69, 3072
  s_add_u32 s52, s52, s53
  buffer_load_dwordx4 v129, s[64:67], s52 offen lds
  s_add_u32 m0, s69, 4096
  s_add_u32 s52, s52, s53
  buffer_load_dwordx4 v129, s[64:67], s52 offen lds
  s_add_u32 m0, s69, 5120
  s_add_u32 s52, s52, s53
  buffer_load_dwordx4 v129, s[64:67], s52 offen lds
  s_add_u32 m0, s69, 6144
  s_add_u32 s52, s52, s53
  buffer_load_dwordx4 v129, s[64:67], s52 offen lds
  s_add_u32 m0, s69, 7168
  s_add_u32 s52, s52, s53
  buffer_load_dwordx4 v129, s[64:67], s52 offen lds
  s_lshl_b32 s62, s59, 6
  v_add_u32 v4, s62, v0
  v_mul_lo_u32 v5, v4, s54
  v_lshrrev_b32 v5, 16, v5
  v_mul_lo_u32 v6, v5, s55
  v_sub_u32 v6, v4, v6
  v_mul_lo_u32 v5, v5, s56
  v_lshl_add_u32 v5, v6, 4, v5
  s_lshl_b32 s63, s55, 4
  s_lshl_b32 s62, s58, 3
  s_mul_i32 s62, s62, s63
  s_add_u32 s62, s62, s57
  v_mov_b32 v6, 0
  v_mov_b32 v7, 0
  s_waitcnt vmcnt(7)
  ds_read_b64_tr_b16 v[48:49], v128 offset:0
  ds_read_b64_tr_b16 v[50:51], v128 offset:512
  s_waitcnt vmcnt(6)
  ds_read_b64_tr_b16 v[52:53], v128 offset:1024
  ds_read_b64_tr_b16 v[54:55], v128 offset:1536
  s_waitcnt vmcnt(5)
  ds_read_b64_tr_b16 v[56:57], v128 offset:2048
  ds_read_b64_tr_b16 v[58:59], v128 offset:2560
  s_waitcnt vmcnt(4)
  ds_read_b64_tr_b16 v[60:61], v128 offset:3072
  ds_read_b64_tr_b16 v[62:63], v128 offset:3584
  s_waitcnt vmcnt(3)
  ds_read_b64_tr_b16 v[64:65], v128 offset:4096
  ds_read_b64_tr_b16 v[66:67], v128 offset:4608
  s_waitcnt vmcnt(2)
  ds_read_b64_tr_b16 v[68:69], v128 offset:5120
  ds_read_b64_tr_b16 v[70:71], v128 offset:5632
  s_waitcnt vmcnt(1)
  ds_read_b64_tr_b16 v[72:73], v128 offset:6144
  ds_read_b64_tr_b16 v[74:75], v128 offset:6656
  s_waitcnt vmcnt(0)
  ds_read_b64_tr_b16 v[76:77], v128 offset:7168
  ds_read_b64_tr_b16 v[78:79], v128 offset:7680
  s_waitcnt lgkmcnt(14)
  buffer_store_dwordx4 v[48:51], v5, s[12:15], s62 offen sc1
  s_add_u32 s62, s62, s63
  s_waitcnt lgkmcnt(12)
  buffer_store_dwordx4 v[52:55], v5, s[12:15], s62 offen sc1
  s_add_u32 s62, s62, s63
  s_waitcnt lgkmcnt(10)
  buffer_store_dwordx4 v[56:59], v5, s[12:15], s62 offen sc1
  s_add_u32 s62, s62, s63
  s_waitcnt lgkmcnt(8)
  buffer_store_dwordx4 v[60:63], v5, s[12:15], s62 offen sc1
  s_add_u32 s62, s62, s63
  s_waitcnt lgkmcnt(6)
  buffer_store_dwordx4 v[64:67], v5, s[12:15], s62 offen sc1
  s_add_u32 s62, s62, s63
  s_waitcnt lgkmcnt(4)
  buffer_store_dwordx4 v[68:71], v5, s[12:15], s62 offen sc1
  s_add_u32 s62, s62, s63
  s_waitcnt lgkmcnt(2)
  buffer_store_dwordx4 v[72:75], v5, s[12:15], s62 offen sc1
  s_add_u32 s62, s62, s63
  s_waitcnt lgkmcnt(0)
  buffer_store_dwordx4 v[76:79], v5, s[12:15], s62 offen sc1
  s_cmp_eq_u32 s60, 0xffffffff
  s_cbranch_scc1 f0_kernel_p0_rp_done
  v_dot2c_f32_bf16 v6, 0x3f803f80, v48
  v_dot2c_f32_bf16 v7, 0x3f803f80, v49
  v_dot2c_f32_bf16 v6, 0x3f803f80, v50
  v_dot2c_f32_bf16 v7, 0x3f803f80, v51
  v_dot2c_f32_bf16 v6, 0x3f803f80, v52
  v_dot2c_f32_bf16 v7, 0x3f803f80, v53
  v_dot2c_f32_bf16 v6, 0x3f803f80, v54
  v_dot2c_f32_bf16 v7, 0x3f803f80, v55
  v_dot2c_f32_bf16 v6, 0x3f803f80, v56
  v_dot2c_f32_bf16 v7, 0x3f803f80, v57
  v_dot2c_f32_bf16 v6, 0x3f803f80, v58
  v_dot2c_f32_bf16 v7, 0x3f803f80, v59
  v_dot2c_f32_bf16 v6, 0x3f803f80, v60
  v_dot2c_f32_bf16 v7, 0x3f803f80, v61
  v_dot2c_f32_bf16 v6, 0x3f803f80, v62
  v_dot2c_f32_bf16 v7, 0x3f803f80, v63
  v_dot2c_f32_bf16 v6, 0x3f803f80, v64
  v_dot2c_f32_bf16 v7, 0x3f803f80, v65
  v_dot2c_f32_bf16 v6, 0x3f803f80, v66
  v_dot2c_f32_bf16 v7, 0x3f803f80, v67
  v_dot2c_f32_bf16 v6, 0x3f803f80, v68
  v_dot2c_f32_bf16 v7, 0x3f803f80, v69
  v_dot2c_f32_bf16 v6, 0x3f803f80, v70
  v_dot2c_f32_bf16 v7, 0x3f803f80, v71
  v_dot2c_f32_bf16 v6, 0x3f803f80, v72
  v_dot2c_f32_bf16 v7, 0x3f803f80, v73
  v_dot2c_f32_bf16 v6, 0x3f803f80, v74
  v_dot2c_f32_bf16 v7, 0x3f803f80, v75
  v_dot2c_f32_bf16 v6, 0x3f803f80, v76
  v_dot2c_f32_bf16 v7, 0x3f803f80, v77
  v_dot2c_f32_bf16 v6, 0x3f803f80, v78
  v_dot2c_f32_bf16 v7, 0x3f803f80, v79
  s_mul_i32 s62, s58, s61
  s_add_u32 s62, s62, s60
  v_lshlrev_b32 v4, 2, v4
  s_nop 3
  v_add_f32 v6, v6, v7
  s_nop 0
  buffer_store_dword v6, v4, s[12:15], s62 offen sc1
f0_kernel_p0_rp_done:
  s_mov_b32 s64, s26
  s_mul_i32 s40, s24, 5
  s_lshr_b32 s40, s40, 1
  s_lshl_b32 s40, s40, 9
  s_mul_i32 s41, s25, 40960
  s_add_u32 s40, s40, s41
  s_add_u32 s40, s40, 18874368
  v_lshlrev_b32 v90, 7, v0
  v_add_u32 v91, 39424, v90
  v_cmp_gt_u32 vcc, 12, v0
  s_nop 1
  v_cndmask_b32 v90, v91, v90, vcc
  s_mov_b64 exec, 0xffffff
  buffer_load_dword v91, v90, s[12:15], s40 offen
  s_mov_b64 exec, -1
  s_lshr_b32 s41, s25, 1
  s_mul_i32 s40, s41, 81920
  s_mul_i32 s42, s24, 2560
  s_add_u32 s40, s40, s42
  s_add_u32 s40, s40, 12582912
  v_lshlrev_b32 v92, 7, v0
  s_mov_b64 exec, 0xfffff
  buffer_load_dword v93, v92, s[12:15], s40 offen
  s_lshr_b32 s40, s24, 1
  s_lshl_b32 s40, s40, 14
  s_lshl_b32 s41, s41, 9
  s_add_u32 s40, s40, s41
  s_and_b32 s41, s24, 1
  s_lshl_b32 s41, s41, 8
  s_add_u32 s40, s40, s41
  s_add_u32 s40, s40, 8912896
  s_mov_b64 exec, 3
  buffer_load_dword v94, v92, s[12:15], s40 offen
  s_mov_b64 exec, -1
  s_setprio 0
  ds_read_b128 v[16:19], v1 offset:0
  ds_read_b64 v[24:25], v2 offset:0
  ds_read_b128 v[20:23], v1 offset:2560
  ds_read_b64 v[26:27], v2 offset:2560
  s_mov_b64 exec, s[34:35]
  ds_read_b128 v[32:35], v3 offset:0
  ds_read_b128 v[36:39], v3 offset:640
  s_mov_b64 exec, -1
  s_waitcnt lgkmcnt(4)
  v_mfma_f32_32x32x16_bf16 v[48:63], v[16:19], v[8:11], 0
  s_mov_b32 s36, 1
  s_nop 7
  s_nop 1
  v_mfma_f32_32x32x8bf16_1k v[48:63], v[24:25], v[12:13], v[48:63]
  s_nop 7
  s_nop 3
f0_kernel_p0_looph:
  s_cmp_eq_u32 s36, 1
  s_cselect_b32 s37, 0, 20480
  s_waitcnt lgkmcnt(0)
  v_mfma_f32_32x32x16_bf16 v[64:79], v[16:19], v[28:31], 0
  v_exp_f32 v48, v48
  v_exp_f32 v49, v49
  v_exp_f32 v50, v50
  v_exp_f32 v51, v51
  v_cvt_pk_bf16_f32 v80, v48, v49
  v_cvt_pk_bf16_f32 v81, v50, v51
  v_mfma_f32_32x32x16_bf16 v[112:127], v[44:47], v[84:87], v[112:127]
  v_exp_f32 v52, v52
  s_mov_b64 exec, s[34:35]
  ds_read_b128 v[40:43], v3 offset:2560
  ds_read_b128 v[44:47], v3 offset:3200
  s_mov_b64 exec, -1
  v_exp_f32 v53, v53
  v_exp_f32 v54, v54
  v_exp_f32 v55, v55
  v_cvt_pk_bf16_f32 v82, v52, v53
  v_cvt_pk_bf16_f32 v83, v54, v55
  v_mfma_f32_32x32x8bf16_1k v[64:79], v[24:25], v[14:15], v[64:79]
  v_exp_f32 v56, v56
  ds_read_b128 v[16:19], v1 offset:5120
  v_exp_f32 v57, v57
  ds_read_b64 v[24:25], v2 offset:5120
  v_exp_f32 v58, v58
  v_exp_f32 v59, v59
  v_cvt_pk_bf16_f32 v84, v56, v57
  v_cvt_pk_bf16_f32 v85, v58, v59
  v_mfma_f32_32x32x16_bf16 v[96:111], v[32:35], v[80:83], v[96:111]
  v_exp_f32 v60, v60
  v_exp_f32 v61, v61
  v_exp_f32 v62, v62
  v_exp_f32 v63, v63
  v_cvt_pk_bf16_f32 v86, v60, v61
  v_cvt_pk_bf16_f32 v87, v62, v63
  v_mfma_f32_32x32x16_bf16 v[48:63], v[20:23], v[8:11], 0
  v_exp_f32 v64, v64
  v_exp_f32 v65, v65
  v_exp_f32 v66, v66
  v_exp_f32 v67, v67
  v_cvt_pk_bf16_f32 v80, v64, v65
  v_cvt_pk_bf16_f32 v81, v66, v67
  v_mfma_f32_32x32x16_bf16 v[96:111], v[36:39], v[84:87], v[96:111]
  v_exp_f32 v68, v68
  v_exp_f32 v69, v69
  v_exp_f32 v70, v70
  v_exp_f32 v71, v71
  v_cvt_pk_bf16_f32 v82, v68, v69
  v_cvt_pk_bf16_f32 v83, v70, v71
  v_mfma_f32_32x32x8bf16_1k v[48:63], v[26:27], v[12:13], v[48:63]
  v_exp_f32 v72, v72
  v_exp_f32 v73, v73
  v_exp_f32 v74, v74
  v_exp_f32 v75, v75
  v_cvt_pk_bf16_f32 v84, v72, v73
  v_cvt_pk_bf16_f32 v85, v74, v75
  v_mfma_f32_32x32x16_bf16 v[112:127], v[32:35], v[80:83], v[112:127]
  v_exp_f32 v76, v76
  v_exp_f32 v77, v77
  v_exp_f32 v78, v78
  v_exp_f32 v79, v79
  v_cvt_pk_bf16_f32 v86, v76, v77
  v_cvt_pk_bf16_f32 v87, v78, v79
  s_waitcnt lgkmcnt(0)
  v_mfma_f32_32x32x16_bf16 v[64:79], v[20:23], v[28:31], 0
  v_exp_f32 v48, v48
  v_exp_f32 v49, v49
  v_exp_f32 v50, v50
  v_exp_f32 v51, v51
  v_cvt_pk_bf16_f32 v80, v48, v49
  v_cvt_pk_bf16_f32 v81, v50, v51
  v_mfma_f32_32x32x16_bf16 v[112:127], v[36:39], v[84:87], v[112:127]
  v_exp_f32 v52, v52
  s_mov_b64 exec, s[34:35]
  ds_read_b128 v[32:35], v3 offset:5120
  ds_read_b128 v[36:39], v3 offset:5760
  s_mov_b64 exec, -1
  v_exp_f32 v53, v53
  v_exp_f32 v54, v54
  v_exp_f32 v55, v55
  v_cvt_pk_bf16_f32 v82, v52, v53
  v_cvt_pk_bf16_f32 v83, v54, v55
  v_mfma_f32_32x32x8bf16_1k v[64:79], v[26:27], v[14:15], v[64:79]
  v_exp_f32 v56, v56
  ds_read_b128 v[20:23], v1 offset:7680
  v_exp_f32 v57, v57
  ds_read_b64 v[26:27], v2 offset:7680
  v_exp_f32 v58, v58
  v_exp_f32 v59, v59
  v_cvt_pk_bf16_f32 v84, v56, v57
  v_cvt_pk_bf16_f32 v85, v58, v59
  v_mfma_f32_32x32x16_bf16 v[96:111], v[40:43], v[80:83], v[96:111]
  v_exp_f32 v60, v60
  v_exp_f32 v61, v61
  v_exp_f32 v62, v62
  v_exp_f32 v63, v63
  v_cvt_pk_bf16_f32 v86, v60, v61
  v_cvt_pk_bf16_f32 v87, v62, v63
  v_mfma_f32_32x32x16_bf16 v[48:63], v[16:19], v[8:11], 0
  v_exp_f32 v64, v64
  v_exp_f32 v65, v65
  v_exp_f32 v66, v66
  v_exp_f32 v67, v67
  v_cvt_pk_bf16_f32 v80, v64, v65
  v_cvt_pk_bf16_f32 v81, v66, v67
  v_mfma_f32_32x32x16_bf16 v[96:111], v[44:47], v[84:87], v[96:111]
  v_exp_f32 v68, v68
  v_exp_f32 v69, v69
  v_exp_f32 v70, v70
  v_exp_f32 v71, v71
  v_cvt_pk_bf16_f32 v82, v68, v69
  v_cvt_pk_bf16_f32 v83, v70, v71
  v_mfma_f32_32x32x8bf16_1k v[48:63], v[24:25], v[12:13], v[48:63]
  v_exp_f32 v72, v72
  v_exp_f32 v73, v73
  v_exp_f32 v74, v74
  v_exp_f32 v75, v75
  v_cvt_pk_bf16_f32 v84, v72, v73
  v_cvt_pk_bf16_f32 v85, v74, v75
  v_mfma_f32_32x32x16_bf16 v[112:127], v[40:43], v[80:83], v[112:127]
  v_exp_f32 v76, v76
  v_exp_f32 v77, v77
  v_exp_f32 v78, v78
  v_exp_f32 v79, v79
  v_cvt_pk_bf16_f32 v86, v76, v77
  v_cvt_pk_bf16_f32 v87, v78, v79
  s_waitcnt lgkmcnt(0)
  s_waitcnt vmcnt(3)
  s_lshl_b32 s52, s2, 2
  s_add_u32 s52, s52, s33
  s_lshl_b32 s52, s52, 2
  s_add_u32 s52, s52, 9224192
  s_mov_b64 exec, 1
  v_mov_b32 v128, 1
  buffer_store_dword v128, off, s[12:15], s52 sc1
  s_mov_b64 exec, -1
  v_mfma_f32_32x32x16_bf16 v[64:79], v[16:19], v[28:31], 0
  v_exp_f32 v48, v48
  v_exp_f32 v49, v49
  v_exp_f32 v50, v50
  v_exp_f32 v51, v51
  v_cvt_pk_bf16_f32 v80, v48, v49
  v_cvt_pk_bf16_f32 v81, v50, v51
  v_mfma_f32_32x32x16_bf16 v[112:127], v[44:47], v[84:87], v[112:127]
  v_exp_f32 v52, v52
  s_mov_b64 exec, s[34:35]
  ds_read_b128 v[40:43], v3 offset:7680
  ds_read_b128 v[44:47], v3 offset:8320
  s_mov_b64 exec, -1
  v_exp_f32 v53, v53
  v_exp_f32 v54, v54
  v_exp_f32 v55, v55
  v_cvt_pk_bf16_f32 v82, v52, v53
  v_cvt_pk_bf16_f32 v83, v54, v55
  v_mfma_f32_32x32x8bf16_1k v[64:79], v[24:25], v[14:15], v[64:79]
  v_exp_f32 v56, v56
  ds_read_b128 v[16:19], v1 offset:10240
  v_exp_f32 v57, v57
  ds_read_b64 v[24:25], v2 offset:10240
  v_exp_f32 v58, v58
  v_exp_f32 v59, v59
  v_cvt_pk_bf16_f32 v84, v56, v57
  v_cvt_pk_bf16_f32 v85, v58, v59
  v_mfma_f32_32x32x16_bf16 v[96:111], v[32:35], v[80:83], v[96:111]
  v_exp_f32 v60, v60
  v_exp_f32 v61, v61
  v_exp_f32 v62, v62
  v_exp_f32 v63, v63
  v_cvt_pk_bf16_f32 v86, v60, v61
  v_cvt_pk_bf16_f32 v87, v62, v63
  v_mfma_f32_32x32x16_bf16 v[48:63], v[20:23], v[8:11], 0
  v_exp_f32 v64, v64
  v_exp_f32 v65, v65
  v_exp_f32 v66, v66
  v_exp_f32 v67, v67
  v_cvt_pk_bf16_f32 v80, v64, v65
  v_cvt_pk_bf16_f32 v81, v66, v67
  v_mfma_f32_32x32x16_bf16 v[96:111], v[36:39], v[84:87], v[96:111]
  v_exp_f32 v68, v68
  v_exp_f32 v69, v69
  v_exp_f32 v70, v70
  v_exp_f32 v71, v71
  v_cvt_pk_bf16_f32 v82, v68, v69
  v_cvt_pk_bf16_f32 v83, v70, v71
  v_mfma_f32_32x32x8bf16_1k v[48:63], v[26:27], v[12:13], v[48:63]
  v_exp_f32 v72, v72
  v_exp_f32 v73, v73
  v_exp_f32 v74, v74
  v_exp_f32 v75, v75
  v_cvt_pk_bf16_f32 v84, v72, v73
  v_cvt_pk_bf16_f32 v85, v74, v75
  v_mfma_f32_32x32x16_bf16 v[112:127], v[32:35], v[80:83], v[112:127]
  v_exp_f32 v76, v76
  v_exp_f32 v77, v77
  v_exp_f32 v78, v78
  v_exp_f32 v79, v79
  v_cvt_pk_bf16_f32 v86, v76, v77
  v_cvt_pk_bf16_f32 v87, v78, v79
  s_waitcnt lgkmcnt(0)
  v_mfma_f32_32x32x16_bf16 v[64:79], v[20:23], v[28:31], 0
  v_exp_f32 v48, v48
  v_exp_f32 v49, v49
  v_exp_f32 v50, v50
  v_exp_f32 v51, v51
  v_cvt_pk_bf16_f32 v80, v48, v49
  v_cvt_pk_bf16_f32 v81, v50, v51
  v_mfma_f32_32x32x16_bf16 v[112:127], v[36:39], v[84:87], v[112:127]
  v_exp_f32 v52, v52
  s_mov_b64 exec, s[34:35]
  ds_read_b128 v[32:35], v3 offset:10240
  ds_read_b128 v[36:39], v3 offset:10880
  s_mov_b64 exec, -1
  v_exp_f32 v53, v53
  v_exp_f32 v54, v54
  v_exp_f32 v55, v55
  v_cvt_pk_bf16_f32 v82, v52, v53
  v_cvt_pk_bf16_f32 v83, v54, v55
  v_mfma_f32_32x32x8bf16_1k v[64:79], v[26:27], v[14:15], v[64:79]
  v_exp_f32 v56, v56
  ds_read_b128 v[20:23], v1 offset:12800
  v_exp_f32 v57, v57
  ds_read_b64 v[26:27], v2 offset:12800
  v_exp_f32 v58, v58
  v_exp_f32 v59, v59
  v_cvt_pk_bf16_f32 v84, v56, v57
  v_cvt_pk_bf16_f32 v85, v58, v59
  v_mfma_f32_32x32x16_bf16 v[96:111], v[40:43], v[80:83], v[96:111]
  v_exp_f32 v60, v60
  v_exp_f32 v61, v61
  v_exp_f32 v62, v62
  v_exp_f32 v63, v63
  v_cvt_pk_bf16_f32 v86, v60, v61
  v_cvt_pk_bf16_f32 v87, v62, v63
  v_mfma_f32_32x32x16_bf16 v[48:63], v[16:19], v[8:11], 0
  v_exp_f32 v64, v64
  v_exp_f32 v65, v65
  v_exp_f32 v66, v66
  v_exp_f32 v67, v67
  v_cvt_pk_bf16_f32 v80, v64, v65
  v_cvt_pk_bf16_f32 v81, v66, v67
  v_mfma_f32_32x32x16_bf16 v[96:111], v[44:47], v[84:87], v[96:111]
  v_exp_f32 v68, v68
  v_exp_f32 v69, v69
  v_exp_f32 v70, v70
  v_exp_f32 v71, v71
  v_cvt_pk_bf16_f32 v82, v68, v69
  v_cvt_pk_bf16_f32 v83, v70, v71
  v_mfma_f32_32x32x8bf16_1k v[48:63], v[24:25], v[12:13], v[48:63]
  v_exp_f32 v72, v72
  v_exp_f32 v73, v73
  v_exp_f32 v74, v74
  v_exp_f32 v75, v75
  v_cvt_pk_bf16_f32 v84, v72, v73
  v_cvt_pk_bf16_f32 v85, v74, v75
  v_mfma_f32_32x32x16_bf16 v[112:127], v[40:43], v[80:83], v[112:127]
  v_exp_f32 v76, v76
  v_exp_f32 v77, v77
  v_exp_f32 v78, v78
  v_exp_f32 v79, v79
  v_cvt_pk_bf16_f32 v86, v76, v77
  v_cvt_pk_bf16_f32 v87, v78, v79
  s_waitcnt lgkmcnt(0)
  v_mfma_f32_32x32x16_bf16 v[64:79], v[16:19], v[28:31], 0
  v_exp_f32 v48, v48
  v_exp_f32 v49, v49
  v_exp_f32 v50, v50
  v_exp_f32 v51, v51
  v_cvt_pk_bf16_f32 v80, v48, v49
  v_cvt_pk_bf16_f32 v81, v50, v51
  v_mfma_f32_32x32x16_bf16 v[112:127], v[44:47], v[84:87], v[112:127]
  v_exp_f32 v52, v52
  s_mov_b64 exec, s[34:35]
  ds_read_b128 v[40:43], v3 offset:12800
  ds_read_b128 v[44:47], v3 offset:13440
  s_mov_b64 exec, -1
  v_exp_f32 v53, v53
  v_exp_f32 v54, v54
  v_exp_f32 v55, v55
  v_cvt_pk_bf16_f32 v82, v52, v53
  v_cvt_pk_bf16_f32 v83, v54, v55
  v_mfma_f32_32x32x8bf16_1k v[64:79], v[24:25], v[14:15], v[64:79]
  v_exp_f32 v56, v56
  ds_read_b128 v[16:19], v1 offset:15360
  v_exp_f32 v57, v57
  ds_read_b64 v[24:25], v2 offset:15360
  v_exp_f32 v58, v58
  v_exp_f32 v59, v59
  v_cvt_pk_bf16_f32 v84, v56, v57
  v_cvt_pk_bf16_f32 v85, v58, v59
  v_mfma_f32_32x32x16_bf16 v[96:111], v[32:35], v[80:83], v[96:111]
  v_exp_f32 v60, v60
  v_exp_f32 v61, v61
  v_exp_f32 v62, v62
  v_exp_f32 v63, v63
  v_cvt_pk_bf16_f32 v86, v60, v61
  v_cvt_pk_bf16_f32 v87, v62, v63
  v_mfma_f32_32x32x16_bf16 v[48:63], v[20:23], v[8:11], 0
  v_exp_f32 v64, v64
  v_exp_f32 v65, v65
  v_exp_f32 v66, v66
  v_exp_f32 v67, v67
  v_cvt_pk_bf16_f32 v80, v64, v65
  v_cvt_pk_bf16_f32 v81, v66, v67
  v_mfma_f32_32x32x16_bf16 v[96:111], v[36:39], v[84:87], v[96:111]
  v_exp_f32 v68, v68
  v_exp_f32 v69, v69
  v_exp_f32 v70, v70
  v_exp_f32 v71, v71
  v_cvt_pk_bf16_f32 v82, v68, v69
  v_cvt_pk_bf16_f32 v83, v70, v71
  v_mfma_f32_32x32x8bf16_1k v[48:63], v[26:27], v[12:13], v[48:63]
  v_exp_f32 v72, v72
  v_exp_f32 v73, v73
  v_exp_f32 v74, v74
  v_exp_f32 v75, v75
  v_cvt_pk_bf16_f32 v84, v72, v73
  v_cvt_pk_bf16_f32 v85, v74, v75
  v_mfma_f32_32x32x16_bf16 v[112:127], v[32:35], v[80:83], v[112:127]
  v_exp_f32 v76, v76
  v_exp_f32 v77, v77
  v_exp_f32 v78, v78
  v_exp_f32 v79, v79
  v_cvt_pk_bf16_f32 v86, v76, v77
  v_cvt_pk_bf16_f32 v87, v78, v79
  s_waitcnt lgkmcnt(0)
  v_mfma_f32_32x32x16_bf16 v[64:79], v[20:23], v[28:31], 0
  v_exp_f32 v48, v48
  v_exp_f32 v49, v49
  v_exp_f32 v50, v50
  v_exp_f32 v51, v51
  v_cvt_pk_bf16_f32 v80, v48, v49
  v_cvt_pk_bf16_f32 v81, v50, v51
  v_mfma_f32_32x32x16_bf16 v[112:127], v[36:39], v[84:87], v[112:127]
  v_exp_f32 v52, v52
  s_mov_b64 exec, s[34:35]
  ds_read_b128 v[32:35], v3 offset:15360
  ds_read_b128 v[36:39], v3 offset:16000
  s_mov_b64 exec, -1
  v_exp_f32 v53, v53
  v_exp_f32 v54, v54
  v_exp_f32 v55, v55
  v_cvt_pk_bf16_f32 v82, v52, v53
  v_cvt_pk_bf16_f32 v83, v54, v55
  v_mfma_f32_32x32x8bf16_1k v[64:79], v[26:27], v[14:15], v[64:79]
  v_exp_f32 v56, v56
  ds_read_b128 v[20:23], v1 offset:17920
  v_exp_f32 v57, v57
  ds_read_b64 v[26:27], v2 offset:17920
  v_exp_f32 v58, v58
  v_exp_f32 v59, v59
  v_cvt_pk_bf16_f32 v84, v56, v57
  v_cvt_pk_bf16_f32 v85, v58, v59
  v_mfma_f32_32x32x16_bf16 v[96:111], v[40:43], v[80:83], v[96:111]
  v_exp_f32 v60, v60
  v_exp_f32 v61, v61
  v_exp_f32 v62, v62
  v_exp_f32 v63, v63
  v_cvt_pk_bf16_f32 v86, v60, v61
  v_cvt_pk_bf16_f32 v87, v62, v63
  v_mfma_f32_32x32x16_bf16 v[48:63], v[16:19], v[8:11], 0
  v_exp_f32 v64, v64
  v_exp_f32 v65, v65
  v_exp_f32 v66, v66
  v_exp_f32 v67, v67
  v_cvt_pk_bf16_f32 v80, v64, v65
  v_cvt_pk_bf16_f32 v81, v66, v67
  v_mfma_f32_32x32x16_bf16 v[96:111], v[44:47], v[84:87], v[96:111]
  v_exp_f32 v68, v68
  v_exp_f32 v69, v69
  v_exp_f32 v70, v70
  v_exp_f32 v71, v71
  v_cvt_pk_bf16_f32 v82, v68, v69
  v_cvt_pk_bf16_f32 v83, v70, v71
  v_mfma_f32_32x32x8bf16_1k v[48:63], v[24:25], v[12:13], v[48:63]
  v_exp_f32 v72, v72
  v_exp_f32 v73, v73
  v_exp_f32 v74, v74
  v_exp_f32 v75, v75
  v_cvt_pk_bf16_f32 v84, v72, v73
  v_cvt_pk_bf16_f32 v85, v74, v75
  v_mfma_f32_32x32x16_bf16 v[112:127], v[40:43], v[80:83], v[112:127]
  v_exp_f32 v76, v76
  v_exp_f32 v77, v77
  v_exp_f32 v78, v78
  v_exp_f32 v79, v79
  v_cvt_pk_bf16_f32 v86, v76, v77
  v_cvt_pk_bf16_f32 v87, v78, v79
  s_waitcnt lgkmcnt(0)
  v_lshlrev_b32 v144, 4, v0
  s_mov_b32 s52, 9224192
  buffer_load_dwordx4 v[128:131], v144, s[12:15], s52 offen offset:0 sc1
  buffer_load_dwordx4 v[132:135], v144, s[12:15], s52 offen offset:1024 sc1
  buffer_load_dwordx4 v[136:139], v144, s[12:15], s52 offen offset:2048 sc1
  buffer_load_dwordx4 v[140:143], v144, s[12:15], s52 offen offset:3072 sc1
  v_mfma_f32_32x32x16_bf16 v[64:79], v[16:19], v[28:31], 0
  v_exp_f32 v48, v48
  v_exp_f32 v49, v49
  v_exp_f32 v50, v50
  v_exp_f32 v51, v51
  v_cvt_pk_bf16_f32 v80, v48, v49
  v_cvt_pk_bf16_f32 v81, v50, v51
  v_mfma_f32_32x32x16_bf16 v[112:127], v[44:47], v[84:87], v[112:127]
  v_exp_f32 v52, v52
  s_mov_b64 exec, s[34:35]
  ds_read_b128 v[40:43], v3 offset:17920
  ds_read_b128 v[44:47], v3 offset:18560
  s_mov_b64 exec, -1
  v_exp_f32 v53, v53
  v_exp_f32 v54, v54
  v_exp_f32 v55, v55
  v_cvt_pk_bf16_f32 v82, v52, v53
  v_cvt_pk_bf16_f32 v83, v54, v55
  v_mfma_f32_32x32x8bf16_1k v[64:79], v[24:25], v[14:15], v[64:79]
  v_add_u32 v1, s37, v1
  v_add_u32 v2, s37, v2
  v_exp_f32 v56, v56
  ds_read_b128 v[16:19], v1 offset:0
  v_exp_f32 v57, v57
  ds_read_b64 v[24:25], v2 offset:0
  v_exp_f32 v58, v58
  v_exp_f32 v59, v59
  v_cvt_pk_bf16_f32 v84, v56, v57
  v_cvt_pk_bf16_f32 v85, v58, v59
  v_mfma_f32_32x32x16_bf16 v[96:111], v[32:35], v[80:83], v[96:111]
  v_exp_f32 v60, v60
  v_exp_f32 v61, v61
  v_exp_f32 v62, v62
  v_exp_f32 v63, v63
  v_cvt_pk_bf16_f32 v86, v60, v61
  v_cvt_pk_bf16_f32 v87, v62, v63
  v_mfma_f32_32x32x16_bf16 v[48:63], v[20:23], v[8:11], 0
  v_exp_f32 v64, v64
  v_exp_f32 v65, v65
  v_exp_f32 v66, v66
  v_exp_f32 v67, v67
  v_cvt_pk_bf16_f32 v80, v64, v65
  v_cvt_pk_bf16_f32 v81, v66, v67
  v_mfma_f32_32x32x16_bf16 v[96:111], v[36:39], v[84:87], v[96:111]
  v_exp_f32 v68, v68
  v_exp_f32 v69, v69
  v_exp_f32 v70, v70
  v_exp_f32 v71, v71
  v_cvt_pk_bf16_f32 v82, v68, v69
  v_cvt_pk_bf16_f32 v83, v70, v71
  v_mfma_f32_32x32x8bf16_1k v[48:63], v[26:27], v[12:13], v[48:63]
  v_exp_f32 v72, v72
  v_exp_f32 v73, v73
  v_exp_f32 v74, v74
  v_exp_f32 v75, v75
  v_cvt_pk_bf16_f32 v84, v72, v73
  v_cvt_pk_bf16_f32 v85, v74, v75
  v_mfma_f32_32x32x16_bf16 v[112:127], v[32:35], v[80:83], v[112:127]
  v_exp_f32 v76, v76
  v_exp_f32 v77, v77
  v_exp_f32 v78, v78
  v_exp_f32 v79, v79
  v_cvt_pk_bf16_f32 v86, v76, v77
  v_cvt_pk_bf16_f32 v87, v78, v79
  s_waitcnt lgkmcnt(0)
  v_mfma_f32_32x32x16_bf16 v[64:79], v[20:23], v[28:31], 0
  v_exp_f32 v48, v48
  v_exp_f32 v49, v49
  v_exp_f32 v50, v50
  v_exp_f32 v51, v51
  v_cvt_pk_bf16_f32 v80, v48, v49
  v_cvt_pk_bf16_f32 v81, v50, v51
  v_mfma_f32_32x32x16_bf16 v[112:127], v[36:39], v[84:87], v[112:127]
  v_add_u32 v3, s37, v3
  v_exp_f32 v52, v52
  s_mov_b64 exec, s[34:35]
  ds_read_b128 v[32:35], v3 offset:0
  ds_read_b128 v[36:39], v3 offset:640
  s_mov_b64 exec, -1
  v_exp_f32 v53, v53
  v_exp_f32 v54, v54
  v_exp_f32 v55, v55
  v_cvt_pk_bf16_f32 v82, v52, v53
  v_cvt_pk_bf16_f32 v83, v54, v55
  v_mfma_f32_32x32x8bf16_1k v[64:79], v[26:27], v[14:15], v[64:79]
  v_exp_f32 v56, v56
  ds_read_b128 v[20:23], v1 offset:2560
  v_exp_f32 v57, v57
  ds_read_b64 v[26:27], v2 offset:2560
  v_exp_f32 v58, v58
  v_exp_f32 v59, v59
  v_cvt_pk_bf16_f32 v84, v56, v57
  v_cvt_pk_bf16_f32 v85, v58, v59
  v_mfma_f32_32x32x16_bf16 v[96:111], v[40:43], v[80:83], v[96:111]
  v_exp_f32 v60, v60
  v_exp_f32 v61, v61
  v_exp_f32 v62, v62
  v_exp_f32 v63, v63
  v_cvt_pk_bf16_f32 v86, v60, v61
  v_cvt_pk_bf16_f32 v87, v62, v63
  v_mfma_f32_32x32x16_bf16 v[48:63], v[16:19], v[8:11], 0
  v_exp_f32 v64, v64
  v_exp_f32 v65, v65
  v_exp_f32 v66, v66
  v_exp_f32 v67, v67
  v_cvt_pk_bf16_f32 v80, v64, v65
  v_cvt_pk_bf16_f32 v81, v66, v67
  v_mfma_f32_32x32x16_bf16 v[96:111], v[44:47], v[84:87], v[96:111]
  v_exp_f32 v68, v68
  v_exp_f32 v69, v69
  v_exp_f32 v70, v70
  v_exp_f32 v71, v71
  v_cvt_pk_bf16_f32 v82, v68, v69
  v_cvt_pk_bf16_f32 v83, v70, v71
  v_mfma_f32_32x32x8bf16_1k v[48:63], v[24:25], v[12:13], v[48:63]
  v_exp_f32 v72, v72
  v_exp_f32 v73, v73
  v_exp_f32 v74, v74
  v_exp_f32 v75, v75
  v_cvt_pk_bf16_f32 v84, v72, v73
  v_cvt_pk_bf16_f32 v85, v74, v75
  v_mfma_f32_32x32x16_bf16 v[112:127], v[40:43], v[80:83], v[112:127]
  v_exp_f32 v76, v76
  v_exp_f32 v77, v77
  v_exp_f32 v78, v78
  v_exp_f32 v79, v79
  v_cvt_pk_bf16_f32 v86, v76, v77
  v_cvt_pk_bf16_f32 v87, v78, v79
  s_sub_u32 s36, s36, 1
  s_cmp_lg_u32 s36, 0
  s_cbranch_scc1 f0_kernel_p0_looph
  s_nop 0
  v_mfma_f32_32x32x16_bf16 v[112:127], v[44:47], v[84:87], v[112:127]
  s_mov_b32 s53, 16384
f0_kernel_p0_wpoll3:
  s_waitcnt vmcnt(0)
  v_and_b32 v128, v128, v129
  v_and_b32 v128, v128, v130
  v_and_b32 v128, v128, v131
  v_and_b32 v128, v128, v132
  v_and_b32 v128, v128, v133
  v_and_b32 v128, v128, v134
  v_and_b32 v128, v128, v135
  v_and_b32 v128, v128, v136
  v_and_b32 v128, v128, v137
  v_and_b32 v128, v128, v138
  v_and_b32 v128, v128, v139
  v_and_b32 v128, v128, v140
  v_and_b32 v128, v128, v141
  v_and_b32 v128, v128, v142
  v_and_b32 v128, v128, v143
  v_cmp_ne_u32 vcc, 0, v128
  s_nop 1
  s_cmp_eq_u64 vcc, -1
  s_cbranch_scc1 f0_kernel_p0_wready4
  s_sleep 4
  v_lshlrev_b32 v144, 4, v0
  s_mov_b32 s52, 9224192
  buffer_load_dwordx4 v[128:131], v144, s[12:15], s52 offen offset:0 sc1
  buffer_load_dwordx4 v[132:135], v144, s[12:15], s52 offen offset:1024 sc1
  buffer_load_dwordx4 v[136:139], v144, s[12:15], s52 offen offset:2048 sc1
  buffer_load_dwordx4 v[140:143], v144, s[12:15], s52 offen offset:3072 sc1
  s_sub_u32 s53, s53, 1
  s_cbranch_scc0 f0_kernel_p0_wpoll3
f0_kernel_p0_wready4:
  s_and_b32 s62, s2, 7
  s_lshl_b32 s62, s62, 7
  s_add_u32 s62, s62, 9216000
  buffer_load_dword v250, off, s[12:15], s62 sc1
  s_lshl_b32 s40, s33, 1
  s_add_u32 s41, s40, 1
  s_add_u32 s40, s40, 0
  s_mul_i32 s41, s41, 2688
  s_mul_i32 s40, s40, 2688
  v_lshlrev_b32 v4, 4, v0
  v_and_b32 v5, 31, v0
  v_lshlrev_b32 v5, 2, v5
  v_add_u32 v16, s41, v4
  v_add_u32 v17, s41, v5
  v_add_u32 v18, s40, v4
  v_add_u32 v19, s40, v5
  v_mov_b32 v56, 0
  v_mov_b32 v57, 0
  v_mov_b32 v58, 0
  v_mov_b32 v59, 0
  s_waitcnt lgkmcnt(0)
  s_nop 0
  ds_write_b128 v16, v[96:99]
  ds_write_b128 v16, v[100:103] offset:1024
  s_mov_b64 exec, 0xffffffff
  ds_write_b128 v16, v[104:107] offset:2048
  s_not_b64 exec, exec
  ds_write_b32 v17, v104 offset:2560
  s_mov_b64 exec, -1
  s_mul_i32 s42, s24, 5
  v_lshrrev_b32 v21, 5, v0
  v_add_u32 v21, s42, v21
  v_lshrrev_b32 v20, 1, v21
  v_lshlrev_b32 v20, 9, v20
  v_and_b32 v21, 1, v21
  v_lshl_add_u32 v20, v21, 3, v20
  v_and_b32 v21, 31, v0
  v_lshl_add_u32 v20, v21, 4, v20
  s_add_u32 s51, s25, 1
  s_mul_i32 s51, s51, 40960
  s_add_u32 s51, s51, 18874368
  s_waitcnt lgkmcnt(0)
  s_barrier
  ds_read_b128 v[48:51], v18
  ds_read_b128 v[52:55], v18 offset:1024
  s_mov_b64 exec, 0xffffffff
  ds_read_b128 v[56:59], v18 offset:2048
  s_not_b64 exec, exec
  ds_read_b32 v56, v19 offset:2560
  s_mov_b64 exec, -1
  s_waitcnt lgkmcnt(2)
  v_add_f32 v112, v112, v48
  v_add_f32 v113, v113, v49
  v_add_f32 v114, v114, v50
  v_add_f32 v115, v115, v51
  v_add_f32 v116, v116, v52
  v_add_f32 v117, v117, v53
  v_add_f32 v118, v118, v54
  v_add_f32 v119, v119, v55
  s_waitcnt lgkmcnt(0)
  v_add_f32 v120, v120, v56
  v_add_f32 v121, v121, v57
  v_add_f32 v122, v122, v58
  v_add_f32 v123, v123, v59
  v_mov_b32 v4, v120
  v_mov_b32 v5, v120
  v_mov_b32 v16, 0
  s_nop 0
  v_permlane32_swap_b32 v4, v5
  v_fma_f32 v16, v112, 0, v16
  v_fma_f32 v16, v113, 0, v16
  v_fma_f32 v16, v114, 0, v16
  v_fma_f32 v16, v115, 0, v16
  v_fma_f32 v16, v116, 0, v16
  v_fma_f32 v16, v117, 0, v16
  v_fma_f32 v16, v118, 0, v16
  v_fma_f32 v16, v119, 0, v16
  v_fma_f32 v16, v120, 0, v16
  v_fma_f32 v16, v121, 0, v16
  v_fma_f32 v16, v122, 0, v16
  v_fma_f32 v16, v123, 0, v16
  s_mov_b32 s40, 0x53800000
  s_mov_b32 s41, 0x2b800000
  v_cmp_eq_f32 vcc, 0, v16
  v_cmp_lt_f32 s[42:43], s41, v5
  v_cmp_gt_f32 s[44:45], s40, v5
  s_nop 3
  s_and_b64 vcc, vcc, s[42:43]
  s_and_b64 vcc, vcc, s[44:45]
  s_cmp_eq_u64 vcc, -1
  s_cbranch_scc0 f0_kernel_p0_slowh
f0_kernel_p0_finh:
  v_rcp_f32 v5, v5
  s_nop 0
  v_pk_mul_f32 v[112:113], v[112:113], v[4:5] op_sel:[0,1] op_sel_hi:[1,1]
  v_pk_mul_f32 v[114:115], v[114:115], v[4:5] op_sel:[0,1] op_sel_hi:[1,1]
  v_pk_mul_f32 v[116:117], v[116:117], v[4:5] op_sel:[0,1] op_sel_hi:[1,1]
  v_pk_mul_f32 v[118:119], v[118:119], v[4:5] op_sel:[0,1] op_sel_hi:[1,1]
  v_pk_mul_f32 v[120:121], v[120:121], v[4:5] op_sel:[0,1] op_sel_hi:[1,1]
  v_pk_mul_f32 v[122:123], v[122:123], v[4:5] op_sel:[0,1] op_sel_hi:[1,1]
  v_cvt_pk_bf16_f32 v22, v112, v113
  v_cvt_pk_bf16_f32 v23, v114, v115
  v_cvt_pk_bf16_f32 v24, v116, v117
  v_cvt_pk_bf16_f32 v25, v118, v119
  v_cvt_pk_bf16_f32 v26, v120, v121
  v_cvt_pk_bf16_f32 v27, v122, v123
  buffer_store_dwordx2 v[22:23], v20, s[12:15], s51 offen
  buffer_store_dwordx2 v[24:25], v20, s[12:15], s51 offen offset:512
  s_mov_b64 exec, 0xffffffff
  buffer_store_dwordx2 v[26:27], v20, s[12:15], s51 offen offset:1024
  s_waitcnt vmcnt(0)
  s_mov_b64 exec, -1
  s_and_b32 s62, s2, 7
  s_lshl_b32 s62, s62, 7
  s_add_u32 s62, s62, 9216000
  s_mov_b32 s65, 16384
f0_kernel_p0_mpoll5:
  v_readfirstlane_b32 s67, v250
  s_and_b32 s66, s67, 63
  s_cmp_eq_u32 s66, 32
  s_cbranch_scc1 f0_kernel_p0_mpolled6
  s_sleep 2
  buffer_load_dword v250, off, s[12:15], s62 sc1
  s_waitcnt vmcnt(0)
  s_sub_u32 s65, s65, 1
  s_cbranch_scc0 f0_kernel_p0_mpoll5
f0_kernel_p0_mpolled6:
  s_getreg_b32 s66, hwreg(HW_REG_XCC_ID, 0, 4)
  s_mul_i32 s65, s66, s66
  s_lshl_b32 s65, s65, 16
  s_lshl_b32 s66, s66, 6
  s_add_u32 s65, s65, s66
  s_add_u32 s65, s65, 1
  s_lshl_b32 s65, s65, 5
  s_cmp_lg_u32 s65, s67
  s_cselect_b32 s63, 1, 0
  s_add_u32 s37, s25, 1
  s_lshl_b32 s37, s37, 7
  s_lshl_b32 s38, s24, 2
  s_add_u32 s37, s37, s38
  s_add_u32 s37, s37, 9175040
  s_mov_b64 exec, 1
  v_mov_b32 v2, 1
  s_cmp_eq_u32 s63, 0
  s_cbranch_scc1 f0_kernel_p0_afast8
  buffer_wbl2 sc1
  s_waitcnt vmcnt(0)
  buffer_store_dword v2, off, s[12:15], s37 sc1
  s_branch f0_kernel_p0_asig7
f0_kernel_p0_afast8:
  buffer_store_dword v2, off, s[12:15], s37
f0_kernel_p0_asig7:
  s_mov_b64 exec, -1
  s_setprio 0
  s_branch f0_kernel_p1_entry
f0_kernel_p0_slowh:
  v_and_b32 v5, 31, v0
  v_and_b32 v6, 0x13, v5
  v_and_b32 v7, 4, v5
  v_lshl_or_b32 v6, v7, 1, v6
  v_and_b32 v7, 8, v5
  v_lshrrev_b32 v7, 1, v7
  v_or_b32 v6, v6, v7
  v_lshrrev_b32 v7, 5, v0
  v_lshlrev_b32 v1, 9, v7
  v_lshl_add_u32 v1, v6, 4, v1
  v_lshlrev_b32 v2, 3, v6
  v_add_u32 v2, 1024, v2
  v_mul_u32_u24 v3, 320, v7
  v_lshl_add_u32 v3, v5, 4, v3
  v_add_u32 v3, 1280, v3
  v_mov_b32 v88, 0xff61b1e6
  v_mov_b32 v112, 0
  v_mov_b32 v113, 0
  v_mov_b32 v114, 0
  v_mov_b32 v115, 0
  v_mov_b32 v116, 0
  v_mov_b32 v117, 0
  v_mov_b32 v118, 0
  v_mov_b32 v119, 0
  v_mov_b32 v120, 0
  v_mov_b32 v121, 0
  v_mov_b32 v122, 0
  v_mov_b32 v123, 0
  v_mov_b32 v124, 0
  v_mov_b32 v125, 0
  v_mov_b32 v126, 0
  v_mov_b32 v127, 0
  s_mov_b32 s36, 0
f0_kernel_p0_slh:
  buffer_load_dwordx4 v[16:19], v1, s[12:15], s50 offen
  buffer_load_dwordx2 v[24:25], v2, s[12:15], s50 offen
  s_mov_b64 exec, s[34:35]
  buffer_load_dwordx4 v[32:35], v3, s[12:15], s50 offen
  buffer_load_dwordx4 v[36:39], v3, s[12:15], s50 offen offset:640
  s_mov_b64 exec, -1
  s_waitcnt vmcnt(0)
  v_mfma_f32_32x32x16_bf16 v[64:79], v[16:19], v[28:31], 0
  s_nop 7
  s_nop 1
  v_mfma_f32_32x32x8bf16_1k v[64:79], v[24:25], v[14:15], v[64:79]
  s_nop 7
  s_nop 3
  v_max3_f32 v4, v64, v65, v66
  v_max3_f32 v4, v4, v67, v68
  v_max3_f32 v4, v4, v69, v70
  v_max3_f32 v4, v4, v71, v72
  v_max3_f32 v4, v4, v73, v74
  v_max3_f32 v4, v4, v75, v76
  v_max3_f32 v4, v4, v77, v78
  v_max_f32 v4, v4, v79
  v_mov_b32 v5, v4
  s_nop 1
  v_permlane32_swap_b32 v4, v5
  s_nop 1
  v_max3_f32 v4, v4, v5, v88
  v_sub_f32 v5, v88, v4
  v_exp_f32 v5, v5
  v_mov_b32 v88, v4
  v_sub_f32 v64, v64, v4
  v_sub_f32 v65, v65, v4
  v_sub_f32 v66, v66, v4
  v_sub_f32 v67, v67, v4
  v_sub_f32 v68, v68, v4
  v_sub_f32 v69, v69, v4
  v_sub_f32 v70, v70, v4
  v_sub_f32 v71, v71, v4
  v_sub_f32 v72, v72, v4
  v_sub_f32 v73, v73, v4
  v_sub_f32 v74, v74, v4
  v_sub_f32 v75, v75, v4
  v_sub_f32 v76, v76, v4
  v_sub_f32 v77, v77, v4
  v_sub_f32 v78, v78, v4
  v_sub_f32 v79, v79, v4
  v_exp_f32 v64, v64
  v_exp_f32 v65, v65
  v_exp_f32 v66, v66
  v_exp_f32 v67, v67
  v_exp_f32 v68, v68
  v_exp_f32 v69, v69
  v_exp_f32 v70, v70
  v_exp_f32 v71, v71
  v_exp_f32 v72, v72
  v_exp_f32 v73, v73
  v_exp_f32 v74, v74
  v_exp_f32 v75, v75
  v_exp_f32 v76, v76
  v_exp_f32 v77, v77
  v_exp_f32 v78, v78
  v_exp_f32 v79, v79
  v_mul_f32 v112, v112, v5
  v_mul_f32 v113, v113, v5
  v_mul_f32 v114, v114, v5
  v_mul_f32 v115, v115, v5
  v_mul_f32 v116, v116, v5
  v_mul_f32 v117, v117, v5
  v_mul_f32 v118, v118, v5
  v_mul_f32 v119, v119, v5
  v_mul_f32 v120, v120, v5
  v_mul_f32 v121, v121, v5
  v_mul_f32 v122, v122, v5
  v_mul_f32 v123, v123, v5
  v_cvt_pk_bf16_f32 v80, v64, v65
  v_cvt_pk_bf16_f32 v81, v66, v67
  v_cvt_pk_bf16_f32 v82, v68, v69
  v_cvt_pk_bf16_f32 v83, v70, v71
  v_cvt_pk_bf16_f32 v84, v72, v73
  v_cvt_pk_bf16_f32 v85, v74, v75
  v_cvt_pk_bf16_f32 v86, v76, v77
  v_cvt_pk_bf16_f32 v87, v78, v79
  v_add_u32 v1, 2560, v1
  v_add_u32 v2, 2560, v2
  v_add_u32 v3, 2560, v3
  s_nop 4
  v_mfma_f32_32x32x16_bf16 v[112:127], v[32:35], v[80:83], v[112:127]
  v_mfma_f32_32x32x16_bf16 v[112:127], v[36:39], v[84:87], v[112:127]
  s_nop 7
  s_nop 3
  s_add_u32 s36, s36, 1
  s_cmp_lt_u32 s36, 64
  s_cbranch_scc1 f0_kernel_p0_slh
  v_mov_b32 v4, v120
  v_mov_b32 v5, v120
  s_nop 1
  v_permlane32_swap_b32 v4, v5
  s_nop 1
  s_branch f0_kernel_p0_finh
f0_kernel_p0_compute:
  s_setprio 2
  s_waitcnt lgkmcnt(0)
  s_mov_b32 s12, s6
  s_mov_b32 s13, s7
  s_mov_b32 s14, 0x3200000
  s_mov_b32 s15, 0x00020000
  v_and_b32 v5, 31, v0
  v_lshlrev_b32 v6, 3, v5
  v_mov_b32 v12, 0
  v_mov_b32 v13, 0
  v_mov_b32 v14, 0
  v_mov_b32 v15, 0
  buffer_load_dwordx4 v[8:11], v4, s[12:15], s27 offen
  buffer_load_dwordx4 v[28:31], v4, s[12:15], s28 offen
  s_mov_b64 exec, 0xffffffff
  buffer_load_dwordx2 v[12:13], v6, s[12:15], s27 offen offset:1024
  buffer_load_dwordx2 v[14:15], v6, s[12:15], s28 offen offset:1024
  s_mov_b64 exec, -1
  v_and_b32 v5, 31, v0
  v_and_b32 v6, 0x13, v5
  v_and_b32 v7, 4, v5
  v_lshl_or_b32 v6, v7, 1, v6
  v_and_b32 v7, 8, v5
  v_lshrrev_b32 v7, 1, v7
  v_or_b32 v6, v6, v7
  v_lshrrev_b32 v7, 5, v0
  v_lshlrev_b32 v1, 9, v7
  v_lshl_add_u32 v1, v6, 4, v1
  v_lshlrev_b32 v2, 3, v6
  v_add_u32 v2, 1024, v2
  v_mul_u32_u24 v3, 320, v7
  v_lshl_add_u32 v3, v5, 4, v3
  v_add_u32 v3, 1280, v3
  v_cmp_eq_u32 vcc, 20, v5
  v_mov_b32 v7, 0x3f803f80
  s_mov_b32 s34, 0x000fffff
  s_mov_b32 s35, 0x000fffff
  v_cndmask_b32 v32, 0, v7, vcc
  v_mov_b32 v33, v32
  v_mov_b32 v34, v32
  v_mov_b32 v35, v32
  v_mov_b32 v36, v32
  v_mov_b32 v37, v32
  v_mov_b32 v38, v32
  v_mov_b32 v39, v32
  v_mov_b32 v40, v32
  v_mov_b32 v41, v32
  v_mov_b32 v42, v32
  v_mov_b32 v43, v32
  v_mov_b32 v44, v32
  v_mov_b32 v45, v32
  v_mov_b32 v46, v32
  v_mov_b32 v47, v32
  v_mov_b32 v96, 0
  v_mov_b32 v97, 0
  v_mov_b32 v98, 0
  v_mov_b32 v99, 0
  v_mov_b32 v100, 0
  v_mov_b32 v101, 0
  v_mov_b32 v102, 0
  v_mov_b32 v103, 0
  v_mov_b32 v104, 0
  v_mov_b32 v105, 0
  v_mov_b32 v106, 0
  v_mov_b32 v107, 0
  v_mov_b32 v108, 0
  v_mov_b32 v109, 0
  v_mov_b32 v110, 0
  v_mov_b32 v111, 0
  v_mov_b32 v112, 0
  v_mov_b32 v113, 0
  v_mov_b32 v114, 0
  v_mov_b32 v115, 0
  v_mov_b32 v116, 0
  v_mov_b32 v117, 0
  v_mov_b32 v118, 0
  v_mov_b32 v119, 0
  v_mov_b32 v120, 0
  v_mov_b32 v121, 0
  v_mov_b32 v122, 0
  v_mov_b32 v123, 0
  v_mov_b32 v124, 0
  v_mov_b32 v125, 0
  v_mov_b32 v126, 0
  v_mov_b32 v127, 0
  v_mov_b32 v84, 0
  v_mov_b32 v85, 0
  v_mov_b32 v86, 0
  v_mov_b32 v87, 0
  s_waitcnt vmcnt(0)
  s_barrier
  ds_read_b128 v[16:19], v1 offset:0
  ds_read_b64 v[24:25], v2 offset:0
  ds_read_b128 v[20:23], v1 offset:2560
  ds_read_b64 v[26:27], v2 offset:2560
  s_mov_b64 exec, s[34:35]
  ds_read_b128 v[32:35], v3 offset:0
  ds_read_b128 v[36:39], v3 offset:640
  s_mov_b64 exec, -1
  s_waitcnt lgkmcnt(4)
  v_mfma_f32_32x32x16_bf16 v[48:63], v[16:19], v[8:11], 0
  s_mov_b32 s36, 14
  s_mov_b32 s38, 0x3200
  s_nop 7
  s_nop 1
  v_mfma_f32_32x32x8bf16_1k v[48:63], v[24:25], v[12:13], v[48:63]
  s_nop 7
  s_nop 3
f0_kernel_p0_loopm:
  s_bitcmp1_b32 s38, s36
  s_cbranch_scc0 f0_kernel_p0_nosyncm
  s_barrier
f0_kernel_p0_nosyncm:
  s_cmp_eq_u32 s36, 1
  s_cselect_b32 s37, 0, 10240
  s_waitcnt lgkmcnt(0)
  v_mfma_f32_32x32x16_bf16 v[64:79], v[16:19], v[28:31], 0
  v_exp_f32 v48, v48
  v_exp_f32 v49, v49
  v_exp_f32 v50, v50
  v_exp_f32 v51, v51
  v_cvt_pk_bf16_f32 v80, v48, v49
  v_cvt_pk_bf16_f32 v81, v50, v51
  v_mfma_f32_32x32x16_bf16 v[112:127], v[44:47], v[84:87], v[112:127]
  v_exp_f32 v52, v52
  s_mov_b64 exec, s[34:35]
  ds_read_b128 v[40:43], v3 offset:2560
  ds_read_b128 v[44:47], v3 offset:3200
  s_mov_b64 exec, -1
  v_exp_f32 v53, v53
  v_exp_f32 v54, v54
  v_exp_f32 v55, v55
  v_cvt_pk_bf16_f32 v82, v52, v53
  v_cvt_pk_bf16_f32 v83, v54, v55
  v_mfma_f32_32x32x8bf16_1k v[64:79], v[24:25], v[14:15], v[64:79]
  v_exp_f32 v56, v56
  ds_read_b128 v[16:19], v1 offset:5120
  v_exp_f32 v57, v57
  ds_read_b64 v[24:25], v2 offset:5120
  v_exp_f32 v58, v58
  v_exp_f32 v59, v59
  v_cvt_pk_bf16_f32 v84, v56, v57
  v_cvt_pk_bf16_f32 v85, v58, v59
  v_mfma_f32_32x32x16_bf16 v[96:111], v[32:35], v[80:83], v[96:111]
  v_exp_f32 v60, v60
  v_exp_f32 v61, v61
  v_exp_f32 v62, v62
  v_exp_f32 v63, v63
  v_cvt_pk_bf16_f32 v86, v60, v61
  v_cvt_pk_bf16_f32 v87, v62, v63
  v_mfma_f32_32x32x16_bf16 v[48:63], v[20:23], v[8:11], 0
  v_exp_f32 v64, v64
  v_exp_f32 v65, v65
  v_exp_f32 v66, v66
  v_exp_f32 v67, v67
  v_cvt_pk_bf16_f32 v80, v64, v65
  v_cvt_pk_bf16_f32 v81, v66, v67
  v_mfma_f32_32x32x16_bf16 v[96:111], v[36:39], v[84:87], v[96:111]
  v_exp_f32 v68, v68
  v_exp_f32 v69, v69
  v_exp_f32 v70, v70
  v_exp_f32 v71, v71
  v_cvt_pk_bf16_f32 v82, v68, v69
  v_cvt_pk_bf16_f32 v83, v70, v71
  v_mfma_f32_32x32x8bf16_1k v[48:63], v[26:27], v[12:13], v[48:63]
  v_exp_f32 v72, v72
  v_exp_f32 v73, v73
  v_exp_f32 v74, v74
  v_exp_f32 v75, v75
  v_cvt_pk_bf16_f32 v84, v72, v73
  v_cvt_pk_bf16_f32 v85, v74, v75
  v_mfma_f32_32x32x16_bf16 v[112:127], v[32:35], v[80:83], v[112:127]
  v_exp_f32 v76, v76
  v_exp_f32 v77, v77
  v_exp_f32 v78, v78
  v_exp_f32 v79, v79
  v_cvt_pk_bf16_f32 v86, v76, v77
  v_cvt_pk_bf16_f32 v87, v78, v79
  s_waitcnt lgkmcnt(0)
  v_mfma_f32_32x32x16_bf16 v[64:79], v[20:23], v[28:31], 0
  v_exp_f32 v48, v48
  v_exp_f32 v49, v49
  v_exp_f32 v50, v50
  v_exp_f32 v51, v51
  v_cvt_pk_bf16_f32 v80, v48, v49
  v_cvt_pk_bf16_f32 v81, v50, v51
  v_mfma_f32_32x32x16_bf16 v[112:127], v[36:39], v[84:87], v[112:127]
  v_exp_f32 v52, v52
  s_mov_b64 exec, s[34:35]
  ds_read_b128 v[32:35], v3 offset:5120
  ds_read_b128 v[36:39], v3 offset:5760
  s_mov_b64 exec, -1
  v_exp_f32 v53, v53
  v_exp_f32 v54, v54
  v_exp_f32 v55, v55
  v_cvt_pk_bf16_f32 v82, v52, v53
  v_cvt_pk_bf16_f32 v83, v54, v55
  v_mfma_f32_32x32x8bf16_1k v[64:79], v[26:27], v[14:15], v[64:79]
  v_exp_f32 v56, v56
  ds_read_b128 v[20:23], v1 offset:7680
  v_exp_f32 v57, v57
  ds_read_b64 v[26:27], v2 offset:7680
  v_exp_f32 v58, v58
  v_exp_f32 v59, v59
  v_cvt_pk_bf16_f32 v84, v56, v57
  v_cvt_pk_bf16_f32 v85, v58, v59
  v_mfma_f32_32x32x16_bf16 v[96:111], v[40:43], v[80:83], v[96:111]
  v_exp_f32 v60, v60
  v_exp_f32 v61, v61
  v_exp_f32 v62, v62
  v_exp_f32 v63, v63
  v_cvt_pk_bf16_f32 v86, v60, v61
  v_cvt_pk_bf16_f32 v87, v62, v63
  v_mfma_f32_32x32x16_bf16 v[48:63], v[16:19], v[8:11], 0
  v_exp_f32 v64, v64
  v_exp_f32 v65, v65
  v_exp_f32 v66, v66
  v_exp_f32 v67, v67
  v_cvt_pk_bf16_f32 v80, v64, v65
  v_cvt_pk_bf16_f32 v81, v66, v67
  v_mfma_f32_32x32x16_bf16 v[96:111], v[44:47], v[84:87], v[96:111]
  v_exp_f32 v68, v68
  v_exp_f32 v69, v69
  v_exp_f32 v70, v70
  v_exp_f32 v71, v71
  v_cvt_pk_bf16_f32 v82, v68, v69
  v_cvt_pk_bf16_f32 v83, v70, v71
  v_mfma_f32_32x32x8bf16_1k v[48:63], v[24:25], v[12:13], v[48:63]
  v_exp_f32 v72, v72
  v_exp_f32 v73, v73
  v_exp_f32 v74, v74
  v_exp_f32 v75, v75
  v_cvt_pk_bf16_f32 v84, v72, v73
  v_cvt_pk_bf16_f32 v85, v74, v75
  v_mfma_f32_32x32x16_bf16 v[112:127], v[40:43], v[80:83], v[112:127]
  v_exp_f32 v76, v76
  v_exp_f32 v77, v77
  v_exp_f32 v78, v78
  v_exp_f32 v79, v79
  v_cvt_pk_bf16_f32 v86, v76, v77
  v_cvt_pk_bf16_f32 v87, v78, v79
  s_waitcnt lgkmcnt(0)
  v_mfma_f32_32x32x16_bf16 v[64:79], v[16:19], v[28:31], 0
  v_exp_f32 v48, v48
  v_exp_f32 v49, v49
  v_exp_f32 v50, v50
  v_exp_f32 v51, v51
  v_cvt_pk_bf16_f32 v80, v48, v49
  v_cvt_pk_bf16_f32 v81, v50, v51
  v_mfma_f32_32x32x16_bf16 v[112:127], v[44:47], v[84:87], v[112:127]
  v_exp_f32 v52, v52
  s_mov_b64 exec, s[34:35]
  ds_read_b128 v[40:43], v3 offset:7680
  ds_read_b128 v[44:47], v3 offset:8320
  s_mov_b64 exec, -1
  v_exp_f32 v53, v53
  v_exp_f32 v54, v54
  v_exp_f32 v55, v55
  v_cvt_pk_bf16_f32 v82, v52, v53
  v_cvt_pk_bf16_f32 v83, v54, v55
  v_mfma_f32_32x32x8bf16_1k v[64:79], v[24:25], v[14:15], v[64:79]
  v_add_u32 v1, s37, v1
  v_add_u32 v2, s37, v2
  v_exp_f32 v56, v56
  ds_read_b128 v[16:19], v1 offset:0
  v_exp_f32 v57, v57
  ds_read_b64 v[24:25], v2 offset:0
  v_exp_f32 v58, v58
  v_exp_f32 v59, v59
  v_cvt_pk_bf16_f32 v84, v56, v57
  v_cvt_pk_bf16_f32 v85, v58, v59
  v_mfma_f32_32x32x16_bf16 v[96:111], v[32:35], v[80:83], v[96:111]
  v_exp_f32 v60, v60
  v_exp_f32 v61, v61
  v_exp_f32 v62, v62
  v_exp_f32 v63, v63
  v_cvt_pk_bf16_f32 v86, v60, v61
  v_cvt_pk_bf16_f32 v87, v62, v63
  v_mfma_f32_32x32x16_bf16 v[48:63], v[20:23], v[8:11], 0
  v_exp_f32 v64, v64
  v_exp_f32 v65, v65
  v_exp_f32 v66, v66
  v_exp_f32 v67, v67
  v_cvt_pk_bf16_f32 v80, v64, v65
  v_cvt_pk_bf16_f32 v81, v66, v67
  v_mfma_f32_32x32x16_bf16 v[96:111], v[36:39], v[84:87], v[96:111]
  v_exp_f32 v68, v68
  v_exp_f32 v69, v69
  v_exp_f32 v70, v70
  v_exp_f32 v71, v71
  v_cvt_pk_bf16_f32 v82, v68, v69
  v_cvt_pk_bf16_f32 v83, v70, v71
  v_mfma_f32_32x32x8bf16_1k v[48:63], v[26:27], v[12:13], v[48:63]
  v_exp_f32 v72, v72
  v_exp_f32 v73, v73
  v_exp_f32 v74, v74
  v_exp_f32 v75, v75
  v_cvt_pk_bf16_f32 v84, v72, v73
  v_cvt_pk_bf16_f32 v85, v74, v75
  v_mfma_f32_32x32x16_bf16 v[112:127], v[32:35], v[80:83], v[112:127]
  v_exp_f32 v76, v76
  v_exp_f32 v77, v77
  v_exp_f32 v78, v78
  v_exp_f32 v79, v79
  v_cvt_pk_bf16_f32 v86, v76, v77
  v_cvt_pk_bf16_f32 v87, v78, v79
  s_waitcnt lgkmcnt(0)
  v_mfma_f32_32x32x16_bf16 v[64:79], v[20:23], v[28:31], 0
  v_exp_f32 v48, v48
  v_exp_f32 v49, v49
  v_exp_f32 v50, v50
  v_exp_f32 v51, v51
  v_cvt_pk_bf16_f32 v80, v48, v49
  v_cvt_pk_bf16_f32 v81, v50, v51
  v_mfma_f32_32x32x16_bf16 v[112:127], v[36:39], v[84:87], v[112:127]
  v_add_u32 v3, s37, v3
  v_exp_f32 v52, v52
  s_mov_b64 exec, s[34:35]
  ds_read_b128 v[32:35], v3 offset:0
  ds_read_b128 v[36:39], v3 offset:640
  s_mov_b64 exec, -1
  v_exp_f32 v53, v53
  v_exp_f32 v54, v54
  v_exp_f32 v55, v55
  v_cvt_pk_bf16_f32 v82, v52, v53
  v_cvt_pk_bf16_f32 v83, v54, v55
  v_mfma_f32_32x32x8bf16_1k v[64:79], v[26:27], v[14:15], v[64:79]
  v_exp_f32 v56, v56
  ds_read_b128 v[20:23], v1 offset:2560
  v_exp_f32 v57, v57
  ds_read_b64 v[26:27], v2 offset:2560
  v_exp_f32 v58, v58
  v_exp_f32 v59, v59
  v_cvt_pk_bf16_f32 v84, v56, v57
  v_cvt_pk_bf16_f32 v85, v58, v59
  v_mfma_f32_32x32x16_bf16 v[96:111], v[40:43], v[80:83], v[96:111]
  v_exp_f32 v60, v60
  v_exp_f32 v61, v61
  v_exp_f32 v62, v62
  v_exp_f32 v63, v63
  v_cvt_pk_bf16_f32 v86, v60, v61
  v_cvt_pk_bf16_f32 v87, v62, v63
  v_mfma_f32_32x32x16_bf16 v[48:63], v[16:19], v[8:11], 0
  v_exp_f32 v64, v64
  v_exp_f32 v65, v65
  v_exp_f32 v66, v66
  v_exp_f32 v67, v67
  v_cvt_pk_bf16_f32 v80, v64, v65
  v_cvt_pk_bf16_f32 v81, v66, v67
  v_mfma_f32_32x32x16_bf16 v[96:111], v[44:47], v[84:87], v[96:111]
  v_exp_f32 v68, v68
  v_exp_f32 v69, v69
  v_exp_f32 v70, v70
  v_exp_f32 v71, v71
  v_cvt_pk_bf16_f32 v82, v68, v69
  v_cvt_pk_bf16_f32 v83, v70, v71
  v_mfma_f32_32x32x8bf16_1k v[48:63], v[24:25], v[12:13], v[48:63]
  v_exp_f32 v72, v72
  v_exp_f32 v73, v73
  v_exp_f32 v74, v74
  v_exp_f32 v75, v75
  v_cvt_pk_bf16_f32 v84, v72, v73
  v_cvt_pk_bf16_f32 v85, v74, v75
  v_mfma_f32_32x32x16_bf16 v[112:127], v[40:43], v[80:83], v[112:127]
  v_exp_f32 v76, v76
  v_exp_f32 v77, v77
  v_exp_f32 v78, v78
  v_exp_f32 v79, v79
  v_cvt_pk_bf16_f32 v86, v76, v77
  v_cvt_pk_bf16_f32 v87, v78, v79
  s_sub_u32 s36, s36, 1
  s_cmp_lg_u32 s36, 0
  s_cbranch_scc1 f0_kernel_p0_loopm
  s_nop 0
  v_mfma_f32_32x32x16_bf16 v[112:127], v[44:47], v[84:87], v[112:127]
  s_and_b32 s62, s2, 7
  s_lshl_b32 s62, s62, 7
  s_add_u32 s62, s62, 9216000
  buffer_load_dword v250, off, s[12:15], s62 sc1
  s_lshl_b32 s40, s33, 1
  s_add_u32 s41, s40, 0
  s_add_u32 s40, s40, 1
  s_mul_i32 s41, s41, 2688
  s_mul_i32 s40, s40, 2688
  v_lshlrev_b32 v4, 4, v0
  v_and_b32 v5, 31, v0
  v_lshlrev_b32 v5, 2, v5
  v_add_u32 v16, s41, v4
  v_add_u32 v17, s41, v5
  v_add_u32 v18, s40, v4
  v_add_u32 v19, s40, v5
  v_mov_b32 v56, 0
  v_mov_b32 v57, 0
  v_mov_b32 v58, 0
  v_mov_b32 v59, 0
  s_waitcnt lgkmcnt(0)
  s_nop 7
  ds_write_b128 v16, v[112:115]
  ds_write_b128 v16, v[116:119] offset:1024
  s_mov_b64 exec, 0xffffffff
  ds_write_b128 v16, v[120:123] offset:2048
  s_not_b64 exec, exec
  ds_write_b32 v17, v120 offset:2560
  s_mov_b64 exec, -1
  s_mul_i32 s42, s24, 5
  v_lshrrev_b32 v21, 5, v0
  v_add_u32 v21, s42, v21
  v_lshrrev_b32 v20, 1, v21
  v_lshlrev_b32 v20, 9, v20
  v_and_b32 v21, 1, v21
  v_lshl_add_u32 v20, v21, 3, v20
  v_and_b32 v21, 31, v0
  v_lshl_add_u32 v20, v21, 4, v20
  s_add_u32 s51, s25, 0
  s_mul_i32 s51, s51, 40960
  s_add_u32 s51, s51, 18874368
  s_waitcnt lgkmcnt(0)
  s_barrier
  ds_read_b128 v[48:51], v18
  ds_read_b128 v[52:55], v18 offset:1024
  s_mov_b64 exec, 0xffffffff
  ds_read_b128 v[56:59], v18 offset:2048
  s_not_b64 exec, exec
  ds_read_b32 v56, v19 offset:2560
  s_mov_b64 exec, -1
  s_waitcnt lgkmcnt(2)
  v_add_f32 v96, v96, v48
  v_add_f32 v97, v97, v49
  v_add_f32 v98, v98, v50
  v_add_f32 v99, v99, v51
  v_add_f32 v100, v100, v52
  v_add_f32 v101, v101, v53
  v_add_f32 v102, v102, v54
  v_add_f32 v103, v103, v55
  s_waitcnt lgkmcnt(0)
  v_add_f32 v104, v104, v56
  v_add_f32 v105, v105, v57
  v_add_f32 v106, v106, v58
  v_add_f32 v107, v107, v59
  v_mov_b32 v4, v104
  v_mov_b32 v5, v104
  v_mov_b32 v16, 0
  s_nop 0
  v_permlane32_swap_b32 v4, v5
  v_fma_f32 v16, v96, 0, v16
  v_fma_f32 v16, v97, 0, v16
  v_fma_f32 v16, v98, 0, v16
  v_fma_f32 v16, v99, 0, v16
  v_fma_f32 v16, v100, 0, v16
  v_fma_f32 v16, v101, 0, v16
  v_fma_f32 v16, v102, 0, v16
  v_fma_f32 v16, v103, 0, v16
  v_fma_f32 v16, v104, 0, v16
  v_fma_f32 v16, v105, 0, v16
  v_fma_f32 v16, v106, 0, v16
  v_fma_f32 v16, v107, 0, v16
  s_mov_b32 s40, 0x53800000
  s_mov_b32 s41, 0x2b800000
  v_cmp_eq_f32 vcc, 0, v16
  v_cmp_lt_f32 s[42:43], s41, v5
  v_cmp_gt_f32 s[44:45], s40, v5
  s_nop 3
  s_and_b64 vcc, vcc, s[42:43]
  s_and_b64 vcc, vcc, s[44:45]
  s_cmp_eq_u64 vcc, -1
  s_cbranch_scc0 f0_kernel_p0_slowm
f0_kernel_p0_finm:
  v_rcp_f32 v5, v5
  s_nop 0
  v_pk_mul_f32 v[96:97], v[96:97], v[4:5] op_sel:[0,1] op_sel_hi:[1,1]
  v_pk_mul_f32 v[98:99], v[98:99], v[4:5] op_sel:[0,1] op_sel_hi:[1,1]
  v_pk_mul_f32 v[100:101], v[100:101], v[4:5] op_sel:[0,1] op_sel_hi:[1,1]
  v_pk_mul_f32 v[102:103], v[102:103], v[4:5] op_sel:[0,1] op_sel_hi:[1,1]
  v_pk_mul_f32 v[104:105], v[104:105], v[4:5] op_sel:[0,1] op_sel_hi:[1,1]
  v_pk_mul_f32 v[106:107], v[106:107], v[4:5] op_sel:[0,1] op_sel_hi:[1,1]
  v_cvt_pk_bf16_f32 v22, v96, v97
  v_cvt_pk_bf16_f32 v23, v98, v99
  v_cvt_pk_bf16_f32 v24, v100, v101
  v_cvt_pk_bf16_f32 v25, v102, v103
  v_cvt_pk_bf16_f32 v26, v104, v105
  v_cvt_pk_bf16_f32 v27, v106, v107
  buffer_store_dwordx2 v[22:23], v20, s[12:15], s51 offen
  buffer_store_dwordx2 v[24:25], v20, s[12:15], s51 offen offset:512
  s_mov_b64 exec, 0xffffffff
  buffer_store_dwordx2 v[26:27], v20, s[12:15], s51 offen offset:1024
  s_waitcnt vmcnt(0)
  s_mov_b64 exec, -1
  s_and_b32 s62, s2, 7
  s_lshl_b32 s62, s62, 7
  s_add_u32 s62, s62, 9216000
  s_mov_b32 s65, 16384
f0_kernel_p0_mpoll9:
  v_readfirstlane_b32 s67, v250
  s_and_b32 s66, s67, 63
  s_cmp_eq_u32 s66, 32
  s_cbranch_scc1 f0_kernel_p0_mpolled10
  s_sleep 2
  buffer_load_dword v250, off, s[12:15], s62 sc1
  s_waitcnt vmcnt(0)
  s_sub_u32 s65, s65, 1
  s_cbranch_scc0 f0_kernel_p0_mpoll9
f0_kernel_p0_mpolled10:
  s_getreg_b32 s66, hwreg(HW_REG_XCC_ID, 0, 4)
  s_mul_i32 s65, s66, s66
  s_lshl_b32 s65, s65, 16
  s_lshl_b32 s66, s66, 6
  s_add_u32 s65, s65, s66
  s_add_u32 s65, s65, 1
  s_lshl_b32 s65, s65, 5
  s_cmp_lg_u32 s65, s67
  s_cselect_b32 s63, 1, 0
  s_add_u32 s37, s25, 0
  s_lshl_b32 s37, s37, 7
  s_lshl_b32 s38, s24, 2
  s_add_u32 s37, s37, s38
  s_add_u32 s37, s37, 9175040
  s_mov_b64 exec, 1
  v_mov_b32 v2, 1
  s_cmp_eq_u32 s63, 0
  s_cbranch_scc1 f0_kernel_p0_afast12
  buffer_wbl2 sc1
  s_waitcnt vmcnt(0)
  buffer_store_dword v2, off, s[12:15], s37 sc1
  s_branch f0_kernel_p0_asig11
f0_kernel_p0_afast12:
  buffer_store_dword v2, off, s[12:15], s37
f0_kernel_p0_asig11:
  v_mov_b32 v1, 147456
  v_mov_b32 v2, 0
  ds_write_b32 v1, v2
  s_waitcnt lgkmcnt(0)
  s_mov_b64 exec, -1
  s_setprio 0
  s_branch f0_kernel_p1_entry
f0_kernel_p0_slowm:
  v_and_b32 v5, 31, v0
  v_and_b32 v6, 0x13, v5
  v_and_b32 v7, 4, v5
  v_lshl_or_b32 v6, v7, 1, v6
  v_and_b32 v7, 8, v5
  v_lshrrev_b32 v7, 1, v7
  v_or_b32 v6, v6, v7
  v_lshrrev_b32 v7, 5, v0
  v_lshlrev_b32 v1, 9, v7
  v_lshl_add_u32 v1, v6, 4, v1
  v_lshlrev_b32 v2, 3, v6
  v_add_u32 v2, 1024, v2
  v_mul_u32_u24 v3, 320, v7
  v_lshl_add_u32 v3, v5, 4, v3
  v_add_u32 v3, 1280, v3
  v_mov_b32 v88, 0xff61b1e6
  v_mov_b32 v96, 0
  v_mov_b32 v97, 0
  v_mov_b32 v98, 0
  v_mov_b32 v99, 0
  v_mov_b32 v100, 0
  v_mov_b32 v101, 0
  v_mov_b32 v102, 0
  v_mov_b32 v103, 0
  v_mov_b32 v104, 0
  v_mov_b32 v105, 0
  v_mov_b32 v106, 0
  v_mov_b32 v107, 0
  v_mov_b32 v108, 0
  v_mov_b32 v109, 0
  v_mov_b32 v110, 0
  v_mov_b32 v111, 0
  s_mov_b32 s36, 0
f0_kernel_p0_slm:
  buffer_load_dwordx4 v[16:19], v1, s[12:15], s50 offen
  buffer_load_dwordx2 v[24:25], v2, s[12:15], s50 offen
  s_mov_b64 exec, s[34:35]
  buffer_load_dwordx4 v[32:35], v3, s[12:15], s50 offen
  buffer_load_dwordx4 v[36:39], v3, s[12:15], s50 offen offset:640
  s_mov_b64 exec, -1
  s_waitcnt vmcnt(0)
  v_mfma_f32_32x32x16_bf16 v[48:63], v[16:19], v[8:11], 0
  s_nop 7
  s_nop 1
  v_mfma_f32_32x32x8bf16_1k v[48:63], v[24:25], v[12:13], v[48:63]
  s_nop 7
  s_nop 3
  v_max3_f32 v4, v48, v49, v50
  v_max3_f32 v4, v4, v51, v52
  v_max3_f32 v4, v4, v53, v54
  v_max3_f32 v4, v4, v55, v56
  v_max3_f32 v4, v4, v57, v58
  v_max3_f32 v4, v4, v59, v60
  v_max3_f32 v4, v4, v61, v62
  v_max_f32 v4, v4, v63
  v_mov_b32 v5, v4
  s_nop 1
  v_permlane32_swap_b32 v4, v5
  s_nop 1
  v_max3_f32 v4, v4, v5, v88
  v_sub_f32 v5, v88, v4
  v_exp_f32 v5, v5
  v_mov_b32 v88, v4
  v_sub_f32 v48, v48, v4
  v_sub_f32 v49, v49, v4
  v_sub_f32 v50, v50, v4
  v_sub_f32 v51, v51, v4
  v_sub_f32 v52, v52, v4
  v_sub_f32 v53, v53, v4
  v_sub_f32 v54, v54, v4
  v_sub_f32 v55, v55, v4
  v_sub_f32 v56, v56, v4
  v_sub_f32 v57, v57, v4
  v_sub_f32 v58, v58, v4
  v_sub_f32 v59, v59, v4
  v_sub_f32 v60, v60, v4
  v_sub_f32 v61, v61, v4
  v_sub_f32 v62, v62, v4
  v_sub_f32 v63, v63, v4
  v_exp_f32 v48, v48
  v_exp_f32 v49, v49
  v_exp_f32 v50, v50
  v_exp_f32 v51, v51
  v_exp_f32 v52, v52
  v_exp_f32 v53, v53
  v_exp_f32 v54, v54
  v_exp_f32 v55, v55
  v_exp_f32 v56, v56
  v_exp_f32 v57, v57
  v_exp_f32 v58, v58
  v_exp_f32 v59, v59
  v_exp_f32 v60, v60
  v_exp_f32 v61, v61
  v_exp_f32 v62, v62
  v_exp_f32 v63, v63
  v_mul_f32 v96, v96, v5
  v_mul_f32 v97, v97, v5
  v_mul_f32 v98, v98, v5
  v_mul_f32 v99, v99, v5
  v_mul_f32 v100, v100, v5
  v_mul_f32 v101, v101, v5
  v_mul_f32 v102, v102, v5
  v_mul_f32 v103, v103, v5
  v_mul_f32 v104, v104, v5
  v_mul_f32 v105, v105, v5
  v_mul_f32 v106, v106, v5
  v_mul_f32 v107, v107, v5
  v_cvt_pk_bf16_f32 v80, v48, v49
  v_cvt_pk_bf16_f32 v81, v50, v51
  v_cvt_pk_bf16_f32 v82, v52, v53
  v_cvt_pk_bf16_f32 v83, v54, v55
  v_cvt_pk_bf16_f32 v84, v56, v57
  v_cvt_pk_bf16_f32 v85, v58, v59
  v_cvt_pk_bf16_f32 v86, v60, v61
  v_cvt_pk_bf16_f32 v87, v62, v63
  v_add_u32 v1, 2560, v1
  v_add_u32 v2, 2560, v2
  v_add_u32 v3, 2560, v3
  s_nop 4
  v_mfma_f32_32x32x16_bf16 v[96:111], v[32:35], v[80:83], v[96:111]
  v_mfma_f32_32x32x16_bf16 v[96:111], v[36:39], v[84:87], v[96:111]
  s_nop 7
  s_nop 3
  s_add_u32 s36, s36, 1
  s_cmp_lt_u32 s36, 64
  s_cbranch_scc1 f0_kernel_p0_slm
  v_mov_b32 v4, v104
  v_mov_b32 v5, v104
  s_nop 1
  v_permlane32_swap_b32 v4, v5
  s_nop 1
  s_branch f0_kernel_p0_finm
f0_kernel_p1_entry:
  s_mov_b32 s26, s64
  s_load_dwordx2 s[8:9], s[0:1], 0
  s_and_b32 s20, s2, 7
  s_lshr_b32 s21, s2, 3
  s_and_b32 s22, s21, 3
  s_lshl_b32 s23, s20, 2
  s_add_u32 s24, s23, s22
  s_lshr_b32 s25, s21, 2
  s_cmp_lt_u32 s26, 4
  s_cbranch_scc1 f0_kernel_p1_compute
  s_sub_u32 s26, s26, 4
  v_lshlrev_b32 v1, 4, v0
  s_mul_i32 s40, s25, 102400
  s_mul_i32 s41, s26, 5120
  s_add_u32 s40, s40, s41
  s_add_u32 s40, s40, 5242880
  s_mov_b32 s42, s41
  s_lshl_b32 s43, s24, 1
  s_lshr_b32 s47, s26, 1
  s_add_u32 s43, s43, s47
  s_mul_i32 s43, s43, 40960
  s_and_b32 s47, s26, 1
  s_lshl_b32 s47, s47, 12
  s_add_u32 s43, s43, s47
  s_add_u32 s43, s43, 18874368
  s_lshl_b32 s44, s26, 12
  s_waitcnt lgkmcnt(0)
  s_mov_b32 s12, s6
  s_mov_b32 s13, s7
  s_mov_b32 s14, 0x3200000
  s_mov_b32 s15, 0x00020000
  s_add_u32 m0, s42, 32768
  s_add_u32 s45, s40, 0
  buffer_load_dwordx4 v1, s[12:15], s45 offen offset:0 lds
  buffer_load_dwordx4 v1, s[12:15], s45 offen offset:1024 lds
  buffer_load_dwordx4 v1, s[12:15], s45 offen offset:2048 lds
  buffer_load_dwordx4 v1, s[12:15], s45 offen offset:3072 lds
  s_add_u32 m0, s42, 36864
  s_add_u32 s45, s40, 4096
  buffer_load_dwordx4 v1, s[12:15], s45 offen lds
  s_add_u32 m0, s42, 53248
  s_add_u32 s45, s40, 20480
  buffer_load_dwordx4 v1, s[12:15], s45 offen offset:0 lds
  buffer_load_dwordx4 v1, s[12:15], s45 offen offset:1024 lds
  buffer_load_dwordx4 v1, s[12:15], s45 offen offset:2048 lds
  buffer_load_dwordx4 v1, s[12:15], s45 offen offset:3072 lds
  s_add_u32 m0, s42, 57344
  s_add_u32 s45, s40, 24576
  buffer_load_dwordx4 v1, s[12:15], s45 offen lds
  s_lshl_b32 s67, s24, 1
  s_lshr_b32 s47, s26, 1
  s_add_u32 s67, s67, s47
  s_lshl_b32 s66, s67, 7
  s_add_u32 s66, s66, 9175040
  v_lshlrev_b32 v10, 2, v0
  s_mov_b64 exec, 0xffffffff
  s_mov_b32 s65, 16384
f0_kernel_p1_poll:
  buffer_load_dword v11, v10, s[12:15], s66 offen sc1
  s_waitcnt vmcnt(0)
  v_cmp_ne_u32 vcc, 0, v11
  s_cmp_eq_u32 vcc_lo, 0xffffffff
  s_cbranch_scc1 f0_kernel_p1_polled
  s_sleep 1
  s_sub_u32 s65, s65, 1
  s_cbranch_scc0 f0_kernel_p1_poll
f0_kernel_p1_polled:
  s_mov_b64 exec, -1
  s_cmp_eq_u32 s63, 0
  s_cbranch_scc1 f0_kernel_p1_noacq
  buffer_inv sc1
  s_waitcnt vmcnt(0)
f0_kernel_p1_noacq:
  s_add_u32 m0, s44, 114688
  s_add_u32 s45, s43, 0
  buffer_load_dwordx4 v1, s[12:15], s45 offen offset:0 sc1 lds
  buffer_load_dwordx4 v1, s[12:15], s45 offen offset:1024 sc1 lds
  buffer_load_dwordx4 v1, s[12:15], s45 offen offset:2048 sc1 lds
  buffer_load_dwordx4 v1, s[12:15], s45 offen offset:3072 sc1 lds
  s_add_u32 m0, s44, 131072
  s_add_u32 s45, s43, 8192
  buffer_load_dwordx4 v1, s[12:15], s45 offen offset:0 sc1 lds
  buffer_load_dwordx4 v1, s[12:15], s45 offen offset:1024 sc1 lds
  buffer_load_dwordx4 v1, s[12:15], s45 offen offset:2048 sc1 lds
  buffer_load_dwordx4 v1, s[12:15], s45 offen offset:3072 sc1 lds
  s_add_u32 m0, s42, 73728
  s_add_u32 s45, s40, 40960
  buffer_load_dwordx4 v1, s[12:15], s45 offen offset:0 lds
  buffer_load_dwordx4 v1, s[12:15], s45 offen offset:1024 lds
  buffer_load_dwordx4 v1, s[12:15], s45 offen offset:2048 lds
  buffer_load_dwordx4 v1, s[12:15], s45 offen offset:3072 lds
  s_add_u32 m0, s42, 77824
  s_add_u32 s45, s40, 45056
  buffer_load_dwordx4 v1, s[12:15], s45 offen lds
  s_add_u32 m0, s42, 94208
  s_add_u32 s45, s40, 61440
  buffer_load_dwordx4 v1, s[12:15], s45 offen offset:0 lds
  buffer_load_dwordx4 v1, s[12:15], s45 offen offset:1024 lds
  buffer_load_dwordx4 v1, s[12:15], s45 offen offset:2048 lds
  buffer_load_dwordx4 v1, s[12:15], s45 offen offset:3072 lds
  s_add_u32 m0, s42, 98304
  s_add_u32 s45, s40, 65536
  buffer_load_dwordx4 v1, s[12:15], s45 offen lds
  s_waitcnt vmcnt(14)
  s_barrier
  s_add_u32 m0, s44, 0
  s_add_u32 s45, s43, 16384
  buffer_load_dwordx4 v1, s[12:15], s45 offen offset:0 sc1 lds
  buffer_load_dwordx4 v1, s[12:15], s45 offen offset:1024 sc1 lds
  buffer_load_dwordx4 v1, s[12:15], s45 offen offset:2048 sc1 lds
  buffer_load_dwordx4 v1, s[12:15], s45 offen offset:3072 sc1 lds
  s_add_u32 m0, s44, 16384
  s_add_u32 s45, s43, 24576
  buffer_load_dwordx4 v1, s[12:15], s45 offen offset:0 sc1 lds
  buffer_load_dwordx4 v1, s[12:15], s45 offen offset:1024 sc1 lds
  buffer_load_dwordx4 v1, s[12:15], s45 offen offset:2048 sc1 lds
  buffer_load_dwordx4 v1, s[12:15], s45 offen offset:3072 sc1 lds
  s_waitcnt vmcnt(18)
  s_barrier
  s_add_u32 m0, s44, 114688
  s_add_u32 s45, s43, 32768
  buffer_load_dwordx4 v1, s[12:15], s45 offen offset:0 sc1 lds
  buffer_load_dwordx4 v1, s[12:15], s45 offen offset:1024 sc1 lds
  buffer_load_dwordx4 v1, s[12:15], s45 offen offset:2048 sc1 lds
  buffer_load_dwordx4 v1, s[12:15], s45 offen offset:3072 sc1 lds
  s_add_u32 m0, s42, 32768
  s_add_u32 s45, s40, 81920
  buffer_load_dwordx4 v1, s[12:15], s45 offen offset:0 lds
  buffer_load_dwordx4 v1, s[12:15], s45 offen offset:1024 lds
  buffer_load_dwordx4 v1, s[12:15], s45 offen offset:2048 lds
  buffer_load_dwordx4 v1, s[12:15], s45 offen offset:3072 lds
  s_add_u32 m0, s42, 36864
  s_add_u32 s45, s40, 86016
  buffer_load_dwordx4 v1, s[12:15], s45 offen lds
  v_lshlrev_b32 v12, 7, v0
  s_mul_i32 s46, s24, 196608
  s_lshl_b32 s47, s25, 2
  s_add_u32 s47, s47, s26
  s_mul_i32 s47, s47, 6144
  s_add_u32 s46, s46, s47
  s_add_u32 s46, s46, 31457280
  s_mov_b32 exec_hi, 0xffff
  buffer_load_dword v13, v12, s[12:15], s46 offen
  s_mov_b32 exec_hi, -1
  s_waitcnt vmcnt(14)
  s_barrier
  s_waitcnt vmcnt(10)
  s_barrier
  s_waitcnt vmcnt(1)
  s_barrier
  s_branch f0_kernel_p2_entry
f0_kernel_p1_compute:
  s_and_b32 s27, s26, 1
  s_lshr_b32 s36, s26, 1
  v_lshrrev_b32 v17, 4, v0
  v_and_b32 v16, 15, v0
  v_mul_u32_u24 v20, 1280, v17
  v_lshl_add_u32 v20, v16, 4, v20
  s_mul_i32 s37, s27, 768
  s_add_u32 s37, s37, 32768
  v_add_u32 v1, s37, v20
  v_add_u32 v2, 61440, v1
  v_lshlrev_b32 v20, 9, v17
  v_lshl_add_u32 v20, v16, 4, v20
  s_lshl_b32 s37, s36, 13
  s_add_u32 s37, s37, 0
  v_add_u32 v3, s37, v20
  v_add_u32 v4, 114688, v3
  v_lshrrev_b32 v20, 1, v17
  v_lshlrev_b32 v20, 9, v20
  v_lshl_add_u32 v20, v16, 4, v20
  v_and_b32 v21, 1, v17
  v_lshl_add_u32 v20, v21, 3, v20
  s_lshl_b32 s38, s24, 1
  s_add_u32 s38, s38, s36
  s_mul_i32 s39, s38, 40960
  s_mul_i32 s40, s25, 5120
  s_add_u32 s39, s39, s40
  s_mul_i32 s40, s27, 3072
  s_add_u32 s39, s39, s40
  v_mul_u32_u24 v20, 1280, v16
  v_lshl_add_u32 v20, v17, 3, v20
  v_add_u32 v21, 20480, v20
  s_mul_i32 s52, s38, 40960
  s_mul_i32 s40, s25, 160
  s_add_u32 s52, s52, s40
  s_mul_i32 s40, s27, 96
  s_add_u32 s52, s52, s40
  s_waitcnt lgkmcnt(0)
  s_mov_b32 s48, s6
  s_mov_b32 s49, s7
  s_mov_b32 s50, 0x3200000
  s_mov_b32 s51, 0x00020000
  s_mov_b32 s56, s8
  s_mov_b32 s57, s9
  s_mov_b32 s58, 0x280000
  s_mov_b32 s59, 0x00020000
  s_cmp_eq_u32 s27, 1
  s_cbranch_scc1 f0_kernel_p1_p2
  buffer_load_dwordx2 v[104:105], v20, s[56:59], s52 offen offset:0
  buffer_load_dwordx2 v[106:107], v21, s[56:59], s52 offen offset:0
  buffer_load_dwordx2 v[108:109], v20, s[56:59], s52 offen offset:32
  buffer_load_dwordx2 v[110:111], v21, s[56:59], s52 offen offset:32
  buffer_load_dwordx2 v[112:113], v20, s[56:59], s52 offen offset:64
  buffer_load_dwordx2 v[114:115], v21, s[56:59], s52 offen offset:64
  s_barrier
  ds_read_b128 v[88:91], v4 offset:0
  ds_read_b128 v[92:95], v4 offset:256
  ds_read_b128 v[64:67], v1 offset:0
  ds_read_b128 v[68:71], v1 offset:256
  ds_read_b128 v[72:75], v1 offset:512
  s_waitcnt lgkmcnt(0)
  v_mfma_f32_16x16x32_bf16 v[32:35], v[64:67], v[88:91], 0
  ds_read_b128 v[96:99], v4 offset:2048
  ds_read_b128 v[100:103], v4 offset:2304
  v_mfma_f32_16x16x32_bf16 v[36:39], v[64:67], v[92:95], 0
  ds_read_b128 v[76:79], v1 offset:5120
  ds_read_b128 v[80:83], v1 offset:5376
  v_mfma_f32_16x16x32_bf16 v[40:43], v[68:71], v[88:91], 0
  ds_read_b128 v[84:87], v1 offset:5632
  v_mfma_f32_16x16x32_bf16 v[44:47], v[68:71], v[92:95], 0
  v_mfma_f32_16x16x32_bf16 v[48:51], v[72:75], v[88:91], 0
  v_mfma_f32_16x16x32_bf16 v[52:55], v[72:75], v[92:95], 0
  s_waitcnt lgkmcnt(0)
  v_mfma_f32_16x16x32_bf16 v[32:35], v[76:79], v[96:99], v[32:35]
  ds_read_b128 v[88:91], v4 offset:4096
  ds_read_b128 v[92:95], v4 offset:4352
  v_mfma_f32_16x16x32_bf16 v[36:39], v[76:79], v[100:103], v[36:39]
  ds_read_b128 v[64:67], v1 offset:10240
  ds_read_b128 v[68:71], v1 offset:10496
  v_mfma_f32_16x16x32_bf16 v[40:43], v[80:83], v[96:99], v[40:43]
  ds_read_b128 v[72:75], v1 offset:10752
  v_mfma_f32_16x16x32_bf16 v[44:47], v[80:83], v[100:103], v[44:47]
  v_mfma_f32_16x16x32_bf16 v[48:51], v[84:87], v[96:99], v[48:51]
  v_mfma_f32_16x16x32_bf16 v[52:55], v[84:87], v[100:103], v[52:55]
  s_waitcnt lgkmcnt(0)
  v_mfma_f32_16x16x32_bf16 v[32:35], v[64:67], v[88:91], v[32:35]
  ds_read_b128 v[96:99], v4 offset:6144
  ds_read_b128 v[100:103], v4 offset:6400
  v_mfma_f32_16x16x32_bf16 v[36:39], v[64:67], v[92:95], v[36:39]
  ds_read_b128 v[76:79], v1 offset:15360
  ds_read_b128 v[80:83], v1 offset:15616
  v_mfma_f32_16x16x32_bf16 v[40:43], v[68:71], v[88:91], v[40:43]
  ds_read_b128 v[84:87], v1 offset:15872
  v_mfma_f32_16x16x32_bf16 v[44:47], v[68:71], v[92:95], v[44:47]
  v_mfma_f32_16x16x32_bf16 v[48:51], v[72:75], v[88:91], v[48:51]
  v_mfma_f32_16x16x32_bf16 v[52:55], v[72:75], v[92:95], v[52:55]
  s_waitcnt lgkmcnt(0)
  s_barrier
  v_mfma_f32_16x16x32_bf16 v[32:35], v[76:79], v[96:99], v[32:35]
  ds_read_b128 v[88:91], v4 offset:16384
  ds_read_b128 v[92:95], v4 offset:16640
  v_mfma_f32_16x16x32_bf16 v[36:39], v[76:79], v[100:103], v[36:39]
  ds_read_b128 v[64:67], v1 offset:20480
  ds_read_b128 v[68:71], v1 offset:20736
  v_mfma_f32_16x16x32_bf16 v[40:43], v[80:83], v[96:99], v[40:43]
  ds_read_b128 v[72:75], v1 offset:20992
  v_mfma_f32_16x16x32_bf16 v[44:47], v[80:83], v[100:103], v[44:47]
  v_mfma_f32_16x16x32_bf16 v[48:51], v[84:87], v[96:99], v[48:51]
  v_mfma_f32_16x16x32_bf16 v[52:55], v[84:87], v[100:103], v[52:55]
  s_waitcnt lgkmcnt(0)
  v_mfma_f32_16x16x32_bf16 v[32:35], v[64:67], v[88:91], v[32:35]
  ds_read_b128 v[96:99], v4 offset:18432
  ds_read_b128 v[100:103], v4 offset:18688
  v_mfma_f32_16x16x32_bf16 v[36:39], v[64:67], v[92:95], v[36:39]
  ds_read_b128 v[76:79], v1 offset:25600
  ds_read_b128 v[80:83], v1 offset:25856
  v_mfma_f32_16x16x32_bf16 v[40:43], v[68:71], v[88:91], v[40:43]
  ds_read_b128 v[84:87], v1 offset:26112
  v_mfma_f32_16x16x32_bf16 v[44:47], v[68:71], v[92:95], v[44:47]
  v_mfma_f32_16x16x32_bf16 v[48:51], v[72:75], v[88:91], v[48:51]
  v_mfma_f32_16x16x32_bf16 v[52:55], v[72:75], v[92:95], v[52:55]
  s_waitcnt lgkmcnt(0)
  v_mfma_f32_16x16x32_bf16 v[32:35], v[76:79], v[96:99], v[32:35]
  ds_read_b128 v[88:91], v4 offset:20480
  ds_read_b128 v[92:95], v4 offset:20736
  v_mfma_f32_16x16x32_bf16 v[36:39], v[76:79], v[100:103], v[36:39]
  ds_read_b128 v[64:67], v1 offset:30720
  ds_read_b128 v[68:71], v1 offset:30976
  v_mfma_f32_16x16x32_bf16 v[40:43], v[80:83], v[96:99], v[40:43]
  ds_read_b128 v[72:75], v1 offset:31232
  v_mfma_f32_16x16x32_bf16 v[44:47], v[80:83], v[100:103], v[44:47]
  v_mfma_f32_16x16x32_bf16 v[48:51], v[84:87], v[96:99], v[48:51]
  v_mfma_f32_16x16x32_bf16 v[52:55], v[84:87], v[100:103], v[52:55]
  s_waitcnt lgkmcnt(0)
  v_mfma_f32_16x16x32_bf16 v[32:35], v[64:67], v[88:91], v[32:35]
  ds_read_b128 v[96:99], v4 offset:22528
  ds_read_b128 v[100:103], v4 offset:22784
  v_mfma_f32_16x16x32_bf16 v[36:39], v[64:67], v[92:95], v[36:39]
  ds_read_b128 v[76:79], v1 offset:35840
  ds_read_b128 v[80:83], v1 offset:36096
  v_mfma_f32_16x16x32_bf16 v[40:43], v[68:71], v[88:91], v[40:43]
  ds_read_b128 v[84:87], v1 offset:36352
  v_mfma_f32_16x16x32_bf16 v[44:47], v[68:71], v[92:95], v[44:47]
  v_mfma_f32_16x16x32_bf16 v[48:51], v[72:75], v[88:91], v[48:51]
  v_mfma_f32_16x16x32_bf16 v[52:55], v[72:75], v[92:95], v[52:55]
  s_waitcnt lgkmcnt(0)
  s_barrier
  v_mfma_f32_16x16x32_bf16 v[32:35], v[76:79], v[96:99], v[32:35]
  ds_read_b128 v[88:91], v3 offset:0
  ds_read_b128 v[92:95], v3 offset:256
  v_mfma_f32_16x16x32_bf16 v[36:39], v[76:79], v[100:103], v[36:39]
  ds_read_b128 v[64:67], v1 offset:40960
  ds_read_b128 v[68:71], v1 offset:41216
  v_mfma_f32_16x16x32_bf16 v[40:43], v[80:83], v[96:99], v[40:43]
  ds_read_b128 v[72:75], v1 offset:41472
  v_mfma_f32_16x16x32_bf16 v[44:47], v[80:83], v[100:103], v[44:47]
  v_mfma_f32_16x16x32_bf16 v[48:51], v[84:87], v[96:99], v[48:51]
  v_mfma_f32_16x16x32_bf16 v[52:55], v[84:87], v[100:103], v[52:55]
  s_waitcnt lgkmcnt(0)
  v_mfma_f32_16x16x32_bf16 v[32:35], v[64:67], v[88:91], v[32:35]
  ds_read_b128 v[96:99], v3 offset:2048
  ds_read_b128 v[100:103], v3 offset:2304
  v_mfma_f32_16x16x32_bf16 v[36:39], v[64:67], v[92:95], v[36:39]
  ds_read_b128 v[76:79], v1 offset:46080
  ds_read_b128 v[80:83], v1 offset:46336
  v_mfma_f32_16x16x32_bf16 v[40:43], v[68:71], v[88:91], v[40:43]
  ds_read_b128 v[84:87], v1 offset:46592
  v_mfma_f32_16x16x32_bf16 v[44:47], v[68:71], v[92:95], v[44:47]
  v_mfma_f32_16x16x32_bf16 v[48:51], v[72:75], v[88:91], v[48:51]
  v_mfma_f32_16x16x32_bf16 v[52:55], v[72:75], v[92:95], v[52:55]
  s_waitcnt lgkmcnt(0)
  v_mfma_f32_16x16x32_bf16 v[32:35], v[76:79], v[96:99], v[32:35]
  ds_read_b128 v[88:91], v3 offset:4096
  ds_read_b128 v[92:95], v3 offset:4352
  v_mfma_f32_16x16x32_bf16 v[36:39], v[76:79], v[100:103], v[36:39]
  ds_read_b128 v[64:67], v1 offset:51200
  ds_read_b128 v[68:71], v1 offset:51456
  v_mfma_f32_16x16x32_bf16 v[40:43], v[80:83], v[96:99], v[40:43]
  ds_read_b128 v[72:75], v1 offset:51712
  v_mfma_f32_16x16x32_bf16 v[44:47], v[80:83], v[100:103], v[44:47]
  v_mfma_f32_16x16x32_bf16 v[48:51], v[84:87], v[96:99], v[48:51]
  v_mfma_f32_16x16x32_bf16 v[52:55], v[84:87], v[100:103], v[52:55]
  s_waitcnt lgkmcnt(0)
  v_mfma_f32_16x16x32_bf16 v[32:35], v[64:67], v[88:91], v[32:35]
  ds_read_b128 v[96:99], v3 offset:6144
  ds_read_b128 v[100:103], v3 offset:6400
  v_mfma_f32_16x16x32_bf16 v[36:39], v[64:67], v[92:95], v[36:39]
  ds_read_b128 v[76:79], v1 offset:56320
  ds_read_b128 v[80:83], v1 offset:56576
  v_mfma_f32_16x16x32_bf16 v[40:43], v[68:71], v[88:91], v[40:43]
  ds_read_b128 v[84:87], v1 offset:56832
  v_mfma_f32_16x16x32_bf16 v[44:47], v[68:71], v[92:95], v[44:47]
  v_mfma_f32_16x16x32_bf16 v[48:51], v[72:75], v[88:91], v[48:51]
  v_mfma_f32_16x16x32_bf16 v[52:55], v[72:75], v[92:95], v[52:55]
  s_waitcnt lgkmcnt(0)
  s_barrier
  v_mfma_f32_16x16x32_bf16 v[32:35], v[76:79], v[96:99], v[32:35]
  ds_read_b128 v[88:91], v3 offset:16384
  ds_read_b128 v[92:95], v3 offset:16640
  v_mfma_f32_16x16x32_bf16 v[36:39], v[76:79], v[100:103], v[36:39]
  ds_read_b128 v[64:67], v2 offset:0
  ds_read_b128 v[68:71], v2 offset:256
  v_mfma_f32_16x16x32_bf16 v[40:43], v[80:83], v[96:99], v[40:43]
  ds_read_b128 v[72:75], v2 offset:512
  v_mfma_f32_16x16x32_bf16 v[44:47], v[80:83], v[100:103], v[44:47]
  v_mfma_f32_16x16x32_bf16 v[48:51], v[84:87], v[96:99], v[48:51]
  v_mfma_f32_16x16x32_bf16 v[52:55], v[84:87], v[100:103], v[52:55]
  s_waitcnt lgkmcnt(0)
  v_mfma_f32_16x16x32_bf16 v[32:35], v[64:67], v[88:91], v[32:35]
  ds_read_b128 v[96:99], v3 offset:18432
  ds_read_b128 v[100:103], v3 offset:18688
  v_mfma_f32_16x16x32_bf16 v[36:39], v[64:67], v[92:95], v[36:39]
  ds_read_b128 v[76:79], v2 offset:5120
  ds_read_b128 v[80:83], v2 offset:5376
  v_mfma_f32_16x16x32_bf16 v[40:43], v[68:71], v[88:91], v[40:43]
  ds_read_b128 v[84:87], v2 offset:5632
  v_mfma_f32_16x16x32_bf16 v[44:47], v[68:71], v[92:95], v[44:47]
  v_mfma_f32_16x16x32_bf16 v[48:51], v[72:75], v[88:91], v[48:51]
  v_mfma_f32_16x16x32_bf16 v[52:55], v[72:75], v[92:95], v[52:55]
  s_waitcnt lgkmcnt(0)
  v_mfma_f32_16x16x32_bf16 v[32:35], v[76:79], v[96:99], v[32:35]
  ds_read_b128 v[88:91], v3 offset:20480
  ds_read_b128 v[92:95], v3 offset:20736
  v_mfma_f32_16x16x32_bf16 v[36:39], v[76:79], v[100:103], v[36:39]
  ds_read_b128 v[64:67], v2 offset:10240
  ds_read_b128 v[68:71], v2 offset:10496
  v_mfma_f32_16x16x32_bf16 v[40:43], v[80:83], v[96:99], v[40:43]
  ds_read_b128 v[72:75], v2 offset:10752
  v_mfma_f32_16x16x32_bf16 v[44:47], v[80:83], v[100:103], v[44:47]
  v_mfma_f32_16x16x32_bf16 v[48:51], v[84:87], v[96:99], v[48:51]
  v_mfma_f32_16x16x32_bf16 v[52:55], v[84:87], v[100:103], v[52:55]
  s_waitcnt lgkmcnt(0)
  v_mfma_f32_16x16x32_bf16 v[32:35], v[64:67], v[88:91], v[32:35]
  ds_read_b128 v[96:99], v3 offset:22528
  ds_read_b128 v[100:103], v3 offset:22784
  v_mfma_f32_16x16x32_bf16 v[36:39], v[64:67], v[92:95], v[36:39]
  ds_read_b128 v[76:79], v2 offset:15360
  ds_read_b128 v[80:83], v2 offset:15616
  v_mfma_f32_16x16x32_bf16 v[40:43], v[68:71], v[88:91], v[40:43]
  ds_read_b128 v[84:87], v2 offset:15872
  v_mfma_f32_16x16x32_bf16 v[44:47], v[68:71], v[92:95], v[44:47]
  v_mfma_f32_16x16x32_bf16 v[48:51], v[72:75], v[88:91], v[48:51]
  v_mfma_f32_16x16x32_bf16 v[52:55], v[72:75], v[92:95], v[52:55]
  s_waitcnt lgkmcnt(0)
  s_barrier
  v_mfma_f32_16x16x32_bf16 v[32:35], v[76:79], v[96:99], v[32:35]
  ds_read_b128 v[88:91], v4 offset:0
  ds_read_b128 v[92:95], v4 offset:256
  v_mfma_f32_16x16x32_bf16 v[36:39], v[76:79], v[100:103], v[36:39]
  ds_read_b128 v[64:67], v1 offset:0
  ds_read_b128 v[68:71], v1 offset:256
  v_mfma_f32_16x16x32_bf16 v[40:43], v[80:83], v[96:99], v[40:43]
  ds_read_b128 v[72:75], v1 offset:512
  v_mfma_f32_16x16x32_bf16 v[44:47], v[80:83], v[100:103], v[44:47]
  v_mfma_f32_16x16x32_bf16 v[48:51], v[84:87], v[96:99], v[48:51]
  v_mfma_f32_16x16x32_bf16 v[52:55], v[84:87], v[100:103], v[52:55]
  s_waitcnt lgkmcnt(0)
  v_mfma_f32_16x16x32_bf16 v[32:35], v[64:67], v[88:91], v[32:35]
  ds_read_b128 v[96:99], v4 offset:2048
  ds_read_b128 v[100:103], v4 offset:2304
  v_mfma_f32_16x16x32_bf16 v[36:39], v[64:67], v[92:95], v[36:39]
  ds_read_b128 v[76:79], v1 offset:5120
  ds_read_b128 v[80:83], v1 offset:5376
  v_mfma_f32_16x16x32_bf16 v[40:43], v[68:71], v[88:91], v[40:43]
  ds_read_b128 v[84:87], v1 offset:5632
  v_mfma_f32_16x16x32_bf16 v[44:47], v[68:71], v[92:95], v[44:47]
  v_mfma_f32_16x16x32_bf16 v[48:51], v[72:75], v[88:91], v[48:51]
  v_mfma_f32_16x16x32_bf16 v[52:55], v[72:75], v[92:95], v[52:55]
  s_waitcnt lgkmcnt(0)
  v_mfma_f32_16x16x32_bf16 v[32:35], v[76:79], v[96:99], v[32:35]
  ds_read_b128 v[88:91], v4 offset:4096
  ds_read_b128 v[92:95], v4 offset:4352
  v_mfma_f32_16x16x32_bf16 v[36:39], v[76:79], v[100:103], v[36:39]
  ds_read_b128 v[64:67], v1 offset:10240
  ds_read_b128 v[68:71], v1 offset:10496
  v_mfma_f32_16x16x32_bf16 v[40:43], v[80:83], v[96:99], v[40:43]
  ds_read_b128 v[72:75], v1 offset:10752
  v_mfma_f32_16x16x32_bf16 v[44:47], v[80:83], v[100:103], v[44:47]
  v_mfma_f32_16x16x32_bf16 v[48:51], v[84:87], v[96:99], v[48:51]
  v_mfma_f32_16x16x32_bf16 v[52:55], v[84:87], v[100:103], v[52:55]
  s_waitcnt lgkmcnt(0)
  v_mfma_f32_16x16x32_bf16 v[32:35], v[64:67], v[88:91], v[32:35]
  ds_read_b128 v[96:99], v4 offset:6144
  ds_read_b128 v[100:103], v4 offset:6400
  v_mfma_f32_16x16x32_bf16 v[36:39], v[64:67], v[92:95], v[36:39]
  ds_read_b128 v[76:79], v1 offset:15360
  ds_read_b128 v[80:83], v1 offset:15616
  v_mfma_f32_16x16x32_bf16 v[40:43], v[68:71], v[88:91], v[40:43]
  ds_read_b128 v[84:87], v1 offset:15872
  v_mfma_f32_16x16x32_bf16 v[44:47], v[68:71], v[92:95], v[44:47]
  v_mfma_f32_16x16x32_bf16 v[48:51], v[72:75], v[88:91], v[48:51]
  v_mfma_f32_16x16x32_bf16 v[52:55], v[72:75], v[92:95], v[52:55]
  s_waitcnt lgkmcnt(0)
  v_mfma_f32_16x16x32_bf16 v[32:35], v[76:79], v[96:99], v[32:35]
  v_mfma_f32_16x16x32_bf16 v[36:39], v[76:79], v[100:103], v[36:39]
  v_mfma_f32_16x16x32_bf16 v[40:43], v[80:83], v[96:99], v[40:43]
  v_mfma_f32_16x16x32_bf16 v[44:47], v[80:83], v[100:103], v[44:47]
  v_mfma_f32_16x16x32_bf16 v[48:51], v[84:87], v[96:99], v[48:51]
  v_mfma_f32_16x16x32_bf16 v[52:55], v[84:87], v[100:103], v[52:55]
  s_waitcnt vmcnt(0)
  v_mov_b32 v8, 0
  v_mov_b32 v9, 0
  v_mov_b32 v10, 0
  v_mov_b32 v11, 0
  v_lshlrev_b32 v22, 4, v0
  s_add_u32 s53, s39, 12582912
  s_nop 4
  v_lshlrev_b32 v12, 16, v104
  v_and_b32 v13, 0xffff0000, v104
  v_lshlrev_b32 v14, 16, v105
  v_and_b32 v15, 0xffff0000, v105
  v_pk_add_f32 v[32:33], v[32:33], v[12:13]
  v_pk_add_f32 v[34:35], v[34:35], v[14:15]
  v_add_f32 v8, v8, v32
  v_fmac_f32 v10, v32, v32
  v_add_f32 v8, v8, v33
  v_fmac_f32 v10, v33, v33
  v_add_f32 v8, v8, v34
  v_fmac_f32 v10, v34, v34
  v_add_f32 v8, v8, v35
  v_fmac_f32 v10, v35, v35
  v_cvt_pk_bf16_f32 v24, v32, v33
  v_cvt_pk_bf16_f32 v25, v34, v35
  v_lshlrev_b32 v12, 16, v106
  v_and_b32 v13, 0xffff0000, v106
  v_lshlrev_b32 v14, 16, v107
  v_and_b32 v15, 0xffff0000, v107
  v_pk_add_f32 v[36:37], v[36:37], v[12:13]
  v_pk_add_f32 v[38:39], v[38:39], v[14:15]
  v_add_f32 v9, v9, v36
  v_fmac_f32 v11, v36, v36
  v_add_f32 v9, v9, v37
  v_fmac_f32 v11, v37, v37
  v_add_f32 v9, v9, v38
  v_fmac_f32 v11, v38, v38
  v_add_f32 v9, v9, v39
  v_fmac_f32 v11, v39, v39
  v_cvt_pk_bf16_f32 v26, v36, v37
  v_cvt_pk_bf16_f32 v27, v38, v39
  s_nop 1
  v_permlane16_swap_b32 v24, v26
  v_permlane16_swap_b32 v25, v27
  s_nop 1
  buffer_store_dwordx4 v[24:27], v22, s[48:51], s53 offen offset:0
  v_lshlrev_b32 v12, 16, v108
  v_and_b32 v13, 0xffff0000, v108
  v_lshlrev_b32 v14, 16, v109
  v_and_b32 v15, 0xffff0000, v109
  v_pk_add_f32 v[40:41], v[40:41], v[12:13]
  v_pk_add_f32 v[42:43], v[42:43], v[14:15]
  v_add_f32 v8, v8, v40
  v_fmac_f32 v10, v40, v40
  v_add_f32 v8, v8, v41
  v_fmac_f32 v10, v41, v41
  v_add_f32 v8, v8, v42
  v_fmac_f32 v10, v42, v42
  v_add_f32 v8, v8, v43
  v_fmac_f32 v10, v43, v43
  v_cvt_pk_bf16_f32 v28, v40, v41
  v_cvt_pk_bf16_f32 v29, v42, v43
  v_lshlrev_b32 v12, 16, v110
  v_and_b32 v13, 0xffff0000, v110
  v_lshlrev_b32 v14, 16, v111
  v_and_b32 v15, 0xffff0000, v111
  v_pk_add_f32 v[44:45], v[44:45], v[12:13]
  v_pk_add_f32 v[46:47], v[46:47], v[14:15]
  v_add_f32 v9, v9, v44
  v_fmac_f32 v11, v44, v44
  v_add_f32 v9, v9, v45
  v_fmac_f32 v11, v45, v45
  v_add_f32 v9, v9, v46
  v_fmac_f32 v11, v46, v46
  v_add_f32 v9, v9, v47
  v_fmac_f32 v11, v47, v47
  v_cvt_pk_bf16_f32 v30, v44, v45
  v_cvt_pk_bf16_f32 v31, v46, v47
  s_nop 1
  v_permlane16_swap_b32 v28, v30
  v_permlane16_swap_b32 v29, v31
  s_nop 1
  buffer_store_dwordx4 v[28:31], v22, s[48:51], s53 offen offset:1024
  v_lshlrev_b32 v12, 16, v112
  v_and_b32 v13, 0xffff0000, v112
  v_lshlrev_b32 v14, 16, v113
  v_and_b32 v15, 0xffff0000, v113
  v_pk_add_f32 v[48:49], v[48:49], v[12:13]
  v_pk_add_f32 v[50:51], v[50:51], v[14:15]
  v_add_f32 v8, v8, v48
  v_fmac_f32 v10, v48, v48
  v_add_f32 v8, v8, v49
  v_fmac_f32 v10, v49, v49
  v_add_f32 v8, v8, v50
  v_fmac_f32 v10, v50, v50
  v_add_f32 v8, v8, v51
  v_fmac_f32 v10, v51, v51
  v_cvt_pk_bf16_f32 v24, v48, v49
  v_cvt_pk_bf16_f32 v25, v50, v51
  v_lshlrev_b32 v12, 16, v114
  v_and_b32 v13, 0xffff0000, v114
  v_lshlrev_b32 v14, 16, v115
  v_and_b32 v15, 0xffff0000, v115
  v_pk_add_f32 v[52:53], v[52:53], v[12:13]
  v_pk_add_f32 v[54:55], v[54:55], v[14:15]
  v_add_f32 v9, v9, v52
  v_fmac_f32 v11, v52, v52
  v_add_f32 v9, v9, v53
  v_fmac_f32 v11, v53, v53
  v_add_f32 v9, v9, v54
  v_fmac_f32 v11, v54, v54
  v_add_f32 v9, v9, v55
  v_fmac_f32 v11, v55, v55
  v_cvt_pk_bf16_f32 v26, v52, v53
  v_cvt_pk_bf16_f32 v27, v54, v55
  s_nop 1
  v_permlane16_swap_b32 v24, v26
  v_permlane16_swap_b32 v25, v27
  s_nop 1
  buffer_store_dwordx4 v[24:27], v22, s[48:51], s53 offen offset:2048
  v_permlane16_swap_b32 v8, v9
  v_permlane16_swap_b32 v10, v11
  s_nop 1
  v_add_f32 v8, v8, v9
  v_add_f32 v10, v10, v11
  s_nop 1
  v_permlane32_swap_b32 v8, v10
  s_nop 1
  v_add_f32 v8, v8, v10
  v_and_b32 v12, 31, v0
  v_lshlrev_b32 v12, 3, v12
  v_lshrrev_b32 v13, 5, v0
  v_lshl_add_u32 v12, v13, 2, v12
  s_lshl_b32 s40, s25, 1
  s_add_u32 s40, s40, s27
  s_lshl_b32 s40, s40, 14
  s_lshl_b32 s41, s38, 8
  s_add_u32 s40, s40, s41
  s_add_u32 s40, s40, 8912896
  buffer_store_dword v8, v12, s[48:51], s40 offen
  s_waitcnt vmcnt(0)
  s_mov_b64 exec, 1
  v_mov_b32 v1, 147456
  v_mov_b32 v2, 1
  ds_add_rtn_u32 v3, v1, v2
  s_lshl_b32 s37, s24, 7
  s_lshl_b32 s38, s25, 2
  s_add_u32 s37, s37, s38
  s_add_u32 s37, s37, 9183232
  s_waitcnt lgkmcnt(0)
  v_readfirstlane_b32 s38, v3
  s_and_b32 s38, s38, 3
  s_cmp_eq_u32 s38, 3
  s_cbranch_scc0 f0_kernel_p1_nosig13
  s_cmp_eq_u32 s63, 0
  s_cbranch_scc1 f0_kernel_p1_fastsig14
  buffer_wbl2 sc1
  s_waitcnt vmcnt(0)
  buffer_store_dword v2, off, s[48:51], s37 sc1
  s_branch f0_kernel_p1_nosig13
f0_kernel_p1_fastsig14:
  buffer_store_dword v2, off, s[48:51], s37
f0_kernel_p1_nosig13:
  s_mov_b64 exec, -1
  s_branch f0_kernel_p2_entry
f0_kernel_p1_p2:
  buffer_load_dwordx2 v[104:105], v20, s[56:59], s52 offen offset:0
  buffer_load_dwordx2 v[106:107], v21, s[56:59], s52 offen offset:0
  buffer_load_dwordx2 v[108:109], v20, s[56:59], s52 offen offset:32
  buffer_load_dwordx2 v[110:111], v21, s[56:59], s52 offen offset:32
  s_barrier
  ds_read_b128 v[88:91], v4 offset:0
  ds_read_b128 v[92:95], v4 offset:256
  ds_read_b128 v[64:67], v1 offset:0
  ds_read_b128 v[68:71], v1 offset:256
  s_waitcnt lgkmcnt(0)
  v_mfma_f32_16x16x32_bf16 v[32:35], v[64:67], v[88:91], 0
  ds_read_b128 v[96:99], v4 offset:2048
  ds_read_b128 v[100:103], v4 offset:2304
  v_mfma_f32_16x16x32_bf16 v[36:39], v[64:67], v[92:95], 0
  ds_read_b128 v[76:79], v1 offset:5120
  ds_read_b128 v[80:83], v1 offset:5376
  v_mfma_f32_16x16x32_bf16 v[40:43], v[68:71], v[88:91], 0
  v_mfma_f32_16x16x32_bf16 v[44:47], v[68:71], v[92:95], 0
  s_waitcnt lgkmcnt(0)
  v_mfma_f32_16x16x32_bf16 v[32:35], v[76:79], v[96:99], v[32:35]
  ds_read_b128 v[88:91], v4 offset:4096
  ds_read_b128 v[92:95], v4 offset:4352
  v_mfma_f32_16x16x32_bf16 v[36:39], v[76:79], v[100:103], v[36:39]
  ds_read_b128 v[64:67], v1 offset:10240
  ds_read_b128 v[68:71], v1 offset:10496
  v_mfma_f32_16x16x32_bf16 v[40:43], v[80:83], v[96:99], v[40:43]
  v_mfma_f32_16x16x32_bf16 v[44:47], v[80:83], v[100:103], v[44:47]
  s_waitcnt lgkmcnt(0)
  v_mfma_f32_16x16x32_bf16 v[32:35], v[64:67], v[88:91], v[32:35]
  ds_read_b128 v[96:99], v4 offset:6144
  ds_read_b128 v[100:103], v4 offset:6400
  v_mfma_f32_16x16x32_bf16 v[36:39], v[64:67], v[92:95], v[36:39]
  ds_read_b128 v[76:79], v1 offset:15360
  ds_read_b128 v[80:83], v1 offset:15616
  v_mfma_f32_16x16x32_bf16 v[40:43], v[68:71], v[88:91], v[40:43]
  v_mfma_f32_16x16x32_bf16 v[44:47], v[68:71], v[92:95], v[44:47]
  s_waitcnt lgkmcnt(0)
  s_barrier
  v_mfma_f32_16x16x32_bf16 v[32:35], v[76:79], v[96:99], v[32:35]
  ds_read_b128 v[88:91], v4 offset:16384
  ds_read_b128 v[92:95], v4 offset:16640
  v_mfma_f32_16x16x32_bf16 v[36:39], v[76:79], v[100:103], v[36:39]
  ds_read_b128 v[64:67], v1 offset:20480
  ds_read_b128 v[68:71], v1 offset:20736
  v_mfma_f32_16x16x32_bf16 v[40:43], v[80:83], v[96:99], v[40:43]
  v_mfma_f32_16x16x32_bf16 v[44:47], v[80:83], v[100:103], v[44:47]
  s_waitcnt lgkmcnt(0)
  v_mfma_f32_16x16x32_bf16 v[32:35], v[64:67], v[88:91], v[32:35]
  ds_read_b128 v[96:99], v4 offset:18432
  ds_read_b128 v[100:103], v4 offset:18688
  v_mfma_f32_16x16x32_bf16 v[36:39], v[64:67], v[92:95], v[36:39]
  ds_read_b128 v[76:79], v1 offset:25600
  ds_read_b128 v[80:83], v1 offset:25856
  v_mfma_f32_16x16x32_bf16 v[40:43], v[68:71], v[88:91], v[40:43]
  v_mfma_f32_16x16x32_bf16 v[44:47], v[68:71], v[92:95], v[44:47]
  s_waitcnt lgkmcnt(0)
  v_mfma_f32_16x16x32_bf16 v[32:35], v[76:79], v[96:99], v[32:35]
  ds_read_b128 v[88:91], v4 offset:20480
  ds_read_b128 v[92:95], v4 offset:20736
  v_mfma_f32_16x16x32_bf16 v[36:39], v[76:79], v[100:103], v[36:39]
  ds_read_b128 v[64:67], v1 offset:30720
  ds_read_b128 v[68:71], v1 offset:30976
  v_mfma_f32_16x16x32_bf16 v[40:43], v[80:83], v[96:99], v[40:43]
  v_mfma_f32_16x16x32_bf16 v[44:47], v[80:83], v[100:103], v[44:47]
  s_waitcnt lgkmcnt(0)
  v_mfma_f32_16x16x32_bf16 v[32:35], v[64:67], v[88:91], v[32:35]
  ds_read_b128 v[96:99], v4 offset:22528
  ds_read_b128 v[100:103], v4 offset:22784
  v_mfma_f32_16x16x32_bf16 v[36:39], v[64:67], v[92:95], v[36:39]
  ds_read_b128 v[76:79], v1 offset:35840
  ds_read_b128 v[80:83], v1 offset:36096
  v_mfma_f32_16x16x32_bf16 v[40:43], v[68:71], v[88:91], v[40:43]
  v_mfma_f32_16x16x32_bf16 v[44:47], v[68:71], v[92:95], v[44:47]
  s_waitcnt lgkmcnt(0)
  s_barrier
  v_mfma_f32_16x16x32_bf16 v[32:35], v[76:79], v[96:99], v[32:35]
  ds_read_b128 v[88:91], v3 offset:0
  ds_read_b128 v[92:95], v3 offset:256
  v_mfma_f32_16x16x32_bf16 v[36:39], v[76:79], v[100:103], v[36:39]
  ds_read_b128 v[64:67], v1 offset:40960
  ds_read_b128 v[68:71], v1 offset:41216
  v_mfma_f32_16x16x32_bf16 v[40:43], v[80:83], v[96:99], v[40:43]
  v_mfma_f32_16x16x32_bf16 v[44:47], v[80:83], v[100:103], v[44:47]
  s_waitcnt lgkmcnt(0)
  v_mfma_f32_16x16x32_bf16 v[32:35], v[64:67], v[88:91], v[32:35]
  ds_read_b128 v[96:99], v3 offset:2048
  ds_read_b128 v[100:103], v3 offset:2304
  v_mfma_f32_16x16x32_bf16 v[36:39], v[64:67], v[92:95], v[36:39]
  ds_read_b128 v[76:79], v1 offset:46080
  ds_read_b128 v[80:83], v1 offset:46336
  v_mfma_f32_16x16x32_bf16 v[40:43], v[68:71], v[88:91], v[40:43]
  v_mfma_f32_16x16x32_bf16 v[44:47], v[68:71], v[92:95], v[44:47]
  s_waitcnt lgkmcnt(0)
  v_mfma_f32_16x16x32_bf16 v[32:35], v[76:79], v[96:99], v[32:35]
  ds_read_b128 v[88:91], v3 offset:4096
  ds_read_b128 v[92:95], v3 offset:4352
  v_mfma_f32_16x16x32_bf16 v[36:39], v[76:79], v[100:103], v[36:39]
  ds_read_b128 v[64:67], v1 offset:51200
  ds_read_b128 v[68:71], v1 offset:51456
  v_mfma_f32_16x16x32_bf16 v[40:43], v[80:83], v[96:99], v[40:43]
  v_mfma_f32_16x16x32_bf16 v[44:47], v[80:83], v[100:103], v[44:47]
  s_waitcnt lgkmcnt(0)
  v_mfma_f32_16x16x32_bf16 v[32:35], v[64:67], v[88:91], v[32:35]
  ds_read_b128 v[96:99], v3 offset:6144
  ds_read_b128 v[100:103], v3 offset:6400
  v_mfma_f32_16x16x32_bf16 v[36:39], v[64:67], v[92:95], v[36:39]
  ds_read_b128 v[76:79], v1 offset:56320
  ds_read_b128 v[80:83], v1 offset:56576
  v_mfma_f32_16x16x32_bf16 v[40:43], v[68:71], v[88:91], v[40:43]
  v_mfma_f32_16x16x32_bf16 v[44:47], v[68:71], v[92:95], v[44:47]
  s_waitcnt lgkmcnt(0)
  s_barrier
  v_mfma_f32_16x16x32_bf16 v[32:35], v[76:79], v[96:99], v[32:35]
  ds_read_b128 v[88:91], v3 offset:16384
  ds_read_b128 v[92:95], v3 offset:16640
  v_mfma_f32_16x16x32_bf16 v[36:39], v[76:79], v[100:103], v[36:39]
  ds_read_b128 v[64:67], v2 offset:0
  ds_read_b128 v[68:71], v2 offset:256
  v_mfma_f32_16x16x32_bf16 v[40:43], v[80:83], v[96:99], v[40:43]
  v_mfma_f32_16x16x32_bf16 v[44:47], v[80:83], v[100:103], v[44:47]
  s_waitcnt lgkmcnt(0)
  v_mfma_f32_16x16x32_bf16 v[32:35], v[64:67], v[88:91], v[32:35]
  ds_read_b128 v[96:99], v3 offset:18432
  ds_read_b128 v[100:103], v3 offset:18688
  v_mfma_f32_16x16x32_bf16 v[36:39], v[64:67], v[92:95], v[36:39]
  ds_read_b128 v[76:79], v2 offset:5120
  ds_read_b128 v[80:83], v2 offset:5376
  v_mfma_f32_16x16x32_bf16 v[40:43], v[68:71], v[88:91], v[40:43]
  v_mfma_f32_16x16x32_bf16 v[44:47], v[68:71], v[92:95], v[44:47]
  s_waitcnt lgkmcnt(0)
  v_mfma_f32_16x16x32_bf16 v[32:35], v[76:79], v[96:99], v[32:35]
  ds_read_b128 v[88:91], v3 offset:20480
  ds_read_b128 v[92:95], v3 offset:20736
  v_mfma_f32_16x16x32_bf16 v[36:39], v[76:79], v[100:103], v[36:39]
  ds_read_b128 v[64:67], v2 offset:10240
  ds_read_b128 v[68:71], v2 offset:10496
  v_mfma_f32_16x16x32_bf16 v[40:43], v[80:83], v[96:99], v[40:43]
  v_mfma_f32_16x16x32_bf16 v[44:47], v[80:83], v[100:103], v[44:47]
  s_waitcnt lgkmcnt(0)
  v_mfma_f32_16x16x32_bf16 v[32:35], v[64:67], v[88:91], v[32:35]
  ds_read_b128 v[96:99], v3 offset:22528
  ds_read_b128 v[100:103], v3 offset:22784
  v_mfma_f32_16x16x32_bf16 v[36:39], v[64:67], v[92:95], v[36:39]
  ds_read_b128 v[76:79], v2 offset:15360
  ds_read_b128 v[80:83], v2 offset:15616
  v_mfma_f32_16x16x32_bf16 v[40:43], v[68:71], v[88:91], v[40:43]
  v_mfma_f32_16x16x32_bf16 v[44:47], v[68:71], v[92:95], v[44:47]
  s_waitcnt lgkmcnt(0)
  s_barrier
  v_mfma_f32_16x16x32_bf16 v[32:35], v[76:79], v[96:99], v[32:35]
  ds_read_b128 v[88:91], v4 offset:0
  ds_read_b128 v[92:95], v4 offset:256
  v_mfma_f32_16x16x32_bf16 v[36:39], v[76:79], v[100:103], v[36:39]
  ds_read_b128 v[64:67], v1 offset:0
  ds_read_b128 v[68:71], v1 offset:256
  v_mfma_f32_16x16x32_bf16 v[40:43], v[80:83], v[96:99], v[40:43]
  v_mfma_f32_16x16x32_bf16 v[44:47], v[80:83], v[100:103], v[44:47]
  s_waitcnt lgkmcnt(0)
  v_mfma_f32_16x16x32_bf16 v[32:35], v[64:67], v[88:91], v[32:35]
  ds_read_b128 v[96:99], v4 offset:2048
  ds_read_b128 v[100:103], v4 offset:2304
  v_mfma_f32_16x16x32_bf16 v[36:39], v[64:67], v[92:95], v[36:39]
  ds_read_b128 v[76:79], v1 offset:5120
  ds_read_b128 v[80:83], v1 offset:5376
  v_mfma_f32_16x16x32_bf16 v[40:43], v[68:71], v[88:91], v[40:43]
  v_mfma_f32_16x16x32_bf16 v[44:47], v[68:71], v[92:95], v[44:47]
  s_waitcnt lgkmcnt(0)
  v_mfma_f32_16x16x32_bf16 v[32:35], v[76:79], v[96:99], v[32:35]
  ds_read_b128 v[88:91], v4 offset:4096
  ds_read_b128 v[92:95], v4 offset:4352
  v_mfma_f32_16x16x32_bf16 v[36:39], v[76:79], v[100:103], v[36:39]
  ds_read_b128 v[64:67], v1 offset:10240
  ds_read_b128 v[68:71], v1 offset:10496
  v_mfma_f32_16x16x32_bf16 v[40:43], v[80:83], v[96:99], v[40:43]
  v_mfma_f32_16x16x32_bf16 v[44:47], v[80:83], v[100:103], v[44:47]
  s_waitcnt lgkmcnt(0)
  v_mfma_f32_16x16x32_bf16 v[32:35], v[64:67], v[88:91], v[32:35]
  ds_read_b128 v[96:99], v4 offset:6144
  ds_read_b128 v[100:103], v4 offset:6400
  v_mfma_f32_16x16x32_bf16 v[36:39], v[64:67], v[92:95], v[36:39]
  ds_read_b128 v[76:79], v1 offset:15360
  ds_read_b128 v[80:83], v1 offset:15616
  v_mfma_f32_16x16x32_bf16 v[40:43], v[68:71], v[88:91], v[40:43]
  v_mfma_f32_16x16x32_bf16 v[44:47], v[68:71], v[92:95], v[44:47]
  s_waitcnt lgkmcnt(0)
  v_mfma_f32_16x16x32_bf16 v[32:35], v[76:79], v[96:99], v[32:35]
  v_mfma_f32_16x16x32_bf16 v[36:39], v[76:79], v[100:103], v[36:39]
  v_mfma_f32_16x16x32_bf16 v[40:43], v[80:83], v[96:99], v[40:43]
  v_mfma_f32_16x16x32_bf16 v[44:47], v[80:83], v[100:103], v[44:47]
  s_waitcnt vmcnt(0)
  v_mov_b32 v8, 0
  v_mov_b32 v9, 0
  v_mov_b32 v10, 0
  v_mov_b32 v11, 0
  v_lshlrev_b32 v22, 4, v0
  s_add_u32 s53, s39, 12582912
  s_nop 4
  v_lshlrev_b32 v12, 16, v104
  v_and_b32 v13, 0xffff0000, v104
  v_lshlrev_b32 v14, 16, v105
  v_and_b32 v15, 0xffff0000, v105
  v_pk_add_f32 v[32:33], v[32:33], v[12:13]
  v_pk_add_f32 v[34:35], v[34:35], v[14:15]
  v_add_f32 v8, v8, v32
  v_fmac_f32 v10, v32, v32
  v_add_f32 v8, v8, v33
  v_fmac_f32 v10, v33, v33
  v_add_f32 v8, v8, v34
  v_fmac_f32 v10, v34, v34
  v_add_f32 v8, v8, v35
  v_fmac_f32 v10, v35, v35
  v_cvt_pk_bf16_f32 v24, v32, v33
  v_cvt_pk_bf16_f32 v25, v34, v35
  v_lshlrev_b32 v12, 16, v106
  v_and_b32 v13, 0xffff0000, v106
  v_lshlrev_b32 v14, 16, v107
  v_and_b32 v15, 0xffff0000, v107
  v_pk_add_f32 v[36:37], v[36:37], v[12:13]
  v_pk_add_f32 v[38:39], v[38:39], v[14:15]
  v_add_f32 v9, v9, v36
  v_fmac_f32 v11, v36, v36
  v_add_f32 v9, v9, v37
  v_fmac_f32 v11, v37, v37
  v_add_f32 v9, v9, v38
  v_fmac_f32 v11, v38, v38
  v_add_f32 v9, v9, v39
  v_fmac_f32 v11, v39, v39
  v_cvt_pk_bf16_f32 v26, v36, v37
  v_cvt_pk_bf16_f32 v27, v38, v39
  s_nop 1
  v_permlane16_swap_b32 v24, v26
  v_permlane16_swap_b32 v25, v27
  s_nop 1
  buffer_store_dwordx4 v[24:27], v22, s[48:51], s53 offen offset:0
  v_lshlrev_b32 v12, 16, v108
  v_and_b32 v13, 0xffff0000, v108
  v_lshlrev_b32 v14, 16, v109
  v_and_b32 v15, 0xffff0000, v109
  v_pk_add_f32 v[40:41], v[40:41], v[12:13]
  v_pk_add_f32 v[42:43], v[42:43], v[14:15]
  v_add_f32 v8, v8, v40
  v_fmac_f32 v10, v40, v40
  v_add_f32 v8, v8, v41
  v_fmac_f32 v10, v41, v41
  v_add_f32 v8, v8, v42
  v_fmac_f32 v10, v42, v42
  v_add_f32 v8, v8, v43
  v_fmac_f32 v10, v43, v43
  v_cvt_pk_bf16_f32 v28, v40, v41
  v_cvt_pk_bf16_f32 v29, v42, v43
  v_lshlrev_b32 v12, 16, v110
  v_and_b32 v13, 0xffff0000, v110
  v_lshlrev_b32 v14, 16, v111
  v_and_b32 v15, 0xffff0000, v111
  v_pk_add_f32 v[44:45], v[44:45], v[12:13]
  v_pk_add_f32 v[46:47], v[46:47], v[14:15]
  v_add_f32 v9, v9, v44
  v_fmac_f32 v11, v44, v44
  v_add_f32 v9, v9, v45
  v_fmac_f32 v11, v45, v45
  v_add_f32 v9, v9, v46
  v_fmac_f32 v11, v46, v46
  v_add_f32 v9, v9, v47
  v_fmac_f32 v11, v47, v47
  v_cvt_pk_bf16_f32 v30, v44, v45
  v_cvt_pk_bf16_f32 v31, v46, v47
  s_nop 1
  v_permlane16_swap_b32 v28, v30
  v_permlane16_swap_b32 v29, v31
  s_nop 1
  buffer_store_dwordx4 v[28:31], v22, s[48:51], s53 offen offset:1024
  v_permlane16_swap_b32 v8, v9
  v_permlane16_swap_b32 v10, v11
  s_nop 1
  v_add_f32 v8, v8, v9
  v_add_f32 v10, v10, v11
  s_nop 1
  v_permlane32_swap_b32 v8, v10
  s_nop 1
  v_add_f32 v8, v8, v10
  v_and_b32 v12, 31, v0
  v_lshlrev_b32 v12, 3, v12
  v_lshrrev_b32 v13, 5, v0
  v_lshl_add_u32 v12, v13, 2, v12
  s_lshl_b32 s40, s25, 1
  s_add_u32 s40, s40, s27
  s_lshl_b32 s40, s40, 14
  s_lshl_b32 s41, s38, 8
  s_add_u32 s40, s40, s41
  s_add_u32 s40, s40, 8912896
  buffer_store_dword v8, v12, s[48:51], s40 offen
  s_waitcnt vmcnt(0)
  s_mov_b64 exec, 1
  v_mov_b32 v1, 147456
  v_mov_b32 v2, 1
  ds_add_rtn_u32 v3, v1, v2
  s_lshl_b32 s37, s24, 7
  s_lshl_b32 s38, s25, 2
  s_add_u32 s37, s37, s38
  s_add_u32 s37, s37, 9183232
  s_waitcnt lgkmcnt(0)
  v_readfirstlane_b32 s38, v3
  s_and_b32 s38, s38, 3
  s_cmp_eq_u32 s38, 3
  s_cbranch_scc0 f0_kernel_p1_nosig15
  s_cmp_eq_u32 s63, 0
  s_cbranch_scc1 f0_kernel_p1_fastsig16
  buffer_wbl2 sc1
  s_waitcnt vmcnt(0)
  buffer_store_dword v2, off, s[48:51], s37 sc1
  s_branch f0_kernel_p1_nosig15
f0_kernel_p1_fastsig16:
  buffer_store_dword v2, off, s[48:51], s37
f0_kernel_p1_nosig15:
  s_mov_b64 exec, -1
  s_branch f0_kernel_p2_entry
f0_kernel_p2_entry:
  s_mov_b32 s26, s64
  s_load_dwordx2 s[8:9], s[0:1], 40
  s_and_b32 s20, s2, 7
  s_lshr_b32 s21, s2, 3
  s_and_b32 s22, s21, 1
  s_lshl_b32 s23, s20, 1
  s_add_u32 s24, s23, s22
  s_lshr_b32 s25, s21, 1
  s_cmp_lt_u32 s26, 4
  s_cbranch_scc1 f0_kernel_p2_compute
  s_sub_u32 s26, s26, 4
  v_lshlrev_b32 v1, 4, v0
  s_mul_i32 s40, s25, 122880
  s_mul_i32 s41, s26, 3072
  s_add_u32 s40, s40, s41
  s_add_u32 s40, s40, 3145728
  s_mov_b32 s42, s41
  s_lshl_b32 s43, s24, 2
  s_add_u32 s43, s43, s26
  s_mul_i32 s43, s43, 40960
  s_add_u32 s43, s43, 12582912
  s_lshl_b32 s44, s26, 12
  s_waitcnt lgkmcnt(0)
  s_mov_b32 s12, s6
  s_mov_b32 s13, s7
  s_mov_b32 s14, 0x3200000
  s_mov_b32 s15, 0x00020000
  s_add_u32 m0, s42, 0
  s_add_u32 s45, s40, 0
  buffer_load_dwordx4 v1, s[12:15], s45 offen offset:0 lds
  buffer_load_dwordx4 v1, s[12:15], s45 offen offset:1024 lds
  buffer_load_dwordx4 v1, s[12:15], s45 offen offset:2048 lds
  s_add_u32 m0, s42, 147712
  s_add_u32 s45, s40, 12288
  buffer_load_dwordx4 v1, s[12:15], s45 offen offset:0 lds
  buffer_load_dwordx4 v1, s[12:15], s45 offen offset:1024 lds
  buffer_load_dwordx4 v1, s[12:15], s45 offen offset:2048 lds
  v_and_b32 v2, 31, v0
  v_lshrrev_b32 v3, 5, v0
  s_lshl_b32 s47, s26, 5
  v_add_u32 v5, s47, v2
  s_mul_i32 s47, s25, 96
  v_add_u32 v6, s47, v5
  v_lshlrev_b32 v7, 2, v6
  v_mul_u32_u24 v8, 30720, v3
  v_add_u32 v7, v7, v8
  s_mov_b32 s47, 8519680
  buffer_load_dword v32, v7, s[12:15], s47 offen
  s_mov_b32 s47, 8525824
  buffer_load_dword v33, v7, s[12:15], s47 offen
  s_mov_b32 s47, 8531968
  buffer_load_dword v34, v7, s[12:15], s47 offen
  s_mov_b32 s47, 8538112
  buffer_load_dword v35, v7, s[12:15], s47 offen
  s_mov_b32 s47, 8544256
  buffer_load_dword v36, v7, s[12:15], s47 offen
  s_mov_b32 s16, s8
  s_mov_b32 s17, s9
  s_mov_b32 s18, 0xc00
  s_mov_b32 s19, 0x00020000
  v_lshlrev_b32 v9, 1, v6
  buffer_load_ushort v38, v9, s[16:19], 0 offen
  s_lshr_b32 s67, s26, 1
  s_lshl_b32 s46, s24, 1
  s_add_u32 s67, s67, s46
  s_lshl_b32 s66, s67, 7
  s_add_u32 s66, s66, 9183232
  v_lshlrev_b32 v10, 2, v0
  s_mov_b64 exec, 0xff
  s_mov_b32 s65, 16384
f0_kernel_p2_poll:
  buffer_load_dword v11, v10, s[12:15], s66 offen sc1
  s_waitcnt vmcnt(0)
  v_cmp_ne_u32 vcc, 0, v11
  s_cmp_eq_u32 vcc_lo, 0xff
  s_cbranch_scc1 f0_kernel_p2_polled
  s_sleep 1
  s_sub_u32 s65, s65, 1
  s_cbranch_scc0 f0_kernel_p2_poll
f0_kernel_p2_polled:
  s_mov_b64 exec, -1
  s_cmp_eq_u32 s63, 0
  s_cbranch_scc1 f0_kernel_p2_noacq
  buffer_inv sc1
  s_waitcnt vmcnt(0)
f0_kernel_p2_noacq:
  s_add_u32 m0, s44, 65536
  s_add_u32 s45, s43, 0
  buffer_load_dwordx4 v1, s[12:15], s45 offen offset:0 sc1 lds
  buffer_load_dwordx4 v1, s[12:15], s45 offen offset:1024 sc1 lds
  buffer_load_dwordx4 v1, s[12:15], s45 offen offset:2048 sc1 lds
  buffer_load_dwordx4 v1, s[12:15], s45 offen offset:3072 sc1 lds
  s_lshl_b32 s46, s24, 7
  s_lshl_b32 s47, s26, 5
  s_add_u32 s46, s46, s47
  v_add_u32 v4, s46, v2
  v_lshlrev_b32 v4, 3, v4
  v_lshl_add_u32 v4, v3, 17, v4
  s_mov_b32 s47, 8912896
  buffer_load_dwordx2 v[16:17], v4, s[12:15], s47 offen sc1
  s_mov_b32 s47, 8929280
  buffer_load_dwordx2 v[18:19], v4, s[12:15], s47 offen sc1
  s_mov_b32 s47, 8945664
  buffer_load_dwordx2 v[20:21], v4, s[12:15], s47 offen sc1
  s_mov_b32 s47, 8962048
  buffer_load_dwordx2 v[22:23], v4, s[12:15], s47 offen sc1
  s_mov_b32 s47, 8978432
  buffer_load_dwordx2 v[24:25], v4, s[12:15], s47 offen sc1
  s_mov_b32 s47, 8994816
  buffer_load_dwordx2 v[26:27], v4, s[12:15], s47 offen sc1
  s_mov_b32 s47, 9011200
  buffer_load_dwordx2 v[28:29], v4, s[12:15], s47 offen sc1
  s_mov_b32 s47, 9027584
  buffer_load_dwordx2 v[30:31], v4, s[12:15], s47 offen sc1
  s_add_u32 m0, s44, 131072
  s_add_u32 s45, s43, 4096
  buffer_load_dwordx4 v1, s[12:15], s45 offen offset:0 sc1 lds
  buffer_load_dwordx4 v1, s[12:15], s45 offen offset:1024 sc1 lds
  buffer_load_dwordx4 v1, s[12:15], s45 offen offset:2048 sc1 lds
  buffer_load_dwordx4 v1, s[12:15], s45 offen offset:3072 sc1 lds
  s_add_u32 m0, s42, 12288
  s_add_u32 s45, s40, 24576
  buffer_load_dwordx4 v1, s[12:15], s45 offen offset:0 lds
  buffer_load_dwordx4 v1, s[12:15], s45 offen offset:1024 lds
  buffer_load_dwordx4 v1, s[12:15], s45 offen offset:2048 lds
  s_add_u32 m0, s42, 53248
  s_add_u32 s45, s40, 36864
  buffer_load_dwordx4 v1, s[12:15], s45 offen offset:0 lds
  buffer_load_dwordx4 v1, s[12:15], s45 offen offset:1024 lds
  buffer_load_dwordx4 v1, s[12:15], s45 offen offset:2048 lds
  s_waitcnt vmcnt(10)
  s_barrier
  v_add_f32 v16, v16, v18
  v_add_f32 v17, v17, v19
  v_add_f32 v16, v16, v20
  v_add_f32 v17, v17, v21
  v_add_f32 v16, v16, v22
  v_add_f32 v17, v17, v23
  v_add_f32 v16, v16, v24
  v_add_f32 v17, v17, v25
  v_add_f32 v16, v16, v26
  v_add_f32 v17, v17, v27
  v_add_f32 v16, v16, v28
  v_add_f32 v17, v17, v29
  v_add_f32 v16, v16, v30
  v_add_f32 v17, v17, v31
  v_mov_b32 v18, v16
  v_mov_b32 v19, v17
  s_nop 1
  v_permlane32_swap_b32 v16, v18
  v_permlane32_swap_b32 v17, v19
  s_nop 1
  v_add_f32 v16, v16, v18
  v_add_f32 v17, v17, v19
  v_mul_f32 v16, 0x3acccccd, v16
  v_mul_f32 v17, 0x3acccccd, v17
  v_fma_f32 v17, -v16, v16, v17
  v_max_f32 v17, 0, v17
  v_add_f32 v18, 0x3727c5ac, v17
  v_rsq_f32 v18, v18
  s_nop 0
  v_mul_f32 v19, v18, v18
  v_mul_f32 v19, v19, v17
  v_add_f32 v19, 0x3727c5ac, v19
  v_rsq_f32 v19, v19
  s_nop 0
  v_mul_f32 v18, v18, v19
  s_nop 0
  v_mul_f32 v19, v18, v16
  v_add_f32 v32, v32, v33
  v_add_f32 v32, v32, v34
  v_add_f32 v32, v32, v35
  v_add_f32 v32, v32, v36
  v_mov_b32 v33, v32
  s_nop 1
  v_permlane32_swap_b32 v32, v33
  s_nop 1
  v_add_f32 v32, v32, v33
  v_cmp_eq_u32 vcc, 0, v3
  s_lshl_b32 s47, s26, 7
  v_lshlrev_b32 v2, 2, v2
  v_add_u32 v2, s47, v2
  v_add_u32 v2, 160000, v2
  v_lshl_add_u32 v2, v3, 9, v2
  v_cndmask_b32 v18, v19, v18, vcc
  v_lshlrev_b32 v38, 16, v38
  v_cndmask_b32 v32, v38, v32, vcc
  ds_write_b32 v2, v18
  ds_write_b32 v2, v32 offset:1024
  s_waitcnt lgkmcnt(0)
  s_add_u32 m0, s44, 81920
  s_add_u32 s45, s43, 8192
  buffer_load_dwordx4 v1, s[12:15], s45 offen offset:0 sc1 lds
  buffer_load_dwordx4 v1, s[12:15], s45 offen offset:1024 sc1 lds
  buffer_load_dwordx4 v1, s[12:15], s45 offen offset:2048 sc1 lds
  buffer_load_dwordx4 v1, s[12:15], s45 offen offset:3072 sc1 lds
  s_add_u32 m0, s44, 98304
  s_add_u32 s45, s43, 12288
  buffer_load_dwordx4 v1, s[12:15], s45 offen offset:0 sc1 lds
  buffer_load_dwordx4 v1, s[12:15], s45 offen offset:1024 sc1 lds
  buffer_load_dwordx4 v1, s[12:15], s45 offen offset:2048 sc1 lds
  buffer_load_dwordx4 v1, s[12:15], s45 offen offset:3072 sc1 lds
  s_waitcnt vmcnt(14)
  s_barrier
  s_add_u32 m0, s42, 0
  s_add_u32 s45, s40, 49152
  buffer_load_dwordx4 v1, s[12:15], s45 offen offset:0 lds
  buffer_load_dwordx4 v1, s[12:15], s45 offen offset:1024 lds
  buffer_load_dwordx4 v1, s[12:15], s45 offen offset:2048 lds
  s_add_u32 m0, s44, 65536
  s_add_u32 s45, s43, 16384
  buffer_load_dwordx4 v1, s[12:15], s45 offen offset:0 sc1 lds
  buffer_load_dwordx4 v1, s[12:15], s45 offen offset:1024 sc1 lds
  buffer_load_dwordx4 v1, s[12:15], s45 offen offset:2048 sc1 lds
  buffer_load_dwordx4 v1, s[12:15], s45 offen offset:3072 sc1 lds
  s_waitcnt vmcnt(11)
  s_barrier
  s_add_u32 m0, s42, 147712
  s_add_u32 s45, s40, 61440
  buffer_load_dwordx4 v1, s[12:15], s45 offen offset:0 lds
  buffer_load_dwordx4 v1, s[12:15], s45 offen offset:1024 lds
  buffer_load_dwordx4 v1, s[12:15], s45 offen offset:2048 lds
  s_add_u32 m0, s44, 131072
  s_add_u32 s45, s43, 20480
  buffer_load_dwordx4 v1, s[12:15], s45 offen offset:0 sc1 lds
  buffer_load_dwordx4 v1, s[12:15], s45 offen offset:1024 sc1 lds
  buffer_load_dwordx4 v1, s[12:15], s45 offen offset:2048 sc1 lds
  buffer_load_dwordx4 v1, s[12:15], s45 offen offset:3072 sc1 lds
  s_waitcnt vmcnt(14)
  s_barrier
  s_add_u32 m0, s42, 12288
  s_add_u32 s45, s40, 73728
  buffer_load_dwordx4 v1, s[12:15], s45 offen offset:0 lds
  buffer_load_dwordx4 v1, s[12:15], s45 offen offset:1024 lds
  buffer_load_dwordx4 v1, s[12:15], s45 offen offset:2048 lds
  s_add_u32 m0, s44, 81920
  s_add_u32 s45, s43, 24576
  buffer_load_dwordx4 v1, s[12:15], s45 offen offset:0 sc1 lds
  buffer_load_dwordx4 v1, s[12:15], s45 offen offset:1024 sc1 lds
  buffer_load_dwordx4 v1, s[12:15], s45 offen offset:2048 sc1 lds
  buffer_load_dwordx4 v1, s[12:15], s45 offen offset:3072 sc1 lds
  s_waitcnt vmcnt(14)
  s_barrier
  s_add_u32 m0, s42, 53248
  s_add_u32 s45, s40, 86016
  buffer_load_dwordx4 v1, s[12:15], s45 offen offset:0 lds
  buffer_load_dwordx4 v1, s[12:15], s45 offen offset:1024 lds
  buffer_load_dwordx4 v1, s[12:15], s45 offen offset:2048 lds
  s_add_u32 m0, s44, 98304
  s_add_u32 s45, s43, 28672
  buffer_load_dwordx4 v1, s[12:15], s45 offen offset:0 sc1 lds
  buffer_load_dwordx4 v1, s[12:15], s45 offen offset:1024 sc1 lds
  buffer_load_dwordx4 v1, s[12:15], s45 offen offset:2048 sc1 lds
  buffer_load_dwordx4 v1, s[12:15], s45 offen offset:3072 sc1 lds
  s_waitcnt vmcnt(14)
  s_barrier
  s_add_u32 m0, s42, 0
  s_add_u32 s45, s40, 98304
  buffer_load_dwordx4 v1, s[12:15], s45 offen offset:0 lds
  buffer_load_dwordx4 v1, s[12:15], s45 offen offset:1024 lds
  buffer_load_dwordx4 v1, s[12:15], s45 offen offset:2048 lds
  s_add_u32 m0, s44, 65536
  s_add_u32 s45, s43, 32768
  buffer_load_dwordx4 v1, s[12:15], s45 offen offset:0 sc1 lds
  buffer_load_dwordx4 v1, s[12:15], s45 offen offset:1024 sc1 lds
  buffer_load_dwordx4 v1, s[12:15], s45 offen offset:2048 sc1 lds
  buffer_load_dwordx4 v1, s[12:15], s45 offen offset:3072 sc1 lds
  s_waitcnt vmcnt(14)
  s_barrier
  s_add_u32 m0, s42, 147712
  s_add_u32 s45, s40, 110592
  buffer_load_dwordx4 v1, s[12:15], s45 offen offset:0 lds
  buffer_load_dwordx4 v1, s[12:15], s45 offen offset:1024 lds
  buffer_load_dwordx4 v1, s[12:15], s45 offen offset:2048 lds
  s_add_u32 m0, s44, 131072
  s_add_u32 s45, s43, 36864
  buffer_load_dwordx4 v1, s[12:15], s45 offen offset:0 sc1 lds
  buffer_load_dwordx4 v1, s[12:15], s45 offen offset:1024 sc1 lds
  buffer_load_dwordx4 v1, s[12:15], s45 offen offset:2048 sc1 lds
  buffer_load_dwordx4 v1, s[12:15], s45 offen offset:3072 sc1 lds
  v_lshlrev_b32 v12, 7, v0
  s_mul_i32 s46, s24, 163840
  s_lshl_b32 s47, s25, 2
  s_add_u32 s47, s47, s26
  s_mul_i32 s47, s47, 2560
  s_add_u32 s46, s46, s47
  s_add_u32 s46, s46, 15728640
  s_mov_b64 exec, 0xfffff
  buffer_load_dword v13, v12, s[12:15], s46 offen
  s_lshl_b32 s46, s25, 14
  s_lshl_b32 s47, s24, 10
  s_add_u32 s46, s46, s47
  s_lshl_b32 s47, s26, 8
  s_add_u32 s46, s46, s47
  s_add_u32 s46, s46, 8650752
  s_mov_b64 exec, 3
  buffer_load_dword v14, v12, s[12:15], s46 offen
  s_mov_b64 exec, -1
  s_waitcnt vmcnt(16)
  s_barrier
  s_waitcnt vmcnt(9)
  s_barrier
  s_waitcnt vmcnt(2)
  s_barrier
  s_branch f0_kernel_p3_entry
f0_kernel_p2_compute:
  s_mov_b32 s27, 0
  s_mov_b32 s36, s26
  v_lshrrev_b32 v17, 5, v0
  v_and_b32 v16, 31, v0
  v_mul_u32_u24 v20, 1536, v17
  v_lshl_add_u32 v20, v16, 4, v20
  s_mul_i32 s37, s27, 1536
  v_add_u32 v1, s37, v20
  v_add_u32 v2, 147712, v1
  v_lshlrev_b32 v20, 4, v0
  s_mul_i32 s37, s36, 4096
  s_add_u32 s37, s37, 65536
  v_add_u32 v3, s37, v20
  v_add_u32 v4, 65536, v3
  s_waitcnt lgkmcnt(0)
  s_barrier
  ds_read_b128 v[128:131], v1 offset:0
  ds_read_b128 v[132:135], v1 offset:512
  ds_read_b128 v[136:139], v1 offset:1024
  ds_read_b128 v[160:163], v3 offset:0
  s_waitcnt lgkmcnt(0)
  v_mfma_f32_32x32x16_bf16 v[64:79], v[128:131], v[160:163], 0
  ds_read_b128 v[140:143], v1 offset:3072
  ds_read_b128 v[144:147], v1 offset:3584
  v_mfma_f32_32x32x16_bf16 v[80:95], v[132:135], v[160:163], 0
  ds_read_b128 v[148:151], v1 offset:4096
  ds_read_b128 v[164:167], v3 offset:1024
  v_mfma_f32_32x32x16_bf16 v[96:111], v[136:139], v[160:163], 0
  s_waitcnt lgkmcnt(0)
  v_mfma_f32_32x32x16_bf16 v[64:79], v[140:143], v[164:167], v[64:79]
  ds_read_b128 v[128:131], v1 offset:6144
  ds_read_b128 v[132:135], v1 offset:6656
  v_mfma_f32_32x32x16_bf16 v[80:95], v[144:147], v[164:167], v[80:95]
  ds_read_b128 v[136:139], v1 offset:7168
  ds_read_b128 v[160:163], v3 offset:2048
  v_mfma_f32_32x32x16_bf16 v[96:111], v[148:151], v[164:167], v[96:111]
  s_waitcnt lgkmcnt(0)
  v_mfma_f32_32x32x16_bf16 v[64:79], v[128:131], v[160:163], v[64:79]
  ds_read_b128 v[140:143], v1 offset:9216
  ds_read_b128 v[144:147], v1 offset:9728
  v_mfma_f32_32x32x16_bf16 v[80:95], v[132:135], v[160:163], v[80:95]
  ds_read_b128 v[148:151], v1 offset:10240
  ds_read_b128 v[164:167], v3 offset:3072
  v_mfma_f32_32x32x16_bf16 v[96:111], v[136:139], v[160:163], v[96:111]
  s_waitcnt lgkmcnt(0)
  s_barrier
  v_mfma_f32_32x32x16_bf16 v[64:79], v[140:143], v[164:167], v[64:79]
  ds_read_b128 v[128:131], v2 offset:0
  ds_read_b128 v[132:135], v2 offset:512
  v_mfma_f32_32x32x16_bf16 v[80:95], v[144:147], v[164:167], v[80:95]
  ds_read_b128 v[136:139], v2 offset:1024
  ds_read_b128 v[160:163], v4 offset:0
  v_mfma_f32_32x32x16_bf16 v[96:111], v[148:151], v[164:167], v[96:111]
  s_waitcnt lgkmcnt(0)
  v_mfma_f32_32x32x16_bf16 v[64:79], v[128:131], v[160:163], v[64:79]
  ds_read_b128 v[140:143], v2 offset:3072
  ds_read_b128 v[144:147], v2 offset:3584
  v_mfma_f32_32x32x16_bf16 v[80:95], v[132:135], v[160:163], v[80:95]
  ds_read_b128 v[148:151], v2 offset:4096
  ds_read_b128 v[164:167], v4 offset:1024
  v_mfma_f32_32x32x16_bf16 v[96:111], v[136:139], v[160:163], v[96:111]
  s_waitcnt lgkmcnt(0)
  v_mfma_f32_32x32x16_bf16 v[64:79], v[140:143], v[164:167], v[64:79]
  ds_read_b128 v[128:131], v2 offset:6144
  ds_read_b128 v[132:135], v2 offset:6656
  v_mfma_f32_32x32x16_bf16 v[80:95], v[144:147], v[164:167], v[80:95]
  ds_read_b128 v[136:139], v2 offset:7168
  ds_read_b128 v[160:163], v4 offset:2048
  v_mfma_f32_32x32x16_bf16 v[96:111], v[148:151], v[164:167], v[96:111]
  s_waitcnt lgkmcnt(0)
  v_mfma_f32_32x32x16_bf16 v[64:79], v[128:131], v[160:163], v[64:79]
  ds_read_b128 v[140:143], v2 offset:9216
  ds_read_b128 v[144:147], v2 offset:9728
  v_mfma_f32_32x32x16_bf16 v[80:95], v[132:135], v[160:163], v[80:95]
  ds_read_b128 v[148:151], v2 offset:10240
  ds_read_b128 v[164:167], v4 offset:3072
  v_mfma_f32_32x32x16_bf16 v[96:111], v[136:139], v[160:163], v[96:111]
  s_waitcnt lgkmcnt(0)
  s_barrier
  v_mfma_f32_32x32x16_bf16 v[64:79], v[140:143], v[164:167], v[64:79]
  ds_read_b128 v[128:131], v1 offset:12288
  ds_read_b128 v[132:135], v1 offset:12800
  v_mfma_f32_32x32x16_bf16 v[80:95], v[144:147], v[164:167], v[80:95]
  ds_read_b128 v[136:139], v1 offset:13312
  ds_read_b128 v[160:163], v3 offset:16384
  v_mfma_f32_32x32x16_bf16 v[96:111], v[148:151], v[164:167], v[96:111]
  s_waitcnt lgkmcnt(0)
  v_mfma_f32_32x32x16_bf16 v[64:79], v[128:131], v[160:163], v[64:79]
  ds_read_b128 v[140:143], v1 offset:15360
  ds_read_b128 v[144:147], v1 offset:15872
  v_mfma_f32_32x32x16_bf16 v[80:95], v[132:135], v[160:163], v[80:95]
  ds_read_b128 v[148:151], v1 offset:16384
  ds_read_b128 v[164:167], v3 offset:17408
  v_mfma_f32_32x32x16_bf16 v[96:111], v[136:139], v[160:163], v[96:111]
  s_waitcnt lgkmcnt(0)
  v_mfma_f32_32x32x16_bf16 v[64:79], v[140:143], v[164:167], v[64:79]
  ds_read_b128 v[128:131], v1 offset:18432
  ds_read_b128 v[132:135], v1 offset:18944
  v_mfma_f32_32x32x16_bf16 v[80:95], v[144:147], v[164:167], v[80:95]
  ds_read_b128 v[136:139], v1 offset:19456
  ds_read_b128 v[160:163], v3 offset:18432
  v_mfma_f32_32x32x16_bf16 v[96:111], v[148:151], v[164:167], v[96:111]
  s_waitcnt lgkmcnt(0)
  v_mfma_f32_32x32x16_bf16 v[64:79], v[128:131], v[160:163], v[64:79]
  ds_read_b128 v[140:143], v1 offset:21504
  ds_read_b128 v[144:147], v1 offset:22016
  v_mfma_f32_32x32x16_bf16 v[80:95], v[132:135], v[160:163], v[80:95]
  ds_read_b128 v[148:151], v1 offset:22528
  ds_read_b128 v[164:167], v3 offset:19456
  v_mfma_f32_32x32x16_bf16 v[96:111], v[136:139], v[160:163], v[96:111]
  s_waitcnt lgkmcnt(0)
  s_barrier
  v_mfma_f32_32x32x16_bf16 v[64:79], v[140:143], v[164:167], v[64:79]
  ds_read_b128 v[128:131], v1 offset:53248
  ds_read_b128 v[132:135], v1 offset:53760
  v_mfma_f32_32x32x16_bf16 v[80:95], v[144:147], v[164:167], v[80:95]
  ds_read_b128 v[136:139], v1 offset:54272
  ds_read_b128 v[160:163], v3 offset:32768
  v_mfma_f32_32x32x16_bf16 v[96:111], v[148:151], v[164:167], v[96:111]
  s_waitcnt lgkmcnt(0)
  v_mfma_f32_32x32x16_bf16 v[64:79], v[128:131], v[160:163], v[64:79]
  ds_read_b128 v[140:143], v1 offset:56320
  ds_read_b128 v[144:147], v1 offset:56832
  v_mfma_f32_32x32x16_bf16 v[80:95], v[132:135], v[160:163], v[80:95]
  ds_read_b128 v[148:151], v1 offset:57344
  ds_read_b128 v[164:167], v3 offset:33792
  v_mfma_f32_32x32x16_bf16 v[96:111], v[136:139], v[160:163], v[96:111]
  s_waitcnt lgkmcnt(0)
  v_mfma_f32_32x32x16_bf16 v[64:79], v[140:143], v[164:167], v[64:79]
  ds_read_b128 v[128:131], v1 offset:59392
  ds_read_b128 v[132:135], v1 offset:59904
  v_mfma_f32_32x32x16_bf16 v[80:95], v[144:147], v[164:167], v[80:95]
  ds_read_b128 v[136:139], v1 offset:60416
  ds_read_b128 v[160:163], v3 offset:34816
  v_mfma_f32_32x32x16_bf16 v[96:111], v[148:151], v[164:167], v[96:111]
  s_waitcnt lgkmcnt(0)
  v_mfma_f32_32x32x16_bf16 v[64:79], v[128:131], v[160:163], v[64:79]
  ds_read_b128 v[140:143], v1 offset:62464
  ds_read_b128 v[144:147], v1 offset:62976
  v_mfma_f32_32x32x16_bf16 v[80:95], v[132:135], v[160:163], v[80:95]
  ds_read_b128 v[148:151], v1 offset:63488
  ds_read_b128 v[164:167], v3 offset:35840
  v_mfma_f32_32x32x16_bf16 v[96:111], v[136:139], v[160:163], v[96:111]
  s_waitcnt lgkmcnt(0)
  s_barrier
  v_mfma_f32_32x32x16_bf16 v[64:79], v[140:143], v[164:167], v[64:79]
  ds_read_b128 v[128:131], v1 offset:0
  ds_read_b128 v[132:135], v1 offset:512
  v_mfma_f32_32x32x16_bf16 v[80:95], v[144:147], v[164:167], v[80:95]
  ds_read_b128 v[136:139], v1 offset:1024
  ds_read_b128 v[160:163], v3 offset:0
  v_mfma_f32_32x32x16_bf16 v[96:111], v[148:151], v[164:167], v[96:111]
  s_waitcnt lgkmcnt(0)
  v_mfma_f32_32x32x16_bf16 v[64:79], v[128:131], v[160:163], v[64:79]
  ds_read_b128 v[140:143], v1 offset:3072
  ds_read_b128 v[144:147], v1 offset:3584
  v_mfma_f32_32x32x16_bf16 v[80:95], v[132:135], v[160:163], v[80:95]
  ds_read_b128 v[148:151], v1 offset:4096
  ds_read_b128 v[164:167], v3 offset:1024
  v_mfma_f32_32x32x16_bf16 v[96:111], v[136:139], v[160:163], v[96:111]
  s_waitcnt lgkmcnt(0)
  v_mfma_f32_32x32x16_bf16 v[64:79], v[140:143], v[164:167], v[64:79]
  ds_read_b128 v[128:131], v1 offset:6144
  ds_read_b128 v[132:135], v1 offset:6656
  v_mfma_f32_32x32x16_bf16 v[80:95], v[144:147], v[164:167], v[80:95]
  ds_read_b128 v[136:139], v1 offset:7168
  ds_read_b128 v[160:163], v3 offset:2048
  v_mfma_f32_32x32x16_bf16 v[96:111], v[148:151], v[164:167], v[96:111]
  s_waitcnt lgkmcnt(0)
  v_mfma_f32_32x32x16_bf16 v[64:79], v[128:131], v[160:163], v[64:79]
  ds_read_b128 v[140:143], v1 offset:9216
  ds_read_b128 v[144:147], v1 offset:9728
  v_mfma_f32_32x32x16_bf16 v[80:95], v[132:135], v[160:163], v[80:95]
  ds_read_b128 v[148:151], v1 offset:10240
  ds_read_b128 v[164:167], v3 offset:3072
  v_mfma_f32_32x32x16_bf16 v[96:111], v[136:139], v[160:163], v[96:111]
  s_waitcnt lgkmcnt(0)
  s_barrier
  v_mfma_f32_32x32x16_bf16 v[64:79], v[140:143], v[164:167], v[64:79]
  ds_read_b128 v[128:131], v2 offset:0
  ds_read_b128 v[132:135], v2 offset:512
  v_mfma_f32_32x32x16_bf16 v[80:95], v[144:147], v[164:167], v[80:95]
  ds_read_b128 v[136:139], v2 offset:1024
  ds_read_b128 v[160:163], v4 offset:0
  v_mfma_f32_32x32x16_bf16 v[96:111], v[148:151], v[164:167], v[96:111]
  s_waitcnt lgkmcnt(0)
  v_mfma_f32_32x32x16_bf16 v[64:79], v[128:131], v[160:163], v[64:79]
  ds_read_b128 v[140:143], v2 offset:3072
  ds_read_b128 v[144:147], v2 offset:3584
  v_mfma_f32_32x32x16_bf16 v[80:95], v[132:135], v[160:163], v[80:95]
  ds_read_b128 v[148:151], v2 offset:4096
  ds_read_b128 v[164:167], v4 offset:1024
  v_mfma_f32_32x32x16_bf16 v[96:111], v[136:139], v[160:163], v[96:111]
  s_waitcnt lgkmcnt(0)
  v_mfma_f32_32x32x16_bf16 v[64:79], v[140:143], v[164:167], v[64:79]
  ds_read_b128 v[128:131], v2 offset:6144
  ds_read_b128 v[132:135], v2 offset:6656
  v_mfma_f32_32x32x16_bf16 v[80:95], v[144:147], v[164:167], v[80:95]
  ds_read_b128 v[136:139], v2 offset:7168
  ds_read_b128 v[160:163], v4 offset:2048
  v_mfma_f32_32x32x16_bf16 v[96:111], v[148:151], v[164:167], v[96:111]
  s_waitcnt lgkmcnt(0)
  v_mfma_f32_32x32x16_bf16 v[64:79], v[128:131], v[160:163], v[64:79]
  ds_read_b128 v[140:143], v2 offset:9216
  ds_read_b128 v[144:147], v2 offset:9728
  v_mfma_f32_32x32x16_bf16 v[80:95], v[132:135], v[160:163], v[80:95]
  ds_read_b128 v[148:151], v2 offset:10240
  ds_read_b128 v[164:167], v4 offset:3072
  v_mfma_f32_32x32x16_bf16 v[96:111], v[136:139], v[160:163], v[96:111]
  s_waitcnt lgkmcnt(0)
  s_barrier
  v_mfma_f32_32x32x16_bf16 v[64:79], v[140:143], v[164:167], v[64:79]
  ds_read_b128 v[128:131], v1 offset:12288
  ds_read_b128 v[132:135], v1 offset:12800
  v_mfma_f32_32x32x16_bf16 v[80:95], v[144:147], v[164:167], v[80:95]
  ds_read_b128 v[136:139], v1 offset:13312
  ds_read_b128 v[160:163], v3 offset:16384
  v_mfma_f32_32x32x16_bf16 v[96:111], v[148:151], v[164:167], v[96:111]
  s_waitcnt lgkmcnt(0)
  v_mfma_f32_32x32x16_bf16 v[64:79], v[128:131], v[160:163], v[64:79]
  ds_read_b128 v[140:143], v1 offset:15360
  ds_read_b128 v[144:147], v1 offset:15872
  v_mfma_f32_32x32x16_bf16 v[80:95], v[132:135], v[160:163], v[80:95]
  ds_read_b128 v[148:151], v1 offset:16384
  ds_read_b128 v[164:167], v3 offset:17408
  v_mfma_f32_32x32x16_bf16 v[96:111], v[136:139], v[160:163], v[96:111]
  s_waitcnt lgkmcnt(0)
  v_mfma_f32_32x32x16_bf16 v[64:79], v[140:143], v[164:167], v[64:79]
  ds_read_b128 v[128:131], v1 offset:18432
  ds_read_b128 v[132:135], v1 offset:18944
  v_mfma_f32_32x32x16_bf16 v[80:95], v[144:147], v[164:167], v[80:95]
  ds_read_b128 v[136:139], v1 offset:19456
  ds_read_b128 v[160:163], v3 offset:18432
  v_mfma_f32_32x32x16_bf16 v[96:111], v[148:151], v[164:167], v[96:111]
  s_waitcnt lgkmcnt(0)
  v_mfma_f32_32x32x16_bf16 v[64:79], v[128:131], v[160:163], v[64:79]
  ds_read_b128 v[140:143], v1 offset:21504
  ds_read_b128 v[144:147], v1 offset:22016
  v_mfma_f32_32x32x16_bf16 v[80:95], v[132:135], v[160:163], v[80:95]
  ds_read_b128 v[148:151], v1 offset:22528
  ds_read_b128 v[164:167], v3 offset:19456
  v_mfma_f32_32x32x16_bf16 v[96:111], v[136:139], v[160:163], v[96:111]
  s_waitcnt lgkmcnt(0)
  s_barrier
  v_mfma_f32_32x32x16_bf16 v[64:79], v[140:143], v[164:167], v[64:79]
  ds_read_b128 v[128:131], v1 offset:53248
  ds_read_b128 v[132:135], v1 offset:53760
  v_mfma_f32_32x32x16_bf16 v[80:95], v[144:147], v[164:167], v[80:95]
  ds_read_b128 v[136:139], v1 offset:54272
  ds_read_b128 v[160:163], v3 offset:32768
  v_mfma_f32_32x32x16_bf16 v[96:111], v[148:151], v[164:167], v[96:111]
  s_waitcnt lgkmcnt(0)
  v_mfma_f32_32x32x16_bf16 v[64:79], v[128:131], v[160:163], v[64:79]
  ds_read_b128 v[140:143], v1 offset:56320
  ds_read_b128 v[144:147], v1 offset:56832
  v_mfma_f32_32x32x16_bf16 v[80:95], v[132:135], v[160:163], v[80:95]
  ds_read_b128 v[148:151], v1 offset:57344
  ds_read_b128 v[164:167], v3 offset:33792
  v_mfma_f32_32x32x16_bf16 v[96:111], v[136:139], v[160:163], v[96:111]
  s_waitcnt lgkmcnt(0)
  v_mfma_f32_32x32x16_bf16 v[64:79], v[140:143], v[164:167], v[64:79]
  ds_read_b128 v[128:131], v1 offset:59392
  ds_read_b128 v[132:135], v1 offset:59904
  v_mfma_f32_32x32x16_bf16 v[80:95], v[144:147], v[164:167], v[80:95]
  ds_read_b128 v[136:139], v1 offset:60416
  ds_read_b128 v[160:163], v3 offset:34816
  v_mfma_f32_32x32x16_bf16 v[96:111], v[148:151], v[164:167], v[96:111]
  s_waitcnt lgkmcnt(0)
  v_mfma_f32_32x32x16_bf16 v[64:79], v[128:131], v[160:163], v[64:79]
  ds_read_b128 v[140:143], v1 offset:62464
  ds_read_b128 v[144:147], v1 offset:62976
  v_mfma_f32_32x32x16_bf16 v[80:95], v[132:135], v[160:163], v[80:95]
  ds_read_b128 v[148:151], v1 offset:63488
  ds_read_b128 v[164:167], v3 offset:35840
  v_mfma_f32_32x32x16_bf16 v[96:111], v[136:139], v[160:163], v[96:111]
  s_waitcnt lgkmcnt(0)
  s_barrier
  v_mfma_f32_32x32x16_bf16 v[64:79], v[140:143], v[164:167], v[64:79]
  ds_read_b128 v[128:131], v1 offset:0
  ds_read_b128 v[132:135], v1 offset:512
  v_mfma_f32_32x32x16_bf16 v[80:95], v[144:147], v[164:167], v[80:95]
  ds_read_b128 v[136:139], v1 offset:1024
  ds_read_b128 v[160:163], v3 offset:0
  v_mfma_f32_32x32x16_bf16 v[96:111], v[148:151], v[164:167], v[96:111]
  s_waitcnt lgkmcnt(0)
  v_mfma_f32_32x32x16_bf16 v[64:79], v[128:131], v[160:163], v[64:79]
  ds_read_b128 v[140:143], v1 offset:3072
  ds_read_b128 v[144:147], v1 offset:3584
  v_mfma_f32_32x32x16_bf16 v[80:95], v[132:135], v[160:163], v[80:95]
  ds_read_b128 v[148:151], v1 offset:4096
  ds_read_b128 v[164:167], v3 offset:1024
  v_mfma_f32_32x32x16_bf16 v[96:111], v[136:139], v[160:163], v[96:111]
  s_waitcnt lgkmcnt(0)
  v_mfma_f32_32x32x16_bf16 v[64:79], v[140:143], v[164:167], v[64:79]
  ds_read_b128 v[128:131], v1 offset:6144
  ds_read_b128 v[132:135], v1 offset:6656
  v_mfma_f32_32x32x16_bf16 v[80:95], v[144:147], v[164:167], v[80:95]
  ds_read_b128 v[136:139], v1 offset:7168
  ds_read_b128 v[160:163], v3 offset:2048
  v_mfma_f32_32x32x16_bf16 v[96:111], v[148:151], v[164:167], v[96:111]
  s_waitcnt lgkmcnt(0)
  v_mfma_f32_32x32x16_bf16 v[64:79], v[128:131], v[160:163], v[64:79]
  ds_read_b128 v[140:143], v1 offset:9216
  ds_read_b128 v[144:147], v1 offset:9728
  v_mfma_f32_32x32x16_bf16 v[80:95], v[132:135], v[160:163], v[80:95]
  ds_read_b128 v[148:151], v1 offset:10240
  ds_read_b128 v[164:167], v3 offset:3072
  v_mfma_f32_32x32x16_bf16 v[96:111], v[136:139], v[160:163], v[96:111]
  s_waitcnt lgkmcnt(0)
  s_barrier
  v_mfma_f32_32x32x16_bf16 v[64:79], v[140:143], v[164:167], v[64:79]
  ds_read_b128 v[128:131], v2 offset:0
  ds_read_b128 v[132:135], v2 offset:512
  v_mfma_f32_32x32x16_bf16 v[80:95], v[144:147], v[164:167], v[80:95]
  ds_read_b128 v[136:139], v2 offset:1024
  ds_read_b128 v[160:163], v4 offset:0
  v_mfma_f32_32x32x16_bf16 v[96:111], v[148:151], v[164:167], v[96:111]
  s_waitcnt lgkmcnt(0)
  v_mfma_f32_32x32x16_bf16 v[64:79], v[128:131], v[160:163], v[64:79]
  ds_read_b128 v[140:143], v2 offset:3072
  ds_read_b128 v[144:147], v2 offset:3584
  v_mfma_f32_32x32x16_bf16 v[80:95], v[132:135], v[160:163], v[80:95]
  ds_read_b128 v[148:151], v2 offset:4096
  ds_read_b128 v[164:167], v4 offset:1024
  v_mfma_f32_32x32x16_bf16 v[96:111], v[136:139], v[160:163], v[96:111]
  s_waitcnt lgkmcnt(0)
  v_mfma_f32_32x32x16_bf16 v[64:79], v[140:143], v[164:167], v[64:79]
  ds_read_b128 v[128:131], v2 offset:6144
  ds_read_b128 v[132:135], v2 offset:6656
  v_mfma_f32_32x32x16_bf16 v[80:95], v[144:147], v[164:167], v[80:95]
  ds_read_b128 v[136:139], v2 offset:7168
  ds_read_b128 v[160:163], v4 offset:2048
  v_mfma_f32_32x32x16_bf16 v[96:111], v[148:151], v[164:167], v[96:111]
  s_waitcnt lgkmcnt(0)
  v_mfma_f32_32x32x16_bf16 v[64:79], v[128:131], v[160:163], v[64:79]
  ds_read_b128 v[140:143], v2 offset:9216
  ds_read_b128 v[144:147], v2 offset:9728
  v_mfma_f32_32x32x16_bf16 v[80:95], v[132:135], v[160:163], v[80:95]
  ds_read_b128 v[148:151], v2 offset:10240
  ds_read_b128 v[164:167], v4 offset:3072
  v_mfma_f32_32x32x16_bf16 v[96:111], v[136:139], v[160:163], v[96:111]
  s_waitcnt lgkmcnt(0)
  v_mfma_f32_32x32x16_bf16 v[64:79], v[140:143], v[164:167], v[64:79]
  v_mfma_f32_32x32x16_bf16 v[80:95], v[144:147], v[164:167], v[80:95]
  v_mfma_f32_32x32x16_bf16 v[96:111], v[148:151], v[164:167], v[96:111]
  s_mov_b32 s48, s6
  s_mov_b32 s49, s7
  s_mov_b32 s50, 0x3200000
  s_mov_b32 s51, 0x00020000
  s_lshl_b32 s37, s36, 7
  v_lshlrev_b32 v20, 2, v16
  v_add_u32 v20, s37, v20
  v_add_u32 v20, 160000, v20
  ds_read_b32 v32, v20
  ds_read_b32 v33, v20 offset:512
  v_lshlrev_b32 v21, 4, v17
  v_add_u32 v21, 161024, v21
  ds_read_b128 v[128:131], v21 offset:0
  ds_read_b128 v[132:135], v21 offset:32
  ds_read_b128 v[136:139], v21 offset:64
  ds_read_b128 v[140:143], v21 offset:96
  ds_read_b128 v[144:147], v21 offset:128
  ds_read_b128 v[148:151], v21 offset:160
  ds_read_b128 v[152:155], v21 offset:192
  ds_read_b128 v[156:159], v21 offset:224
  ds_read_b128 v[160:163], v21 offset:256
  ds_read_b128 v[164:167], v21 offset:288
  ds_read_b128 v[168:171], v21 offset:320
  ds_read_b128 v[172:175], v21 offset:352
  s_waitcnt lgkmcnt(6)
  ds_read_b128 v[176:179], v21 offset:512
  ds_read_b128 v[180:183], v21 offset:544
  ds_read_b128 v[184:187], v21 offset:576
  ds_read_b128 v[188:191], v21 offset:608
  ds_read_b128 v[192:195], v21 offset:640
  ds_read_b128 v[196:199], v21 offset:672
  ds_read_b128 v[200:203], v21 offset:704
  ds_read_b128 v[204:207], v21 offset:736
  ds_read_b128 v[208:211], v21 offset:768
  ds_read_b128 v[212:215], v21 offset:800
  ds_read_b128 v[216:219], v21 offset:832
  ds_read_b128 v[220:223], v21 offset:864
  s_lshl_b32 s39, s24, 2
  s_add_u32 s39, s39, s36
  s_mul_i32 s39, s39, 98304
  s_mul_i32 s40, s25, 6144
  s_add_u32 s39, s39, s40
  s_add_u32 s52, s39, 31457280
  s_add_u32 s53, s52, 2048
  s_add_u32 s54, s52, 4096
  v_lshlrev_b32 v22, 4, v0
  v_mov_b32 v34, 0xc0135761
  v_mov_b32 v35, 0xbdd2d3e8
  s_waitcnt lgkmcnt(0)
  s_nop 7
  v_pk_fma_f32 v[36:37], v[128:129], v[32:33], v[176:177] op_sel:[0,1,0] op_sel_hi:[1,1,1] neg_lo:[1,0,0] neg_hi:[1,0,0]
  v_pk_fma_f32 v[38:39], v[130:131], v[32:33], v[178:179] op_sel:[0,1,0] op_sel_hi:[1,1,1] neg_lo:[1,0,0] neg_hi:[1,0,0]
  v_pk_fma_f32 v[36:37], v[64:65], v[32:33], v[36:37] op_sel_hi:[1,0,1]
  v_pk_fma_f32 v[38:39], v[66:67], v[32:33], v[38:39] op_sel_hi:[1,0,1]
  v_pk_mul_f32 v[40:41], v[36:37], v[36:37]
  v_pk_mul_f32 v[42:43], v[38:39], v[38:39]
  v_pk_fma_f32 v[40:41], v[40:41], v[34:35], v[34:35] op_sel:[0,1,0] op_sel_hi:[1,1,0]
  v_pk_fma_f32 v[42:43], v[42:43], v[34:35], v[34:35] op_sel:[0,1,0] op_sel_hi:[1,1,0]
  v_pk_mul_f32 v[40:41], v[40:41], v[36:37]
  v_pk_mul_f32 v[42:43], v[42:43], v[38:39]
  v_exp_f32 v40, v40
  v_exp_f32 v41, v41
  v_exp_f32 v42, v42
  v_exp_f32 v43, v43
  s_nop 0
  v_pk_add_f32 v[40:41], v[40:41], 1.0 op_sel_hi:[1,0]
  v_pk_add_f32 v[42:43], v[42:43], 1.0 op_sel_hi:[1,0]
  v_rcp_f32 v40, v40
  v_rcp_f32 v41, v41
  v_rcp_f32 v42, v42
  v_rcp_f32 v43, v43
  s_nop 0
  v_pk_mul_f32 v[36:37], v[36:37], v[40:41]
  v_pk_mul_f32 v[38:39], v[38:39], v[42:43]
  v_cvt_pk_bf16_f32 v56, v36, v37
  v_cvt_pk_bf16_f32 v57, v38, v39
  v_pk_fma_f32 v[36:37], v[132:133], v[32:33], v[180:181] op_sel:[0,1,0] op_sel_hi:[1,1,1] neg_lo:[1,0,0] neg_hi:[1,0,0]
  v_pk_fma_f32 v[38:39], v[134:135], v[32:33], v[182:183] op_sel:[0,1,0] op_sel_hi:[1,1,1] neg_lo:[1,0,0] neg_hi:[1,0,0]
  v_pk_fma_f32 v[36:37], v[68:69], v[32:33], v[36:37] op_sel_hi:[1,0,1]
  v_pk_fma_f32 v[38:39], v[70:71], v[32:33], v[38:39] op_sel_hi:[1,0,1]
  v_pk_mul_f32 v[40:41], v[36:37], v[36:37]
  v_pk_mul_f32 v[42:43], v[38:39], v[38:39]
  v_pk_fma_f32 v[40:41], v[40:41], v[34:35], v[34:35] op_sel:[0,1,0] op_sel_hi:[1,1,0]
  v_pk_fma_f32 v[42:43], v[42:43], v[34:35], v[34:35] op_sel:[0,1,0] op_sel_hi:[1,1,0]
  v_pk_mul_f32 v[40:41], v[40:41], v[36:37]
  v_pk_mul_f32 v[42:43], v[42:43], v[38:39]
  v_exp_f32 v40, v40
  v_exp_f32 v41, v41
  v_exp_f32 v42, v42
  v_exp_f32 v43, v43
  s_nop 0
  v_pk_add_f32 v[40:41], v[40:41], 1.0 op_sel_hi:[1,0]
  v_pk_add_f32 v[42:43], v[42:43], 1.0 op_sel_hi:[1,0]
  v_rcp_f32 v40, v40
  v_rcp_f32 v41, v41
  v_rcp_f32 v42, v42
  v_rcp_f32 v43, v43
  s_nop 0
  v_pk_mul_f32 v[36:37], v[36:37], v[40:41]
  v_pk_mul_f32 v[38:39], v[38:39], v[42:43]
  v_cvt_pk_bf16_f32 v58, v36, v37
  v_cvt_pk_bf16_f32 v59, v38, v39
  s_nop 1
  v_permlane32_swap_b32 v56, v58
  v_permlane32_swap_b32 v57, v59
  s_nop 1
  buffer_store_dwordx4 v[56:59], v22, s[48:51], s52 offen offset:0
  v_pk_fma_f32 v[36:37], v[136:137], v[32:33], v[184:185] op_sel:[0,1,0] op_sel_hi:[1,1,1] neg_lo:[1,0,0] neg_hi:[1,0,0]
  v_pk_fma_f32 v[38:39], v[138:139], v[32:33], v[186:187] op_sel:[0,1,0] op_sel_hi:[1,1,1] neg_lo:[1,0,0] neg_hi:[1,0,0]
  v_pk_fma_f32 v[36:37], v[72:73], v[32:33], v[36:37] op_sel_hi:[1,0,1]
  v_pk_fma_f32 v[38:39], v[74:75], v[32:33], v[38:39] op_sel_hi:[1,0,1]
  v_pk_mul_f32 v[40:41], v[36:37], v[36:37]
  v_pk_mul_f32 v[42:43], v[38:39], v[38:39]
  v_pk_fma_f32 v[40:41], v[40:41], v[34:35], v[34:35] op_sel:[0,1,0] op_sel_hi:[1,1,0]
  v_pk_fma_f32 v[42:43], v[42:43], v[34:35], v[34:35] op_sel:[0,1,0] op_sel_hi:[1,1,0]
  v_pk_mul_f32 v[40:41], v[40:41], v[36:37]
  v_pk_mul_f32 v[42:43], v[42:43], v[38:39]
  v_exp_f32 v40, v40
  v_exp_f32 v41, v41
  v_exp_f32 v42, v42
  v_exp_f32 v43, v43
  s_nop 0
  v_pk_add_f32 v[40:41], v[40:41], 1.0 op_sel_hi:[1,0]
  v_pk_add_f32 v[42:43], v[42:43], 1.0 op_sel_hi:[1,0]
  v_rcp_f32 v40, v40
  v_rcp_f32 v41, v41
  v_rcp_f32 v42, v42
  v_rcp_f32 v43, v43
  s_nop 0
  v_pk_mul_f32 v[36:37], v[36:37], v[40:41]
  v_pk_mul_f32 v[38:39], v[38:39], v[42:43]
  v_cvt_pk_bf16_f32 v60, v36, v37
  v_cvt_pk_bf16_f32 v61, v38, v39
  v_pk_fma_f32 v[36:37], v[140:141], v[32:33], v[188:189] op_sel:[0,1,0] op_sel_hi:[1,1,1] neg_lo:[1,0,0] neg_hi:[1,0,0]
  v_pk_fma_f32 v[38:39], v[142:143], v[32:33], v[190:191] op_sel:[0,1,0] op_sel_hi:[1,1,1] neg_lo:[1,0,0] neg_hi:[1,0,0]
  v_pk_fma_f32 v[36:37], v[76:77], v[32:33], v[36:37] op_sel_hi:[1,0,1]
  v_pk_fma_f32 v[38:39], v[78:79], v[32:33], v[38:39] op_sel_hi:[1,0,1]
  v_pk_mul_f32 v[40:41], v[36:37], v[36:37]
  v_pk_mul_f32 v[42:43], v[38:39], v[38:39]
  v_pk_fma_f32 v[40:41], v[40:41], v[34:35], v[34:35] op_sel:[0,1,0] op_sel_hi:[1,1,0]
  v_pk_fma_f32 v[42:43], v[42:43], v[34:35], v[34:35] op_sel:[0,1,0] op_sel_hi:[1,1,0]
  v_pk_mul_f32 v[40:41], v[40:41], v[36:37]
  v_pk_mul_f32 v[42:43], v[42:43], v[38:39]
  v_exp_f32 v40, v40
  v_exp_f32 v41, v41
  v_exp_f32 v42, v42
  v_exp_f32 v43, v43
  s_nop 0
  v_pk_add_f32 v[40:41], v[40:41], 1.0 op_sel_hi:[1,0]
  v_pk_add_f32 v[42:43], v[42:43], 1.0 op_sel_hi:[1,0]
  v_rcp_f32 v40, v40
  v_rcp_f32 v41, v41
  v_rcp_f32 v42, v42
  v_rcp_f32 v43, v43
  s_nop 0
  v_pk_mul_f32 v[36:37], v[36:37], v[40:41]
  v_pk_mul_f32 v[38:39], v[38:39], v[42:43]
  v_cvt_pk_bf16_f32 v62, v36, v37
  v_cvt_pk_bf16_f32 v63, v38, v39
  s_nop 1
  v_permlane32_swap_b32 v60, v62
  v_permlane32_swap_b32 v61, v63
  s_nop 1
  buffer_store_dwordx4 v[60:63], v22, s[48:51], s52 offen offset:1024
  v_pk_fma_f32 v[36:37], v[144:145], v[32:33], v[192:193] op_sel:[0,1,0] op_sel_hi:[1,1,1] neg_lo:[1,0,0] neg_hi:[1,0,0]
  v_pk_fma_f32 v[38:39], v[146:147], v[32:33], v[194:195] op_sel:[0,1,0] op_sel_hi:[1,1,1] neg_lo:[1,0,0] neg_hi:[1,0,0]
  v_pk_fma_f32 v[36:37], v[80:81], v[32:33], v[36:37] op_sel_hi:[1,0,1]
  v_pk_fma_f32 v[38:39], v[82:83], v[32:33], v[38:39] op_sel_hi:[1,0,1]
  v_pk_mul_f32 v[40:41], v[36:37], v[36:37]
  v_pk_mul_f32 v[42:43], v[38:39], v[38:39]
  v_pk_fma_f32 v[40:41], v[40:41], v[34:35], v[34:35] op_sel:[0,1,0] op_sel_hi:[1,1,0]
  v_pk_fma_f32 v[42:43], v[42:43], v[34:35], v[34:35] op_sel:[0,1,0] op_sel_hi:[1,1,0]
  v_pk_mul_f32 v[40:41], v[40:41], v[36:37]
  v_pk_mul_f32 v[42:43], v[42:43], v[38:39]
  v_exp_f32 v40, v40
  v_exp_f32 v41, v41
  v_exp_f32 v42, v42
  v_exp_f32 v43, v43
  s_nop 0
  v_pk_add_f32 v[40:41], v[40:41], 1.0 op_sel_hi:[1,0]
  v_pk_add_f32 v[42:43], v[42:43], 1.0 op_sel_hi:[1,0]
  v_rcp_f32 v40, v40
  v_rcp_f32 v41, v41
  v_rcp_f32 v42, v42
  v_rcp_f32 v43, v43
  s_nop 0
  v_pk_mul_f32 v[36:37], v[36:37], v[40:41]
  v_pk_mul_f32 v[38:39], v[38:39], v[42:43]
  v_cvt_pk_bf16_f32 v56, v36, v37
  v_cvt_pk_bf16_f32 v57, v38, v39
  v_pk_fma_f32 v[36:37], v[148:149], v[32:33], v[196:197] op_sel:[0,1,0] op_sel_hi:[1,1,1] neg_lo:[1,0,0] neg_hi:[1,0,0]
  v_pk_fma_f32 v[38:39], v[150:151], v[32:33], v[198:199] op_sel:[0,1,0] op_sel_hi:[1,1,1] neg_lo:[1,0,0] neg_hi:[1,0,0]
  v_pk_fma_f32 v[36:37], v[84:85], v[32:33], v[36:37] op_sel_hi:[1,0,1]
  v_pk_fma_f32 v[38:39], v[86:87], v[32:33], v[38:39] op_sel_hi:[1,0,1]
  v_pk_mul_f32 v[40:41], v[36:37], v[36:37]
  v_pk_mul_f32 v[42:43], v[38:39], v[38:39]
  v_pk_fma_f32 v[40:41], v[40:41], v[34:35], v[34:35] op_sel:[0,1,0] op_sel_hi:[1,1,0]
  v_pk_fma_f32 v[42:43], v[42:43], v[34:35], v[34:35] op_sel:[0,1,0] op_sel_hi:[1,1,0]
  v_pk_mul_f32 v[40:41], v[40:41], v[36:37]
  v_pk_mul_f32 v[42:43], v[42:43], v[38:39]
  v_exp_f32 v40, v40
  v_exp_f32 v41, v41
  v_exp_f32 v42, v42
  v_exp_f32 v43, v43
  s_nop 0
  v_pk_add_f32 v[40:41], v[40:41], 1.0 op_sel_hi:[1,0]
  v_pk_add_f32 v[42:43], v[42:43], 1.0 op_sel_hi:[1,0]
  v_rcp_f32 v40, v40
  v_rcp_f32 v41, v41
  v_rcp_f32 v42, v42
  v_rcp_f32 v43, v43
  s_nop 0
  v_pk_mul_f32 v[36:37], v[36:37], v[40:41]
  v_pk_mul_f32 v[38:39], v[38:39], v[42:43]
  v_cvt_pk_bf16_f32 v58, v36, v37
  v_cvt_pk_bf16_f32 v59, v38, v39
  s_nop 1
  v_permlane32_swap_b32 v56, v58
  v_permlane32_swap_b32 v57, v59
  s_nop 1
  buffer_store_dwordx4 v[56:59], v22, s[48:51], s53 offen offset:0
  v_pk_fma_f32 v[36:37], v[152:153], v[32:33], v[200:201] op_sel:[0,1,0] op_sel_hi:[1,1,1] neg_lo:[1,0,0] neg_hi:[1,0,0]
  v_pk_fma_f32 v[38:39], v[154:155], v[32:33], v[202:203] op_sel:[0,1,0] op_sel_hi:[1,1,1] neg_lo:[1,0,0] neg_hi:[1,0,0]
  v_pk_fma_f32 v[36:37], v[88:89], v[32:33], v[36:37] op_sel_hi:[1,0,1]
  v_pk_fma_f32 v[38:39], v[90:91], v[32:33], v[38:39] op_sel_hi:[1,0,1]
  v_pk_mul_f32 v[40:41], v[36:37], v[36:37]
  v_pk_mul_f32 v[42:43], v[38:39], v[38:39]
  v_pk_fma_f32 v[40:41], v[40:41], v[34:35], v[34:35] op_sel:[0,1,0] op_sel_hi:[1,1,0]
  v_pk_fma_f32 v[42:43], v[42:43], v[34:35], v[34:35] op_sel:[0,1,0] op_sel_hi:[1,1,0]
  v_pk_mul_f32 v[40:41], v[40:41], v[36:37]
  v_pk_mul_f32 v[42:43], v[42:43], v[38:39]
  v_exp_f32 v40, v40
  v_exp_f32 v41, v41
  v_exp_f32 v42, v42
  v_exp_f32 v43, v43
  s_nop 0
  v_pk_add_f32 v[40:41], v[40:41], 1.0 op_sel_hi:[1,0]
  v_pk_add_f32 v[42:43], v[42:43], 1.0 op_sel_hi:[1,0]
  v_rcp_f32 v40, v40
  v_rcp_f32 v41, v41
  v_rcp_f32 v42, v42
  v_rcp_f32 v43, v43
  s_nop 0
  v_pk_mul_f32 v[36:37], v[36:37], v[40:41]
  v_pk_mul_f32 v[38:39], v[38:39], v[42:43]
  v_cvt_pk_bf16_f32 v60, v36, v37
  v_cvt_pk_bf16_f32 v61, v38, v39
  v_pk_fma_f32 v[36:37], v[156:157], v[32:33], v[204:205] op_sel:[0,1,0] op_sel_hi:[1,1,1] neg_lo:[1,0,0] neg_hi:[1,0,0]
  v_pk_fma_f32 v[38:39], v[158:159], v[32:33], v[206:207] op_sel:[0,1,0] op_sel_hi:[1,1,1] neg_lo:[1,0,0] neg_hi:[1,0,0]
  v_pk_fma_f32 v[36:37], v[92:93], v[32:33], v[36:37] op_sel_hi:[1,0,1]
  v_pk_fma_f32 v[38:39], v[94:95], v[32:33], v[38:39] op_sel_hi:[1,0,1]
  v_pk_mul_f32 v[40:41], v[36:37], v[36:37]
  v_pk_mul_f32 v[42:43], v[38:39], v[38:39]
  v_pk_fma_f32 v[40:41], v[40:41], v[34:35], v[34:35] op_sel:[0,1,0] op_sel_hi:[1,1,0]
  v_pk_fma_f32 v[42:43], v[42:43], v[34:35], v[34:35] op_sel:[0,1,0] op_sel_hi:[1,1,0]
  v_pk_mul_f32 v[40:41], v[40:41], v[36:37]
  v_pk_mul_f32 v[42:43], v[42:43], v[38:39]
  v_exp_f32 v40, v40
  v_exp_f32 v41, v41
  v_exp_f32 v42, v42
  v_exp_f32 v43, v43
  s_nop 0
  v_pk_add_f32 v[40:41], v[40:41], 1.0 op_sel_hi:[1,0]
  v_pk_add_f32 v[42:43], v[42:43], 1.0 op_sel_hi:[1,0]
  v_rcp_f32 v40, v40
  v_rcp_f32 v41, v41
  v_rcp_f32 v42, v42
  v_rcp_f32 v43, v43
  s_nop 0
  v_pk_mul_f32 v[36:37], v[36:37], v[40:41]
  v_pk_mul_f32 v[38:39], v[38:39], v[42:43]
  v_cvt_pk_bf16_f32 v62, v36, v37
  v_cvt_pk_bf16_f32 v63, v38, v39
  s_nop 1
  v_permlane32_swap_b32 v60, v62
  v_permlane32_swap_b32 v61, v63
  s_nop 1
  buffer_store_dwordx4 v[60:63], v22, s[48:51], s53 offen offset:1024
  v_pk_fma_f32 v[36:37], v[160:161], v[32:33], v[208:209] op_sel:[0,1,0] op_sel_hi:[1,1,1] neg_lo:[1,0,0] neg_hi:[1,0,0]
  v_pk_fma_f32 v[38:39], v[162:163], v[32:33], v[210:211] op_sel:[0,1,0] op_sel_hi:[1,1,1] neg_lo:[1,0,0] neg_hi:[1,0,0]
  v_pk_fma_f32 v[36:37], v[96:97], v[32:33], v[36:37] op_sel_hi:[1,0,1]
  v_pk_fma_f32 v[38:39], v[98:99], v[32:33], v[38:39] op_sel_hi:[1,0,1]
  v_pk_mul_f32 v[40:41], v[36:37], v[36:37]
  v_pk_mul_f32 v[42:43], v[38:39], v[38:39]
  v_pk_fma_f32 v[40:41], v[40:41], v[34:35], v[34:35] op_sel:[0,1,0] op_sel_hi:[1,1,0]
  v_pk_fma_f32 v[42:43], v[42:43], v[34:35], v[34:35] op_sel:[0,1,0] op_sel_hi:[1,1,0]
  v_pk_mul_f32 v[40:41], v[40:41], v[36:37]
  v_pk_mul_f32 v[42:43], v[42:43], v[38:39]
  v_exp_f32 v40, v40
  v_exp_f32 v41, v41
  v_exp_f32 v42, v42
  v_exp_f32 v43, v43
  s_nop 0
  v_pk_add_f32 v[40:41], v[40:41], 1.0 op_sel_hi:[1,0]
  v_pk_add_f32 v[42:43], v[42:43], 1.0 op_sel_hi:[1,0]
  v_rcp_f32 v40, v40
  v_rcp_f32 v41, v41
  v_rcp_f32 v42, v42
  v_rcp_f32 v43, v43
  s_nop 0
  v_pk_mul_f32 v[36:37], v[36:37], v[40:41]
  v_pk_mul_f32 v[38:39], v[38:39], v[42:43]
  v_cvt_pk_bf16_f32 v56, v36, v37
  v_cvt_pk_bf16_f32 v57, v38, v39
  v_pk_fma_f32 v[36:37], v[164:165], v[32:33], v[212:213] op_sel:[0,1,0] op_sel_hi:[1,1,1] neg_lo:[1,0,0] neg_hi:[1,0,0]
  v_pk_fma_f32 v[38:39], v[166:167], v[32:33], v[214:215] op_sel:[0,1,0] op_sel_hi:[1,1,1] neg_lo:[1,0,0] neg_hi:[1,0,0]
  v_pk_fma_f32 v[36:37], v[100:101], v[32:33], v[36:37] op_sel_hi:[1,0,1]
  v_pk_fma_f32 v[38:39], v[102:103], v[32:33], v[38:39] op_sel_hi:[1,0,1]
  v_pk_mul_f32 v[40:41], v[36:37], v[36:37]
  v_pk_mul_f32 v[42:43], v[38:39], v[38:39]
  v_pk_fma_f32 v[40:41], v[40:41], v[34:35], v[34:35] op_sel:[0,1,0] op_sel_hi:[1,1,0]
  v_pk_fma_f32 v[42:43], v[42:43], v[34:35], v[34:35] op_sel:[0,1,0] op_sel_hi:[1,1,0]
  v_pk_mul_f32 v[40:41], v[40:41], v[36:37]
  v_pk_mul_f32 v[42:43], v[42:43], v[38:39]
  v_exp_f32 v40, v40
  v_exp_f32 v41, v41
  v_exp_f32 v42, v42
  v_exp_f32 v43, v43
  s_nop 0
  v_pk_add_f32 v[40:41], v[40:41], 1.0 op_sel_hi:[1,0]
  v_pk_add_f32 v[42:43], v[42:43], 1.0 op_sel_hi:[1,0]
  v_rcp_f32 v40, v40
  v_rcp_f32 v41, v41
  v_rcp_f32 v42, v42
  v_rcp_f32 v43, v43
  s_nop 0
  v_pk_mul_f32 v[36:37], v[36:37], v[40:41]
  v_pk_mul_f32 v[38:39], v[38:39], v[42:43]
  v_cvt_pk_bf16_f32 v58, v36, v37
  v_cvt_pk_bf16_f32 v59, v38, v39
  s_nop 1
  v_permlane32_swap_b32 v56, v58
  v_permlane32_swap_b32 v57, v59
  s_nop 1
  buffer_store_dwordx4 v[56:59], v22, s[48:51], s54 offen offset:0
  v_pk_fma_f32 v[36:37], v[168:169], v[32:33], v[216:217] op_sel:[0,1,0] op_sel_hi:[1,1,1] neg_lo:[1,0,0] neg_hi:[1,0,0]
  v_pk_fma_f32 v[38:39], v[170:171], v[32:33], v[218:219] op_sel:[0,1,0] op_sel_hi:[1,1,1] neg_lo:[1,0,0] neg_hi:[1,0,0]
  v_pk_fma_f32 v[36:37], v[104:105], v[32:33], v[36:37] op_sel_hi:[1,0,1]
  v_pk_fma_f32 v[38:39], v[106:107], v[32:33], v[38:39] op_sel_hi:[1,0,1]
  v_pk_mul_f32 v[40:41], v[36:37], v[36:37]
  v_pk_mul_f32 v[42:43], v[38:39], v[38:39]
  v_pk_fma_f32 v[40:41], v[40:41], v[34:35], v[34:35] op_sel:[0,1,0] op_sel_hi:[1,1,0]
  v_pk_fma_f32 v[42:43], v[42:43], v[34:35], v[34:35] op_sel:[0,1,0] op_sel_hi:[1,1,0]
  v_pk_mul_f32 v[40:41], v[40:41], v[36:37]
  v_pk_mul_f32 v[42:43], v[42:43], v[38:39]
  v_exp_f32 v40, v40
  v_exp_f32 v41, v41
  v_exp_f32 v42, v42
  v_exp_f32 v43, v43
  s_nop 0
  v_pk_add_f32 v[40:41], v[40:41], 1.0 op_sel_hi:[1,0]
  v_pk_add_f32 v[42:43], v[42:43], 1.0 op_sel_hi:[1,0]
  v_rcp_f32 v40, v40
  v_rcp_f32 v41, v41
  v_rcp_f32 v42, v42
  v_rcp_f32 v43, v43
  s_nop 0
  v_pk_mul_f32 v[36:37], v[36:37], v[40:41]
  v_pk_mul_f32 v[38:39], v[38:39], v[42:43]
  v_cvt_pk_bf16_f32 v60, v36, v37
  v_cvt_pk_bf16_f32 v61, v38, v39
  v_pk_fma_f32 v[36:37], v[172:173], v[32:33], v[220:221] op_sel:[0,1,0] op_sel_hi:[1,1,1] neg_lo:[1,0,0] neg_hi:[1,0,0]
  v_pk_fma_f32 v[38:39], v[174:175], v[32:33], v[222:223] op_sel:[0,1,0] op_sel_hi:[1,1,1] neg_lo:[1,0,0] neg_hi:[1,0,0]
  v_pk_fma_f32 v[36:37], v[108:109], v[32:33], v[36:37] op_sel_hi:[1,0,1]
  v_pk_fma_f32 v[38:39], v[110:111], v[32:33], v[38:39] op_sel_hi:[1,0,1]
  v_pk_mul_f32 v[40:41], v[36:37], v[36:37]
  v_pk_mul_f32 v[42:43], v[38:39], v[38:39]
  v_pk_fma_f32 v[40:41], v[40:41], v[34:35], v[34:35] op_sel:[0,1,0] op_sel_hi:[1,1,0]
  v_pk_fma_f32 v[42:43], v[42:43], v[34:35], v[34:35] op_sel:[0,1,0] op_sel_hi:[1,1,0]
  v_pk_mul_f32 v[40:41], v[40:41], v[36:37]
  v_pk_mul_f32 v[42:43], v[42:43], v[38:39]
  v_exp_f32 v40, v40
  v_exp_f32 v41, v41
  v_exp_f32 v42, v42
  v_exp_f32 v43, v43
  s_nop 0
  v_pk_add_f32 v[40:41], v[40:41], 1.0 op_sel_hi:[1,0]
  v_pk_add_f32 v[42:43], v[42:43], 1.0 op_sel_hi:[1,0]
  v_rcp_f32 v40, v40
  v_rcp_f32 v41, v41
  v_rcp_f32 v42, v42
  v_rcp_f32 v43, v43
  s_nop 0
  v_pk_mul_f32 v[36:37], v[36:37], v[40:41]
  v_pk_mul_f32 v[38:39], v[38:39], v[42:43]
  v_cvt_pk_bf16_f32 v62, v36, v37
  v_cvt_pk_bf16_f32 v63, v38, v39
  s_nop 1
  v_permlane32_swap_b32 v60, v62
  v_permlane32_swap_b32 v61, v63
  s_nop 1
  buffer_store_dwordx4 v[60:63], v22, s[48:51], s54 offen offset:1024
  s_waitcnt vmcnt(0)
  s_mov_b64 exec, 1
  v_mov_b32 v1, 147456
  v_mov_b32 v2, 1
  ds_add_rtn_u32 v3, v1, v2
  s_lshl_b32 s37, s24, 7
  s_lshl_b32 s38, s25, 2
  s_add_u32 s37, s37, s38
  s_add_u32 s37, s37, 9187328
  s_waitcnt lgkmcnt(0)
  v_readfirstlane_b32 s38, v3
  s_and_b32 s38, s38, 3
  s_cmp_eq_u32 s38, 3
  s_cbranch_scc0 f0_kernel_p2_nosig17
  s_cmp_eq_u32 s63, 0
  s_cbranch_scc1 f0_kernel_p2_fastsig18
  buffer_wbl2 sc1
  s_waitcnt vmcnt(0)
  buffer_store_dword v2, off, s[48:51], s37 sc1
  s_branch f0_kernel_p2_nosig17
f0_kernel_p2_fastsig18:
  buffer_store_dword v2, off, s[48:51], s37
f0_kernel_p2_nosig17:
  s_mov_b64 exec, -1
  s_branch f0_kernel_p3_entry
f0_kernel_p3_entry:
  s_mov_b32 s26, s64
  s_load_dwordx2 s[8:9], s[0:1], 56
  s_and_b32 s20, s2, 7
  s_lshr_b32 s21, s2, 3
  s_and_b32 s22, s21, 3
  s_lshl_b32 s23, s20, 2
  s_add_u32 s24, s23, s22
  s_lshr_b32 s25, s21, 2
  s_cmp_lt_u32 s26, 4
  s_cbranch_scc1 f0_kernel_p3_compute
  s_sub_u32 s26, s26, 4
  v_lshlrev_b32 v1, 4, v0
  s_mul_i32 s40, s25, 245760
  s_mul_i32 s41, s26, 5120
  s_add_u32 s40, s40, s41
  s_add_u32 s40, s40, 6291456
  s_mov_b32 s42, s41
  s_lshl_b32 s43, s24, 1
  s_lshr_b32 s47, s26, 1
  s_add_u32 s43, s43, s47
  s_mul_i32 s43, s43, 98304
  s_and_b32 s47, s26, 1
  s_lshl_b32 s47, s47, 12
  s_add_u32 s43, s43, s47
  s_add_u32 s43, s43, 31457280
  s_lshl_b32 s44, s26, 12
  s_waitcnt lgkmcnt(0)
  s_mov_b32 s12, s6
  s_mov_b32 s13, s7
  s_mov_b32 s14, 0x3200000
  s_mov_b32 s15, 0x00020000
  s_add_u32 m0, s42, 0
  s_add_u32 s45, s40, 0
  buffer_load_dwordx4 v1, s[12:15], s45 offen offset:0 lds
  buffer_load_dwordx4 v1, s[12:15], s45 offen offset:1024 lds
  buffer_load_dwordx4 v1, s[12:15], s45 offen offset:2048 lds
  buffer_load_dwordx4 v1, s[12:15], s45 offen offset:3072 lds
  s_add_u32 m0, s42, 4096
  s_add_u32 s45, s40, 4096
  buffer_load_dwordx4 v1, s[12:15], s45 offen lds
  s_add_u32 m0, s42, 20480
  s_add_u32 s45, s40, 20480
  buffer_load_dwordx4 v1, s[12:15], s45 offen offset:0 lds
  buffer_load_dwordx4 v1, s[12:15], s45 offen offset:1024 lds
  buffer_load_dwordx4 v1, s[12:15], s45 offen offset:2048 lds
  buffer_load_dwordx4 v1, s[12:15], s45 offen offset:3072 lds
  s_add_u32 m0, s42, 24576
  s_add_u32 s45, s40, 24576
  buffer_load_dwordx4 v1, s[12:15], s45 offen lds
  s_lshr_b32 s67, s24, 1
  s_lshl_b32 s66, s67, 7
  s_add_u32 s66, s66, 9187328
  v_lshlrev_b32 v10, 2, v0
  s_mov_b64 exec, 0xffff
  s_mov_b32 s65, 16384
f0_kernel_p3_poll:
  buffer_load_dword v11, v10, s[12:15], s66 offen sc1
  s_waitcnt vmcnt(0)
  v_cmp_ne_u32 vcc, 0, v11
  s_cmp_eq_u32 vcc_lo, 0xffff
  s_cbranch_scc1 f0_kernel_p3_polled
  s_sleep 1
  s_sub_u32 s65, s65, 1
  s_cbranch_scc0 f0_kernel_p3_poll
f0_kernel_p3_polled:
  s_mov_b64 exec, -1
  s_cmp_eq_u32 s63, 0
  s_cbranch_scc1 f0_kernel_p3_noacq
  buffer_inv sc1
  s_waitcnt vmcnt(0)
f0_kernel_p3_noacq:
  s_add_u32 m0, s44, 81920
  s_add_u32 s45, s43, 0
  buffer_load_dwordx4 v1, s[12:15], s45 offen offset:0 sc1 lds
  buffer_load_dwordx4 v1, s[12:15], s45 offen offset:1024 sc1 lds
  buffer_load_dwordx4 v1, s[12:15], s45 offen offset:2048 sc1 lds
  buffer_load_dwordx4 v1, s[12:15], s45 offen offset:3072 sc1 lds
  s_add_u32 m0, s44, 98304
  s_add_u32 s45, s43, 8192
  buffer_load_dwordx4 v1, s[12:15], s45 offen offset:0 sc1 lds
  buffer_load_dwordx4 v1, s[12:15], s45 offen offset:1024 sc1 lds
  buffer_load_dwordx4 v1, s[12:15], s45 offen offset:2048 sc1 lds
  buffer_load_dwordx4 v1, s[12:15], s45 offen offset:3072 sc1 lds
  s_add_u32 m0, s42, 40960
  s_add_u32 s45, s40, 40960
  buffer_load_dwordx4 v1, s[12:15], s45 offen offset:0 lds
  buffer_load_dwordx4 v1, s[12:15], s45 offen offset:1024 lds
  buffer_load_dwordx4 v1, s[12:15], s45 offen offset:2048 lds
  buffer_load_dwordx4 v1, s[12:15], s45 offen offset:3072 lds
  s_add_u32 m0, s42, 45056
  s_add_u32 s45, s40, 45056
  buffer_load_dwordx4 v1, s[12:15], s45 offen lds
  s_add_u32 m0, s42, 61440
  s_add_u32 s45, s40, 61440
  buffer_load_dwordx4 v1, s[12:15], s45 offen offset:0 lds
  buffer_load_dwordx4 v1, s[12:15], s45 offen offset:1024 lds
  buffer_load_dwordx4 v1, s[12:15], s45 offen offset:2048 lds
  buffer_load_dwordx4 v1, s[12:15], s45 offen offset:3072 lds
  s_add_u32 m0, s42, 65536
  s_add_u32 s45, s40, 65536
  buffer_load_dwordx4 v1, s[12:15], s45 offen lds
  s_waitcnt vmcnt(14)
  s_barrier
  s_add_u32 m0, s44, 114688
  s_add_u32 s45, s43, 16384
  buffer_load_dwordx4 v1, s[12:15], s45 offen offset:0 sc1 lds
  buffer_load_dwordx4 v1, s[12:15], s45 offen offset:1024 sc1 lds
  buffer_load_dwordx4 v1, s[12:15], s45 offen offset:2048 sc1 lds
  buffer_load_dwordx4 v1, s[12:15], s45 offen offset:3072 sc1 lds
  s_add_u32 m0, s44, 131072
  s_add_u32 s45, s43, 24576
  buffer_load_dwordx4 v1, s[12:15], s45 offen offset:0 sc1 lds
  buffer_load_dwordx4 v1, s[12:15], s45 offen offset:1024 sc1 lds
  buffer_load_dwordx4 v1, s[12:15], s45 offen offset:2048 sc1 lds
  buffer_load_dwordx4 v1, s[12:15], s45 offen offset:3072 sc1 lds
  s_waitcnt vmcnt(18)
  s_barrier
  s_add_u32 m0, s44, 81920
  s_add_u32 s45, s43, 32768
  buffer_load_dwordx4 v1, s[12:15], s45 offen offset:0 sc1 lds
  buffer_load_dwordx4 v1, s[12:15], s45 offen offset:1024 sc1 lds
  buffer_load_dwordx4 v1, s[12:15], s45 offen offset:2048 sc1 lds
  buffer_load_dwordx4 v1, s[12:15], s45 offen offset:3072 sc1 lds
  s_add_u32 m0, s42, 0
  s_add_u32 s45, s40, 81920
  buffer_load_dwordx4 v1, s[12:15], s45 offen offset:0 lds
  buffer_load_dwordx4 v1, s[12:15], s45 offen offset:1024 lds
  buffer_load_dwordx4 v1, s[12:15], s45 offen offset:2048 lds
  buffer_load_dwordx4 v1, s[12:15], s45 offen offset:3072 lds
  s_add_u32 m0, s42, 4096
  s_add_u32 s45, s40, 86016
  buffer_load_dwordx4 v1, s[12:15], s45 offen lds
  s_waitcnt vmcnt(13)
  s_barrier
  s_add_u32 m0, s44, 98304
  s_add_u32 s45, s43, 40960
  buffer_load_dwordx4 v1, s[12:15], s45 offen offset:0 sc1 lds
  buffer_load_dwordx4 v1, s[12:15], s45 offen offset:1024 sc1 lds
  buffer_load_dwordx4 v1, s[12:15], s45 offen offset:2048 sc1 lds
  buffer_load_dwordx4 v1, s[12:15], s45 offen offset:3072 sc1 lds
  s_add_u32 m0, s42, 20480
  s_add_u32 s45, s40, 102400
  buffer_load_dwordx4 v1, s[12:15], s45 offen offset:0 lds
  buffer_load_dwordx4 v1, s[12:15], s45 offen offset:1024 lds
  buffer_load_dwordx4 v1, s[12:15], s45 offen offset:2048 lds
  buffer_load_dwordx4 v1, s[12:15], s45 offen offset:3072 lds
  s_add_u32 m0, s42, 24576
  s_add_u32 s45, s40, 106496
  buffer_load_dwordx4 v1, s[12:15], s45 offen lds
  s_waitcnt vmcnt(18)
  s_barrier
  s_add_u32 m0, s44, 114688
  s_add_u32 s45, s43, 49152
  buffer_load_dwordx4 v1, s[12:15], s45 offen offset:0 sc1 lds
  buffer_load_dwordx4 v1, s[12:15], s45 offen offset:1024 sc1 lds
  buffer_load_dwordx4 v1, s[12:15], s45 offen offset:2048 sc1 lds
  buffer_load_dwordx4 v1, s[12:15], s45 offen offset:3072 sc1 lds
  s_add_u32 m0, s42, 40960
  s_add_u32 s45, s40, 122880
  buffer_load_dwordx4 v1, s[12:15], s45 offen offset:0 lds
  buffer_load_dwordx4 v1, s[12:15], s45 offen offset:1024 lds
  buffer_load_dwordx4 v1, s[12:15], s45 offen offset:2048 lds
  buffer_load_dwordx4 v1, s[12:15], s45 offen offset:3072 lds
  s_add_u32 m0, s42, 45056
  s_add_u32 s45, s40, 126976
  buffer_load_dwordx4 v1, s[12:15], s45 offen lds
  s_waitcnt vmcnt(18)
  s_barrier
  s_add_u32 m0, s44, 131072
  s_add_u32 s45, s43, 57344
  buffer_load_dwordx4 v1, s[12:15], s45 offen offset:0 sc1 lds
  buffer_load_dwordx4 v1, s[12:15], s45 offen offset:1024 sc1 lds
  buffer_load_dwordx4 v1, s[12:15], s45 offen offset:2048 sc1 lds
  buffer_load_dwordx4 v1, s[12:15], s45 offen offset:3072 sc1 lds
  s_add_u32 m0, s42, 61440
  s_add_u32 s45, s40, 143360
  buffer_load_dwordx4 v1, s[12:15], s45 offen offset:0 lds
  buffer_load_dwordx4 v1, s[12:15], s45 offen offset:1024 lds
  buffer_load_dwordx4 v1, s[12:15], s45 offen offset:2048 lds
  buffer_load_dwordx4 v1, s[12:15], s45 offen offset:3072 lds
  s_add_u32 m0, s42, 65536
  s_add_u32 s45, s40, 147456
  buffer_load_dwordx4 v1, s[12:15], s45 offen lds
  s_waitcnt vmcnt(18)
  s_barrier
  s_add_u32 m0, s44, 81920
  s_add_u32 s45, s43, 65536
  buffer_load_dwordx4 v1, s[12:15], s45 offen offset:0 sc1 lds
  buffer_load_dwordx4 v1, s[12:15], s45 offen offset:1024 sc1 lds
  buffer_load_dwordx4 v1, s[12:15], s45 offen offset:2048 sc1 lds
  buffer_load_dwordx4 v1, s[12:15], s45 offen offset:3072 sc1 lds
  s_add_u32 m0, s42, 0
  s_add_u32 s45, s40, 163840
  buffer_load_dwordx4 v1, s[12:15], s45 offen offset:0 lds
  buffer_load_dwordx4 v1, s[12:15], s45 offen offset:1024 lds
  buffer_load_dwordx4 v1, s[12:15], s45 offen offset:2048 lds
  buffer_load_dwordx4 v1, s[12:15], s45 offen offset:3072 lds
  s_add_u32 m0, s42, 4096
  s_add_u32 s45, s40, 167936
  buffer_load_dwordx4 v1, s[12:15], s45 offen lds
  s_waitcnt vmcnt(18)
  s_barrier
  s_add_u32 m0, s44, 98304
  s_add_u32 s45, s43, 73728
  buffer_load_dwordx4 v1, s[12:15], s45 offen offset:0 sc1 lds
  buffer_load_dwordx4 v1, s[12:15], s45 offen offset:1024 sc1 lds
  buffer_load_dwordx4 v1, s[12:15], s45 offen offset:2048 sc1 lds
  buffer_load_dwordx4 v1, s[12:15], s45 offen offset:3072 sc1 lds
  s_add_u32 m0, s42, 20480
  s_add_u32 s45, s40, 184320
  buffer_load_dwordx4 v1, s[12:15], s45 offen offset:0 lds
  buffer_load_dwordx4 v1, s[12:15], s45 offen offset:1024 lds
  buffer_load_dwordx4 v1, s[12:15], s45 offen offset:2048 lds
  buffer_load_dwordx4 v1, s[12:15], s45 offen offset:3072 lds
  s_add_u32 m0, s42, 24576
  s_add_u32 s45, s40, 188416
  buffer_load_dwordx4 v1, s[12:15], s45 offen lds
  s_waitcnt vmcnt(18)
  s_barrier
  s_add_u32 m0, s44, 114688
  s_add_u32 s45, s43, 81920
  buffer_load_dwordx4 v1, s[12:15], s45 offen offset:0 sc1 lds
  buffer_load_dwordx4 v1, s[12:15], s45 offen offset:1024 sc1 lds
  buffer_load_dwordx4 v1, s[12:15], s45 offen offset:2048 sc1 lds
  buffer_load_dwordx4 v1, s[12:15], s45 offen offset:3072 sc1 lds
  s_add_u32 m0, s42, 40960
  s_add_u32 s45, s40, 204800
  buffer_load_dwordx4 v1, s[12:15], s45 offen offset:0 lds
  buffer_load_dwordx4 v1, s[12:15], s45 offen offset:1024 lds
  buffer_load_dwordx4 v1, s[12:15], s45 offen offset:2048 lds
  buffer_load_dwordx4 v1, s[12:15], s45 offen offset:3072 lds
  s_add_u32 m0, s42, 45056
  s_add_u32 s45, s40, 208896
  buffer_load_dwordx4 v1, s[12:15], s45 offen lds
  s_waitcnt vmcnt(18)
  s_barrier
  s_add_u32 m0, s44, 131072
  s_add_u32 s45, s43, 90112
  buffer_load_dwordx4 v1, s[12:15], s45 offen offset:0 sc1 lds
  buffer_load_dwordx4 v1, s[12:15], s45 offen offset:1024 sc1 lds
  buffer_load_dwordx4 v1, s[12:15], s45 offen offset:2048 sc1 lds
  buffer_load_dwordx4 v1, s[12:15], s45 offen offset:3072 sc1 lds
  s_add_u32 m0, s42, 61440
  s_add_u32 s45, s40, 225280
  buffer_load_dwordx4 v1, s[12:15], s45 offen offset:0 lds
  buffer_load_dwordx4 v1, s[12:15], s45 offen offset:1024 lds
  buffer_load_dwordx4 v1, s[12:15], s45 offen offset:2048 lds
  buffer_load_dwordx4 v1, s[12:15], s45 offen offset:3072 lds
  s_add_u32 m0, s42, 65536
  s_add_u32 s45, s40, 229376
  buffer_load_dwordx4 v1, s[12:15], s45 offen lds
  s_waitcnt vmcnt(18)
  s_barrier
  s_waitcnt vmcnt(9)
  s_barrier
  s_waitcnt vmcnt(0)
  s_barrier
  s_branch f0_kernel_p4_entry
f0_kernel_p3_compute:
  s_and_b32 s27, s26, 1
  s_lshr_b32 s36, s26, 1
  v_lshrrev_b32 v17, 4, v0
  v_and_b32 v16, 15, v0
  v_mul_u32_u24 v20, 1280, v17
  v_lshl_add_u32 v20, v16, 4, v20
  s_mul_i32 s37, s27, 768
  v_add_u32 v1, s37, v20
  v_add_u32 v2, 61440, v1
  v_lshlrev_b32 v20, 9, v17
  v_lshl_add_u32 v20, v16, 4, v20
  s_lshl_b32 s37, s36, 13
  s_add_u32 s37, s37, 81920
  v_add_u32 v3, s37, v20
  v_add_u32 v4, 49152, v3
  v_lshrrev_b32 v20, 1, v17
  v_lshlrev_b32 v20, 9, v20
  v_lshl_add_u32 v20, v16, 4, v20
  v_and_b32 v21, 1, v17
  v_lshl_add_u32 v20, v21, 3, v20
  s_lshl_b32 s38, s24, 1
  s_add_u32 s38, s38, s36
  s_mul_i32 s39, s38, 40960
  s_mul_i32 s40, s25, 5120
  s_add_u32 s39, s39, s40
  s_mul_i32 s40, s27, 3072
  s_add_u32 s39, s39, s40
  s_add_u32 s52, s39, 12582912
  s_waitcnt lgkmcnt(0)
  s_mov_b32 s48, s6
  s_mov_b32 s49, s7
  s_mov_b32 s50, 0x3200000
  s_mov_b32 s51, 0x00020000
  s_cmp_eq_u32 s27, 1
  s_cbranch_scc1 f0_kernel_p3_p2
  buffer_load_dwordx2 v[104:105], v20, s[48:51], s52 offen offset:0 sc1
  buffer_load_dwordx2 v[106:107], v20, s[48:51], s52 offen offset:256 sc1
  buffer_load_dwordx2 v[108:109], v20, s[48:51], s52 offen offset:1024 sc1
  buffer_load_dwordx2 v[110:111], v20, s[48:51], s52 offen offset:1280 sc1
  buffer_load_dwordx2 v[112:113], v20, s[48:51], s52 offen offset:2048 sc1
  buffer_load_dwordx2 v[114:115], v20, s[48:51], s52 offen offset:2304 sc1
  s_mov_b32 s56, s8
  s_mov_b32 s57, s9
  s_mov_b32 s58, 0x500
  s_mov_b32 s59, 0x00020000
  s_mul_i32 s40, s25, 160
  s_mul_i32 s41, s27, 96
  s_add_u32 s40, s40, s41
  v_lshlrev_b32 v21, 3, v17
  buffer_load_dwordx2 v[116:117], v21, s[56:59], s40 offen offset:0
  buffer_load_dwordx2 v[118:119], v21, s[56:59], s40 offen offset:32
  buffer_load_dwordx2 v[120:121], v21, s[56:59], s40 offen offset:64
  s_barrier
  ds_read_b128 v[88:91], v3 offset:0
  ds_read_b128 v[92:95], v3 offset:256
  ds_read_b128 v[64:67], v1 offset:0
  ds_read_b128 v[68:71], v1 offset:256
  ds_read_b128 v[72:75], v1 offset:512
  s_waitcnt lgkmcnt(0)
  v_mfma_f32_16x16x32_bf16 v[32:35], v[64:67], v[88:91], 0
  ds_read_b128 v[96:99], v3 offset:2048
  ds_read_b128 v[100:103], v3 offset:2304
  v_mfma_f32_16x16x32_bf16 v[36:39], v[64:67], v[92:95], 0
  ds_read_b128 v[76:79], v1 offset:5120
  ds_read_b128 v[80:83], v1 offset:5376
  v_mfma_f32_16x16x32_bf16 v[40:43], v[68:71], v[88:91], 0
  ds_read_b128 v[84:87], v1 offset:5632
  v_mfma_f32_16x16x32_bf16 v[44:47], v[68:71], v[92:95], 0
  v_mfma_f32_16x16x32_bf16 v[48:51], v[72:75], v[88:91], 0
  v_mfma_f32_16x16x32_bf16 v[52:55], v[72:75], v[92:95], 0
  s_waitcnt lgkmcnt(0)
  v_mfma_f32_16x16x32_bf16 v[32:35], v[76:79], v[96:99], v[32:35]
  ds_read_b128 v[88:91], v3 offset:4096
  ds_read_b128 v[92:95], v3 offset:4352
  v_mfma_f32_16x16x32_bf16 v[36:39], v[76:79], v[100:103], v[36:39]
  ds_read_b128 v[64:67], v1 offset:10240
  ds_read_b128 v[68:71], v1 offset:10496
  v_mfma_f32_16x16x32_bf16 v[40:43], v[80:83], v[96:99], v[40:43]
  ds_read_b128 v[72:75], v1 offset:10752
  v_mfma_f32_16x16x32_bf16 v[44:47], v[80:83], v[100:103], v[44:47]
  v_mfma_f32_16x16x32_bf16 v[48:51], v[84:87], v[96:99], v[48:51]
  v_mfma_f32_16x16x32_bf16 v[52:55], v[84:87], v[100:103], v[52:55]
  s_waitcnt lgkmcnt(0)
  v_mfma_f32_16x16x32_bf16 v[32:35], v[64:67], v[88:91], v[32:35]
  ds_read_b128 v[96:99], v3 offset:6144
  ds_read_b128 v[100:103], v3 offset:6400
  v_mfma_f32_16x16x32_bf16 v[36:39], v[64:67], v[92:95], v[36:39]
  ds_read_b128 v[76:79], v1 offset:15360
  ds_read_b128 v[80:83], v1 offset:15616
  v_mfma_f32_16x16x32_bf16 v[40:43], v[68:71], v[88:91], v[40:43]
  ds_read_b128 v[84:87], v1 offset:15872
  v_mfma_f32_16x16x32_bf16 v[44:47], v[68:71], v[92:95], v[44:47]
  v_mfma_f32_16x16x32_bf16 v[48:51], v[72:75], v[88:91], v[48:51]
  v_mfma_f32_16x16x32_bf16 v[52:55], v[72:75], v[92:95], v[52:55]
  s_waitcnt lgkmcnt(0)
  s_barrier
  v_mfma_f32_16x16x32_bf16 v[32:35], v[76:79], v[96:99], v[32:35]
  ds_read_b128 v[88:91], v3 offset:16384
  ds_read_b128 v[92:95], v3 offset:16640
  v_mfma_f32_16x16x32_bf16 v[36:39], v[76:79], v[100:103], v[36:39]
  ds_read_b128 v[64:67], v1 offset:20480
  ds_read_b128 v[68:71], v1 offset:20736
  v_mfma_f32_16x16x32_bf16 v[40:43], v[80:83], v[96:99], v[40:43]
  ds_read_b128 v[72:75], v1 offset:20992
  v_mfma_f32_16x16x32_bf16 v[44:47], v[80:83], v[100:103], v[44:47]
  v_mfma_f32_16x16x32_bf16 v[48:51], v[84:87], v[96:99], v[48:51]
  v_mfma_f32_16x16x32_bf16 v[52:55], v[84:87], v[100:103], v[52:55]
  s_waitcnt lgkmcnt(0)
  v_mfma_f32_16x16x32_bf16 v[32:35], v[64:67], v[88:91], v[32:35]
  ds_read_b128 v[96:99], v3 offset:18432
  ds_read_b128 v[100:103], v3 offset:18688
  v_mfma_f32_16x16x32_bf16 v[36:39], v[64:67], v[92:95], v[36:39]
  ds_read_b128 v[76:79], v1 offset:25600
  ds_read_b128 v[80:83], v1 offset:25856
  v_mfma_f32_16x16x32_bf16 v[40:43], v[68:71], v[88:91], v[40:43]
  ds_read_b128 v[84:87], v1 offset:26112
  v_mfma_f32_16x16x32_bf16 v[44:47], v[68:71], v[92:95], v[44:47]
  v_mfma_f32_16x16x32_bf16 v[48:51], v[72:75], v[88:91], v[48:51]
  v_mfma_f32_16x16x32_bf16 v[52:55], v[72:75], v[92:95], v[52:55]
  s_waitcnt lgkmcnt(0)
  v_mfma_f32_16x16x32_bf16 v[32:35], v[76:79], v[96:99], v[32:35]
  ds_read_b128 v[88:91], v3 offset:20480
  ds_read_b128 v[92:95], v3 offset:20736
  v_mfma_f32_16x16x32_bf16 v[36:39], v[76:79], v[100:103], v[36:39]
  ds_read_b128 v[64:67], v1 offset:30720
  ds_read_b128 v[68:71], v1 offset:30976
  v_mfma_f32_16x16x32_bf16 v[40:43], v[80:83], v[96:99], v[40:43]
  ds_read_b128 v[72:75], v1 offset:31232
  v_mfma_f32_16x16x32_bf16 v[44:47], v[80:83], v[100:103], v[44:47]
  v_mfma_f32_16x16x32_bf16 v[48:51], v[84:87], v[96:99], v[48:51]
  v_mfma_f32_16x16x32_bf16 v[52:55], v[84:87], v[100:103], v[52:55]
  s_waitcnt lgkmcnt(0)
  v_mfma_f32_16x16x32_bf16 v[32:35], v[64:67], v[88:91], v[32:35]
  ds_read_b128 v[96:99], v3 offset:22528
  ds_read_b128 v[100:103], v3 offset:22784
  v_mfma_f32_16x16x32_bf16 v[36:39], v[64:67], v[92:95], v[36:39]
  ds_read_b128 v[76:79], v1 offset:35840
  ds_read_b128 v[80:83], v1 offset:36096
  v_mfma_f32_16x16x32_bf16 v[40:43], v[68:71], v[88:91], v[40:43]
  ds_read_b128 v[84:87], v1 offset:36352
  v_mfma_f32_16x16x32_bf16 v[44:47], v[68:71], v[92:95], v[44:47]
  v_mfma_f32_16x16x32_bf16 v[48:51], v[72:75], v[88:91], v[48:51]
  v_mfma_f32_16x16x32_bf16 v[52:55], v[72:75], v[92:95], v[52:55]
  s_waitcnt lgkmcnt(0)
  s_barrier
  v_mfma_f32_16x16x32_bf16 v[32:35], v[76:79], v[96:99], v[32:35]
  ds_read_b128 v[88:91], v3 offset:32768
  ds_read_b128 v[92:95], v3 offset:33024
  v_mfma_f32_16x16x32_bf16 v[36:39], v[76:79], v[100:103], v[36:39]
  ds_read_b128 v[64:67], v1 offset:40960
  ds_read_b128 v[68:71], v1 offset:41216
  v_mfma_f32_16x16x32_bf16 v[40:43], v[80:83], v[96:99], v[40:43]
  ds_read_b128 v[72:75], v1 offset:41472
  v_mfma_f32_16x16x32_bf16 v[44:47], v[80:83], v[100:103], v[44:47]
  v_mfma_f32_16x16x32_bf16 v[48:51], v[84:87], v[96:99], v[48:51]
  v_mfma_f32_16x16x32_bf16 v[52:55], v[84:87], v[100:103], v[52:55]
  s_waitcnt lgkmcnt(0)
  v_mfma_f32_16x16x32_bf16 v[32:35], v[64:67], v[88:91], v[32:35]
  ds_read_b128 v[96:99], v3 offset:34816
  ds_read_b128 v[100:103], v3 offset:35072
  v_mfma_f32_16x16x32_bf16 v[36:39], v[64:67], v[92:95], v[36:39]
  ds_read_b128 v[76:79], v1 offset:46080
  ds_read_b128 v[80:83], v1 offset:46336
  v_mfma_f32_16x16x32_bf16 v[40:43], v[68:71], v[88:91], v[40:43]
  ds_read_b128 v[84:87], v1 offset:46592
  v_mfma_f32_16x16x32_bf16 v[44:47], v[68:71], v[92:95], v[44:47]
  v_mfma_f32_16x16x32_bf16 v[48:51], v[72:75], v[88:91], v[48:51]
  v_mfma_f32_16x16x32_bf16 v[52:55], v[72:75], v[92:95], v[52:55]
  s_waitcnt lgkmcnt(0)
  v_mfma_f32_16x16x32_bf16 v[32:35], v[76:79], v[96:99], v[32:35]
  ds_read_b128 v[88:91], v3 offset:36864
  ds_read_b128 v[92:95], v3 offset:37120
  v_mfma_f32_16x16x32_bf16 v[36:39], v[76:79], v[100:103], v[36:39]
  ds_read_b128 v[64:67], v1 offset:51200
  ds_read_b128 v[68:71], v1 offset:51456
  v_mfma_f32_16x16x32_bf16 v[40:43], v[80:83], v[96:99], v[40:43]
  ds_read_b128 v[72:75], v1 offset:51712
  v_mfma_f32_16x16x32_bf16 v[44:47], v[80:83], v[100:103], v[44:47]
  v_mfma_f32_16x16x32_bf16 v[48:51], v[84:87], v[96:99], v[48:51]
  v_mfma_f32_16x16x32_bf16 v[52:55], v[84:87], v[100:103], v[52:55]
  s_waitcnt lgkmcnt(0)
  v_mfma_f32_16x16x32_bf16 v[32:35], v[64:67], v[88:91], v[32:35]
  ds_read_b128 v[96:99], v3 offset:38912
  ds_read_b128 v[100:103], v3 offset:39168
  v_mfma_f32_16x16x32_bf16 v[36:39], v[64:67], v[92:95], v[36:39]
  ds_read_b128 v[76:79], v1 offset:56320
  ds_read_b128 v[80:83], v1 offset:56576
  v_mfma_f32_16x16x32_bf16 v[40:43], v[68:71], v[88:91], v[40:43]
  ds_read_b128 v[84:87], v1 offset:56832
  v_mfma_f32_16x16x32_bf16 v[44:47], v[68:71], v[92:95], v[44:47]
  v_mfma_f32_16x16x32_bf16 v[48:51], v[72:75], v[88:91], v[48:51]
  v_mfma_f32_16x16x32_bf16 v[52:55], v[72:75], v[92:95], v[52:55]
  s_waitcnt lgkmcnt(0)
  s_barrier
  v_mfma_f32_16x16x32_bf16 v[32:35], v[76:79], v[96:99], v[32:35]
  ds_read_b128 v[88:91], v4 offset:0
  ds_read_b128 v[92:95], v4 offset:256
  v_mfma_f32_16x16x32_bf16 v[36:39], v[76:79], v[100:103], v[36:39]
  ds_read_b128 v[64:67], v2 offset:0
  ds_read_b128 v[68:71], v2 offset:256
  v_mfma_f32_16x16x32_bf16 v[40:43], v[80:83], v[96:99], v[40:43]
  ds_read_b128 v[72:75], v2 offset:512
  v_mfma_f32_16x16x32_bf16 v[44:47], v[80:83], v[100:103], v[44:47]
  v_mfma_f32_16x16x32_bf16 v[48:51], v[84:87], v[96:99], v[48:51]
  v_mfma_f32_16x16x32_bf16 v[52:55], v[84:87], v[100:103], v[52:55]
  s_waitcnt lgkmcnt(0)
  v_mfma_f32_16x16x32_bf16 v[32:35], v[64:67], v[88:91], v[32:35]
  ds_read_b128 v[96:99], v4 offset:2048
  ds_read_b128 v[100:103], v4 offset:2304
  v_mfma_f32_16x16x32_bf16 v[36:39], v[64:67], v[92:95], v[36:39]
  ds_read_b128 v[76:79], v2 offset:5120
  ds_read_b128 v[80:83], v2 offset:5376
  v_mfma_f32_16x16x32_bf16 v[40:43], v[68:71], v[88:91], v[40:43]
  ds_read_b128 v[84:87], v2 offset:5632
  v_mfma_f32_16x16x32_bf16 v[44:47], v[68:71], v[92:95], v[44:47]
  v_mfma_f32_16x16x32_bf16 v[48:51], v[72:75], v[88:91], v[48:51]
  v_mfma_f32_16x16x32_bf16 v[52:55], v[72:75], v[92:95], v[52:55]
  s_waitcnt lgkmcnt(0)
  v_mfma_f32_16x16x32_bf16 v[32:35], v[76:79], v[96:99], v[32:35]
  ds_read_b128 v[88:91], v4 offset:4096
  ds_read_b128 v[92:95], v4 offset:4352
  v_mfma_f32_16x16x32_bf16 v[36:39], v[76:79], v[100:103], v[36:39]
  ds_read_b128 v[64:67], v2 offset:10240
  ds_read_b128 v[68:71], v2 offset:10496
  v_mfma_f32_16x16x32_bf16 v[40:43], v[80:83], v[96:99], v[40:43]
  ds_read_b128 v[72:75], v2 offset:10752
  v_mfma_f32_16x16x32_bf16 v[44:47], v[80:83], v[100:103], v[44:47]
  v_mfma_f32_16x16x32_bf16 v[48:51], v[84:87], v[96:99], v[48:51]
  v_mfma_f32_16x16x32_bf16 v[52:55], v[84:87], v[100:103], v[52:55]
  s_waitcnt lgkmcnt(0)
  v_mfma_f32_16x16x32_bf16 v[32:35], v[64:67], v[88:91], v[32:35]
  ds_read_b128 v[96:99], v4 offset:6144
  ds_read_b128 v[100:103], v4 offset:6400
  v_mfma_f32_16x16x32_bf16 v[36:39], v[64:67], v[92:95], v[36:39]
  ds_read_b128 v[76:79], v2 offset:15360
  ds_read_b128 v[80:83], v2 offset:15616
  v_mfma_f32_16x16x32_bf16 v[40:43], v[68:71], v[88:91], v[40:43]
  ds_read_b128 v[84:87], v2 offset:15872
  v_mfma_f32_16x16x32_bf16 v[44:47], v[68:71], v[92:95], v[44:47]
  v_mfma_f32_16x16x32_bf16 v[48:51], v[72:75], v[88:91], v[48:51]
  v_mfma_f32_16x16x32_bf16 v[52:55], v[72:75], v[92:95], v[52:55]
  s_waitcnt lgkmcnt(0)
  s_barrier
  v_mfma_f32_16x16x32_bf16 v[32:35], v[76:79], v[96:99], v[32:35]
  ds_read_b128 v[88:91], v3 offset:0
  ds_read_b128 v[92:95], v3 offset:256
  v_mfma_f32_16x16x32_bf16 v[36:39], v[76:79], v[100:103], v[36:39]
  ds_read_b128 v[64:67], v1 offset:0
  ds_read_b128 v[68:71], v1 offset:256
  v_mfma_f32_16x16x32_bf16 v[40:43], v[80:83], v[96:99], v[40:43]
  ds_read_b128 v[72:75], v1 offset:512
  v_mfma_f32_16x16x32_bf16 v[44:47], v[80:83], v[100:103], v[44:47]
  v_mfma_f32_16x16x32_bf16 v[48:51], v[84:87], v[96:99], v[48:51]
  v_mfma_f32_16x16x32_bf16 v[52:55], v[84:87], v[100:103], v[52:55]
  s_waitcnt lgkmcnt(0)
  v_mfma_f32_16x16x32_bf16 v[32:35], v[64:67], v[88:91], v[32:35]
  ds_read_b128 v[96:99], v3 offset:2048
  ds_read_b128 v[100:103], v3 offset:2304
  v_mfma_f32_16x16x32_bf16 v[36:39], v[64:67], v[92:95], v[36:39]
  ds_read_b128 v[76:79], v1 offset:5120
  ds_read_b128 v[80:83], v1 offset:5376
  v_mfma_f32_16x16x32_bf16 v[40:43], v[68:71], v[88:91], v[40:43]
  ds_read_b128 v[84:87], v1 offset:5632
  v_mfma_f32_16x16x32_bf16 v[44:47], v[68:71], v[92:95], v[44:47]
  v_mfma_f32_16x16x32_bf16 v[48:51], v[72:75], v[88:91], v[48:51]
  v_mfma_f32_16x16x32_bf16 v[52:55], v[72:75], v[92:95], v[52:55]
  s_waitcnt lgkmcnt(0)
  v_mfma_f32_16x16x32_bf16 v[32:35], v[76:79], v[96:99], v[32:35]
  ds_read_b128 v[88:91], v3 offset:4096
  ds_read_b128 v[92:95], v3 offset:4352
  v_mfma_f32_16x16x32_bf16 v[36:39], v[76:79], v[100:103], v[36:39]
  ds_read_b128 v[64:67], v1 offset:10240
  ds_read_b128 v[68:71], v1 offset:10496
  v_mfma_f32_16x16x32_bf16 v[40:43], v[80:83], v[96:99], v[40:43]
  ds_read_b128 v[72:75], v1 offset:10752
  v_mfma_f32_16x16x32_bf16 v[44:47], v[80:83], v[100:103], v[44:47]
  v_mfma_f32_16x16x32_bf16 v[48:51], v[84:87], v[96:99], v[48:51]
  v_mfma_f32_16x16x32_bf16 v[52:55], v[84:87], v[100:103], v[52:55]
  s_waitcnt lgkmcnt(0)
  v_mfma_f32_16x16x32_bf16 v[32:35], v[64:67], v[88:91], v[32:35]
  ds_read_b128 v[96:99], v3 offset:6144
  ds_read_b128 v[100:103], v3 offset:6400
  v_mfma_f32_16x16x32_bf16 v[36:39], v[64:67], v[92:95], v[36:39]
  ds_read_b128 v[76:79], v1 offset:15360
  ds_read_b128 v[80:83], v1 offset:15616
  v_mfma_f32_16x16x32_bf16 v[40:43], v[68:71], v[88:91], v[40:43]
  ds_read_b128 v[84:87], v1 offset:15872
  v_mfma_f32_16x16x32_bf16 v[44:47], v[68:71], v[92:95], v[44:47]
  v_mfma_f32_16x16x32_bf16 v[48:51], v[72:75], v[88:91], v[48:51]
  v_mfma_f32_16x16x32_bf16 v[52:55], v[72:75], v[92:95], v[52:55]
  s_waitcnt lgkmcnt(0)
  s_barrier
  v_mfma_f32_16x16x32_bf16 v[32:35], v[76:79], v[96:99], v[32:35]
  ds_read_b128 v[88:91], v3 offset:16384
  ds_read_b128 v[92:95], v3 offset:16640
  v_mfma_f32_16x16x32_bf16 v[36:39], v[76:79], v[100:103], v[36:39]
  ds_read_b128 v[64:67], v1 offset:20480
  ds_read_b128 v[68:71], v1 offset:20736
  v_mfma_f32_16x16x32_bf16 v[40:43], v[80:83], v[96:99], v[40:43]
  ds_read_b128 v[72:75], v1 offset:20992
  v_mfma_f32_16x16x32_bf16 v[44:47], v[80:83], v[100:103], v[44:47]
  v_mfma_f32_16x16x32_bf16 v[48:51], v[84:87], v[96:99], v[48:51]
  v_mfma_f32_16x16x32_bf16 v[52:55], v[84:87], v[100:103], v[52:55]
  s_waitcnt lgkmcnt(0)
  v_mfma_f32_16x16x32_bf16 v[32:35], v[64:67], v[88:91], v[32:35]
  ds_read_b128 v[96:99], v3 offset:18432
  ds_read_b128 v[100:103], v3 offset:18688
  v_mfma_f32_16x16x32_bf16 v[36:39], v[64:67], v[92:95], v[36:39]
  ds_read_b128 v[76:79], v1 offset:25600
  ds_read_b128 v[80:83], v1 offset:25856
  v_mfma_f32_16x16x32_bf16 v[40:43], v[68:71], v[88:91], v[40:43]
  ds_read_b128 v[84:87], v1 offset:26112
  v_mfma_f32_16x16x32_bf16 v[44:47], v[68:71], v[92:95], v[44:47]
  v_mfma_f32_16x16x32_bf16 v[48:51], v[72:75], v[88:91], v[48:51]
  v_mfma_f32_16x16x32_bf16 v[52:55], v[72:75], v[92:95], v[52:55]
  s_waitcnt lgkmcnt(0)
  v_mfma_f32_16x16x32_bf16 v[32:35], v[76:79], v[96:99], v[32:35]
  ds_read_b128 v[88:91], v3 offset:20480
  ds_read_b128 v[92:95], v3 offset:20736
  v_mfma_f32_16x16x32_bf16 v[36:39], v[76:79], v[100:103], v[36:39]
  ds_read_b128 v[64:67], v1 offset:30720
  ds_read_b128 v[68:71], v1 offset:30976
  v_mfma_f32_16x16x32_bf16 v[40:43], v[80:83], v[96:99], v[40:43]
  ds_read_b128 v[72:75], v1 offset:31232
  v_mfma_f32_16x16x32_bf16 v[44:47], v[80:83], v[100:103], v[44:47]
  v_mfma_f32_16x16x32_bf16 v[48:51], v[84:87], v[96:99], v[48:51]
  v_mfma_f32_16x16x32_bf16 v[52:55], v[84:87], v[100:103], v[52:55]
  s_waitcnt lgkmcnt(0)
  v_mfma_f32_16x16x32_bf16 v[32:35], v[64:67], v[88:91], v[32:35]
  ds_read_b128 v[96:99], v3 offset:22528
  ds_read_b128 v[100:103], v3 offset:22784
  v_mfma_f32_16x16x32_bf16 v[36:39], v[64:67], v[92:95], v[36:39]
  ds_read_b128 v[76:79], v1 offset:35840
  ds_read_b128 v[80:83], v1 offset:36096
  v_mfma_f32_16x16x32_bf16 v[40:43], v[68:71], v[88:91], v[40:43]
  ds_read_b128 v[84:87], v1 offset:36352
  v_mfma_f32_16x16x32_bf16 v[44:47], v[68:71], v[92:95], v[44:47]
  v_mfma_f32_16x16x32_bf16 v[48:51], v[72:75], v[88:91], v[48:51]
  v_mfma_f32_16x16x32_bf16 v[52:55], v[72:75], v[92:95], v[52:55]
  s_waitcnt lgkmcnt(0)
  s_barrier
  v_mfma_f32_16x16x32_bf16 v[32:35], v[76:79], v[96:99], v[32:35]
  ds_read_b128 v[88:91], v3 offset:32768
  ds_read_b128 v[92:95], v3 offset:33024
  v_mfma_f32_16x16x32_bf16 v[36:39], v[76:79], v[100:103], v[36:39]
  ds_read_b128 v[64:67], v1 offset:40960
  ds_read_b128 v[68:71], v1 offset:41216
  v_mfma_f32_16x16x32_bf16 v[40:43], v[80:83], v[96:99], v[40:43]
  ds_read_b128 v[72:75], v1 offset:41472
  v_mfma_f32_16x16x32_bf16 v[44:47], v[80:83], v[100:103], v[44:47]
  v_mfma_f32_16x16x32_bf16 v[48:51], v[84:87], v[96:99], v[48:51]
  v_mfma_f32_16x16x32_bf16 v[52:55], v[84:87], v[100:103], v[52:55]
  s_waitcnt lgkmcnt(0)
  v_mfma_f32_16x16x32_bf16 v[32:35], v[64:67], v[88:91], v[32:35]
  ds_read_b128 v[96:99], v3 offset:34816
  ds_read_b128 v[100:103], v3 offset:35072
  v_mfma_f32_16x16x32_bf16 v[36:39], v[64:67], v[92:95], v[36:39]
  ds_read_b128 v[76:79], v1 offset:46080
  ds_read_b128 v[80:83], v1 offset:46336
  v_mfma_f32_16x16x32_bf16 v[40:43], v[68:71], v[88:91], v[40:43]
  ds_read_b128 v[84:87], v1 offset:46592
  v_mfma_f32_16x16x32_bf16 v[44:47], v[68:71], v[92:95], v[44:47]
  v_mfma_f32_16x16x32_bf16 v[48:51], v[72:75], v[88:91], v[48:51]
  v_mfma_f32_16x16x32_bf16 v[52:55], v[72:75], v[92:95], v[52:55]
  s_waitcnt lgkmcnt(0)
  v_mfma_f32_16x16x32_bf16 v[32:35], v[76:79], v[96:99], v[32:35]
  ds_read_b128 v[88:91], v3 offset:36864
  ds_read_b128 v[92:95], v3 offset:37120
  v_mfma_f32_16x16x32_bf16 v[36:39], v[76:79], v[100:103], v[36:39]
  ds_read_b128 v[64:67], v1 offset:51200
  ds_read_b128 v[68:71], v1 offset:51456
  v_mfma_f32_16x16x32_bf16 v[40:43], v[80:83], v[96:99], v[40:43]
  ds_read_b128 v[72:75], v1 offset:51712
  v_mfma_f32_16x16x32_bf16 v[44:47], v[80:83], v[100:103], v[44:47]
  v_mfma_f32_16x16x32_bf16 v[48:51], v[84:87], v[96:99], v[48:51]
  v_mfma_f32_16x16x32_bf16 v[52:55], v[84:87], v[100:103], v[52:55]
  s_waitcnt lgkmcnt(0)
  v_mfma_f32_16x16x32_bf16 v[32:35], v[64:67], v[88:91], v[32:35]
  ds_read_b128 v[96:99], v3 offset:38912
  ds_read_b128 v[100:103], v3 offset:39168
  v_mfma_f32_16x16x32_bf16 v[36:39], v[64:67], v[92:95], v[36:39]
  ds_read_b128 v[76:79], v1 offset:56320
  ds_read_b128 v[80:83], v1 offset:56576
  v_mfma_f32_16x16x32_bf16 v[40:43], v[68:71], v[88:91], v[40:43]
  ds_read_b128 v[84:87], v1 offset:56832
  v_mfma_f32_16x16x32_bf16 v[44:47], v[68:71], v[92:95], v[44:47]
  v_mfma_f32_16x16x32_bf16 v[48:51], v[72:75], v[88:91], v[48:51]
  v_mfma_f32_16x16x32_bf16 v[52:55], v[72:75], v[92:95], v[52:55]
  s_waitcnt lgkmcnt(0)
  s_barrier
  v_mfma_f32_16x16x32_bf16 v[32:35], v[76:79], v[96:99], v[32:35]
  ds_read_b128 v[88:91], v4 offset:0
  ds_read_b128 v[92:95], v4 offset:256
  v_mfma_f32_16x16x32_bf16 v[36:39], v[76:79], v[100:103], v[36:39]
  ds_read_b128 v[64:67], v2 offset:0
  ds_read_b128 v[68:71], v2 offset:256
  v_mfma_f32_16x16x32_bf16 v[40:43], v[80:83], v[96:99], v[40:43]
  ds_read_b128 v[72:75], v2 offset:512
  v_mfma_f32_16x16x32_bf16 v[44:47], v[80:83], v[100:103], v[44:47]
  v_mfma_f32_16x16x32_bf16 v[48:51], v[84:87], v[96:99], v[48:51]
  v_mfma_f32_16x16x32_bf16 v[52:55], v[84:87], v[100:103], v[52:55]
  s_waitcnt lgkmcnt(0)
  v_mfma_f32_16x16x32_bf16 v[32:35], v[64:67], v[88:91], v[32:35]
  ds_read_b128 v[96:99], v4 offset:2048
  ds_read_b128 v[100:103], v4 offset:2304
  v_mfma_f32_16x16x32_bf16 v[36:39], v[64:67], v[92:95], v[36:39]
  ds_read_b128 v[76:79], v2 offset:5120
  ds_read_b128 v[80:83], v2 offset:5376
  v_mfma_f32_16x16x32_bf16 v[40:43], v[68:71], v[88:91], v[40:43]
  ds_read_b128 v[84:87], v2 offset:5632
  v_mfma_f32_16x16x32_bf16 v[44:47], v[68:71], v[92:95], v[44:47]
  v_mfma_f32_16x16x32_bf16 v[48:51], v[72:75], v[88:91], v[48:51]
  v_mfma_f32_16x16x32_bf16 v[52:55], v[72:75], v[92:95], v[52:55]
  s_waitcnt lgkmcnt(0)
  v_mfma_f32_16x16x32_bf16 v[32:35], v[76:79], v[96:99], v[32:35]
  ds_read_b128 v[88:91], v4 offset:4096
  ds_read_b128 v[92:95], v4 offset:4352
  v_mfma_f32_16x16x32_bf16 v[36:39], v[76:79], v[100:103], v[36:39]
  ds_read_b128 v[64:67], v2 offset:10240
  ds_read_b128 v[68:71], v2 offset:10496
  v_mfma_f32_16x16x32_bf16 v[40:43], v[80:83], v[96:99], v[40:43]
  ds_read_b128 v[72:75], v2 offset:10752
  v_mfma_f32_16x16x32_bf16 v[44:47], v[80:83], v[100:103], v[44:47]
  v_mfma_f32_16x16x32_bf16 v[48:51], v[84:87], v[96:99], v[48:51]
  v_mfma_f32_16x16x32_bf16 v[52:55], v[84:87], v[100:103], v[52:55]
  s_waitcnt lgkmcnt(0)
  v_mfma_f32_16x16x32_bf16 v[32:35], v[64:67], v[88:91], v[32:35]
  ds_read_b128 v[96:99], v4 offset:6144
  ds_read_b128 v[100:103], v4 offset:6400
  v_mfma_f32_16x16x32_bf16 v[36:39], v[64:67], v[92:95], v[36:39]
  ds_read_b128 v[76:79], v2 offset:15360
  ds_read_b128 v[80:83], v2 offset:15616
  v_mfma_f32_16x16x32_bf16 v[40:43], v[68:71], v[88:91], v[40:43]
  ds_read_b128 v[84:87], v2 offset:15872
  v_mfma_f32_16x16x32_bf16 v[44:47], v[68:71], v[92:95], v[44:47]
  v_mfma_f32_16x16x32_bf16 v[48:51], v[72:75], v[88:91], v[48:51]
  v_mfma_f32_16x16x32_bf16 v[52:55], v[72:75], v[92:95], v[52:55]
  s_waitcnt lgkmcnt(0)
  s_barrier
  v_mfma_f32_16x16x32_bf16 v[32:35], v[76:79], v[96:99], v[32:35]
  ds_read_b128 v[88:91], v3 offset:0
  ds_read_b128 v[92:95], v3 offset:256
  v_mfma_f32_16x16x32_bf16 v[36:39], v[76:79], v[100:103], v[36:39]
  ds_read_b128 v[64:67], v1 offset:0
  ds_read_b128 v[68:71], v1 offset:256
  v_mfma_f32_16x16x32_bf16 v[40:43], v[80:83], v[96:99], v[40:43]
  ds_read_b128 v[72:75], v1 offset:512
  v_mfma_f32_16x16x32_bf16 v[44:47], v[80:83], v[100:103], v[44:47]
  v_mfma_f32_16x16x32_bf16 v[48:51], v[84:87], v[96:99], v[48:51]
  v_mfma_f32_16x16x32_bf16 v[52:55], v[84:87], v[100:103], v[52:55]
  s_waitcnt lgkmcnt(0)
  v_mfma_f32_16x16x32_bf16 v[32:35], v[64:67], v[88:91], v[32:35]
  ds_read_b128 v[96:99], v3 offset:2048
  ds_read_b128 v[100:103], v3 offset:2304
  v_mfma_f32_16x16x32_bf16 v[36:39], v[64:67], v[92:95], v[36:39]
  ds_read_b128 v[76:79], v1 offset:5120
  ds_read_b128 v[80:83], v1 offset:5376
  v_mfma_f32_16x16x32_bf16 v[40:43], v[68:71], v[88:91], v[40:43]
  ds_read_b128 v[84:87], v1 offset:5632
  v_mfma_f32_16x16x32_bf16 v[44:47], v[68:71], v[92:95], v[44:47]
  v_mfma_f32_16x16x32_bf16 v[48:51], v[72:75], v[88:91], v[48:51]
  v_mfma_f32_16x16x32_bf16 v[52:55], v[72:75], v[92:95], v[52:55]
  s_waitcnt lgkmcnt(0)
  v_mfma_f32_16x16x32_bf16 v[32:35], v[76:79], v[96:99], v[32:35]
  ds_read_b128 v[88:91], v3 offset:4096
  ds_read_b128 v[92:95], v3 offset:4352
  v_mfma_f32_16x16x32_bf16 v[36:39], v[76:79], v[100:103], v[36:39]
  ds_read_b128 v[64:67], v1 offset:10240
  ds_read_b128 v[68:71], v1 offset:10496
  v_mfma_f32_16x16x32_bf16 v[40:43], v[80:83], v[96:99], v[40:43]
  ds_read_b128 v[72:75], v1 offset:10752
  v_mfma_f32_16x16x32_bf16 v[44:47], v[80:83], v[100:103], v[44:47]
  v_mfma_f32_16x16x32_bf16 v[48:51], v[84:87], v[96:99], v[48:51]
  v_mfma_f32_16x16x32_bf16 v[52:55], v[84:87], v[100:103], v[52:55]
  s_waitcnt lgkmcnt(0)
  v_mfma_f32_16x16x32_bf16 v[32:35], v[64:67], v[88:91], v[32:35]
  ds_read_b128 v[96:99], v3 offset:6144
  ds_read_b128 v[100:103], v3 offset:6400
  v_mfma_f32_16x16x32_bf16 v[36:39], v[64:67], v[92:95], v[36:39]
  ds_read_b128 v[76:79], v1 offset:15360
  ds_read_b128 v[80:83], v1 offset:15616
  v_mfma_f32_16x16x32_bf16 v[40:43], v[68:71], v[88:91], v[40:43]
  ds_read_b128 v[84:87], v1 offset:15872
  v_mfma_f32_16x16x32_bf16 v[44:47], v[68:71], v[92:95], v[44:47]
  v_mfma_f32_16x16x32_bf16 v[48:51], v[72:75], v[88:91], v[48:51]
  v_mfma_f32_16x16x32_bf16 v[52:55], v[72:75], v[92:95], v[52:55]
  s_waitcnt lgkmcnt(0)
  s_barrier
  v_mfma_f32_16x16x32_bf16 v[32:35], v[76:79], v[96:99], v[32:35]
  ds_read_b128 v[88:91], v3 offset:16384
  ds_read_b128 v[92:95], v3 offset:16640
  v_mfma_f32_16x16x32_bf16 v[36:39], v[76:79], v[100:103], v[36:39]
  ds_read_b128 v[64:67], v1 offset:20480
  ds_read_b128 v[68:71], v1 offset:20736
  v_mfma_f32_16x16x32_bf16 v[40:43], v[80:83], v[96:99], v[40:43]
  ds_read_b128 v[72:75], v1 offset:20992
  v_mfma_f32_16x16x32_bf16 v[44:47], v[80:83], v[100:103], v[44:47]
  v_mfma_f32_16x16x32_bf16 v[48:51], v[84:87], v[96:99], v[48:51]
  v_mfma_f32_16x16x32_bf16 v[52:55], v[84:87], v[100:103], v[52:55]
  s_waitcnt lgkmcnt(0)
  v_mfma_f32_16x16x32_bf16 v[32:35], v[64:67], v[88:91], v[32:35]
  ds_read_b128 v[96:99], v3 offset:18432
  ds_read_b128 v[100:103], v3 offset:18688
  v_mfma_f32_16x16x32_bf16 v[36:39], v[64:67], v[92:95], v[36:39]
  ds_read_b128 v[76:79], v1 offset:25600
  ds_read_b128 v[80:83], v1 offset:25856
  v_mfma_f32_16x16x32_bf16 v[40:43], v[68:71], v[88:91], v[40:43]
  ds_read_b128 v[84:87], v1 offset:26112
  v_mfma_f32_16x16x32_bf16 v[44:47], v[68:71], v[92:95], v[44:47]
  v_mfma_f32_16x16x32_bf16 v[48:51], v[72:75], v[88:91], v[48:51]
  v_mfma_f32_16x16x32_bf16 v[52:55], v[72:75], v[92:95], v[52:55]
  s_waitcnt lgkmcnt(0)
  v_mfma_f32_16x16x32_bf16 v[32:35], v[76:79], v[96:99], v[32:35]
  ds_read_b128 v[88:91], v3 offset:20480
  ds_read_b128 v[92:95], v3 offset:20736
  v_mfma_f32_16x16x32_bf16 v[36:39], v[76:79], v[100:103], v[36:39]
  ds_read_b128 v[64:67], v1 offset:30720
  ds_read_b128 v[68:71], v1 offset:30976
  v_mfma_f32_16x16x32_bf16 v[40:43], v[80:83], v[96:99], v[40:43]
  ds_read_b128 v[72:75], v1 offset:31232
  v_mfma_f32_16x16x32_bf16 v[44:47], v[80:83], v[100:103], v[44:47]
  v_mfma_f32_16x16x32_bf16 v[48:51], v[84:87], v[96:99], v[48:51]
  v_mfma_f32_16x16x32_bf16 v[52:55], v[84:87], v[100:103], v[52:55]
  s_waitcnt lgkmcnt(0)
  v_mfma_f32_16x16x32_bf16 v[32:35], v[64:67], v[88:91], v[32:35]
  ds_read_b128 v[96:99], v3 offset:22528
  ds_read_b128 v[100:103], v3 offset:22784
  v_mfma_f32_16x16x32_bf16 v[36:39], v[64:67], v[92:95], v[36:39]
  ds_read_b128 v[76:79], v1 offset:35840
  ds_read_b128 v[80:83], v1 offset:36096
  v_mfma_f32_16x16x32_bf16 v[40:43], v[68:71], v[88:91], v[40:43]
  ds_read_b128 v[84:87], v1 offset:36352
  v_mfma_f32_16x16x32_bf16 v[44:47], v[68:71], v[92:95], v[44:47]
  v_mfma_f32_16x16x32_bf16 v[48:51], v[72:75], v[88:91], v[48:51]
  v_mfma_f32_16x16x32_bf16 v[52:55], v[72:75], v[92:95], v[52:55]
  s_waitcnt lgkmcnt(0)
  s_barrier
  v_mfma_f32_16x16x32_bf16 v[32:35], v[76:79], v[96:99], v[32:35]
  ds_read_b128 v[88:91], v3 offset:32768
  ds_read_b128 v[92:95], v3 offset:33024
  v_mfma_f32_16x16x32_bf16 v[36:39], v[76:79], v[100:103], v[36:39]
  ds_read_b128 v[64:67], v1 offset:40960
  ds_read_b128 v[68:71], v1 offset:41216
  v_mfma_f32_16x16x32_bf16 v[40:43], v[80:83], v[96:99], v[40:43]
  ds_read_b128 v[72:75], v1 offset:41472
  v_mfma_f32_16x16x32_bf16 v[44:47], v[80:83], v[100:103], v[44:47]
  v_mfma_f32_16x16x32_bf16 v[48:51], v[84:87], v[96:99], v[48:51]
  v_mfma_f32_16x16x32_bf16 v[52:55], v[84:87], v[100:103], v[52:55]
  s_waitcnt lgkmcnt(0)
  v_mfma_f32_16x16x32_bf16 v[32:35], v[64:67], v[88:91], v[32:35]
  ds_read_b128 v[96:99], v3 offset:34816
  ds_read_b128 v[100:103], v3 offset:35072
  v_mfma_f32_16x16x32_bf16 v[36:39], v[64:67], v[92:95], v[36:39]
  ds_read_b128 v[76:79], v1 offset:46080
  ds_read_b128 v[80:83], v1 offset:46336
  v_mfma_f32_16x16x32_bf16 v[40:43], v[68:71], v[88:91], v[40:43]
  ds_read_b128 v[84:87], v1 offset:46592
  v_mfma_f32_16x16x32_bf16 v[44:47], v[68:71], v[92:95], v[44:47]
  v_mfma_f32_16x16x32_bf16 v[48:51], v[72:75], v[88:91], v[48:51]
  v_mfma_f32_16x16x32_bf16 v[52:55], v[72:75], v[92:95], v[52:55]
  s_waitcnt lgkmcnt(0)
  v_mfma_f32_16x16x32_bf16 v[32:35], v[76:79], v[96:99], v[32:35]
  ds_read_b128 v[88:91], v3 offset:36864
  ds_read_b128 v[92:95], v3 offset:37120
  v_mfma_f32_16x16x32_bf16 v[36:39], v[76:79], v[100:103], v[36:39]
  ds_read_b128 v[64:67], v1 offset:51200
  ds_read_b128 v[68:71], v1 offset:51456
  v_mfma_f32_16x16x32_bf16 v[40:43], v[80:83], v[96:99], v[40:43]
  ds_read_b128 v[72:75], v1 offset:51712
  v_mfma_f32_16x16x32_bf16 v[44:47], v[80:83], v[100:103], v[44:47]
  v_mfma_f32_16x16x32_bf16 v[48:51], v[84:87], v[96:99], v[48:51]
  v_mfma_f32_16x16x32_bf16 v[52:55], v[84:87], v[100:103], v[52:55]
  s_waitcnt lgkmcnt(0)
  v_mfma_f32_16x16x32_bf16 v[32:35], v[64:67], v[88:91], v[32:35]
  ds_read_b128 v[96:99], v3 offset:38912
  ds_read_b128 v[100:103], v3 offset:39168
  v_mfma_f32_16x16x32_bf16 v[36:39], v[64:67], v[92:95], v[36:39]
  ds_read_b128 v[76:79], v1 offset:56320
  ds_read_b128 v[80:83], v1 offset:56576
  v_mfma_f32_16x16x32_bf16 v[40:43], v[68:71], v[88:91], v[40:43]
  ds_read_b128 v[84:87], v1 offset:56832
  v_mfma_f32_16x16x32_bf16 v[44:47], v[68:71], v[92:95], v[44:47]
  v_mfma_f32_16x16x32_bf16 v[48:51], v[72:75], v[88:91], v[48:51]
  v_mfma_f32_16x16x32_bf16 v[52:55], v[72:75], v[92:95], v[52:55]
  s_waitcnt lgkmcnt(0)
  s_barrier
  v_mfma_f32_16x16x32_bf16 v[32:35], v[76:79], v[96:99], v[32:35]
  ds_read_b128 v[88:91], v4 offset:0
  ds_read_b128 v[92:95], v4 offset:256
  v_mfma_f32_16x16x32_bf16 v[36:39], v[76:79], v[100:103], v[36:39]
  ds_read_b128 v[64:67], v2 offset:0
  ds_read_b128 v[68:71], v2 offset:256
  v_mfma_f32_16x16x32_bf16 v[40:43], v[80:83], v[96:99], v[40:43]
  ds_read_b128 v[72:75], v2 offset:512
  v_mfma_f32_16x16x32_bf16 v[44:47], v[80:83], v[100:103], v[44:47]
  v_mfma_f32_16x16x32_bf16 v[48:51], v[84:87], v[96:99], v[48:51]
  v_mfma_f32_16x16x32_bf16 v[52:55], v[84:87], v[100:103], v[52:55]
  s_waitcnt lgkmcnt(0)
  v_mfma_f32_16x16x32_bf16 v[32:35], v[64:67], v[88:91], v[32:35]
  ds_read_b128 v[96:99], v4 offset:2048
  ds_read_b128 v[100:103], v4 offset:2304
  v_mfma_f32_16x16x32_bf16 v[36:39], v[64:67], v[92:95], v[36:39]
  ds_read_b128 v[76:79], v2 offset:5120
  ds_read_b128 v[80:83], v2 offset:5376
  v_mfma_f32_16x16x32_bf16 v[40:43], v[68:71], v[88:91], v[40:43]
  ds_read_b128 v[84:87], v2 offset:5632
  v_mfma_f32_16x16x32_bf16 v[44:47], v[68:71], v[92:95], v[44:47]
  v_mfma_f32_16x16x32_bf16 v[48:51], v[72:75], v[88:91], v[48:51]
  v_mfma_f32_16x16x32_bf16 v[52:55], v[72:75], v[92:95], v[52:55]
  s_waitcnt lgkmcnt(0)
  v_mfma_f32_16x16x32_bf16 v[32:35], v[76:79], v[96:99], v[32:35]
  ds_read_b128 v[88:91], v4 offset:4096
  ds_read_b128 v[92:95], v4 offset:4352
  v_mfma_f32_16x16x32_bf16 v[36:39], v[76:79], v[100:103], v[36:39]
  ds_read_b128 v[64:67], v2 offset:10240
  ds_read_b128 v[68:71], v2 offset:10496
  v_mfma_f32_16x16x32_bf16 v[40:43], v[80:83], v[96:99], v[40:43]
  ds_read_b128 v[72:75], v2 offset:10752
  v_mfma_f32_16x16x32_bf16 v[44:47], v[80:83], v[100:103], v[44:47]
  v_mfma_f32_16x16x32_bf16 v[48:51], v[84:87], v[96:99], v[48:51]
  v_mfma_f32_16x16x32_bf16 v[52:55], v[84:87], v[100:103], v[52:55]
  s_waitcnt lgkmcnt(0)
  v_mfma_f32_16x16x32_bf16 v[32:35], v[64:67], v[88:91], v[32:35]
  ds_read_b128 v[96:99], v4 offset:6144
  ds_read_b128 v[100:103], v4 offset:6400
  v_mfma_f32_16x16x32_bf16 v[36:39], v[64:67], v[92:95], v[36:39]
  ds_read_b128 v[76:79], v2 offset:15360
  ds_read_b128 v[80:83], v2 offset:15616
  v_mfma_f32_16x16x32_bf16 v[40:43], v[68:71], v[88:91], v[40:43]
  ds_read_b128 v[84:87], v2 offset:15872
  v_mfma_f32_16x16x32_bf16 v[44:47], v[68:71], v[92:95], v[44:47]
  v_mfma_f32_16x16x32_bf16 v[48:51], v[72:75], v[88:91], v[48:51]
  v_mfma_f32_16x16x32_bf16 v[52:55], v[72:75], v[92:95], v[52:55]
  s_waitcnt lgkmcnt(0)
  v_mfma_f32_16x16x32_bf16 v[32:35], v[76:79], v[96:99], v[32:35]
  v_mfma_f32_16x16x32_bf16 v[36:39], v[76:79], v[100:103], v[36:39]
  v_mfma_f32_16x16x32_bf16 v[40:43], v[80:83], v[96:99], v[40:43]
  v_mfma_f32_16x16x32_bf16 v[44:47], v[80:83], v[100:103], v[44:47]
  v_mfma_f32_16x16x32_bf16 v[48:51], v[84:87], v[96:99], v[48:51]
  v_mfma_f32_16x16x32_bf16 v[52:55], v[84:87], v[100:103], v[52:55]
  s_waitcnt vmcnt(0)
  v_mov_b32 v8, 0
  v_mov_b32 v9, 0
  v_mov_b32 v10, 0
  v_mov_b32 v11, 0
  v_lshlrev_b32 v22, 4, v0
  s_add_u32 s53, s39, 15728640
  s_nop 4
  v_lshlrev_b32 v12, 16, v104
  v_and_b32 v13, 0xffff0000, v104
  v_lshlrev_b32 v14, 16, v105
  v_and_b32 v15, 0xffff0000, v105
  v_pk_add_f32 v[32:33], v[32:33], v[12:13]
  v_pk_add_f32 v[34:35], v[34:35], v[14:15]
  v_lshlrev_b32 v16, 16, v116
  v_and_b32 v17, 0xffff0000, v116
  v_lshlrev_b32 v18, 16, v117
  v_and_b32 v19, 0xffff0000, v117
  v_pk_add_f32 v[32:33], v[32:33], v[16:17]
  v_pk_add_f32 v[34:35], v[34:35], v[18:19]
  v_add_f32 v8, v8, v32
  v_fmac_f32 v10, v32, v32
  v_add_f32 v8, v8, v33
  v_fmac_f32 v10, v33, v33
  v_add_f32 v8, v8, v34
  v_fmac_f32 v10, v34, v34
  v_add_f32 v8, v8, v35
  v_fmac_f32 v10, v35, v35
  v_cvt_pk_bf16_f32 v24, v32, v33
  v_cvt_pk_bf16_f32 v25, v34, v35
  v_lshlrev_b32 v12, 16, v106
  v_and_b32 v13, 0xffff0000, v106
  v_lshlrev_b32 v14, 16, v107
  v_and_b32 v15, 0xffff0000, v107
  v_pk_add_f32 v[36:37], v[36:37], v[12:13]
  v_pk_add_f32 v[38:39], v[38:39], v[14:15]
  v_lshlrev_b32 v16, 16, v116
  v_and_b32 v17, 0xffff0000, v116
  v_lshlrev_b32 v18, 16, v117
  v_and_b32 v19, 0xffff0000, v117
  v_pk_add_f32 v[36:37], v[36:37], v[16:17]
  v_pk_add_f32 v[38:39], v[38:39], v[18:19]
  v_add_f32 v9, v9, v36
  v_fmac_f32 v11, v36, v36
  v_add_f32 v9, v9, v37
  v_fmac_f32 v11, v37, v37
  v_add_f32 v9, v9, v38
  v_fmac_f32 v11, v38, v38
  v_add_f32 v9, v9, v39
  v_fmac_f32 v11, v39, v39
  v_cvt_pk_bf16_f32 v26, v36, v37
  v_cvt_pk_bf16_f32 v27, v38, v39
  s_nop 1
  v_permlane16_swap_b32 v24, v26
  v_permlane16_swap_b32 v25, v27
  s_nop 1
  buffer_store_dwordx4 v[24:27], v22, s[48:51], s53 offen offset:0
  v_lshlrev_b32 v12, 16, v108
  v_and_b32 v13, 0xffff0000, v108
  v_lshlrev_b32 v14, 16, v109
  v_and_b32 v15, 0xffff0000, v109
  v_pk_add_f32 v[40:41], v[40:41], v[12:13]
  v_pk_add_f32 v[42:43], v[42:43], v[14:15]
  v_lshlrev_b32 v16, 16, v118
  v_and_b32 v17, 0xffff0000, v118
  v_lshlrev_b32 v18, 16, v119
  v_and_b32 v19, 0xffff0000, v119
  v_pk_add_f32 v[40:41], v[40:41], v[16:17]
  v_pk_add_f32 v[42:43], v[42:43], v[18:19]
  v_add_f32 v8, v8, v40
  v_fmac_f32 v10, v40, v40
  v_add_f32 v8, v8, v41
  v_fmac_f32 v10, v41, v41
  v_add_f32 v8, v8, v42
  v_fmac_f32 v10, v42, v42
  v_add_f32 v8, v8, v43
  v_fmac_f32 v10, v43, v43
  v_cvt_pk_bf16_f32 v28, v40, v41
  v_cvt_pk_bf16_f32 v29, v42, v43
  v_lshlrev_b32 v12, 16, v110
  v_and_b32 v13, 0xffff0000, v110
  v_lshlrev_b32 v14, 16, v111
  v_and_b32 v15, 0xffff0000, v111
  v_pk_add_f32 v[44:45], v[44:45], v[12:13]
  v_pk_add_f32 v[46:47], v[46:47], v[14:15]
  v_lshlrev_b32 v16, 16, v118
  v_and_b32 v17, 0xffff0000, v118
  v_lshlrev_b32 v18, 16, v119
  v_and_b32 v19, 0xffff0000, v119
  v_pk_add_f32 v[44:45], v[44:45], v[16:17]
  v_pk_add_f32 v[46:47], v[46:47], v[18:19]
  v_add_f32 v9, v9, v44
  v_fmac_f32 v11, v44, v44
  v_add_f32 v9, v9, v45
  v_fmac_f32 v11, v45, v45
  v_add_f32 v9, v9, v46
  v_fmac_f32 v11, v46, v46
  v_add_f32 v9, v9, v47
  v_fmac_f32 v11, v47, v47
  v_cvt_pk_bf16_f32 v30, v44, v45
  v_cvt_pk_bf16_f32 v31, v46, v47
  s_nop 1
  v_permlane16_swap_b32 v28, v30
  v_permlane16_swap_b32 v29, v31
  s_nop 1
  buffer_store_dwordx4 v[28:31], v22, s[48:51], s53 offen offset:1024
  v_lshlrev_b32 v12, 16, v112
  v_and_b32 v13, 0xffff0000, v112
  v_lshlrev_b32 v14, 16, v113
  v_and_b32 v15, 0xffff0000, v113
  v_pk_add_f32 v[48:49], v[48:49], v[12:13]
  v_pk_add_f32 v[50:51], v[50:51], v[14:15]
  v_lshlrev_b32 v16, 16, v120
  v_and_b32 v17, 0xffff0000, v120
  v_lshlrev_b32 v18, 16, v121
  v_and_b32 v19, 0xffff0000, v121
  v_pk_add_f32 v[48:49], v[48:49], v[16:17]
  v_pk_add_f32 v[50:51], v[50:51], v[18:19]
  v_add_f32 v8, v8, v48
  v_fmac_f32 v10, v48, v48
  v_add_f32 v8, v8, v49
  v_fmac_f32 v10, v49, v49
  v_add_f32 v8, v8, v50
  v_fmac_f32 v10, v50, v50
  v_add_f32 v8, v8, v51
  v_fmac_f32 v10, v51, v51
  v_cvt_pk_bf16_f32 v24, v48, v49
  v_cvt_pk_bf16_f32 v25, v50, v51
  v_lshlrev_b32 v12, 16, v114
  v_and_b32 v13, 0xffff0000, v114
  v_lshlrev_b32 v14, 16, v115
  v_and_b32 v15, 0xffff0000, v115
  v_pk_add_f32 v[52:53], v[52:53], v[12:13]
  v_pk_add_f32 v[54:55], v[54:55], v[14:15]
  v_lshlrev_b32 v16, 16, v120
  v_and_b32 v17, 0xffff0000, v120
  v_lshlrev_b32 v18, 16, v121
  v_and_b32 v19, 0xffff0000, v121
  v_pk_add_f32 v[52:53], v[52:53], v[16:17]
  v_pk_add_f32 v[54:55], v[54:55], v[18:19]
  v_add_f32 v9, v9, v52
  v_fmac_f32 v11, v52, v52
  v_add_f32 v9, v9, v53
  v_fmac_f32 v11, v53, v53
  v_add_f32 v9, v9, v54
  v_fmac_f32 v11, v54, v54
  v_add_f32 v9, v9, v55
  v_fmac_f32 v11, v55, v55
  v_cvt_pk_bf16_f32 v26, v52, v53
  v_cvt_pk_bf16_f32 v27, v54, v55
  s_nop 1
  v_permlane16_swap_b32 v24, v26
  v_permlane16_swap_b32 v25, v27
  s_nop 1
  buffer_store_dwordx4 v[24:27], v22, s[48:51], s53 offen offset:2048
  v_permlane16_swap_b32 v8, v9
  v_permlane16_swap_b32 v10, v11
  s_nop 1
  v_add_f32 v8, v8, v9
  v_add_f32 v10, v10, v11
  s_nop 1
  v_permlane32_swap_b32 v8, v10
  s_nop 1
  v_add_f32 v8, v8, v10
  v_and_b32 v12, 31, v0
  v_lshlrev_b32 v12, 3, v12
  v_lshrrev_b32 v13, 5, v0
  v_lshl_add_u32 v12, v13, 2, v12
  s_lshl_b32 s40, s25, 1
  s_add_u32 s40, s40, s27
  s_lshl_b32 s40, s40, 14
  s_lshl_b32 s41, s38, 8
  s_add_u32 s40, s40, s41
  s_add_u32 s40, s40, 8650752
  buffer_store_dword v8, v12, s[48:51], s40 offen
  s_waitcnt vmcnt(0)
  s_mov_b64 exec, 1
  v_mov_b32 v1, 147456
  v_mov_b32 v2, 1
  ds_add_rtn_u32 v3, v1, v2
  s_lshl_b32 s37, s24, 7
  s_lshl_b32 s38, s25, 2
  s_add_u32 s37, s37, s38
  s_add_u32 s37, s37, 9191424
  s_waitcnt lgkmcnt(0)
  v_readfirstlane_b32 s38, v3
  s_and_b32 s38, s38, 3
  s_cmp_eq_u32 s38, 3
  s_cbranch_scc0 f0_kernel_p3_nosig19
  s_cmp_eq_u32 s63, 0
  s_cbranch_scc1 f0_kernel_p3_fastsig20
  buffer_wbl2 sc1
  s_waitcnt vmcnt(0)
  buffer_store_dword v2, off, s[48:51], s37 sc1
  s_branch f0_kernel_p3_nosig19
f0_kernel_p3_fastsig20:
  buffer_store_dword v2, off, s[48:51], s37
f0_kernel_p3_nosig19:
  s_mov_b64 exec, -1
  s_branch f0_kernel_p4_entry
f0_kernel_p3_p2:
  buffer_load_dwordx2 v[104:105], v20, s[48:51], s52 offen offset:0 sc1
  buffer_load_dwordx2 v[106:107], v20, s[48:51], s52 offen offset:256 sc1
  buffer_load_dwordx2 v[108:109], v20, s[48:51], s52 offen offset:1024 sc1
  buffer_load_dwordx2 v[110:111], v20, s[48:51], s52 offen offset:1280 sc1
  s_mov_b32 s56, s8
  s_mov_b32 s57, s9
  s_mov_b32 s58, 0x500
  s_mov_b32 s59, 0x00020000
  s_mul_i32 s40, s25, 160
  s_mul_i32 s41, s27, 96
  s_add_u32 s40, s40, s41
  v_lshlrev_b32 v21, 3, v17
  buffer_load_dwordx2 v[116:117], v21, s[56:59], s40 offen offset:0
  buffer_load_dwordx2 v[118:119], v21, s[56:59], s40 offen offset:32
  s_barrier
  ds_read_b128 v[88:91], v3 offset:0
  ds_read_b128 v[92:95], v3 offset:256
  ds_read_b128 v[64:67], v1 offset:0
  ds_read_b128 v[68:71], v1 offset:256
  s_waitcnt lgkmcnt(0)
  v_mfma_f32_16x16x32_bf16 v[32:35], v[64:67], v[88:91], 0
  ds_read_b128 v[96:99], v3 offset:2048
  ds_read_b128 v[100:103], v3 offset:2304
  v_mfma_f32_16x16x32_bf16 v[36:39], v[64:67], v[92:95], 0
  ds_read_b128 v[76:79], v1 offset:5120
  ds_read_b128 v[80:83], v1 offset:5376
  v_mfma_f32_16x16x32_bf16 v[40:43], v[68:71], v[88:91], 0
  v_mfma_f32_16x16x32_bf16 v[44:47], v[68:71], v[92:95], 0
  s_waitcnt lgkmcnt(0)
  v_mfma_f32_16x16x32_bf16 v[32:35], v[76:79], v[96:99], v[32:35]
  ds_read_b128 v[88:91], v3 offset:4096
  ds_read_b128 v[92:95], v3 offset:4352
  v_mfma_f32_16x16x32_bf16 v[36:39], v[76:79], v[100:103], v[36:39]
  ds_read_b128 v[64:67], v1 offset:10240
  ds_read_b128 v[68:71], v1 offset:10496
  v_mfma_f32_16x16x32_bf16 v[40:43], v[80:83], v[96:99], v[40:43]
  v_mfma_f32_16x16x32_bf16 v[44:47], v[80:83], v[100:103], v[44:47]
  s_waitcnt lgkmcnt(0)
  v_mfma_f32_16x16x32_bf16 v[32:35], v[64:67], v[88:91], v[32:35]
  ds_read_b128 v[96:99], v3 offset:6144
  ds_read_b128 v[100:103], v3 offset:6400
  v_mfma_f32_16x16x32_bf16 v[36:39], v[64:67], v[92:95], v[36:39]
  ds_read_b128 v[76:79], v1 offset:15360
  ds_read_b128 v[80:83], v1 offset:15616
  v_mfma_f32_16x16x32_bf16 v[40:43], v[68:71], v[88:91], v[40:43]
  v_mfma_f32_16x16x32_bf16 v[44:47], v[68:71], v[92:95], v[44:47]
  s_waitcnt lgkmcnt(0)
  s_barrier
  v_mfma_f32_16x16x32_bf16 v[32:35], v[76:79], v[96:99], v[32:35]
  ds_read_b128 v[88:91], v3 offset:16384
  ds_read_b128 v[92:95], v3 offset:16640
  v_mfma_f32_16x16x32_bf16 v[36:39], v[76:79], v[100:103], v[36:39]
  ds_read_b128 v[64:67], v1 offset:20480
  ds_read_b128 v[68:71], v1 offset:20736
  v_mfma_f32_16x16x32_bf16 v[40:43], v[80:83], v[96:99], v[40:43]
  v_mfma_f32_16x16x32_bf16 v[44:47], v[80:83], v[100:103], v[44:47]
  s_waitcnt lgkmcnt(0)
  v_mfma_f32_16x16x32_bf16 v[32:35], v[64:67], v[88:91], v[32:35]
  ds_read_b128 v[96:99], v3 offset:18432
  ds_read_b128 v[100:103], v3 offset:18688
  v_mfma_f32_16x16x32_bf16 v[36:39], v[64:67], v[92:95], v[36:39]
  ds_read_b128 v[76:79], v1 offset:25600
  ds_read_b128 v[80:83], v1 offset:25856
  v_mfma_f32_16x16x32_bf16 v[40:43], v[68:71], v[88:91], v[40:43]
  v_mfma_f32_16x16x32_bf16 v[44:47], v[68:71], v[92:95], v[44:47]
  s_waitcnt lgkmcnt(0)
  v_mfma_f32_16x16x32_bf16 v[32:35], v[76:79], v[96:99], v[32:35]
  ds_read_b128 v[88:91], v3 offset:20480
  ds_read_b128 v[92:95], v3 offset:20736
  v_mfma_f32_16x16x32_bf16 v[36:39], v[76:79], v[100:103], v[36:39]
  ds_read_b128 v[64:67], v1 offset:30720
  ds_read_b128 v[68:71], v1 offset:30976
  v_mfma_f32_16x16x32_bf16 v[40:43], v[80:83], v[96:99], v[40:43]
  v_mfma_f32_16x16x32_bf16 v[44:47], v[80:83], v[100:103], v[44:47]
  s_waitcnt lgkmcnt(0)
  v_mfma_f32_16x16x32_bf16 v[32:35], v[64:67], v[88:91], v[32:35]
  ds_read_b128 v[96:99], v3 offset:22528
  ds_read_b128 v[100:103], v3 offset:22784
  v_mfma_f32_16x16x32_bf16 v[36:39], v[64:67], v[92:95], v[36:39]
  ds_read_b128 v[76:79], v1 offset:35840
  ds_read_b128 v[80:83], v1 offset:36096
  v_mfma_f32_16x16x32_bf16 v[40:43], v[68:71], v[88:91], v[40:43]
  v_mfma_f32_16x16x32_bf16 v[44:47], v[68:71], v[92:95], v[44:47]
  s_waitcnt lgkmcnt(0)
  s_barrier
  v_mfma_f32_16x16x32_bf16 v[32:35], v[76:79], v[96:99], v[32:35]
  ds_read_b128 v[88:91], v3 offset:32768
  ds_read_b128 v[92:95], v3 offset:33024
  v_mfma_f32_16x16x32_bf16 v[36:39], v[76:79], v[100:103], v[36:39]
  ds_read_b128 v[64:67], v1 offset:40960
  ds_read_b128 v[68:71], v1 offset:41216
  v_mfma_f32_16x16x32_bf16 v[40:43], v[80:83], v[96:99], v[40:43]
  v_mfma_f32_16x16x32_bf16 v[44:47], v[80:83], v[100:103], v[44:47]
  s_waitcnt lgkmcnt(0)
  v_mfma_f32_16x16x32_bf16 v[32:35], v[64:67], v[88:91], v[32:35]
  ds_read_b128 v[96:99], v3 offset:34816
  ds_read_b128 v[100:103], v3 offset:35072
  v_mfma_f32_16x16x32_bf16 v[36:39], v[64:67], v[92:95], v[36:39]
  ds_read_b128 v[76:79], v1 offset:46080
  ds_read_b128 v[80:83], v1 offset:46336
  v_mfma_f32_16x16x32_bf16 v[40:43], v[68:71], v[88:91], v[40:43]
  v_mfma_f32_16x16x32_bf16 v[44:47], v[68:71], v[92:95], v[44:47]
  s_waitcnt lgkmcnt(0)
  v_mfma_f32_16x16x32_bf16 v[32:35], v[76:79], v[96:99], v[32:35]
  ds_read_b128 v[88:91], v3 offset:36864
  ds_read_b128 v[92:95], v3 offset:37120
  v_mfma_f32_16x16x32_bf16 v[36:39], v[76:79], v[100:103], v[36:39]
  ds_read_b128 v[64:67], v1 offset:51200
  ds_read_b128 v[68:71], v1 offset:51456
  v_mfma_f32_16x16x32_bf16 v[40:43], v[80:83], v[96:99], v[40:43]
  v_mfma_f32_16x16x32_bf16 v[44:47], v[80:83], v[100:103], v[44:47]
  s_waitcnt lgkmcnt(0)
  v_mfma_f32_16x16x32_bf16 v[32:35], v[64:67], v[88:91], v[32:35]
  ds_read_b128 v[96:99], v3 offset:38912
  ds_read_b128 v[100:103], v3 offset:39168
  v_mfma_f32_16x16x32_bf16 v[36:39], v[64:67], v[92:95], v[36:39]
  ds_read_b128 v[76:79], v1 offset:56320
  ds_read_b128 v[80:83], v1 offset:56576
  v_mfma_f32_16x16x32_bf16 v[40:43], v[68:71], v[88:91], v[40:43]
  v_mfma_f32_16x16x32_bf16 v[44:47], v[68:71], v[92:95], v[44:47]
  s_waitcnt lgkmcnt(0)
  s_barrier
  v_mfma_f32_16x16x32_bf16 v[32:35], v[76:79], v[96:99], v[32:35]
  ds_read_b128 v[88:91], v4 offset:0
  ds_read_b128 v[92:95], v4 offset:256
  v_mfma_f32_16x16x32_bf16 v[36:39], v[76:79], v[100:103], v[36:39]
  ds_read_b128 v[64:67], v2 offset:0
  ds_read_b128 v[68:71], v2 offset:256
  v_mfma_f32_16x16x32_bf16 v[40:43], v[80:83], v[96:99], v[40:43]
  v_mfma_f32_16x16x32_bf16 v[44:47], v[80:83], v[100:103], v[44:47]
  s_waitcnt lgkmcnt(0)
  v_mfma_f32_16x16x32_bf16 v[32:35], v[64:67], v[88:91], v[32:35]
  ds_read_b128 v[96:99], v4 offset:2048
  ds_read_b128 v[100:103], v4 offset:2304
  v_mfma_f32_16x16x32_bf16 v[36:39], v[64:67], v[92:95], v[36:39]
  ds_read_b128 v[76:79], v2 offset:5120
  ds_read_b128 v[80:83], v2 offset:5376
  v_mfma_f32_16x16x32_bf16 v[40:43], v[68:71], v[88:91], v[40:43]
  v_mfma_f32_16x16x32_bf16 v[44:47], v[68:71], v[92:95], v[44:47]
  s_waitcnt lgkmcnt(0)
  v_mfma_f32_16x16x32_bf16 v[32:35], v[76:79], v[96:99], v[32:35]
  ds_read_b128 v[88:91], v4 offset:4096
  ds_read_b128 v[92:95], v4 offset:4352
  v_mfma_f32_16x16x32_bf16 v[36:39], v[76:79], v[100:103], v[36:39]
  ds_read_b128 v[64:67], v2 offset:10240
  ds_read_b128 v[68:71], v2 offset:10496
  v_mfma_f32_16x16x32_bf16 v[40:43], v[80:83], v[96:99], v[40:43]
  v_mfma_f32_16x16x32_bf16 v[44:47], v[80:83], v[100:103], v[44:47]
  s_waitcnt lgkmcnt(0)
  v_mfma_f32_16x16x32_bf16 v[32:35], v[64:67], v[88:91], v[32:35]
  ds_read_b128 v[96:99], v4 offset:6144
  ds_read_b128 v[100:103], v4 offset:6400
  v_mfma_f32_16x16x32_bf16 v[36:39], v[64:67], v[92:95], v[36:39]
  ds_read_b128 v[76:79], v2 offset:15360
  ds_read_b128 v[80:83], v2 offset:15616
  v_mfma_f32_16x16x32_bf16 v[40:43], v[68:71], v[88:91], v[40:43]
  v_mfma_f32_16x16x32_bf16 v[44:47], v[68:71], v[92:95], v[44:47]
  s_waitcnt lgkmcnt(0)
  s_barrier
  v_mfma_f32_16x16x32_bf16 v[32:35], v[76:79], v[96:99], v[32:35]
  ds_read_b128 v[88:91], v3 offset:0
  ds_read_b128 v[92:95], v3 offset:256
  v_mfma_f32_16x16x32_bf16 v[36:39], v[76:79], v[100:103], v[36:39]
  ds_read_b128 v[64:67], v1 offset:0
  ds_read_b128 v[68:71], v1 offset:256
  v_mfma_f32_16x16x32_bf16 v[40:43], v[80:83], v[96:99], v[40:43]
  v_mfma_f32_16x16x32_bf16 v[44:47], v[80:83], v[100:103], v[44:47]
  s_waitcnt lgkmcnt(0)
  v_mfma_f32_16x16x32_bf16 v[32:35], v[64:67], v[88:91], v[32:35]
  ds_read_b128 v[96:99], v3 offset:2048
  ds_read_b128 v[100:103], v3 offset:2304
  v_mfma_f32_16x16x32_bf16 v[36:39], v[64:67], v[92:95], v[36:39]
  ds_read_b128 v[76:79], v1 offset:5120
  ds_read_b128 v[80:83], v1 offset:5376
  v_mfma_f32_16x16x32_bf16 v[40:43], v[68:71], v[88:91], v[40:43]
  v_mfma_f32_16x16x32_bf16 v[44:47], v[68:71], v[92:95], v[44:47]
  s_waitcnt lgkmcnt(0)
  v_mfma_f32_16x16x32_bf16 v[32:35], v[76:79], v[96:99], v[32:35]
  ds_read_b128 v[88:91], v3 offset:4096
  ds_read_b128 v[92:95], v3 offset:4352
  v_mfma_f32_16x16x32_bf16 v[36:39], v[76:79], v[100:103], v[36:39]
  ds_read_b128 v[64:67], v1 offset:10240
  ds_read_b128 v[68:71], v1 offset:10496
  v_mfma_f32_16x16x32_bf16 v[40:43], v[80:83], v[96:99], v[40:43]
  v_mfma_f32_16x16x32_bf16 v[44:47], v[80:83], v[100:103], v[44:47]
  s_waitcnt lgkmcnt(0)
  v_mfma_f32_16x16x32_bf16 v[32:35], v[64:67], v[88:91], v[32:35]
  ds_read_b128 v[96:99], v3 offset:6144
  ds_read_b128 v[100:103], v3 offset:6400
  v_mfma_f32_16x16x32_bf16 v[36:39], v[64:67], v[92:95], v[36:39]
  ds_read_b128 v[76:79], v1 offset:15360
  ds_read_b128 v[80:83], v1 offset:15616
  v_mfma_f32_16x16x32_bf16 v[40:43], v[68:71], v[88:91], v[40:43]
  v_mfma_f32_16x16x32_bf16 v[44:47], v[68:71], v[92:95], v[44:47]
  s_waitcnt lgkmcnt(0)
  s_barrier
  v_mfma_f32_16x16x32_bf16 v[32:35], v[76:79], v[96:99], v[32:35]
  ds_read_b128 v[88:91], v3 offset:16384
  ds_read_b128 v[92:95], v3 offset:16640
  v_mfma_f32_16x16x32_bf16 v[36:39], v[76:79], v[100:103], v[36:39]
  ds_read_b128 v[64:67], v1 offset:20480
  ds_read_b128 v[68:71], v1 offset:20736
  v_mfma_f32_16x16x32_bf16 v[40:43], v[80:83], v[96:99], v[40:43]
  v_mfma_f32_16x16x32_bf16 v[44:47], v[80:83], v[100:103], v[44:47]
  s_waitcnt lgkmcnt(0)
  v_mfma_f32_16x16x32_bf16 v[32:35], v[64:67], v[88:91], v[32:35]
  ds_read_b128 v[96:99], v3 offset:18432
  ds_read_b128 v[100:103], v3 offset:18688
  v_mfma_f32_16x16x32_bf16 v[36:39], v[64:67], v[92:95], v[36:39]
  ds_read_b128 v[76:79], v1 offset:25600
  ds_read_b128 v[80:83], v1 offset:25856
  v_mfma_f32_16x16x32_bf16 v[40:43], v[68:71], v[88:91], v[40:43]
  v_mfma_f32_16x16x32_bf16 v[44:47], v[68:71], v[92:95], v[44:47]
  s_waitcnt lgkmcnt(0)
  v_mfma_f32_16x16x32_bf16 v[32:35], v[76:79], v[96:99], v[32:35]
  ds_read_b128 v[88:91], v3 offset:20480
  ds_read_b128 v[92:95], v3 offset:20736
  v_mfma_f32_16x16x32_bf16 v[36:39], v[76:79], v[100:103], v[36:39]
  ds_read_b128 v[64:67], v1 offset:30720
  ds_read_b128 v[68:71], v1 offset:30976
  v_mfma_f32_16x16x32_bf16 v[40:43], v[80:83], v[96:99], v[40:43]
  v_mfma_f32_16x16x32_bf16 v[44:47], v[80:83], v[100:103], v[44:47]
  s_waitcnt lgkmcnt(0)
  v_mfma_f32_16x16x32_bf16 v[32:35], v[64:67], v[88:91], v[32:35]
  ds_read_b128 v[96:99], v3 offset:22528
  ds_read_b128 v[100:103], v3 offset:22784
  v_mfma_f32_16x16x32_bf16 v[36:39], v[64:67], v[92:95], v[36:39]
  ds_read_b128 v[76:79], v1 offset:35840
  ds_read_b128 v[80:83], v1 offset:36096
  v_mfma_f32_16x16x32_bf16 v[40:43], v[68:71], v[88:91], v[40:43]
  v_mfma_f32_16x16x32_bf16 v[44:47], v[68:71], v[92:95], v[44:47]
  s_waitcnt lgkmcnt(0)
  s_barrier
  v_mfma_f32_16x16x32_bf16 v[32:35], v[76:79], v[96:99], v[32:35]
  ds_read_b128 v[88:91], v3 offset:32768
  ds_read_b128 v[92:95], v3 offset:33024
  v_mfma_f32_16x16x32_bf16 v[36:39], v[76:79], v[100:103], v[36:39]
  ds_read_b128 v[64:67], v1 offset:40960
  ds_read_b128 v[68:71], v1 offset:41216
  v_mfma_f32_16x16x32_bf16 v[40:43], v[80:83], v[96:99], v[40:43]
  v_mfma_f32_16x16x32_bf16 v[44:47], v[80:83], v[100:103], v[44:47]
  s_waitcnt lgkmcnt(0)
  v_mfma_f32_16x16x32_bf16 v[32:35], v[64:67], v[88:91], v[32:35]
  ds_read_b128 v[96:99], v3 offset:34816
  ds_read_b128 v[100:103], v3 offset:35072
  v_mfma_f32_16x16x32_bf16 v[36:39], v[64:67], v[92:95], v[36:39]
  ds_read_b128 v[76:79], v1 offset:46080
  ds_read_b128 v[80:83], v1 offset:46336
  v_mfma_f32_16x16x32_bf16 v[40:43], v[68:71], v[88:91], v[40:43]
  v_mfma_f32_16x16x32_bf16 v[44:47], v[68:71], v[92:95], v[44:47]
  s_waitcnt lgkmcnt(0)
  v_mfma_f32_16x16x32_bf16 v[32:35], v[76:79], v[96:99], v[32:35]
  ds_read_b128 v[88:91], v3 offset:36864
  ds_read_b128 v[92:95], v3 offset:37120
  v_mfma_f32_16x16x32_bf16 v[36:39], v[76:79], v[100:103], v[36:39]
  ds_read_b128 v[64:67], v1 offset:51200
  ds_read_b128 v[68:71], v1 offset:51456
  v_mfma_f32_16x16x32_bf16 v[40:43], v[80:83], v[96:99], v[40:43]
  v_mfma_f32_16x16x32_bf16 v[44:47], v[80:83], v[100:103], v[44:47]
  s_waitcnt lgkmcnt(0)
  v_mfma_f32_16x16x32_bf16 v[32:35], v[64:67], v[88:91], v[32:35]
  ds_read_b128 v[96:99], v3 offset:38912
  ds_read_b128 v[100:103], v3 offset:39168
  v_mfma_f32_16x16x32_bf16 v[36:39], v[64:67], v[92:95], v[36:39]
  ds_read_b128 v[76:79], v1 offset:56320
  ds_read_b128 v[80:83], v1 offset:56576
  v_mfma_f32_16x16x32_bf16 v[40:43], v[68:71], v[88:91], v[40:43]
  v_mfma_f32_16x16x32_bf16 v[44:47], v[68:71], v[92:95], v[44:47]
  s_waitcnt lgkmcnt(0)
  s_barrier
  v_mfma_f32_16x16x32_bf16 v[32:35], v[76:79], v[96:99], v[32:35]
  ds_read_b128 v[88:91], v4 offset:0
  ds_read_b128 v[92:95], v4 offset:256
  v_mfma_f32_16x16x32_bf16 v[36:39], v[76:79], v[100:103], v[36:39]
  ds_read_b128 v[64:67], v2 offset:0
  ds_read_b128 v[68:71], v2 offset:256
  v_mfma_f32_16x16x32_bf16 v[40:43], v[80:83], v[96:99], v[40:43]
  v_mfma_f32_16x16x32_bf16 v[44:47], v[80:83], v[100:103], v[44:47]
  s_waitcnt lgkmcnt(0)
  v_mfma_f32_16x16x32_bf16 v[32:35], v[64:67], v[88:91], v[32:35]
  ds_read_b128 v[96:99], v4 offset:2048
  ds_read_b128 v[100:103], v4 offset:2304
  v_mfma_f32_16x16x32_bf16 v[36:39], v[64:67], v[92:95], v[36:39]
  ds_read_b128 v[76:79], v2 offset:5120
  ds_read_b128 v[80:83], v2 offset:5376
  v_mfma_f32_16x16x32_bf16 v[40:43], v[68:71], v[88:91], v[40:43]
  v_mfma_f32_16x16x32_bf16 v[44:47], v[68:71], v[92:95], v[44:47]
  s_waitcnt lgkmcnt(0)
  v_mfma_f32_16x16x32_bf16 v[32:35], v[76:79], v[96:99], v[32:35]
  ds_read_b128 v[88:91], v4 offset:4096
  ds_read_b128 v[92:95], v4 offset:4352
  v_mfma_f32_16x16x32_bf16 v[36:39], v[76:79], v[100:103], v[36:39]
  ds_read_b128 v[64:67], v2 offset:10240
  ds_read_b128 v[68:71], v2 offset:10496
  v_mfma_f32_16x16x32_bf16 v[40:43], v[80:83], v[96:99], v[40:43]
  v_mfma_f32_16x16x32_bf16 v[44:47], v[80:83], v[100:103], v[44:47]
  s_waitcnt lgkmcnt(0)
  v_mfma_f32_16x16x32_bf16 v[32:35], v[64:67], v[88:91], v[32:35]
  ds_read_b128 v[96:99], v4 offset:6144
  ds_read_b128 v[100:103], v4 offset:6400
  v_mfma_f32_16x16x32_bf16 v[36:39], v[64:67], v[92:95], v[36:39]
  ds_read_b128 v[76:79], v2 offset:15360
  ds_read_b128 v[80:83], v2 offset:15616
  v_mfma_f32_16x16x32_bf16 v[40:43], v[68:71], v[88:91], v[40:43]
  v_mfma_f32_16x16x32_bf16 v[44:47], v[68:71], v[92:95], v[44:47]
  s_waitcnt lgkmcnt(0)
  s_barrier
  v_mfma_f32_16x16x32_bf16 v[32:35], v[76:79], v[96:99], v[32:35]
  ds_read_b128 v[88:91], v3 offset:0
  ds_read_b128 v[92:95], v3 offset:256
  v_mfma_f32_16x16x32_bf16 v[36:39], v[76:79], v[100:103], v[36:39]
  ds_read_b128 v[64:67], v1 offset:0
  ds_read_b128 v[68:71], v1 offset:256
  v_mfma_f32_16x16x32_bf16 v[40:43], v[80:83], v[96:99], v[40:43]
  v_mfma_f32_16x16x32_bf16 v[44:47], v[80:83], v[100:103], v[44:47]
  s_waitcnt lgkmcnt(0)
  v_mfma_f32_16x16x32_bf16 v[32:35], v[64:67], v[88:91], v[32:35]
  ds_read_b128 v[96:99], v3 offset:2048
  ds_read_b128 v[100:103], v3 offset:2304
  v_mfma_f32_16x16x32_bf16 v[36:39], v[64:67], v[92:95], v[36:39]
  ds_read_b128 v[76:79], v1 offset:5120
  ds_read_b128 v[80:83], v1 offset:5376
  v_mfma_f32_16x16x32_bf16 v[40:43], v[68:71], v[88:91], v[40:43]
  v_mfma_f32_16x16x32_bf16 v[44:47], v[68:71], v[92:95], v[44:47]
  s_waitcnt lgkmcnt(0)
  v_mfma_f32_16x16x32_bf16 v[32:35], v[76:79], v[96:99], v[32:35]
  ds_read_b128 v[88:91], v3 offset:4096
  ds_read_b128 v[92:95], v3 offset:4352
  v_mfma_f32_16x16x32_bf16 v[36:39], v[76:79], v[100:103], v[36:39]
  ds_read_b128 v[64:67], v1 offset:10240
  ds_read_b128 v[68:71], v1 offset:10496
  v_mfma_f32_16x16x32_bf16 v[40:43], v[80:83], v[96:99], v[40:43]
  v_mfma_f32_16x16x32_bf16 v[44:47], v[80:83], v[100:103], v[44:47]
  s_waitcnt lgkmcnt(0)
  v_mfma_f32_16x16x32_bf16 v[32:35], v[64:67], v[88:91], v[32:35]
  ds_read_b128 v[96:99], v3 offset:6144
  ds_read_b128 v[100:103], v3 offset:6400
  v_mfma_f32_16x16x32_bf16 v[36:39], v[64:67], v[92:95], v[36:39]
  ds_read_b128 v[76:79], v1 offset:15360
  ds_read_b128 v[80:83], v1 offset:15616
  v_mfma_f32_16x16x32_bf16 v[40:43], v[68:71], v[88:91], v[40:43]
  v_mfma_f32_16x16x32_bf16 v[44:47], v[68:71], v[92:95], v[44:47]
  s_waitcnt lgkmcnt(0)
  s_barrier
  v_mfma_f32_16x16x32_bf16 v[32:35], v[76:79], v[96:99], v[32:35]
  ds_read_b128 v[88:91], v3 offset:16384
  ds_read_b128 v[92:95], v3 offset:16640
  v_mfma_f32_16x16x32_bf16 v[36:39], v[76:79], v[100:103], v[36:39]
  ds_read_b128 v[64:67], v1 offset:20480
  ds_read_b128 v[68:71], v1 offset:20736
  v_mfma_f32_16x16x32_bf16 v[40:43], v[80:83], v[96:99], v[40:43]
  v_mfma_f32_16x16x32_bf16 v[44:47], v[80:83], v[100:103], v[44:47]
  s_waitcnt lgkmcnt(0)
  v_mfma_f32_16x16x32_bf16 v[32:35], v[64:67], v[88:91], v[32:35]
  ds_read_b128 v[96:99], v3 offset:18432
  ds_read_b128 v[100:103], v3 offset:18688
  v_mfma_f32_16x16x32_bf16 v[36:39], v[64:67], v[92:95], v[36:39]
  ds_read_b128 v[76:79], v1 offset:25600
  ds_read_b128 v[80:83], v1 offset:25856
  v_mfma_f32_16x16x32_bf16 v[40:43], v[68:71], v[88:91], v[40:43]
  v_mfma_f32_16x16x32_bf16 v[44:47], v[68:71], v[92:95], v[44:47]
  s_waitcnt lgkmcnt(0)
  v_mfma_f32_16x16x32_bf16 v[32:35], v[76:79], v[96:99], v[32:35]
  ds_read_b128 v[88:91], v3 offset:20480
  ds_read_b128 v[92:95], v3 offset:20736
  v_mfma_f32_16x16x32_bf16 v[36:39], v[76:79], v[100:103], v[36:39]
  ds_read_b128 v[64:67], v1 offset:30720
  ds_read_b128 v[68:71], v1 offset:30976
  v_mfma_f32_16x16x32_bf16 v[40:43], v[80:83], v[96:99], v[40:43]
  v_mfma_f32_16x16x32_bf16 v[44:47], v[80:83], v[100:103], v[44:47]
  s_waitcnt lgkmcnt(0)
  v_mfma_f32_16x16x32_bf16 v[32:35], v[64:67], v[88:91], v[32:35]
  ds_read_b128 v[96:99], v3 offset:22528
  ds_read_b128 v[100:103], v3 offset:22784
  v_mfma_f32_16x16x32_bf16 v[36:39], v[64:67], v[92:95], v[36:39]
  ds_read_b128 v[76:79], v1 offset:35840
  ds_read_b128 v[80:83], v1 offset:36096
  v_mfma_f32_16x16x32_bf16 v[40:43], v[68:71], v[88:91], v[40:43]
  v_mfma_f32_16x16x32_bf16 v[44:47], v[68:71], v[92:95], v[44:47]
  s_waitcnt lgkmcnt(0)
  s_barrier
  v_mfma_f32_16x16x32_bf16 v[32:35], v[76:79], v[96:99], v[32:35]
  ds_read_b128 v[88:91], v3 offset:32768
  ds_read_b128 v[92:95], v3 offset:33024
  v_mfma_f32_16x16x32_bf16 v[36:39], v[76:79], v[100:103], v[36:39]
  ds_read_b128 v[64:67], v1 offset:40960
  ds_read_b128 v[68:71], v1 offset:41216
  v_mfma_f32_16x16x32_bf16 v[40:43], v[80:83], v[96:99], v[40:43]
  v_mfma_f32_16x16x32_bf16 v[44:47], v[80:83], v[100:103], v[44:47]
  s_waitcnt lgkmcnt(0)
  v_mfma_f32_16x16x32_bf16 v[32:35], v[64:67], v[88:91], v[32:35]
  ds_read_b128 v[96:99], v3 offset:34816
  ds_read_b128 v[100:103], v3 offset:35072
  v_mfma_f32_16x16x32_bf16 v[36:39], v[64:67], v[92:95], v[36:39]
  ds_read_b128 v[76:79], v1 offset:46080
  ds_read_b128 v[80:83], v1 offset:46336
  v_mfma_f32_16x16x32_bf16 v[40:43], v[68:71], v[88:91], v[40:43]
  v_mfma_f32_16x16x32_bf16 v[44:47], v[68:71], v[92:95], v[44:47]
  s_waitcnt lgkmcnt(0)
  v_mfma_f32_16x16x32_bf16 v[32:35], v[76:79], v[96:99], v[32:35]
  ds_read_b128 v[88:91], v3 offset:36864
  ds_read_b128 v[92:95], v3 offset:37120
  v_mfma_f32_16x16x32_bf16 v[36:39], v[76:79], v[100:103], v[36:39]
  ds_read_b128 v[64:67], v1 offset:51200
  ds_read_b128 v[68:71], v1 offset:51456
  v_mfma_f32_16x16x32_bf16 v[40:43], v[80:83], v[96:99], v[40:43]
  v_mfma_f32_16x16x32_bf16 v[44:47], v[80:83], v[100:103], v[44:47]
  s_waitcnt lgkmcnt(0)
  v_mfma_f32_16x16x32_bf16 v[32:35], v[64:67], v[88:91], v[32:35]
  ds_read_b128 v[96:99], v3 offset:38912
  ds_read_b128 v[100:103], v3 offset:39168
  v_mfma_f32_16x16x32_bf16 v[36:39], v[64:67], v[92:95], v[36:39]
  ds_read_b128 v[76:79], v1 offset:56320
  ds_read_b128 v[80:83], v1 offset:56576
  v_mfma_f32_16x16x32_bf16 v[40:43], v[68:71], v[88:91], v[40:43]
  v_mfma_f32_16x16x32_bf16 v[44:47], v[68:71], v[92:95], v[44:47]
  s_waitcnt lgkmcnt(0)
  s_barrier
  v_mfma_f32_16x16x32_bf16 v[32:35], v[76:79], v[96:99], v[32:35]
  ds_read_b128 v[88:91], v4 offset:0
  ds_read_b128 v[92:95], v4 offset:256
  v_mfma_f32_16x16x32_bf16 v[36:39], v[76:79], v[100:103], v[36:39]
  ds_read_b128 v[64:67], v2 offset:0
  ds_read_b128 v[68:71], v2 offset:256
  v_mfma_f32_16x16x32_bf16 v[40:43], v[80:83], v[96:99], v[40:43]
  v_mfma_f32_16x16x32_bf16 v[44:47], v[80:83], v[100:103], v[44:47]
  s_waitcnt lgkmcnt(0)
  v_mfma_f32_16x16x32_bf16 v[32:35], v[64:67], v[88:91], v[32:35]
  ds_read_b128 v[96:99], v4 offset:2048
  ds_read_b128 v[100:103], v4 offset:2304
  v_mfma_f32_16x16x32_bf16 v[36:39], v[64:67], v[92:95], v[36:39]
  ds_read_b128 v[76:79], v2 offset:5120
  ds_read_b128 v[80:83], v2 offset:5376
  v_mfma_f32_16x16x32_bf16 v[40:43], v[68:71], v[88:91], v[40:43]
  v_mfma_f32_16x16x32_bf16 v[44:47], v[68:71], v[92:95], v[44:47]
  s_waitcnt lgkmcnt(0)
  v_mfma_f32_16x16x32_bf16 v[32:35], v[76:79], v[96:99], v[32:35]
  ds_read_b128 v[88:91], v4 offset:4096
  ds_read_b128 v[92:95], v4 offset:4352
  v_mfma_f32_16x16x32_bf16 v[36:39], v[76:79], v[100:103], v[36:39]
  ds_read_b128 v[64:67], v2 offset:10240
  ds_read_b128 v[68:71], v2 offset:10496
  v_mfma_f32_16x16x32_bf16 v[40:43], v[80:83], v[96:99], v[40:43]
  v_mfma_f32_16x16x32_bf16 v[44:47], v[80:83], v[100:103], v[44:47]
  s_waitcnt lgkmcnt(0)
  v_mfma_f32_16x16x32_bf16 v[32:35], v[64:67], v[88:91], v[32:35]
  ds_read_b128 v[96:99], v4 offset:6144
  ds_read_b128 v[100:103], v4 offset:6400
  v_mfma_f32_16x16x32_bf16 v[36:39], v[64:67], v[92:95], v[36:39]
  ds_read_b128 v[76:79], v2 offset:15360
  ds_read_b128 v[80:83], v2 offset:15616
  v_mfma_f32_16x16x32_bf16 v[40:43], v[68:71], v[88:91], v[40:43]
  v_mfma_f32_16x16x32_bf16 v[44:47], v[68:71], v[92:95], v[44:47]
  s_waitcnt lgkmcnt(0)
  v_mfma_f32_16x16x32_bf16 v[32:35], v[76:79], v[96:99], v[32:35]
  v_mfma_f32_16x16x32_bf16 v[36:39], v[76:79], v[100:103], v[36:39]
  v_mfma_f32_16x16x32_bf16 v[40:43], v[80:83], v[96:99], v[40:43]
  v_mfma_f32_16x16x32_bf16 v[44:47], v[80:83], v[100:103], v[44:47]
  s_waitcnt vmcnt(0)
  v_mov_b32 v8, 0
  v_mov_b32 v9, 0
  v_mov_b32 v10, 0
  v_mov_b32 v11, 0
  v_lshlrev_b32 v22, 4, v0
  s_add_u32 s53, s39, 15728640
  s_nop 4
  v_lshlrev_b32 v12, 16, v104
  v_and_b32 v13, 0xffff0000, v104
  v_lshlrev_b32 v14, 16, v105
  v_and_b32 v15, 0xffff0000, v105
  v_pk_add_f32 v[32:33], v[32:33], v[12:13]
  v_pk_add_f32 v[34:35], v[34:35], v[14:15]
  v_lshlrev_b32 v16, 16, v116
  v_and_b32 v17, 0xffff0000, v116
  v_lshlrev_b32 v18, 16, v117
  v_and_b32 v19, 0xffff0000, v117
  v_pk_add_f32 v[32:33], v[32:33], v[16:17]
  v_pk_add_f32 v[34:35], v[34:35], v[18:19]
  v_add_f32 v8, v8, v32
  v_fmac_f32 v10, v32, v32
  v_add_f32 v8, v8, v33
  v_fmac_f32 v10, v33, v33
  v_add_f32 v8, v8, v34
  v_fmac_f32 v10, v34, v34
  v_add_f32 v8, v8, v35
  v_fmac_f32 v10, v35, v35
  v_cvt_pk_bf16_f32 v24, v32, v33
  v_cvt_pk_bf16_f32 v25, v34, v35
  v_lshlrev_b32 v12, 16, v106
  v_and_b32 v13, 0xffff0000, v106
  v_lshlrev_b32 v14, 16, v107
  v_and_b32 v15, 0xffff0000, v107
  v_pk_add_f32 v[36:37], v[36:37], v[12:13]
  v_pk_add_f32 v[38:39], v[38:39], v[14:15]
  v_lshlrev_b32 v16, 16, v116
  v_and_b32 v17, 0xffff0000, v116
  v_lshlrev_b32 v18, 16, v117
  v_and_b32 v19, 0xffff0000, v117
  v_pk_add_f32 v[36:37], v[36:37], v[16:17]
  v_pk_add_f32 v[38:39], v[38:39], v[18:19]
  v_add_f32 v9, v9, v36
  v_fmac_f32 v11, v36, v36
  v_add_f32 v9, v9, v37
  v_fmac_f32 v11, v37, v37
  v_add_f32 v9, v9, v38
  v_fmac_f32 v11, v38, v38
  v_add_f32 v9, v9, v39
  v_fmac_f32 v11, v39, v39
  v_cvt_pk_bf16_f32 v26, v36, v37
  v_cvt_pk_bf16_f32 v27, v38, v39
  s_nop 1
  v_permlane16_swap_b32 v24, v26
  v_permlane16_swap_b32 v25, v27
  s_nop 1
  buffer_store_dwordx4 v[24:27], v22, s[48:51], s53 offen offset:0
  v_lshlrev_b32 v12, 16, v108
  v_and_b32 v13, 0xffff0000, v108
  v_lshlrev_b32 v14, 16, v109
  v_and_b32 v15, 0xffff0000, v109
  v_pk_add_f32 v[40:41], v[40:41], v[12:13]
  v_pk_add_f32 v[42:43], v[42:43], v[14:15]
  v_lshlrev_b32 v16, 16, v118
  v_and_b32 v17, 0xffff0000, v118
  v_lshlrev_b32 v18, 16, v119
  v_and_b32 v19, 0xffff0000, v119
  v_pk_add_f32 v[40:41], v[40:41], v[16:17]
  v_pk_add_f32 v[42:43], v[42:43], v[18:19]
  v_add_f32 v8, v8, v40
  v_fmac_f32 v10, v40, v40
  v_add_f32 v8, v8, v41
  v_fmac_f32 v10, v41, v41
  v_add_f32 v8, v8, v42
  v_fmac_f32 v10, v42, v42
  v_add_f32 v8, v8, v43
  v_fmac_f32 v10, v43, v43
  v_cvt_pk_bf16_f32 v28, v40, v41
  v_cvt_pk_bf16_f32 v29, v42, v43
  v_lshlrev_b32 v12, 16, v110
  v_and_b32 v13, 0xffff0000, v110
  v_lshlrev_b32 v14, 16, v111
  v_and_b32 v15, 0xffff0000, v111
  v_pk_add_f32 v[44:45], v[44:45], v[12:13]
  v_pk_add_f32 v[46:47], v[46:47], v[14:15]
  v_lshlrev_b32 v16, 16, v118
  v_and_b32 v17, 0xffff0000, v118
  v_lshlrev_b32 v18, 16, v119
  v_and_b32 v19, 0xffff0000, v119
  v_pk_add_f32 v[44:45], v[44:45], v[16:17]
  v_pk_add_f32 v[46:47], v[46:47], v[18:19]
  v_add_f32 v9, v9, v44
  v_fmac_f32 v11, v44, v44
  v_add_f32 v9, v9, v45
  v_fmac_f32 v11, v45, v45
  v_add_f32 v9, v9, v46
  v_fmac_f32 v11, v46, v46
  v_add_f32 v9, v9, v47
  v_fmac_f32 v11, v47, v47
  v_cvt_pk_bf16_f32 v30, v44, v45
  v_cvt_pk_bf16_f32 v31, v46, v47
  s_nop 1
  v_permlane16_swap_b32 v28, v30
  v_permlane16_swap_b32 v29, v31
  s_nop 1
  buffer_store_dwordx4 v[28:31], v22, s[48:51], s53 offen offset:1024
  v_permlane16_swap_b32 v8, v9
  v_permlane16_swap_b32 v10, v11
  s_nop 1
  v_add_f32 v8, v8, v9
  v_add_f32 v10, v10, v11
  s_nop 1
  v_permlane32_swap_b32 v8, v10
  s_nop 1
  v_add_f32 v8, v8, v10
  v_and_b32 v12, 31, v0
  v_lshlrev_b32 v12, 3, v12
  v_lshrrev_b32 v13, 5, v0
  v_lshl_add_u32 v12, v13, 2, v12
  s_lshl_b32 s40, s25, 1
  s_add_u32 s40, s40, s27
  s_lshl_b32 s40, s40, 14
  s_lshl_b32 s41, s38, 8
  s_add_u32 s40, s40, s41
  s_add_u32 s40, s40, 8650752
  buffer_store_dword v8, v12, s[48:51], s40 offen
  s_waitcnt vmcnt(0)
  s_mov_b64 exec, 1
  v_mov_b32 v1, 147456
  v_mov_b32 v2, 1
  ds_add_rtn_u32 v3, v1, v2
  s_lshl_b32 s37, s24, 7
  s_lshl_b32 s38, s25, 2
  s_add_u32 s37, s37, s38
  s_add_u32 s37, s37, 9191424
  s_waitcnt lgkmcnt(0)
  v_readfirstlane_b32 s38, v3
  s_and_b32 s38, s38, 3
  s_cmp_eq_u32 s38, 3
  s_cbranch_scc0 f0_kernel_p3_nosig21
  s_cmp_eq_u32 s63, 0
  s_cbranch_scc1 f0_kernel_p3_fastsig22
  buffer_wbl2 sc1
  s_waitcnt vmcnt(0)
  buffer_store_dword v2, off, s[48:51], s37 sc1
  s_branch f0_kernel_p3_nosig21
f0_kernel_p3_fastsig22:
  buffer_store_dword v2, off, s[48:51], s37
f0_kernel_p3_nosig21:
  s_mov_b64 exec, -1
  s_branch f0_kernel_p4_entry
f0_kernel_p4_entry:
  s_mov_b32 s26, s64
  s_cmp_ge_u32 s2, 240
  s_cbranch_scc1 f0_kernel_p5_entry
  s_and_b32 s20, s2, 7
  s_lshr_b32 s21, s2, 3
  s_and_b32 s22, s21, 1
  s_lshl_b32 s23, s20, 1
  s_add_u32 s24, s23, s22
  s_lshr_b32 s25, s21, 1
  s_cmp_lt_u32 s26, 4
  s_cbranch_scc1 f0_kernel_p4_compute
  s_sub_u32 s26, s26, 4
  v_lshlrev_b32 v1, 4, v0
  s_mul_i32 s40, s25, 163840
  s_mul_i32 s41, s26, 4096
  s_add_u32 s40, s40, s41
  s_add_u32 s40, s40, 0
  s_mov_b32 s42, s41
  s_lshl_b32 s43, s24, 2
  s_add_u32 s43, s43, s26
  s_mul_i32 s43, s43, 40960
  s_add_u32 s43, s43, 15728640
  s_lshl_b32 s44, s26, 12
  s_waitcnt lgkmcnt(0)
  s_mov_b32 s12, s6
  s_mov_b32 s13, s7
  s_mov_b32 s14, 0x3200000
  s_mov_b32 s15, 0x00020000
  s_add_u32 m0, s42, 0
  s_add_u32 s45, s40, 0
  buffer_load_dwordx4 v1, s[12:15], s45 offen offset:0 lds
  buffer_load_dwordx4 v1, s[12:15], s45 offen offset:1024 lds
  buffer_load_dwordx4 v1, s[12:15], s45 offen offset:2048 lds
  buffer_load_dwordx4 v1, s[12:15], s45 offen offset:3072 lds
  s_add_u32 m0, s42, 16384
  s_add_u32 s45, s40, 16384
  buffer_load_dwordx4 v1, s[12:15], s45 offen offset:0 lds
  buffer_load_dwordx4 v1, s[12:15], s45 offen offset:1024 lds
  buffer_load_dwordx4 v1, s[12:15], s45 offen offset:2048 lds
  buffer_load_dwordx4 v1, s[12:15], s45 offen offset:3072 lds
  v_and_b32 v2, 31, v0
  v_lshrrev_b32 v3, 5, v0
  s_lshl_b32 s47, s26, 5
  v_add_u32 v5, s47, v2
  s_mul_i32 s47, s25, 128
  v_add_u32 v6, s47, v5
  v_lshlrev_b32 v7, 2, v6
  v_mul_u32_u24 v8, 38400, v3
  v_add_u32 v7, v7, v8
  s_mov_b32 s47, 8388608
  buffer_load_dword v32, v7, s[12:15], s47 offen
  s_mov_b32 s47, 8396288
  buffer_load_dword v33, v7, s[12:15], s47 offen
  s_mov_b32 s47, 8403968
  buffer_load_dword v34, v7, s[12:15], s47 offen
  s_mov_b32 s47, 8411648
  buffer_load_dword v35, v7, s[12:15], s47 offen
  s_mov_b32 s47, 8419328
  buffer_load_dword v36, v7, s[12:15], s47 offen
  s_lshr_b32 s67, s26, 1
  s_lshl_b32 s46, s24, 1
  s_add_u32 s67, s67, s46
  s_lshl_b32 s66, s67, 7
  s_add_u32 s66, s66, 9191424
  v_lshlrev_b32 v10, 2, v0
  s_mov_b64 exec, 0xff
  s_mov_b32 s65, 16384
f0_kernel_p4_poll:
  buffer_load_dword v11, v10, s[12:15], s66 offen sc1
  s_waitcnt vmcnt(0)
  v_cmp_ne_u32 vcc, 0, v11
  s_cmp_eq_u32 vcc_lo, 0xff
  s_cbranch_scc1 f0_kernel_p4_polled
  s_sleep 1
  s_sub_u32 s65, s65, 1
  s_cbranch_scc0 f0_kernel_p4_poll
f0_kernel_p4_polled:
  s_mov_b64 exec, -1
  s_cmp_eq_u32 s63, 0
  s_cbranch_scc1 f0_kernel_p4_noacq
  buffer_inv sc1
  s_waitcnt vmcnt(0)
f0_kernel_p4_noacq:
  s_add_u32 m0, s44, 81920
  s_add_u32 s45, s43, 0
  buffer_load_dwordx4 v1, s[12:15], s45 offen offset:0 sc1 lds
  buffer_load_dwordx4 v1, s[12:15], s45 offen offset:1024 sc1 lds
  buffer_load_dwordx4 v1, s[12:15], s45 offen offset:2048 sc1 lds
  buffer_load_dwordx4 v1, s[12:15], s45 offen offset:3072 sc1 lds
  s_lshl_b32 s46, s24, 7
  s_lshl_b32 s47, s26, 5
  s_add_u32 s46, s46, s47
  v_add_u32 v4, s46, v2
  v_lshlrev_b32 v4, 3, v4
  v_lshl_add_u32 v4, v3, 17, v4
  s_mov_b32 s47, 8650752
  buffer_load_dwordx2 v[16:17], v4, s[12:15], s47 offen sc1
  s_mov_b32 s47, 8667136
  buffer_load_dwordx2 v[18:19], v4, s[12:15], s47 offen sc1
  s_mov_b32 s47, 8683520
  buffer_load_dwordx2 v[20:21], v4, s[12:15], s47 offen sc1
  s_mov_b32 s47, 8699904
  buffer_load_dwordx2 v[22:23], v4, s[12:15], s47 offen sc1
  s_mov_b32 s47, 8716288
  buffer_load_dwordx2 v[24:25], v4, s[12:15], s47 offen sc1
  s_mov_b32 s47, 8732672
  buffer_load_dwordx2 v[26:27], v4, s[12:15], s47 offen sc1
  s_mov_b32 s47, 8749056
  buffer_load_dwordx2 v[28:29], v4, s[12:15], s47 offen sc1
  s_mov_b32 s47, 8765440
  buffer_load_dwordx2 v[30:31], v4, s[12:15], s47 offen sc1
  s_add_u32 m0, s44, 98304
  s_add_u32 s45, s43, 4096
  buffer_load_dwordx4 v1, s[12:15], s45 offen offset:0 sc1 lds
  buffer_load_dwordx4 v1, s[12:15], s45 offen offset:1024 sc1 lds
  buffer_load_dwordx4 v1, s[12:15], s45 offen offset:2048 sc1 lds
  buffer_load_dwordx4 v1, s[12:15], s45 offen offset:3072 sc1 lds
  s_add_u32 m0, s42, 32768
  s_add_u32 s45, s40, 32768
  buffer_load_dwordx4 v1, s[12:15], s45 offen offset:0 lds
  buffer_load_dwordx4 v1, s[12:15], s45 offen offset:1024 lds
  buffer_load_dwordx4 v1, s[12:15], s45 offen offset:2048 lds
  buffer_load_dwordx4 v1, s[12:15], s45 offen offset:3072 lds
  s_add_u32 m0, s42, 114688
  s_add_u32 s45, s40, 49152
  buffer_load_dwordx4 v1, s[12:15], s45 offen offset:0 lds
  buffer_load_dwordx4 v1, s[12:15], s45 offen offset:1024 lds
  buffer_load_dwordx4 v1, s[12:15], s45 offen offset:2048 lds
  buffer_load_dwordx4 v1, s[12:15], s45 offen offset:3072 lds
  s_waitcnt vmcnt(12)
  s_barrier
  v_add_f32 v16, v16, v18
  v_add_f32 v17, v17, v19
  v_add_f32 v16, v16, v20
  v_add_f32 v17, v17, v21
  v_add_f32 v16, v16, v22
  v_add_f32 v17, v17, v23
  v_add_f32 v16, v16, v24
  v_add_f32 v17, v17, v25
  v_add_f32 v16, v16, v26
  v_add_f32 v17, v17, v27
  v_add_f32 v16, v16, v28
  v_add_f32 v17, v17, v29
  v_add_f32 v16, v16, v30
  v_add_f32 v17, v17, v31
  v_mov_b32 v18, v16
  v_mov_b32 v19, v17
  s_nop 1
  v_permlane32_swap_b32 v16, v18
  v_permlane32_swap_b32 v17, v19
  s_nop 1
  v_add_f32 v16, v16, v18
  v_add_f32 v17, v17, v19
  v_mul_f32 v16, 0x3acccccd, v16
  v_mul_f32 v17, 0x3acccccd, v17
  v_fma_f32 v17, -v16, v16, v17
  v_max_f32 v17, 0, v17
  v_add_f32 v18, 0x3727c5ac, v17
  v_rsq_f32 v18, v18
  s_cmp_lt_u32 s25, 5
  s_cselect_b32 s46, 0x3ea52b5c, 1.0
  v_mul_f32 v18, s46, v18
  s_nop 0
  v_mul_f32 v19, v18, v16
  v_add_f32 v32, v32, v33
  v_add_f32 v32, v32, v34
  v_add_f32 v32, v32, v35
  v_add_f32 v32, v32, v36
  v_mov_b32 v33, v32
  s_nop 1
  v_permlane32_swap_b32 v32, v33
  s_nop 1
  v_add_f32 v32, v32, v33
  v_cmp_eq_u32 vcc, 0, v3
  s_lshl_b32 s47, s26, 7
  v_lshlrev_b32 v2, 2, v2
  v_add_u32 v2, s47, v2
  v_add_u32 v2, 131072, v2
  v_lshl_add_u32 v2, v3, 9, v2
  v_cndmask_b32 v18, v19, v18, vcc
  ds_write_b32 v2, v18
  ds_write_b32 v2, v32 offset:1024
  s_waitcnt lgkmcnt(0)
  s_add_u32 m0, s44, 49152
  s_add_u32 s45, s43, 8192
  buffer_load_dwordx4 v1, s[12:15], s45 offen offset:0 sc1 lds
  buffer_load_dwordx4 v1, s[12:15], s45 offen offset:1024 sc1 lds
  buffer_load_dwordx4 v1, s[12:15], s45 offen offset:2048 sc1 lds
  buffer_load_dwordx4 v1, s[12:15], s45 offen offset:3072 sc1 lds
  s_add_u32 m0, s44, 65536
  s_add_u32 s45, s43, 12288
  buffer_load_dwordx4 v1, s[12:15], s45 offen offset:0 sc1 lds
  buffer_load_dwordx4 v1, s[12:15], s45 offen offset:1024 sc1 lds
  buffer_load_dwordx4 v1, s[12:15], s45 offen offset:2048 sc1 lds
  buffer_load_dwordx4 v1, s[12:15], s45 offen offset:3072 sc1 lds
  s_waitcnt vmcnt(16)
  s_barrier
  s_add_u32 m0, s42, 0
  s_add_u32 s45, s40, 65536
  buffer_load_dwordx4 v1, s[12:15], s45 offen offset:0 lds
  buffer_load_dwordx4 v1, s[12:15], s45 offen offset:1024 lds
  buffer_load_dwordx4 v1, s[12:15], s45 offen offset:2048 lds
  buffer_load_dwordx4 v1, s[12:15], s45 offen offset:3072 lds
  s_add_u32 m0, s44, 81920
  s_add_u32 s45, s43, 16384
  buffer_load_dwordx4 v1, s[12:15], s45 offen offset:0 sc1 lds
  buffer_load_dwordx4 v1, s[12:15], s45 offen offset:1024 sc1 lds
  buffer_load_dwordx4 v1, s[12:15], s45 offen offset:2048 sc1 lds
  buffer_load_dwordx4 v1, s[12:15], s45 offen offset:3072 sc1 lds
  s_waitcnt vmcnt(12)
  s_barrier
  s_add_u32 m0, s42, 16384
  s_add_u32 s45, s40, 81920
  buffer_load_dwordx4 v1, s[12:15], s45 offen offset:0 lds
  buffer_load_dwordx4 v1, s[12:15], s45 offen offset:1024 lds
  buffer_load_dwordx4 v1, s[12:15], s45 offen offset:2048 lds
  buffer_load_dwordx4 v1, s[12:15], s45 offen offset:3072 lds
  s_add_u32 m0, s44, 98304
  s_add_u32 s45, s43, 20480
  buffer_load_dwordx4 v1, s[12:15], s45 offen offset:0 sc1 lds
  buffer_load_dwordx4 v1, s[12:15], s45 offen offset:1024 sc1 lds
  buffer_load_dwordx4 v1, s[12:15], s45 offen offset:2048 sc1 lds
  buffer_load_dwordx4 v1, s[12:15], s45 offen offset:3072 sc1 lds
  s_waitcnt vmcnt(16)
  s_barrier
  s_add_u32 m0, s42, 32768
  s_add_u32 s45, s40, 98304
  buffer_load_dwordx4 v1, s[12:15], s45 offen offset:0 lds
  buffer_load_dwordx4 v1, s[12:15], s45 offen offset:1024 lds
  buffer_load_dwordx4 v1, s[12:15], s45 offen offset:2048 lds
  buffer_load_dwordx4 v1, s[12:15], s45 offen offset:3072 lds
  s_add_u32 m0, s44, 49152
  s_add_u32 s45, s43, 24576
  buffer_load_dwordx4 v1, s[12:15], s45 offen offset:0 sc1 lds
  buffer_load_dwordx4 v1, s[12:15], s45 offen offset:1024 sc1 lds
  buffer_load_dwordx4 v1, s[12:15], s45 offen offset:2048 sc1 lds
  buffer_load_dwordx4 v1, s[12:15], s45 offen offset:3072 sc1 lds
  s_waitcnt vmcnt(16)
  s_barrier
  s_add_u32 m0, s42, 114688
  s_add_u32 s45, s40, 114688
  buffer_load_dwordx4 v1, s[12:15], s45 offen offset:0 lds
  buffer_load_dwordx4 v1, s[12:15], s45 offen offset:1024 lds
  buffer_load_dwordx4 v1, s[12:15], s45 offen offset:2048 lds
  buffer_load_dwordx4 v1, s[12:15], s45 offen offset:3072 lds
  s_add_u32 m0, s44, 65536
  s_add_u32 s45, s43, 28672
  buffer_load_dwordx4 v1, s[12:15], s45 offen offset:0 sc1 lds
  buffer_load_dwordx4 v1, s[12:15], s45 offen offset:1024 sc1 lds
  buffer_load_dwordx4 v1, s[12:15], s45 offen offset:2048 sc1 lds
  buffer_load_dwordx4 v1, s[12:15], s45 offen offset:3072 sc1 lds
  s_waitcnt vmcnt(16)
  s_barrier
  s_add_u32 m0, s42, 0
  s_add_u32 s45, s40, 131072
  buffer_load_dwordx4 v1, s[12:15], s45 offen offset:0 lds
  buffer_load_dwordx4 v1, s[12:15], s45 offen offset:1024 lds
  buffer_load_dwordx4 v1, s[12:15], s45 offen offset:2048 lds
  buffer_load_dwordx4 v1, s[12:15], s45 offen offset:3072 lds
  s_add_u32 m0, s44, 81920
  s_add_u32 s45, s43, 32768
  buffer_load_dwordx4 v1, s[12:15], s45 offen offset:0 sc1 lds
  buffer_load_dwordx4 v1, s[12:15], s45 offen offset:1024 sc1 lds
  buffer_load_dwordx4 v1, s[12:15], s45 offen offset:2048 sc1 lds
  buffer_load_dwordx4 v1, s[12:15], s45 offen offset:3072 sc1 lds
  s_waitcnt vmcnt(16)
  s_barrier
  s_add_u32 m0, s42, 16384
  s_add_u32 s45, s40, 147456
  buffer_load_dwordx4 v1, s[12:15], s45 offen offset:0 lds
  buffer_load_dwordx4 v1, s[12:15], s45 offen offset:1024 lds
  buffer_load_dwordx4 v1, s[12:15], s45 offen offset:2048 lds
  buffer_load_dwordx4 v1, s[12:15], s45 offen offset:3072 lds
  s_add_u32 m0, s44, 98304
  s_add_u32 s45, s43, 36864
  buffer_load_dwordx4 v1, s[12:15], s45 offen offset:0 sc1 lds
  buffer_load_dwordx4 v1, s[12:15], s45 offen offset:1024 sc1 lds
  buffer_load_dwordx4 v1, s[12:15], s45 offen offset:2048 sc1 lds
  buffer_load_dwordx4 v1, s[12:15], s45 offen offset:3072 sc1 lds
  s_waitcnt vmcnt(16)
  s_barrier
  s_waitcnt vmcnt(8)
  s_barrier
  s_waitcnt vmcnt(0)
  s_barrier
  s_barrier
  s_branch f0_kernel_p5_entry
f0_kernel_p4_compute:
  s_and_b32 s27, s26, 1
  s_lshr_b32 s36, s26, 1
  v_lshrrev_b32 v17, 5, v0
  v_and_b32 v16, 31, v0
  v_mul_u32_u24 v20, 2048, v17
  v_lshl_add_u32 v20, v16, 4, v20
  s_mul_i32 s37, s27, 1024
  v_add_u32 v1, s37, v20
  v_add_u32 v2, 114688, v1
  v_lshlrev_b32 v20, 4, v0
  s_mul_i32 s37, s36, 8192
  s_add_u32 s37, s37, 49152
  v_add_u32 v3, s37, v20
  v_add_u32 v4, 49152, v3
  s_waitcnt lgkmcnt(0)
  s_cmp_ge_u32 s25, 10
  s_cbranch_scc1 f0_kernel_p4_vpath
  s_mov_b32 s48, s6
  s_mov_b32 s49, s7
  s_mov_b32 s50, 0x3200000
  s_mov_b32 s51, 0x00020000
  s_cmp_lt_u32 s25, 5
  s_mov_b32 s37, 46137344
  s_cselect_b32 s37, 42991616, s37
  s_cselect_b32 s38, 0, 5
  s_movk_i32 s39, 2560
  s_cselect_b32 s39, 1280, s39
  s_lshl_b32 s40, s39, 6
  s_sub_u32 s38, s25, s38
  s_lshl_b32 s41, s38, 5
  s_mul_i32 s42, s41, 205
  s_lshr_b32 s42, s42, 10
  s_mul_i32 s54, s42, s40
  s_add_u32 s54, s54, s37
  s_lshl_b32 s41, s24, 2
  s_add_u32 s41, s41, s26
  s_mul_i32 s41, s41, s39
  s_add_u32 s54, s54, s41
  s_mov_b32 s55, s42
  s_mov_b32 s60, s38
  s_barrier
  ds_read_b128 v[128:131], v1 offset:0
  ds_read_b128 v[132:135], v1 offset:512
  ds_read_b128 v[160:163], v3 offset:32768
  ds_read_b128 v[164:167], v3 offset:36864
  s_waitcnt lgkmcnt(0)
  v_mfma_f32_32x32x16_bf16 v[64:79], v[128:131], v[160:163], 0
  ds_read_b128 v[136:139], v1 offset:4096
  ds_read_b128 v[140:143], v1 offset:4608
  v_mfma_f32_32x32x16_bf16 v[80:95], v[128:131], v[164:167], 0
  ds_read_b128 v[168:171], v3 offset:33792
  ds_read_b128 v[172:175], v3 offset:37888
  v_mfma_f32_32x32x16_bf16 v[96:111], v[132:135], v[160:163], 0
  v_mfma_f32_32x32x16_bf16 v[112:127], v[132:135], v[164:167], 0
  s_waitcnt lgkmcnt(0)
  v_mfma_f32_32x32x16_bf16 v[64:79], v[136:139], v[168:171], v[64:79]
  ds_read_b128 v[128:131], v1 offset:8192
  ds_read_b128 v[132:135], v1 offset:8704
  v_mfma_f32_32x32x16_bf16 v[80:95], v[136:139], v[172:175], v[80:95]
  ds_read_b128 v[160:163], v3 offset:34816
  ds_read_b128 v[164:167], v3 offset:38912
  v_mfma_f32_32x32x16_bf16 v[96:111], v[140:143], v[168:171], v[96:111]
  v_mfma_f32_32x32x16_bf16 v[112:127], v[140:143], v[172:175], v[112:127]
  s_waitcnt lgkmcnt(0)
  v_mfma_f32_32x32x16_bf16 v[64:79], v[128:131], v[160:163], v[64:79]
  ds_read_b128 v[136:139], v1 offset:12288
  ds_read_b128 v[140:143], v1 offset:12800
  v_mfma_f32_32x32x16_bf16 v[80:95], v[128:131], v[164:167], v[80:95]
  ds_read_b128 v[168:171], v3 offset:35840
  ds_read_b128 v[172:175], v3 offset:39936
  v_mfma_f32_32x32x16_bf16 v[96:111], v[132:135], v[160:163], v[96:111]
  v_mfma_f32_32x32x16_bf16 v[112:127], v[132:135], v[164:167], v[112:127]
  s_mov_b32 s44, 0x7ffff
  s_cmp_eq_u32 s60, 1
  s_cselect_b32 s44, 0xffffe, s44
  s_cmp_eq_u32 s60, 2
  s_cselect_b32 s44, 0x9ffffc, s44
  s_cmp_eq_u32 s60, 3
  s_cselect_b32 s44, 0x17fffb, s44
  s_cmp_eq_u32 s60, 4
  s_cselect_b32 s44, 0x1ffffa, s44
  v_add_u32 v18, 0, v0
  v_mul_u32_u24 v19, 205, v18
  v_lshrrev_b32 v19, 14, v19
  v_mul_u32_u24 v23, 80, v19
  v_sub_u32 v18, v18, v23
  v_mul_u32_u24 v208, s40, v19
  v_lshl_add_u32 v208, v18, 4, v208
  v_mul_u32_u24 v19, 3, v19
  v_lshrrev_b32 v18, 5, v18
  v_add_u32 v19, v19, v18
  v_bfe_u32 v19, s44, v19, 1
  v_cmp_ne_u32 vcc, 0, v19
  v_mov_b32 v23, 0x80000000
  s_nop 0
  v_cndmask_b32 v208, v23, v208, vcc
  v_add_u32 v18, 64, v0
  v_mul_u32_u24 v19, 205, v18
  v_lshrrev_b32 v19, 14, v19
  v_mul_u32_u24 v23, 80, v19
  v_sub_u32 v18, v18, v23
  v_mul_u32_u24 v209, s40, v19
  v_lshl_add_u32 v209, v18, 4, v209
  v_mul_u32_u24 v19, 3, v19
  v_lshrrev_b32 v18, 5, v18
  v_add_u32 v19, v19, v18
  v_bfe_u32 v19, s44, v19, 1
  v_cmp_ne_u32 vcc, 0, v19
  v_mov_b32 v23, 0x80000000
  s_nop 0
  v_cndmask_b32 v209, v23, v209, vcc
  v_add_u32 v18, 128, v0
  v_mul_u32_u24 v19, 205, v18
  v_lshrrev_b32 v19, 14, v19
  v_mul_u32_u24 v23, 80, v19
  v_sub_u32 v18, v18, v23
  v_mul_u32_u24 v210, s40, v19
  v_lshl_add_u32 v210, v18, 4, v210
  v_mul_u32_u24 v19, 3, v19
  v_lshrrev_b32 v18, 5, v18
  v_add_u32 v19, v19, v18
  v_bfe_u32 v19, s44, v19, 1
  v_cmp_ne_u32 vcc, 0, v19
  v_mov_b32 v23, 0x80000000
  s_nop 0
  v_cndmask_b32 v210, v23, v210, vcc
  v_add_u32 v18, 192, v0
  v_mul_u32_u24 v19, 205, v18
  v_lshrrev_b32 v19, 14, v19
  v_mul_u32_u24 v23, 80, v19
  v_sub_u32 v18, v18, v23
  v_mul_u32_u24 v211, s40, v19
  v_lshl_add_u32 v211, v18, 4, v211
  v_mul_u32_u24 v19, 3, v19
  v_lshrrev_b32 v18, 5, v18
  v_add_u32 v19, v19, v18
  v_bfe_u32 v19, s44, v19, 1
  v_cmp_ne_u32 vcc, 0, v19
  v_mov_b32 v23, 0x80000000
  s_nop 0
  v_cndmask_b32 v211, v23, v211, vcc
  v_add_u32 v18, 256, v0
  v_mul_u32_u24 v19, 205, v18
  v_lshrrev_b32 v19, 14, v19
  v_mul_u32_u24 v23, 80, v19
  v_sub_u32 v18, v18, v23
  v_mul_u32_u24 v212, s40, v19
  v_lshl_add_u32 v212, v18, 4, v212
  v_mul_u32_u24 v19, 3, v19
  v_lshrrev_b32 v18, 5, v18
  v_add_u32 v19, v19, v18
  v_bfe_u32 v19, s44, v19, 1
  v_cmp_ne_u32 vcc, 0, v19
  v_mov_b32 v23, 0x80000000
  s_nop 0
  v_cndmask_b32 v212, v23, v212, vcc
  v_add_u32 v18, 320, v0
  v_mul_u32_u24 v19, 205, v18
  v_lshrrev_b32 v19, 14, v19
  v_mul_u32_u24 v23, 80, v19
  v_sub_u32 v18, v18, v23
  v_mul_u32_u24 v213, s40, v19
  v_lshl_add_u32 v213, v18, 4, v213
  v_mul_u32_u24 v19, 3, v19
  v_lshrrev_b32 v18, 5, v18
  v_add_u32 v19, v19, v18
  v_bfe_u32 v19, s44, v19, 1
  v_cmp_ne_u32 vcc, 0, v19
  v_mov_b32 v23, 0x80000000
  s_nop 0
  v_cndmask_b32 v213, v23, v213, vcc
  v_add_u32 v18, 384, v0
  v_mul_u32_u24 v19, 205, v18
  v_lshrrev_b32 v19, 14, v19
  v_mul_u32_u24 v23, 80, v19
  v_sub_u32 v18, v18, v23
  v_mul_u32_u24 v214, s40, v19
  v_lshl_add_u32 v214, v18, 4, v214
  v_mul_u32_u24 v19, 3, v19
  v_lshrrev_b32 v18, 5, v18
  v_add_u32 v19, v19, v18
  v_bfe_u32 v19, s44, v19, 1
  v_cmp_ne_u32 vcc, 0, v19
  v_mov_b32 v23, 0x80000000
  s_nop 0
  v_cndmask_b32 v214, v23, v214, vcc
  v_add_u32 v18, 448, v0
  v_mul_u32_u24 v19, 205, v18
  v_lshrrev_b32 v19, 14, v19
  v_mul_u32_u24 v23, 80, v19
  v_sub_u32 v18, v18, v23
  v_mul_u32_u24 v215, s40, v19
  v_lshl_add_u32 v215, v18, 4, v215
  v_mul_u32_u24 v19, 3, v19
  v_lshrrev_b32 v18, 5, v18
  v_add_u32 v19, v19, v18
  v_bfe_u32 v19, s44, v19, 1
  v_cmp_ne_u32 vcc, 0, v19
  v_mov_b32 v23, 0x80000000
  s_nop 0
  v_cndmask_b32 v215, v23, v215, vcc
  v_add_u32 v18, 512, v0
  v_mul_u32_u24 v19, 205, v18
  v_lshrrev_b32 v19, 14, v19
  v_mul_u32_u24 v23, 80, v19
  v_sub_u32 v18, v18, v23
  v_mul_u32_u24 v216, s40, v19
  v_lshl_add_u32 v216, v18, 4, v216
  v_mul_u32_u24 v19, 3, v19
  v_lshrrev_b32 v18, 5, v18
  v_add_u32 v19, v19, v18
  v_bfe_u32 v19, s44, v19, 1
  v_cmp_ne_u32 vcc, 0, v19
  v_mov_b32 v23, 0x80000000
  s_nop 0
  v_cndmask_b32 v216, v23, v216, vcc
  v_add_u32 v18, 576, v0
  v_mul_u32_u24 v19, 205, v18
  v_lshrrev_b32 v19, 14, v19
  v_mul_u32_u24 v23, 80, v19
  v_sub_u32 v18, v18, v23
  v_mul_u32_u24 v217, s40, v19
  v_lshl_add_u32 v217, v18, 4, v217
  v_mul_u32_u24 v19, 3, v19
  v_lshrrev_b32 v18, 5, v18
  v_add_u32 v19, v19, v18
  v_bfe_u32 v19, s44, v19, 1
  v_cmp_ne_u32 vcc, 0, v19
  v_mov_b32 v23, 0x80000000
  s_nop 0
  v_cndmask_b32 v217, v23, v217, vcc
  s_lshl_b32 s41, s26, 14
  s_add_u32 s41, s41, 32768
  v_lshlrev_b32 v218, 4, v0
  v_add_u32 v218, s41, v218
  s_lshl_b32 s52, s36, 15
  s_add_u32 s52, s52, 32768
  s_lshl_b32 s38, s60, 5
  s_lshl_b32 s42, s27, 4
  s_add_u32 s38, s38, s42
  v_add_u32 v21, s38, v17
  v_lshlrev_b32 v22, 3, v16
  s_mov_b32 s42, 0x32104
  s_mov_b32 s43, 0x32410
  v_add_u32 v23, 0, v21
  v_mul_u32_u24 v18, 205, v23
  v_lshrrev_b32 v18, 10, v18
  v_mul_u32_u24 v19, 5, v18
  v_sub_u32 v23, v23, v19
  v_cmp_eq_u32 vcc, 19, v18
  v_mov_b32 v19, 0x43210
  v_mov_b32 v20, s42
  v_cndmask_b32 v19, v19, v20, vcc
  v_cmp_eq_u32 vcc, 25, v18
  v_mov_b32 v20, s43
  v_lshlrev_b32 v23, 2, v23
  v_cndmask_b32 v19, v19, v20, vcc
  v_bfe_u32 v23, v19, v23, 4
  v_subrev_u32 v18, s55, v18
  v_mul_u32_u24 v18, 1280, v18
  v_cmp_gt_u32 vcc, 4, v23
  v_lshrrev_b32 v19, 1, v23
  v_lshl_add_u32 v18, v19, 9, v18
  v_and_b32 v19, 1, v23
  v_lshl_add_u32 v18, v19, 3, v18
  v_cndmask_b32 v19, 0, v22, vcc
  v_add_u32 v18, v18, v22
  v_add_u32 v18, v18, v19
  v_add_u32 v24, s52, v18
  v_add_u32 v23, 2, v21
  v_mul_u32_u24 v18, 205, v23
  v_lshrrev_b32 v18, 10, v18
  v_mul_u32_u24 v19, 5, v18
  v_sub_u32 v23, v23, v19
  v_cmp_eq_u32 vcc, 19, v18
  v_mov_b32 v19, 0x43210
  v_mov_b32 v20, s42
  v_cndmask_b32 v19, v19, v20, vcc
  v_cmp_eq_u32 vcc, 25, v18
  v_mov_b32 v20, s43
  v_lshlrev_b32 v23, 2, v23
  v_cndmask_b32 v19, v19, v20, vcc
  v_bfe_u32 v23, v19, v23, 4
  v_subrev_u32 v18, s55, v18
  v_mul_u32_u24 v18, 1280, v18
  v_cmp_gt_u32 vcc, 4, v23
  v_lshrrev_b32 v19, 1, v23
  v_lshl_add_u32 v18, v19, 9, v18
  v_and_b32 v19, 1, v23
  v_lshl_add_u32 v18, v19, 3, v18
  v_cndmask_b32 v19, 0, v22, vcc
  v_add_u32 v18, v18, v22
  v_add_u32 v18, v18, v19
  v_add_u32 v25, s52, v18
  v_add_u32 v23, 4, v21
  v_mul_u32_u24 v18, 205, v23
  v_lshrrev_b32 v18, 10, v18
  v_mul_u32_u24 v19, 5, v18
  v_sub_u32 v23, v23, v19
  v_cmp_eq_u32 vcc, 19, v18
  v_mov_b32 v19, 0x43210
  v_mov_b32 v20, s42
  v_cndmask_b32 v19, v19, v20, vcc
  v_cmp_eq_u32 vcc, 25, v18
  v_mov_b32 v20, s43
  v_lshlrev_b32 v23, 2, v23
  v_cndmask_b32 v19, v19, v20, vcc
  v_bfe_u32 v23, v19, v23, 4
  v_subrev_u32 v18, s55, v18
  v_mul_u32_u24 v18, 1280, v18
  v_cmp_gt_u32 vcc, 4, v23
  v_lshrrev_b32 v19, 1, v23
  v_lshl_add_u32 v18, v19, 9, v18
  v_and_b32 v19, 1, v23
  v_lshl_add_u32 v18, v19, 3, v18
  v_cndmask_b32 v19, 0, v22, vcc
  v_add_u32 v18, v18, v22
  v_add_u32 v18, v18, v19
  v_add_u32 v26, s52, v18
  v_add_u32 v23, 6, v21
  v_mul_u32_u24 v18, 205, v23
  v_lshrrev_b32 v18, 10, v18
  v_mul_u32_u24 v19, 5, v18
  v_sub_u32 v23, v23, v19
  v_cmp_eq_u32 vcc, 19, v18
  v_mov_b32 v19, 0x43210
  v_mov_b32 v20, s42
  v_cndmask_b32 v19, v19, v20, vcc
  v_cmp_eq_u32 vcc, 25, v18
  v_mov_b32 v20, s43
  v_lshlrev_b32 v23, 2, v23
  v_cndmask_b32 v19, v19, v20, vcc
  v_bfe_u32 v23, v19, v23, 4
  v_subrev_u32 v18, s55, v18
  v_mul_u32_u24 v18, 1280, v18
  v_cmp_gt_u32 vcc, 4, v23
  v_lshrrev_b32 v19, 1, v23
  v_lshl_add_u32 v18, v19, 9, v18
  v_and_b32 v19, 1, v23
  v_lshl_add_u32 v18, v19, 3, v18
  v_cndmask_b32 v19, 0, v22, vcc
  v_add_u32 v18, v18, v22
  v_add_u32 v18, v18, v19
  v_add_u32 v27, s52, v18
  v_add_u32 v23, 8, v21
  v_mul_u32_u24 v18, 205, v23
  v_lshrrev_b32 v18, 10, v18
  v_mul_u32_u24 v19, 5, v18
  v_sub_u32 v23, v23, v19
  v_cmp_eq_u32 vcc, 19, v18
  v_mov_b32 v19, 0x43210
  v_mov_b32 v20, s42
  v_cndmask_b32 v19, v19, v20, vcc
  v_cmp_eq_u32 vcc, 25, v18
  v_mov_b32 v20, s43
  v_lshlrev_b32 v23, 2, v23
  v_cndmask_b32 v19, v19, v20, vcc
  v_bfe_u32 v23, v19, v23, 4
  v_subrev_u32 v18, s55, v18
  v_mul_u32_u24 v18, 1280, v18
  v_cmp_gt_u32 vcc, 4, v23
  v_lshrrev_b32 v19, 1, v23
  v_lshl_add_u32 v18, v19, 9, v18
  v_and_b32 v19, 1, v23
  v_lshl_add_u32 v18, v19, 3, v18
  v_cndmask_b32 v19, 0, v22, vcc
  v_add_u32 v18, v18, v22
  v_add_u32 v18, v18, v19
  v_add_u32 v28, s52, v18
  v_add_u32 v23, 10, v21
  v_mul_u32_u24 v18, 205, v23
  v_lshrrev_b32 v18, 10, v18
  v_mul_u32_u24 v19, 5, v18
  v_sub_u32 v23, v23, v19
  v_cmp_eq_u32 vcc, 19, v18
  v_mov_b32 v19, 0x43210
  v_mov_b32 v20, s42
  v_cndmask_b32 v19, v19, v20, vcc
  v_cmp_eq_u32 vcc, 25, v18
  v_mov_b32 v20, s43
  v_lshlrev_b32 v23, 2, v23
  v_cndmask_b32 v19, v19, v20, vcc
  v_bfe_u32 v23, v19, v23, 4
  v_subrev_u32 v18, s55, v18
  v_mul_u32_u24 v18, 1280, v18
  v_cmp_gt_u32 vcc, 4, v23
  v_lshrrev_b32 v19, 1, v23
  v_lshl_add_u32 v18, v19, 9, v18
  v_and_b32 v19, 1, v23
  v_lshl_add_u32 v18, v19, 3, v18
  v_cndmask_b32 v19, 0, v22, vcc
  v_add_u32 v18, v18, v22
  v_add_u32 v18, v18, v19
  v_add_u32 v29, s52, v18
  v_add_u32 v23, 12, v21
  v_mul_u32_u24 v18, 205, v23
  v_lshrrev_b32 v18, 10, v18
  v_mul_u32_u24 v19, 5, v18
  v_sub_u32 v23, v23, v19
  v_cmp_eq_u32 vcc, 19, v18
  v_mov_b32 v19, 0x43210
  v_mov_b32 v20, s42
  v_cndmask_b32 v19, v19, v20, vcc
  v_cmp_eq_u32 vcc, 25, v18
  v_mov_b32 v20, s43
  v_lshlrev_b32 v23, 2, v23
  v_cndmask_b32 v19, v19, v20, vcc
  v_bfe_u32 v23, v19, v23, 4
  v_subrev_u32 v18, s55, v18
  v_mul_u32_u24 v18, 1280, v18
  v_cmp_gt_u32 vcc, 4, v23
  v_lshrrev_b32 v19, 1, v23
  v_lshl_add_u32 v18, v19, 9, v18
  v_and_b32 v19, 1, v23
  v_lshl_add_u32 v18, v19, 3, v18
  v_cndmask_b32 v19, 0, v22, vcc
  v_add_u32 v18, v18, v22
  v_add_u32 v18, v18, v19
  v_add_u32 v30, s52, v18
  v_add_u32 v23, 14, v21
  v_mul_u32_u24 v18, 205, v23
  v_lshrrev_b32 v18, 10, v18
  v_mul_u32_u24 v19, 5, v18
  v_sub_u32 v23, v23, v19
  v_cmp_eq_u32 vcc, 19, v18
  v_mov_b32 v19, 0x43210
  v_mov_b32 v20, s42
  v_cndmask_b32 v19, v19, v20, vcc
  v_cmp_eq_u32 vcc, 25, v18
  v_mov_b32 v20, s43
  v_lshlrev_b32 v23, 2, v23
  v_cndmask_b32 v19, v19, v20, vcc
  v_bfe_u32 v23, v19, v23, 4
  v_subrev_u32 v18, s55, v18
  v_mul_u32_u24 v18, 1280, v18
  v_cmp_gt_u32 vcc, 4, v23
  v_lshrrev_b32 v19, 1, v23
  v_lshl_add_u32 v18, v19, 9, v18
  v_and_b32 v19, 1, v23
  v_lshl_add_u32 v18, v19, 3, v18
  v_cndmask_b32 v19, 0, v22, vcc
  v_add_u32 v18, v18, v22
  v_add_u32 v18, v18, v19
  v_add_u32 v31, s52, v18
  s_waitcnt lgkmcnt(0)
  s_barrier
  v_mfma_f32_32x32x16_bf16 v[64:79], v[136:139], v[168:171], v[64:79]
  ds_read_b128 v[128:131], v1 offset:16384
  ds_read_b128 v[132:135], v1 offset:16896
  v_mfma_f32_32x32x16_bf16 v[80:95], v[136:139], v[172:175], v[80:95]
  ds_read_b128 v[160:163], v4 offset:0
  ds_read_b128 v[164:167], v4 offset:4096
  v_mfma_f32_32x32x16_bf16 v[96:111], v[140:143], v[168:171], v[96:111]
  v_mfma_f32_32x32x16_bf16 v[112:127], v[140:143], v[172:175], v[112:127]
  s_waitcnt lgkmcnt(0)
  v_mfma_f32_32x32x16_bf16 v[64:79], v[128:131], v[160:163], v[64:79]
  ds_read_b128 v[136:139], v1 offset:20480
  ds_read_b128 v[140:143], v1 offset:20992
  v_mfma_f32_32x32x16_bf16 v[80:95], v[128:131], v[164:167], v[80:95]
  ds_read_b128 v[168:171], v4 offset:1024
  ds_read_b128 v[172:175], v4 offset:5120
  v_mfma_f32_32x32x16_bf16 v[96:111], v[132:135], v[160:163], v[96:111]
  v_mfma_f32_32x32x16_bf16 v[112:127], v[132:135], v[164:167], v[112:127]
  s_waitcnt lgkmcnt(0)
  v_mfma_f32_32x32x16_bf16 v[64:79], v[136:139], v[168:171], v[64:79]
  ds_read_b128 v[128:131], v1 offset:24576
  ds_read_b128 v[132:135], v1 offset:25088
  v_mfma_f32_32x32x16_bf16 v[80:95], v[136:139], v[172:175], v[80:95]
  ds_read_b128 v[160:163], v4 offset:2048
  ds_read_b128 v[164:167], v4 offset:6144
  v_mfma_f32_32x32x16_bf16 v[96:111], v[140:143], v[168:171], v[96:111]
  v_mfma_f32_32x32x16_bf16 v[112:127], v[140:143], v[172:175], v[112:127]
  s_waitcnt lgkmcnt(0)
  v_mfma_f32_32x32x16_bf16 v[64:79], v[128:131], v[160:163], v[64:79]
  ds_read_b128 v[136:139], v1 offset:28672
  ds_read_b128 v[140:143], v1 offset:29184
  v_mfma_f32_32x32x16_bf16 v[80:95], v[128:131], v[164:167], v[80:95]
  ds_read_b128 v[168:171], v4 offset:3072
  ds_read_b128 v[172:175], v4 offset:7168
  v_mfma_f32_32x32x16_bf16 v[96:111], v[132:135], v[160:163], v[96:111]
  v_mfma_f32_32x32x16_bf16 v[112:127], v[132:135], v[164:167], v[112:127]
  s_waitcnt lgkmcnt(0)
  s_barrier
  v_mfma_f32_32x32x16_bf16 v[64:79], v[136:139], v[168:171], v[64:79]
  ds_read_b128 v[128:131], v1 offset:32768
  ds_read_b128 v[132:135], v1 offset:33280
  v_mfma_f32_32x32x16_bf16 v[80:95], v[136:139], v[172:175], v[80:95]
  ds_read_b128 v[160:163], v3 offset:0
  ds_read_b128 v[164:167], v3 offset:4096
  v_mfma_f32_32x32x16_bf16 v[96:111], v[140:143], v[168:171], v[96:111]
  v_mfma_f32_32x32x16_bf16 v[112:127], v[140:143], v[172:175], v[112:127]
  s_waitcnt lgkmcnt(0)
  v_mfma_f32_32x32x16_bf16 v[64:79], v[128:131], v[160:163], v[64:79]
  ds_read_b128 v[136:139], v1 offset:36864
  ds_read_b128 v[140:143], v1 offset:37376
  v_mfma_f32_32x32x16_bf16 v[80:95], v[128:131], v[164:167], v[80:95]
  ds_read_b128 v[168:171], v3 offset:1024
  ds_read_b128 v[172:175], v3 offset:5120
  v_mfma_f32_32x32x16_bf16 v[96:111], v[132:135], v[160:163], v[96:111]
  v_mfma_f32_32x32x16_bf16 v[112:127], v[132:135], v[164:167], v[112:127]
  s_waitcnt lgkmcnt(0)
  v_mfma_f32_32x32x16_bf16 v[64:79], v[136:139], v[168:171], v[64:79]
  ds_read_b128 v[128:131], v1 offset:40960
  ds_read_b128 v[132:135], v1 offset:41472
  v_mfma_f32_32x32x16_bf16 v[80:95], v[136:139], v[172:175], v[80:95]
  ds_read_b128 v[160:163], v3 offset:2048
  ds_read_b128 v[164:167], v3 offset:6144
  v_mfma_f32_32x32x16_bf16 v[96:111], v[140:143], v[168:171], v[96:111]
  v_mfma_f32_32x32x16_bf16 v[112:127], v[140:143], v[172:175], v[112:127]
  s_waitcnt lgkmcnt(0)
  v_mfma_f32_32x32x16_bf16 v[64:79], v[128:131], v[160:163], v[64:79]
  ds_read_b128 v[136:139], v1 offset:45056
  ds_read_b128 v[140:143], v1 offset:45568
  v_mfma_f32_32x32x16_bf16 v[80:95], v[128:131], v[164:167], v[80:95]
  ds_read_b128 v[168:171], v3 offset:3072
  ds_read_b128 v[172:175], v3 offset:7168
  v_mfma_f32_32x32x16_bf16 v[96:111], v[132:135], v[160:163], v[96:111]
  v_mfma_f32_32x32x16_bf16 v[112:127], v[132:135], v[164:167], v[112:127]
  s_waitcnt lgkmcnt(0)
  s_barrier
  v_mfma_f32_32x32x16_bf16 v[64:79], v[136:139], v[168:171], v[64:79]
  ds_read_b128 v[128:131], v2 offset:0
  ds_read_b128 v[132:135], v2 offset:512
  v_mfma_f32_32x32x16_bf16 v[80:95], v[136:139], v[172:175], v[80:95]
  ds_read_b128 v[160:163], v3 offset:16384
  ds_read_b128 v[164:167], v3 offset:20480
  v_mfma_f32_32x32x16_bf16 v[96:111], v[140:143], v[168:171], v[96:111]
  v_mfma_f32_32x32x16_bf16 v[112:127], v[140:143], v[172:175], v[112:127]
  s_waitcnt lgkmcnt(0)
  v_mfma_f32_32x32x16_bf16 v[64:79], v[128:131], v[160:163], v[64:79]
  ds_read_b128 v[136:139], v2 offset:4096
  ds_read_b128 v[140:143], v2 offset:4608
  v_mfma_f32_32x32x16_bf16 v[80:95], v[128:131], v[164:167], v[80:95]
  ds_read_b128 v[168:171], v3 offset:17408
  ds_read_b128 v[172:175], v3 offset:21504
  v_mfma_f32_32x32x16_bf16 v[96:111], v[132:135], v[160:163], v[96:111]
  v_mfma_f32_32x32x16_bf16 v[112:127], v[132:135], v[164:167], v[112:127]
  s_waitcnt lgkmcnt(0)
  v_mfma_f32_32x32x16_bf16 v[64:79], v[136:139], v[168:171], v[64:79]
  ds_read_b128 v[128:131], v2 offset:8192
  ds_read_b128 v[132:135], v2 offset:8704
  v_mfma_f32_32x32x16_bf16 v[80:95], v[136:139], v[172:175], v[80:95]
  ds_read_b128 v[160:163], v3 offset:18432
  ds_read_b128 v[164:167], v3 offset:22528
  v_mfma_f32_32x32x16_bf16 v[96:111], v[140:143], v[168:171], v[96:111]
  v_mfma_f32_32x32x16_bf16 v[112:127], v[140:143], v[172:175], v[112:127]
  s_waitcnt lgkmcnt(0)
  v_mfma_f32_32x32x16_bf16 v[64:79], v[128:131], v[160:163], v[64:79]
  ds_read_b128 v[136:139], v2 offset:12288
  ds_read_b128 v[140:143], v2 offset:12800
  v_mfma_f32_32x32x16_bf16 v[80:95], v[128:131], v[164:167], v[80:95]
  ds_read_b128 v[168:171], v3 offset:19456
  ds_read_b128 v[172:175], v3 offset:23552
  v_mfma_f32_32x32x16_bf16 v[96:111], v[132:135], v[160:163], v[96:111]
  v_mfma_f32_32x32x16_bf16 v[112:127], v[132:135], v[164:167], v[112:127]
  s_waitcnt lgkmcnt(0)
  s_barrier
  v_mfma_f32_32x32x16_bf16 v[64:79], v[136:139], v[168:171], v[64:79]
  ds_read_b128 v[128:131], v1 offset:0
  ds_read_b128 v[132:135], v1 offset:512
  v_mfma_f32_32x32x16_bf16 v[80:95], v[136:139], v[172:175], v[80:95]
  ds_read_b128 v[160:163], v3 offset:32768
  ds_read_b128 v[164:167], v3 offset:36864
  v_mfma_f32_32x32x16_bf16 v[96:111], v[140:143], v[168:171], v[96:111]
  v_mfma_f32_32x32x16_bf16 v[112:127], v[140:143], v[172:175], v[112:127]
  s_waitcnt lgkmcnt(0)
  v_mfma_f32_32x32x16_bf16 v[64:79], v[128:131], v[160:163], v[64:79]
  ds_read_b128 v[136:139], v1 offset:4096
  ds_read_b128 v[140:143], v1 offset:4608
  v_mfma_f32_32x32x16_bf16 v[80:95], v[128:131], v[164:167], v[80:95]
  ds_read_b128 v[168:171], v3 offset:33792
  ds_read_b128 v[172:175], v3 offset:37888
  v_mfma_f32_32x32x16_bf16 v[96:111], v[132:135], v[160:163], v[96:111]
  v_mfma_f32_32x32x16_bf16 v[112:127], v[132:135], v[164:167], v[112:127]
  s_waitcnt lgkmcnt(0)
  v_mfma_f32_32x32x16_bf16 v[64:79], v[136:139], v[168:171], v[64:79]
  ds_read_b128 v[128:131], v1 offset:8192
  ds_read_b128 v[132:135], v1 offset:8704
  v_mfma_f32_32x32x16_bf16 v[80:95], v[136:139], v[172:175], v[80:95]
  ds_read_b128 v[160:163], v3 offset:34816
  ds_read_b128 v[164:167], v3 offset:38912
  v_mfma_f32_32x32x16_bf16 v[96:111], v[140:143], v[168:171], v[96:111]
  v_mfma_f32_32x32x16_bf16 v[112:127], v[140:143], v[172:175], v[112:127]
  s_waitcnt lgkmcnt(0)
  v_mfma_f32_32x32x16_bf16 v[64:79], v[128:131], v[160:163], v[64:79]
  ds_read_b128 v[136:139], v1 offset:12288
  ds_read_b128 v[140:143], v1 offset:12800
  v_mfma_f32_32x32x16_bf16 v[80:95], v[128:131], v[164:167], v[80:95]
  ds_read_b128 v[168:171], v3 offset:35840
  ds_read_b128 v[172:175], v3 offset:39936
  v_mfma_f32_32x32x16_bf16 v[96:111], v[132:135], v[160:163], v[96:111]
  v_mfma_f32_32x32x16_bf16 v[112:127], v[132:135], v[164:167], v[112:127]
  s_waitcnt lgkmcnt(0)
  s_barrier
  v_mfma_f32_32x32x16_bf16 v[64:79], v[136:139], v[168:171], v[64:79]
  ds_read_b128 v[128:131], v1 offset:16384
  ds_read_b128 v[132:135], v1 offset:16896
  v_mfma_f32_32x32x16_bf16 v[80:95], v[136:139], v[172:175], v[80:95]
  ds_read_b128 v[160:163], v4 offset:0
  ds_read_b128 v[164:167], v4 offset:4096
  v_mfma_f32_32x32x16_bf16 v[96:111], v[140:143], v[168:171], v[96:111]
  v_mfma_f32_32x32x16_bf16 v[112:127], v[140:143], v[172:175], v[112:127]
  s_waitcnt lgkmcnt(0)
  v_mfma_f32_32x32x16_bf16 v[64:79], v[128:131], v[160:163], v[64:79]
  ds_read_b128 v[136:139], v1 offset:20480
  ds_read_b128 v[140:143], v1 offset:20992
  v_mfma_f32_32x32x16_bf16 v[80:95], v[128:131], v[164:167], v[80:95]
  ds_read_b128 v[168:171], v4 offset:1024
  ds_read_b128 v[172:175], v4 offset:5120
  v_mfma_f32_32x32x16_bf16 v[96:111], v[132:135], v[160:163], v[96:111]
  v_mfma_f32_32x32x16_bf16 v[112:127], v[132:135], v[164:167], v[112:127]
  s_waitcnt lgkmcnt(0)
  v_mfma_f32_32x32x16_bf16 v[64:79], v[136:139], v[168:171], v[64:79]
  ds_read_b128 v[128:131], v1 offset:24576
  ds_read_b128 v[132:135], v1 offset:25088
  v_mfma_f32_32x32x16_bf16 v[80:95], v[136:139], v[172:175], v[80:95]
  ds_read_b128 v[160:163], v4 offset:2048
  ds_read_b128 v[164:167], v4 offset:6144
  v_mfma_f32_32x32x16_bf16 v[96:111], v[140:143], v[168:171], v[96:111]
  v_mfma_f32_32x32x16_bf16 v[112:127], v[140:143], v[172:175], v[112:127]
  s_waitcnt lgkmcnt(0)
  v_mfma_f32_32x32x16_bf16 v[64:79], v[128:131], v[160:163], v[64:79]
  ds_read_b128 v[136:139], v1 offset:28672
  ds_read_b128 v[140:143], v1 offset:29184
  v_mfma_f32_32x32x16_bf16 v[80:95], v[128:131], v[164:167], v[80:95]
  ds_read_b128 v[168:171], v4 offset:3072
  ds_read_b128 v[172:175], v4 offset:7168
  v_mfma_f32_32x32x16_bf16 v[96:111], v[132:135], v[160:163], v[96:111]
  v_mfma_f32_32x32x16_bf16 v[112:127], v[132:135], v[164:167], v[112:127]
  s_waitcnt lgkmcnt(0)
  s_barrier
  v_mfma_f32_32x32x16_bf16 v[64:79], v[136:139], v[168:171], v[64:79]
  ds_read_b128 v[128:131], v1 offset:32768
  ds_read_b128 v[132:135], v1 offset:33280
  v_mfma_f32_32x32x16_bf16 v[80:95], v[136:139], v[172:175], v[80:95]
  ds_read_b128 v[160:163], v3 offset:0
  ds_read_b128 v[164:167], v3 offset:4096
  v_mfma_f32_32x32x16_bf16 v[96:111], v[140:143], v[168:171], v[96:111]
  v_mfma_f32_32x32x16_bf16 v[112:127], v[140:143], v[172:175], v[112:127]
  s_waitcnt lgkmcnt(0)
  v_mfma_f32_32x32x16_bf16 v[64:79], v[128:131], v[160:163], v[64:79]
  ds_read_b128 v[136:139], v1 offset:36864
  ds_read_b128 v[140:143], v1 offset:37376
  v_mfma_f32_32x32x16_bf16 v[80:95], v[128:131], v[164:167], v[80:95]
  ds_read_b128 v[168:171], v3 offset:1024
  ds_read_b128 v[172:175], v3 offset:5120
  v_mfma_f32_32x32x16_bf16 v[96:111], v[132:135], v[160:163], v[96:111]
  v_mfma_f32_32x32x16_bf16 v[112:127], v[132:135], v[164:167], v[112:127]
  s_waitcnt lgkmcnt(0)
  v_mfma_f32_32x32x16_bf16 v[64:79], v[136:139], v[168:171], v[64:79]
  ds_read_b128 v[128:131], v1 offset:40960
  ds_read_b128 v[132:135], v1 offset:41472
  v_mfma_f32_32x32x16_bf16 v[80:95], v[136:139], v[172:175], v[80:95]
  ds_read_b128 v[160:163], v3 offset:2048
  ds_read_b128 v[164:167], v3 offset:6144
  v_mfma_f32_32x32x16_bf16 v[96:111], v[140:143], v[168:171], v[96:111]
  v_mfma_f32_32x32x16_bf16 v[112:127], v[140:143], v[172:175], v[112:127]
  s_waitcnt lgkmcnt(0)
  v_mfma_f32_32x32x16_bf16 v[64:79], v[128:131], v[160:163], v[64:79]
  ds_read_b128 v[136:139], v1 offset:45056
  ds_read_b128 v[140:143], v1 offset:45568
  v_mfma_f32_32x32x16_bf16 v[80:95], v[128:131], v[164:167], v[80:95]
  ds_read_b128 v[168:171], v3 offset:3072
  ds_read_b128 v[172:175], v3 offset:7168
  v_mfma_f32_32x32x16_bf16 v[96:111], v[132:135], v[160:163], v[96:111]
  v_mfma_f32_32x32x16_bf16 v[112:127], v[132:135], v[164:167], v[112:127]
  s_waitcnt lgkmcnt(0)
  s_barrier
  v_mfma_f32_32x32x16_bf16 v[64:79], v[136:139], v[168:171], v[64:79]
  ds_read_b128 v[128:131], v2 offset:0
  ds_read_b128 v[132:135], v2 offset:512
  v_mfma_f32_32x32x16_bf16 v[80:95], v[136:139], v[172:175], v[80:95]
  ds_read_b128 v[160:163], v3 offset:16384
  ds_read_b128 v[164:167], v3 offset:20480
  v_mfma_f32_32x32x16_bf16 v[96:111], v[140:143], v[168:171], v[96:111]
  v_mfma_f32_32x32x16_bf16 v[112:127], v[140:143], v[172:175], v[112:127]
  s_waitcnt lgkmcnt(0)
  v_mfma_f32_32x32x16_bf16 v[64:79], v[128:131], v[160:163], v[64:79]
  ds_read_b128 v[136:139], v2 offset:4096
  ds_read_b128 v[140:143], v2 offset:4608
  v_mfma_f32_32x32x16_bf16 v[80:95], v[128:131], v[164:167], v[80:95]
  ds_read_b128 v[168:171], v3 offset:17408
  ds_read_b128 v[172:175], v3 offset:21504
  v_mfma_f32_32x32x16_bf16 v[96:111], v[132:135], v[160:163], v[96:111]
  v_mfma_f32_32x32x16_bf16 v[112:127], v[132:135], v[164:167], v[112:127]
  s_waitcnt lgkmcnt(0)
  v_mfma_f32_32x32x16_bf16 v[64:79], v[136:139], v[168:171], v[64:79]
  ds_read_b128 v[128:131], v2 offset:8192
  ds_read_b128 v[132:135], v2 offset:8704
  v_mfma_f32_32x32x16_bf16 v[80:95], v[136:139], v[172:175], v[80:95]
  ds_read_b128 v[160:163], v3 offset:18432
  ds_read_b128 v[164:167], v3 offset:22528
  v_mfma_f32_32x32x16_bf16 v[96:111], v[140:143], v[168:171], v[96:111]
  v_mfma_f32_32x32x16_bf16 v[112:127], v[140:143], v[172:175], v[112:127]
  s_waitcnt lgkmcnt(0)
  v_mfma_f32_32x32x16_bf16 v[64:79], v[128:131], v[160:163], v[64:79]
  ds_read_b128 v[136:139], v2 offset:12288
  ds_read_b128 v[140:143], v2 offset:12800
  v_mfma_f32_32x32x16_bf16 v[80:95], v[128:131], v[164:167], v[80:95]
  ds_read_b128 v[168:171], v3 offset:19456
  ds_read_b128 v[172:175], v3 offset:23552
  v_mfma_f32_32x32x16_bf16 v[96:111], v[132:135], v[160:163], v[96:111]
  v_mfma_f32_32x32x16_bf16 v[112:127], v[132:135], v[164:167], v[112:127]
  s_waitcnt lgkmcnt(0)
  s_barrier
  v_mfma_f32_32x32x16_bf16 v[64:79], v[136:139], v[168:171], v[64:79]
  ds_read_b128 v[128:131], v1 offset:0
  ds_read_b128 v[132:135], v1 offset:512
  v_mfma_f32_32x32x16_bf16 v[80:95], v[136:139], v[172:175], v[80:95]
  ds_read_b128 v[160:163], v3 offset:32768
  ds_read_b128 v[164:167], v3 offset:36864
  v_mfma_f32_32x32x16_bf16 v[96:111], v[140:143], v[168:171], v[96:111]
  v_mfma_f32_32x32x16_bf16 v[112:127], v[140:143], v[172:175], v[112:127]
  s_waitcnt lgkmcnt(0)
  v_mfma_f32_32x32x16_bf16 v[64:79], v[128:131], v[160:163], v[64:79]
  ds_read_b128 v[136:139], v1 offset:4096
  ds_read_b128 v[140:143], v1 offset:4608
  v_mfma_f32_32x32x16_bf16 v[80:95], v[128:131], v[164:167], v[80:95]
  ds_read_b128 v[168:171], v3 offset:33792
  ds_read_b128 v[172:175], v3 offset:37888
  v_mfma_f32_32x32x16_bf16 v[96:111], v[132:135], v[160:163], v[96:111]
  v_mfma_f32_32x32x16_bf16 v[112:127], v[132:135], v[164:167], v[112:127]
  s_waitcnt lgkmcnt(0)
  v_mfma_f32_32x32x16_bf16 v[64:79], v[136:139], v[168:171], v[64:79]
  ds_read_b128 v[128:131], v1 offset:8192
  ds_read_b128 v[132:135], v1 offset:8704
  v_mfma_f32_32x32x16_bf16 v[80:95], v[136:139], v[172:175], v[80:95]
  ds_read_b128 v[160:163], v3 offset:34816
  ds_read_b128 v[164:167], v3 offset:38912
  v_mfma_f32_32x32x16_bf16 v[96:111], v[140:143], v[168:171], v[96:111]
  v_mfma_f32_32x32x16_bf16 v[112:127], v[140:143], v[172:175], v[112:127]
  s_waitcnt lgkmcnt(0)
  v_mfma_f32_32x32x16_bf16 v[64:79], v[128:131], v[160:163], v[64:79]
  ds_read_b128 v[136:139], v1 offset:12288
  ds_read_b128 v[140:143], v1 offset:12800
  v_mfma_f32_32x32x16_bf16 v[80:95], v[128:131], v[164:167], v[80:95]
  ds_read_b128 v[168:171], v3 offset:35840
  ds_read_b128 v[172:175], v3 offset:39936
  v_mfma_f32_32x32x16_bf16 v[96:111], v[132:135], v[160:163], v[96:111]
  v_mfma_f32_32x32x16_bf16 v[112:127], v[132:135], v[164:167], v[112:127]
  s_waitcnt lgkmcnt(0)
  s_barrier
  v_mfma_f32_32x32x16_bf16 v[64:79], v[136:139], v[168:171], v[64:79]
  ds_read_b128 v[128:131], v1 offset:16384
  ds_read_b128 v[132:135], v1 offset:16896
  v_mfma_f32_32x32x16_bf16 v[80:95], v[136:139], v[172:175], v[80:95]
  ds_read_b128 v[160:163], v4 offset:0
  ds_read_b128 v[164:167], v4 offset:4096
  v_mfma_f32_32x32x16_bf16 v[96:111], v[140:143], v[168:171], v[96:111]
  v_mfma_f32_32x32x16_bf16 v[112:127], v[140:143], v[172:175], v[112:127]
  s_waitcnt lgkmcnt(0)
  v_mfma_f32_32x32x16_bf16 v[64:79], v[128:131], v[160:163], v[64:79]
  ds_read_b128 v[136:139], v1 offset:20480
  ds_read_b128 v[140:143], v1 offset:20992
  v_mfma_f32_32x32x16_bf16 v[80:95], v[128:131], v[164:167], v[80:95]
  ds_read_b128 v[168:171], v4 offset:1024
  ds_read_b128 v[172:175], v4 offset:5120
  v_mfma_f32_32x32x16_bf16 v[96:111], v[132:135], v[160:163], v[96:111]
  v_mfma_f32_32x32x16_bf16 v[112:127], v[132:135], v[164:167], v[112:127]
  s_waitcnt lgkmcnt(0)
  v_mfma_f32_32x32x16_bf16 v[64:79], v[136:139], v[168:171], v[64:79]
  ds_read_b128 v[128:131], v1 offset:24576
  ds_read_b128 v[132:135], v1 offset:25088
  v_mfma_f32_32x32x16_bf16 v[80:95], v[136:139], v[172:175], v[80:95]
  ds_read_b128 v[160:163], v4 offset:2048
  ds_read_b128 v[164:167], v4 offset:6144
  v_mfma_f32_32x32x16_bf16 v[96:111], v[140:143], v[168:171], v[96:111]
  v_mfma_f32_32x32x16_bf16 v[112:127], v[140:143], v[172:175], v[112:127]
  s_waitcnt lgkmcnt(0)
  v_mfma_f32_32x32x16_bf16 v[64:79], v[128:131], v[160:163], v[64:79]
  ds_read_b128 v[136:139], v1 offset:28672
  ds_read_b128 v[140:143], v1 offset:29184
  v_mfma_f32_32x32x16_bf16 v[80:95], v[128:131], v[164:167], v[80:95]
  ds_read_b128 v[168:171], v4 offset:3072
  ds_read_b128 v[172:175], v4 offset:7168
  v_mfma_f32_32x32x16_bf16 v[96:111], v[132:135], v[160:163], v[96:111]
  v_mfma_f32_32x32x16_bf16 v[112:127], v[132:135], v[164:167], v[112:127]
  s_waitcnt lgkmcnt(0)
  v_mfma_f32_32x32x16_bf16 v[64:79], v[136:139], v[168:171], v[64:79]
  v_mfma_f32_32x32x16_bf16 v[80:95], v[136:139], v[172:175], v[80:95]
  v_mfma_f32_32x32x16_bf16 v[96:111], v[140:143], v[168:171], v[96:111]
  v_mfma_f32_32x32x16_bf16 v[112:127], v[140:143], v[172:175], v[112:127]
  s_mul_i32 s37, s36, 256
  v_lshlrev_b32 v20, 2, v16
  v_add_u32 v20, s37, v20
  v_add_u32 v20, 131072, v20
  ds_read_b32 v32, v20 offset:0
  ds_read_b32 v33, v20 offset:512
  ds_read_b32 v34, v20 offset:128
  ds_read_b32 v35, v20 offset:640
  v_lshlrev_b32 v21, 4, v17
  s_lshl_b32 s37, s27, 8
  v_add_u32 v21, s37, v21
  v_add_u32 v21, 132096, v21
  ds_read_b128 v[128:131], v21 offset:0
  ds_read_b128 v[132:135], v21 offset:32
  ds_read_b128 v[136:139], v21 offset:64
  ds_read_b128 v[140:143], v21 offset:96
  ds_read_b128 v[144:147], v21 offset:128
  ds_read_b128 v[148:151], v21 offset:160
  ds_read_b128 v[152:155], v21 offset:192
  ds_read_b128 v[156:159], v21 offset:224
  s_waitcnt lgkmcnt(0)
  s_nop 7
  v_pk_mul_f32 v[36:37], v[128:129], v[32:33] op_sel:[0,1] op_sel_hi:[1,1]
  v_pk_mul_f32 v[38:39], v[130:131], v[32:33] op_sel:[0,1] op_sel_hi:[1,1]
  v_pk_fma_f32 v[36:37], v[64:65], v[32:33], v[36:37] op_sel_hi:[1,0,1] neg_lo:[0,0,1] neg_hi:[0,0,1]
  v_pk_fma_f32 v[38:39], v[66:67], v[32:33], v[38:39] op_sel_hi:[1,0,1] neg_lo:[0,0,1] neg_hi:[0,0,1]
  v_cvt_pk_bf16_f32 v44, v36, v37
  v_cvt_pk_bf16_f32 v45, v38, v39
  ds_write_b64 v24, v[44:45]
  v_pk_mul_f32 v[40:41], v[128:129], v[34:35] op_sel:[0,1] op_sel_hi:[1,1]
  v_pk_mul_f32 v[42:43], v[130:131], v[34:35] op_sel:[0,1] op_sel_hi:[1,1]
  v_pk_fma_f32 v[40:41], v[80:81], v[34:35], v[40:41] op_sel_hi:[1,0,1] neg_lo:[0,0,1] neg_hi:[0,0,1]
  v_pk_fma_f32 v[42:43], v[82:83], v[34:35], v[42:43] op_sel_hi:[1,0,1] neg_lo:[0,0,1] neg_hi:[0,0,1]
  v_cvt_pk_bf16_f32 v46, v40, v41
  v_cvt_pk_bf16_f32 v47, v42, v43
  v_xor_b32 v24, 16384, v24
  ds_write_b64 v24, v[46:47]
  v_pk_mul_f32 v[36:37], v[132:133], v[32:33] op_sel:[0,1] op_sel_hi:[1,1]
  v_pk_mul_f32 v[38:39], v[134:135], v[32:33] op_sel:[0,1] op_sel_hi:[1,1]
  v_pk_fma_f32 v[36:37], v[68:69], v[32:33], v[36:37] op_sel_hi:[1,0,1] neg_lo:[0,0,1] neg_hi:[0,0,1]
  v_pk_fma_f32 v[38:39], v[70:71], v[32:33], v[38:39] op_sel_hi:[1,0,1] neg_lo:[0,0,1] neg_hi:[0,0,1]
  v_cvt_pk_bf16_f32 v48, v36, v37
  v_cvt_pk_bf16_f32 v49, v38, v39
  ds_write_b64 v25, v[48:49]
  v_pk_mul_f32 v[40:41], v[132:133], v[34:35] op_sel:[0,1] op_sel_hi:[1,1]
  v_pk_mul_f32 v[42:43], v[134:135], v[34:35] op_sel:[0,1] op_sel_hi:[1,1]
  v_pk_fma_f32 v[40:41], v[84:85], v[34:35], v[40:41] op_sel_hi:[1,0,1] neg_lo:[0,0,1] neg_hi:[0,0,1]
  v_pk_fma_f32 v[42:43], v[86:87], v[34:35], v[42:43] op_sel_hi:[1,0,1] neg_lo:[0,0,1] neg_hi:[0,0,1]
  v_cvt_pk_bf16_f32 v50, v40, v41
  v_cvt_pk_bf16_f32 v51, v42, v43
  v_xor_b32 v25, 16384, v25
  ds_write_b64 v25, v[50:51]
  v_pk_mul_f32 v[36:37], v[136:137], v[32:33] op_sel:[0,1] op_sel_hi:[1,1]
  v_pk_mul_f32 v[38:39], v[138:139], v[32:33] op_sel:[0,1] op_sel_hi:[1,1]
  v_pk_fma_f32 v[36:37], v[72:73], v[32:33], v[36:37] op_sel_hi:[1,0,1] neg_lo:[0,0,1] neg_hi:[0,0,1]
  v_pk_fma_f32 v[38:39], v[74:75], v[32:33], v[38:39] op_sel_hi:[1,0,1] neg_lo:[0,0,1] neg_hi:[0,0,1]
  v_cvt_pk_bf16_f32 v44, v36, v37
  v_cvt_pk_bf16_f32 v45, v38, v39
  ds_write_b64 v26, v[44:45]
  v_pk_mul_f32 v[40:41], v[136:137], v[34:35] op_sel:[0,1] op_sel_hi:[1,1]
  v_pk_mul_f32 v[42:43], v[138:139], v[34:35] op_sel:[0,1] op_sel_hi:[1,1]
  v_pk_fma_f32 v[40:41], v[88:89], v[34:35], v[40:41] op_sel_hi:[1,0,1] neg_lo:[0,0,1] neg_hi:[0,0,1]
  v_pk_fma_f32 v[42:43], v[90:91], v[34:35], v[42:43] op_sel_hi:[1,0,1] neg_lo:[0,0,1] neg_hi:[0,0,1]
  v_cvt_pk_bf16_f32 v46, v40, v41
  v_cvt_pk_bf16_f32 v47, v42, v43
  v_xor_b32 v26, 16384, v26
  ds_write_b64 v26, v[46:47]
  v_pk_mul_f32 v[36:37], v[140:141], v[32:33] op_sel:[0,1] op_sel_hi:[1,1]
  v_pk_mul_f32 v[38:39], v[142:143], v[32:33] op_sel:[0,1] op_sel_hi:[1,1]
  v_pk_fma_f32 v[36:37], v[76:77], v[32:33], v[36:37] op_sel_hi:[1,0,1] neg_lo:[0,0,1] neg_hi:[0,0,1]
  v_pk_fma_f32 v[38:39], v[78:79], v[32:33], v[38:39] op_sel_hi:[1,0,1] neg_lo:[0,0,1] neg_hi:[0,0,1]
  v_cvt_pk_bf16_f32 v48, v36, v37
  v_cvt_pk_bf16_f32 v49, v38, v39
  ds_write_b64 v27, v[48:49]
  v_pk_mul_f32 v[40:41], v[140:141], v[34:35] op_sel:[0,1] op_sel_hi:[1,1]
  v_pk_mul_f32 v[42:43], v[142:143], v[34:35] op_sel:[0,1] op_sel_hi:[1,1]
  v_pk_fma_f32 v[40:41], v[92:93], v[34:35], v[40:41] op_sel_hi:[1,0,1] neg_lo:[0,0,1] neg_hi:[0,0,1]
  v_pk_fma_f32 v[42:43], v[94:95], v[34:35], v[42:43] op_sel_hi:[1,0,1] neg_lo:[0,0,1] neg_hi:[0,0,1]
  v_cvt_pk_bf16_f32 v50, v40, v41
  v_cvt_pk_bf16_f32 v51, v42, v43
  v_xor_b32 v27, 16384, v27
  ds_write_b64 v27, v[50:51]
  v_pk_mul_f32 v[36:37], v[144:145], v[32:33] op_sel:[0,1] op_sel_hi:[1,1]
  v_pk_mul_f32 v[38:39], v[146:147], v[32:33] op_sel:[0,1] op_sel_hi:[1,1]
  v_pk_fma_f32 v[36:37], v[96:97], v[32:33], v[36:37] op_sel_hi:[1,0,1] neg_lo:[0,0,1] neg_hi:[0,0,1]
  v_pk_fma_f32 v[38:39], v[98:99], v[32:33], v[38:39] op_sel_hi:[1,0,1] neg_lo:[0,0,1] neg_hi:[0,0,1]
  v_cvt_pk_bf16_f32 v44, v36, v37
  v_cvt_pk_bf16_f32 v45, v38, v39
  ds_write_b64 v28, v[44:45]
  v_pk_mul_f32 v[40:41], v[144:145], v[34:35] op_sel:[0,1] op_sel_hi:[1,1]
  v_pk_mul_f32 v[42:43], v[146:147], v[34:35] op_sel:[0,1] op_sel_hi:[1,1]
  v_pk_fma_f32 v[40:41], v[112:113], v[34:35], v[40:41] op_sel_hi:[1,0,1] neg_lo:[0,0,1] neg_hi:[0,0,1]
  v_pk_fma_f32 v[42:43], v[114:115], v[34:35], v[42:43] op_sel_hi:[1,0,1] neg_lo:[0,0,1] neg_hi:[0,0,1]
  v_cvt_pk_bf16_f32 v46, v40, v41
  v_cvt_pk_bf16_f32 v47, v42, v43
  v_xor_b32 v28, 16384, v28
  ds_write_b64 v28, v[46:47]
  v_pk_mul_f32 v[36:37], v[148:149], v[32:33] op_sel:[0,1] op_sel_hi:[1,1]
  v_pk_mul_f32 v[38:39], v[150:151], v[32:33] op_sel:[0,1] op_sel_hi:[1,1]
  v_pk_fma_f32 v[36:37], v[100:101], v[32:33], v[36:37] op_sel_hi:[1,0,1] neg_lo:[0,0,1] neg_hi:[0,0,1]
  v_pk_fma_f32 v[38:39], v[102:103], v[32:33], v[38:39] op_sel_hi:[1,0,1] neg_lo:[0,0,1] neg_hi:[0,0,1]
  v_cvt_pk_bf16_f32 v48, v36, v37
  v_cvt_pk_bf16_f32 v49, v38, v39
  ds_write_b64 v29, v[48:49]
  v_pk_mul_f32 v[40:41], v[148:149], v[34:35] op_sel:[0,1] op_sel_hi:[1,1]
  v_pk_mul_f32 v[42:43], v[150:151], v[34:35] op_sel:[0,1] op_sel_hi:[1,1]
  v_pk_fma_f32 v[40:41], v[116:117], v[34:35], v[40:41] op_sel_hi:[1,0,1] neg_lo:[0,0,1] neg_hi:[0,0,1]
  v_pk_fma_f32 v[42:43], v[118:119], v[34:35], v[42:43] op_sel_hi:[1,0,1] neg_lo:[0,0,1] neg_hi:[0,0,1]
  v_cvt_pk_bf16_f32 v50, v40, v41
  v_cvt_pk_bf16_f32 v51, v42, v43
  v_xor_b32 v29, 16384, v29
  ds_write_b64 v29, v[50:51]
  v_pk_mul_f32 v[36:37], v[152:153], v[32:33] op_sel:[0,1] op_sel_hi:[1,1]
  v_pk_mul_f32 v[38:39], v[154:155], v[32:33] op_sel:[0,1] op_sel_hi:[1,1]
  v_pk_fma_f32 v[36:37], v[104:105], v[32:33], v[36:37] op_sel_hi:[1,0,1] neg_lo:[0,0,1] neg_hi:[0,0,1]
  v_pk_fma_f32 v[38:39], v[106:107], v[32:33], v[38:39] op_sel_hi:[1,0,1] neg_lo:[0,0,1] neg_hi:[0,0,1]
  v_cvt_pk_bf16_f32 v44, v36, v37
  v_cvt_pk_bf16_f32 v45, v38, v39
  ds_write_b64 v30, v[44:45]
  v_pk_mul_f32 v[40:41], v[152:153], v[34:35] op_sel:[0,1] op_sel_hi:[1,1]
  v_pk_mul_f32 v[42:43], v[154:155], v[34:35] op_sel:[0,1] op_sel_hi:[1,1]
  v_pk_fma_f32 v[40:41], v[120:121], v[34:35], v[40:41] op_sel_hi:[1,0,1] neg_lo:[0,0,1] neg_hi:[0,0,1]
  v_pk_fma_f32 v[42:43], v[122:123], v[34:35], v[42:43] op_sel_hi:[1,0,1] neg_lo:[0,0,1] neg_hi:[0,0,1]
  v_cvt_pk_bf16_f32 v46, v40, v41
  v_cvt_pk_bf16_f32 v47, v42, v43
  v_xor_b32 v30, 16384, v30
  ds_write_b64 v30, v[46:47]
  v_pk_mul_f32 v[36:37], v[156:157], v[32:33] op_sel:[0,1] op_sel_hi:[1,1]
  v_pk_mul_f32 v[38:39], v[158:159], v[32:33] op_sel:[0,1] op_sel_hi:[1,1]
  v_pk_fma_f32 v[36:37], v[108:109], v[32:33], v[36:37] op_sel_hi:[1,0,1] neg_lo:[0,0,1] neg_hi:[0,0,1]
  v_pk_fma_f32 v[38:39], v[110:111], v[32:33], v[38:39] op_sel_hi:[1,0,1] neg_lo:[0,0,1] neg_hi:[0,0,1]
  v_cvt_pk_bf16_f32 v48, v36, v37
  v_cvt_pk_bf16_f32 v49, v38, v39
  ds_write_b64 v31, v[48:49]
  v_pk_mul_f32 v[40:41], v[156:157], v[34:35] op_sel:[0,1] op_sel_hi:[1,1]
  v_pk_mul_f32 v[42:43], v[158:159], v[34:35] op_sel:[0,1] op_sel_hi:[1,1]
  v_pk_fma_f32 v[40:41], v[124:125], v[34:35], v[40:41] op_sel_hi:[1,0,1] neg_lo:[0,0,1] neg_hi:[0,0,1]
  v_pk_fma_f32 v[42:43], v[126:127], v[34:35], v[42:43] op_sel_hi:[1,0,1] neg_lo:[0,0,1] neg_hi:[0,0,1]
  v_cvt_pk_bf16_f32 v50, v40, v41
  v_cvt_pk_bf16_f32 v51, v42, v43
  v_xor_b32 v31, 16384, v31
  ds_write_b64 v31, v[50:51]
  s_waitcnt lgkmcnt(0)
  s_barrier
  ds_read_b128 v[64:67], v218 offset:0
  ds_read_b128 v[68:71], v218 offset:1024
  ds_read_b128 v[72:75], v218 offset:2048
  ds_read_b128 v[76:79], v218 offset:3072
  ds_read_b128 v[80:83], v218 offset:4096
  ds_read_b128 v[84:87], v218 offset:5120
  ds_read_b128 v[88:91], v218 offset:6144
  ds_read_b128 v[92:95], v218 offset:7168
  ds_read_b128 v[96:99], v218 offset:8192
  ds_read_b128 v[100:103], v218 offset:9216
  s_waitcnt lgkmcnt(9)
  buffer_store_dwordx4 v[64:67], v208, s[48:51], s54 offen sc1
  s_waitcnt lgkmcnt(8)
  buffer_store_dwordx4 v[68:71], v209, s[48:51], s54 offen sc1
  s_waitcnt lgkmcnt(7)
  buffer_store_dwordx4 v[72:75], v210, s[48:51], s54 offen sc1
  s_waitcnt lgkmcnt(6)
  buffer_store_dwordx4 v[76:79], v211, s[48:51], s54 offen sc1
  s_waitcnt lgkmcnt(5)
  buffer_store_dwordx4 v[80:83], v212, s[48:51], s54 offen sc1
  s_waitcnt lgkmcnt(4)
  buffer_store_dwordx4 v[84:87], v213, s[48:51], s54 offen sc1
  s_waitcnt lgkmcnt(3)
  buffer_store_dwordx4 v[88:91], v214, s[48:51], s54 offen sc1
  s_waitcnt lgkmcnt(2)
  buffer_store_dwordx4 v[92:95], v215, s[48:51], s54 offen sc1
  s_waitcnt lgkmcnt(1)
  buffer_store_dwordx4 v[96:99], v216, s[48:51], s54 offen sc1
  s_waitcnt lgkmcnt(0)
  buffer_store_dwordx4 v[100:103], v217, s[48:51], s54 offen sc1
  s_waitcnt vmcnt(0)
  s_mov_b64 exec, 1
  v_mov_b32 v1, 147456
  v_mov_b32 v2, 1
  ds_add_rtn_u32 v3, v1, v2
  s_lshl_b32 s37, s24, 7
  s_lshl_b32 s38, s25, 2
  s_add_u32 s37, s37, s38
  s_add_u32 s37, s37, 9211904
  s_waitcnt lgkmcnt(0)
  v_readfirstlane_b32 s38, v3
  s_and_b32 s38, s38, 3
  s_cmp_eq_u32 s38, 3
  s_cbranch_scc0 f0_kernel_p4_nosig23
  s_and_b32 s39, s2, 7
  s_lshl_b32 s37, s39, 7
  s_add_u32 s37, s37, 9211904
  s_cmp_eq_u32 s63, 0
  s_cbranch_scc1 f0_kernel_p4_fastsig24
  buffer_wbl2 sc1
  s_waitcnt vmcnt(0)
  buffer_atomic_add v2, off, s[48:51], s37 sc0 sc1
  s_branch f0_kernel_p4_arrived25
f0_kernel_p4_fastsig24:
  buffer_atomic_add v2, off, s[48:51], s37 sc0
f0_kernel_p4_arrived25:
  s_lshl_b32 s37, s39, 2
  s_add_u32 s37, s37, 9213952
  s_add_u32 s39, s63, 1
  s_waitcnt vmcnt(0)
  v_readfirstlane_b32 s38, v2
  s_cmp_eq_u32 s38, 29
  s_cbranch_scc0 f0_kernel_p4_nosig23
  s_mov_b64 exec, 0xff
  v_lshlrev_b32 v1, 7, v0
  v_mov_b32 v2, s39
  buffer_store_dword v2, v1, s[48:51], s37 offen sc1
f0_kernel_p4_nosig23:
  s_mov_b64 exec, -1
  s_branch f0_kernel_p5_entry
f0_kernel_p4_vpath:
  s_mov_b32 s48, s6
  s_mov_b32 s49, s7
  s_mov_b32 s50, 0x3200000
  s_mov_b32 s51, 0x00020000
  s_sub_u32 s37, s25, 10
  s_lshl_b32 s37, s37, 7
  s_mul_i32 s55, s37, 205
  s_lshr_b32 s55, s55, 12
  s_mul_i32 s43, s55, 20
  s_sub_u32 s43, s43, s37
  s_mov_b32 s40, 163840
  s_mul_i32 s54, s55, s40
  s_lshl_b32 s41, s24, 2
  s_add_u32 s41, s41, s26
  s_mul_i32 s41, s41, 2560
  s_add_u32 s54, s54, s41
  s_add_u32 s54, s54, 46138624
  s_lshl_b32 s52, s36, 15
  s_add_u32 s52, s52, 32768
  s_lshl_b32 s38, s27, 6
  s_add_u32 s37, s37, s38
  v_add_u32 v20, s37, v16
  v_mul_u32_u24 v21, 205, v20
  v_lshrrev_b32 v21, 12, v21
  v_mul_u32_u24 v22, 20, v21
  v_sub_u32 v22, v20, v22
  v_subrev_u32 v21, s55, v21
  v_mul_u32_u24 v21, 1280, v21
  v_lshl_add_u32 v21, v22, 4, v21
  v_mul_u32_u24 v22, 320, v17
  v_add_u32 v21, v21, v22
  v_add_u32 v24, s52, v21
  v_add_u32 v20, s37, v16
  v_add_u32 v20, 32, v20
  v_mul_u32_u24 v21, 205, v20
  v_lshrrev_b32 v21, 12, v21
  v_mul_u32_u24 v22, 20, v21
  v_sub_u32 v22, v20, v22
  v_subrev_u32 v21, s55, v21
  v_mul_u32_u24 v21, 1280, v21
  v_lshl_add_u32 v21, v22, 4, v21
  v_mul_u32_u24 v22, 320, v17
  v_add_u32 v21, v21, v22
  v_add_u32 v25, s52, v21
  s_barrier
  ds_read_b128 v[128:131], v1 offset:0
  ds_read_b128 v[132:135], v1 offset:512
  ds_read_b128 v[160:163], v3 offset:32768
  ds_read_b128 v[164:167], v3 offset:36864
  s_waitcnt lgkmcnt(0)
  v_mfma_f32_32x32x16_bf16 v[64:79], v[160:163], v[128:131], 0
  ds_read_b128 v[136:139], v1 offset:4096
  ds_read_b128 v[140:143], v1 offset:4608
  v_mfma_f32_32x32x16_bf16 v[80:95], v[164:167], v[128:131], 0
  ds_read_b128 v[168:171], v3 offset:33792
  ds_read_b128 v[172:175], v3 offset:37888
  v_mfma_f32_32x32x16_bf16 v[96:111], v[160:163], v[132:135], 0
  v_mfma_f32_32x32x16_bf16 v[112:127], v[164:167], v[132:135], 0
  s_waitcnt lgkmcnt(0)
  v_mfma_f32_32x32x16_bf16 v[64:79], v[168:171], v[136:139], v[64:79]
  ds_read_b128 v[128:131], v1 offset:8192
  ds_read_b128 v[132:135], v1 offset:8704
  v_mfma_f32_32x32x16_bf16 v[80:95], v[172:175], v[136:139], v[80:95]
  ds_read_b128 v[160:163], v3 offset:34816
  ds_read_b128 v[164:167], v3 offset:38912
  v_mfma_f32_32x32x16_bf16 v[96:111], v[168:171], v[140:143], v[96:111]
  v_mfma_f32_32x32x16_bf16 v[112:127], v[172:175], v[140:143], v[112:127]
  s_waitcnt lgkmcnt(0)
  v_mfma_f32_32x32x16_bf16 v[64:79], v[160:163], v[128:131], v[64:79]
  ds_read_b128 v[136:139], v1 offset:12288
  ds_read_b128 v[140:143], v1 offset:12800
  v_mfma_f32_32x32x16_bf16 v[80:95], v[164:167], v[128:131], v[80:95]
  ds_read_b128 v[168:171], v3 offset:35840
  ds_read_b128 v[172:175], v3 offset:39936
  v_mfma_f32_32x32x16_bf16 v[96:111], v[160:163], v[132:135], v[96:111]
  v_mfma_f32_32x32x16_bf16 v[112:127], v[164:167], v[132:135], v[112:127]
  v_add_u32 v18, 0, v0
  v_mul_u32_u24 v19, 205, v18
  v_lshrrev_b32 v19, 14, v19
  v_mul_u32_u24 v23, 80, v19
  v_sub_u32 v18, v18, v23
  v_mul_u32_u24 v208, s40, v19
  v_lshl_add_u32 v208, v18, 4, v208
  v_mul_u32_u24 v23, 205, v18
  v_lshrrev_b32 v23, 12, v23
  v_mul_u32_u24 v23, 20, v23
  v_sub_u32 v18, v18, v23
  v_mul_u32_u24 v19, 20, v19
  v_add_u32 v19, v19, v18
  v_add_u32 v19, s43, v19
  v_cmp_gt_u32 vcc, 128, v19
  v_mov_b32 v23, 0x80000000
  s_nop 0
  v_cndmask_b32 v208, v23, v208, vcc
  v_add_u32 v18, 64, v0
  v_mul_u32_u24 v19, 205, v18
  v_lshrrev_b32 v19, 14, v19
  v_mul_u32_u24 v23, 80, v19
  v_sub_u32 v18, v18, v23
  v_mul_u32_u24 v209, s40, v19
  v_lshl_add_u32 v209, v18, 4, v209
  v_mul_u32_u24 v23, 205, v18
  v_lshrrev_b32 v23, 12, v23
  v_mul_u32_u24 v23, 20, v23
  v_sub_u32 v18, v18, v23
  v_mul_u32_u24 v19, 20, v19
  v_add_u32 v19, v19, v18
  v_add_u32 v19, s43, v19
  v_cmp_gt_u32 vcc, 128, v19
  v_mov_b32 v23, 0x80000000
  s_nop 0
  v_cndmask_b32 v209, v23, v209, vcc
  v_add_u32 v18, 128, v0
  v_mul_u32_u24 v19, 205, v18
  v_lshrrev_b32 v19, 14, v19
  v_mul_u32_u24 v23, 80, v19
  v_sub_u32 v18, v18, v23
  v_mul_u32_u24 v210, s40, v19
  v_lshl_add_u32 v210, v18, 4, v210
  v_mul_u32_u24 v23, 205, v18
  v_lshrrev_b32 v23, 12, v23
  v_mul_u32_u24 v23, 20, v23
  v_sub_u32 v18, v18, v23
  v_mul_u32_u24 v19, 20, v19
  v_add_u32 v19, v19, v18
  v_add_u32 v19, s43, v19
  v_cmp_gt_u32 vcc, 128, v19
  v_mov_b32 v23, 0x80000000
  s_nop 0
  v_cndmask_b32 v210, v23, v210, vcc
  v_add_u32 v18, 192, v0
  v_mul_u32_u24 v19, 205, v18
  v_lshrrev_b32 v19, 14, v19
  v_mul_u32_u24 v23, 80, v19
  v_sub_u32 v18, v18, v23
  v_mul_u32_u24 v211, s40, v19
  v_lshl_add_u32 v211, v18, 4, v211
  v_mul_u32_u24 v23, 205, v18
  v_lshrrev_b32 v23, 12, v23
  v_mul_u32_u24 v23, 20, v23
  v_sub_u32 v18, v18, v23
  v_mul_u32_u24 v19, 20, v19
  v_add_u32 v19, v19, v18
  v_add_u32 v19, s43, v19
  v_cmp_gt_u32 vcc, 128, v19
  v_mov_b32 v23, 0x80000000
  s_nop 0
  v_cndmask_b32 v211, v23, v211, vcc
  v_add_u32 v18, 256, v0
  v_mul_u32_u24 v19, 205, v18
  v_lshrrev_b32 v19, 14, v19
  v_mul_u32_u24 v23, 80, v19
  v_sub_u32 v18, v18, v23
  v_mul_u32_u24 v212, s40, v19
  v_lshl_add_u32 v212, v18, 4, v212
  v_mul_u32_u24 v23, 205, v18
  v_lshrrev_b32 v23, 12, v23
  v_mul_u32_u24 v23, 20, v23
  v_sub_u32 v18, v18, v23
  v_mul_u32_u24 v19, 20, v19
  v_add_u32 v19, v19, v18
  v_add_u32 v19, s43, v19
  v_cmp_gt_u32 vcc, 128, v19
  v_mov_b32 v23, 0x80000000
  s_nop 0
  v_cndmask_b32 v212, v23, v212, vcc
  v_add_u32 v18, 320, v0
  v_mul_u32_u24 v19, 205, v18
  v_lshrrev_b32 v19, 14, v19
  v_mul_u32_u24 v23, 80, v19
  v_sub_u32 v18, v18, v23
  v_mul_u32_u24 v213, s40, v19
  v_lshl_add_u32 v213, v18, 4, v213
  v_mul_u32_u24 v23, 205, v18
  v_lshrrev_b32 v23, 12, v23
  v_mul_u32_u24 v23, 20, v23
  v_sub_u32 v18, v18, v23
  v_mul_u32_u24 v19, 20, v19
  v_add_u32 v19, v19, v18
  v_add_u32 v19, s43, v19
  v_cmp_gt_u32 vcc, 128, v19
  v_mov_b32 v23, 0x80000000
  s_nop 0
  v_cndmask_b32 v213, v23, v213, vcc
  v_add_u32 v18, 384, v0
  v_mul_u32_u24 v19, 205, v18
  v_lshrrev_b32 v19, 14, v19
  v_mul_u32_u24 v23, 80, v19
  v_sub_u32 v18, v18, v23
  v_mul_u32_u24 v214, s40, v19
  v_lshl_add_u32 v214, v18, 4, v214
  v_mul_u32_u24 v23, 205, v18
  v_lshrrev_b32 v23, 12, v23
  v_mul_u32_u24 v23, 20, v23
  v_sub_u32 v18, v18, v23
  v_mul_u32_u24 v19, 20, v19
  v_add_u32 v19, v19, v18
  v_add_u32 v19, s43, v19
  v_cmp_gt_u32 vcc, 128, v19
  v_mov_b32 v23, 0x80000000
  s_nop 0
  v_cndmask_b32 v214, v23, v214, vcc
  v_add_u32 v18, 448, v0
  v_mul_u32_u24 v19, 205, v18
  v_lshrrev_b32 v19, 14, v19
  v_mul_u32_u24 v23, 80, v19
  v_sub_u32 v18, v18, v23
  v_mul_u32_u24 v215, s40, v19
  v_lshl_add_u32 v215, v18, 4, v215
  v_mul_u32_u24 v23, 205, v18
  v_lshrrev_b32 v23, 12, v23
  v_mul_u32_u24 v23, 20, v23
  v_sub_u32 v18, v18, v23
  v_mul_u32_u24 v19, 20, v19
  v_add_u32 v19, v19, v18
  v_add_u32 v19, s43, v19
  v_cmp_gt_u32 vcc, 128, v19
  v_mov_b32 v23, 0x80000000
  s_nop 0
  v_cndmask_b32 v215, v23, v215, vcc
  v_add_u32 v18, 512, v0
  v_mul_u32_u24 v19, 205, v18
  v_lshrrev_b32 v19, 14, v19
  v_mul_u32_u24 v23, 80, v19
  v_sub_u32 v18, v18, v23
  v_mul_u32_u24 v216, s40, v19
  v_lshl_add_u32 v216, v18, 4, v216
  v_mul_u32_u24 v23, 205, v18
  v_lshrrev_b32 v23, 12, v23
  v_mul_u32_u24 v23, 20, v23
  v_sub_u32 v18, v18, v23
  v_mul_u32_u24 v19, 20, v19
  v_add_u32 v19, v19, v18
  v_add_u32 v19, s43, v19
  v_cmp_gt_u32 vcc, 128, v19
  v_mov_b32 v23, 0x80000000
  s_nop 0
  v_cndmask_b32 v216, v23, v216, vcc
  v_add_u32 v18, 576, v0
  v_mul_u32_u24 v19, 205, v18
  v_lshrrev_b32 v19, 14, v19
  v_mul_u32_u24 v23, 80, v19
  v_sub_u32 v18, v18, v23
  v_mul_u32_u24 v217, s40, v19
  v_lshl_add_u32 v217, v18, 4, v217
  v_mul_u32_u24 v23, 205, v18
  v_lshrrev_b32 v23, 12, v23
  v_mul_u32_u24 v23, 20, v23
  v_sub_u32 v18, v18, v23
  v_mul_u32_u24 v19, 20, v19
  v_add_u32 v19, v19, v18
  v_add_u32 v19, s43, v19
  v_cmp_gt_u32 vcc, 128, v19
  v_mov_b32 v23, 0x80000000
  s_nop 0
  v_cndmask_b32 v217, v23, v217, vcc
  s_lshl_b32 s41, s26, 14
  s_add_u32 s41, s41, 32768
  v_lshlrev_b32 v218, 4, v0
  v_add_u32 v218, s41, v218
  s_waitcnt lgkmcnt(0)
  s_barrier
  v_mfma_f32_32x32x16_bf16 v[64:79], v[168:171], v[136:139], v[64:79]
  ds_read_b128 v[128:131], v1 offset:16384
  ds_read_b128 v[132:135], v1 offset:16896
  v_mfma_f32_32x32x16_bf16 v[80:95], v[172:175], v[136:139], v[80:95]
  ds_read_b128 v[160:163], v4 offset:0
  ds_read_b128 v[164:167], v4 offset:4096
  v_mfma_f32_32x32x16_bf16 v[96:111], v[168:171], v[140:143], v[96:111]
  v_mfma_f32_32x32x16_bf16 v[112:127], v[172:175], v[140:143], v[112:127]
  s_waitcnt lgkmcnt(0)
  v_mfma_f32_32x32x16_bf16 v[64:79], v[160:163], v[128:131], v[64:79]
  ds_read_b128 v[136:139], v1 offset:20480
  ds_read_b128 v[140:143], v1 offset:20992
  v_mfma_f32_32x32x16_bf16 v[80:95], v[164:167], v[128:131], v[80:95]
  ds_read_b128 v[168:171], v4 offset:1024
  ds_read_b128 v[172:175], v4 offset:5120
  v_mfma_f32_32x32x16_bf16 v[96:111], v[160:163], v[132:135], v[96:111]
  v_mfma_f32_32x32x16_bf16 v[112:127], v[164:167], v[132:135], v[112:127]
  s_waitcnt lgkmcnt(0)
  v_mfma_f32_32x32x16_bf16 v[64:79], v[168:171], v[136:139], v[64:79]
  ds_read_b128 v[128:131], v1 offset:24576
  ds_read_b128 v[132:135], v1 offset:25088
  v_mfma_f32_32x32x16_bf16 v[80:95], v[172:175], v[136:139], v[80:95]
  ds_read_b128 v[160:163], v4 offset:2048
  ds_read_b128 v[164:167], v4 offset:6144
  v_mfma_f32_32x32x16_bf16 v[96:111], v[168:171], v[140:143], v[96:111]
  v_mfma_f32_32x32x16_bf16 v[112:127], v[172:175], v[140:143], v[112:127]
  s_waitcnt lgkmcnt(0)
  v_mfma_f32_32x32x16_bf16 v[64:79], v[160:163], v[128:131], v[64:79]
  ds_read_b128 v[136:139], v1 offset:28672
  ds_read_b128 v[140:143], v1 offset:29184
  v_mfma_f32_32x32x16_bf16 v[80:95], v[164:167], v[128:131], v[80:95]
  ds_read_b128 v[168:171], v4 offset:3072
  ds_read_b128 v[172:175], v4 offset:7168
  v_mfma_f32_32x32x16_bf16 v[96:111], v[160:163], v[132:135], v[96:111]
  v_mfma_f32_32x32x16_bf16 v[112:127], v[164:167], v[132:135], v[112:127]
  s_waitcnt lgkmcnt(0)
  s_barrier
  v_mfma_f32_32x32x16_bf16 v[64:79], v[168:171], v[136:139], v[64:79]
  ds_read_b128 v[128:131], v1 offset:32768
  ds_read_b128 v[132:135], v1 offset:33280
  v_mfma_f32_32x32x16_bf16 v[80:95], v[172:175], v[136:139], v[80:95]
  ds_read_b128 v[160:163], v3 offset:0
  ds_read_b128 v[164:167], v3 offset:4096
  v_mfma_f32_32x32x16_bf16 v[96:111], v[168:171], v[140:143], v[96:111]
  v_mfma_f32_32x32x16_bf16 v[112:127], v[172:175], v[140:143], v[112:127]
  s_waitcnt lgkmcnt(0)
  v_mfma_f32_32x32x16_bf16 v[64:79], v[160:163], v[128:131], v[64:79]
  ds_read_b128 v[136:139], v1 offset:36864
  ds_read_b128 v[140:143], v1 offset:37376
  v_mfma_f32_32x32x16_bf16 v[80:95], v[164:167], v[128:131], v[80:95]
  ds_read_b128 v[168:171], v3 offset:1024
  ds_read_b128 v[172:175], v3 offset:5120
  v_mfma_f32_32x32x16_bf16 v[96:111], v[160:163], v[132:135], v[96:111]
  v_mfma_f32_32x32x16_bf16 v[112:127], v[164:167], v[132:135], v[112:127]
  s_waitcnt lgkmcnt(0)
  v_mfma_f32_32x32x16_bf16 v[64:79], v[168:171], v[136:139], v[64:79]
  ds_read_b128 v[128:131], v1 offset:40960
  ds_read_b128 v[132:135], v1 offset:41472
  v_mfma_f32_32x32x16_bf16 v[80:95], v[172:175], v[136:139], v[80:95]
  ds_read_b128 v[160:163], v3 offset:2048
  ds_read_b128 v[164:167], v3 offset:6144
  v_mfma_f32_32x32x16_bf16 v[96:111], v[168:171], v[140:143], v[96:111]
  v_mfma_f32_32x32x16_bf16 v[112:127], v[172:175], v[140:143], v[112:127]
  s_waitcnt lgkmcnt(0)
  v_mfma_f32_32x32x16_bf16 v[64:79], v[160:163], v[128:131], v[64:79]
  ds_read_b128 v[136:139], v1 offset:45056
  ds_read_b128 v[140:143], v1 offset:45568
  v_mfma_f32_32x32x16_bf16 v[80:95], v[164:167], v[128:131], v[80:95]
  ds_read_b128 v[168:171], v3 offset:3072
  ds_read_b128 v[172:175], v3 offset:7168
  v_mfma_f32_32x32x16_bf16 v[96:111], v[160:163], v[132:135], v[96:111]
  v_mfma_f32_32x32x16_bf16 v[112:127], v[164:167], v[132:135], v[112:127]
  s_waitcnt lgkmcnt(0)
  s_barrier
  v_mfma_f32_32x32x16_bf16 v[64:79], v[168:171], v[136:139], v[64:79]
  ds_read_b128 v[128:131], v2 offset:0
  ds_read_b128 v[132:135], v2 offset:512
  v_mfma_f32_32x32x16_bf16 v[80:95], v[172:175], v[136:139], v[80:95]
  ds_read_b128 v[160:163], v3 offset:16384
  ds_read_b128 v[164:167], v3 offset:20480
  v_mfma_f32_32x32x16_bf16 v[96:111], v[168:171], v[140:143], v[96:111]
  v_mfma_f32_32x32x16_bf16 v[112:127], v[172:175], v[140:143], v[112:127]
  s_waitcnt lgkmcnt(0)
  v_mfma_f32_32x32x16_bf16 v[64:79], v[160:163], v[128:131], v[64:79]
  ds_read_b128 v[136:139], v2 offset:4096
  ds_read_b128 v[140:143], v2 offset:4608
  v_mfma_f32_32x32x16_bf16 v[80:95], v[164:167], v[128:131], v[80:95]
  ds_read_b128 v[168:171], v3 offset:17408
  ds_read_b128 v[172:175], v3 offset:21504
  v_mfma_f32_32x32x16_bf16 v[96:111], v[160:163], v[132:135], v[96:111]
  v_mfma_f32_32x32x16_bf16 v[112:127], v[164:167], v[132:135], v[112:127]
  s_waitcnt lgkmcnt(0)
  v_mfma_f32_32x32x16_bf16 v[64:79], v[168:171], v[136:139], v[64:79]
  ds_read_b128 v[128:131], v2 offset:8192
  ds_read_b128 v[132:135], v2 offset:8704
  v_mfma_f32_32x32x16_bf16 v[80:95], v[172:175], v[136:139], v[80:95]
  ds_read_b128 v[160:163], v3 offset:18432
  ds_read_b128 v[164:167], v3 offset:22528
  v_mfma_f32_32x32x16_bf16 v[96:111], v[168:171], v[140:143], v[96:111]
  v_mfma_f32_32x32x16_bf16 v[112:127], v[172:175], v[140:143], v[112:127]
  s_waitcnt lgkmcnt(0)
  v_mfma_f32_32x32x16_bf16 v[64:79], v[160:163], v[128:131], v[64:79]
  ds_read_b128 v[136:139], v2 offset:12288
  ds_read_b128 v[140:143], v2 offset:12800
  v_mfma_f32_32x32x16_bf16 v[80:95], v[164:167], v[128:131], v[80:95]
  ds_read_b128 v[168:171], v3 offset:19456
  ds_read_b128 v[172:175], v3 offset:23552
  v_mfma_f32_32x32x16_bf16 v[96:111], v[160:163], v[132:135], v[96:111]
  v_mfma_f32_32x32x16_bf16 v[112:127], v[164:167], v[132:135], v[112:127]
  s_waitcnt lgkmcnt(0)
  s_barrier
  v_mfma_f32_32x32x16_bf16 v[64:79], v[168:171], v[136:139], v[64:79]
  ds_read_b128 v[128:131], v1 offset:0
  ds_read_b128 v[132:135], v1 offset:512
  v_mfma_f32_32x32x16_bf16 v[80:95], v[172:175], v[136:139], v[80:95]
  ds_read_b128 v[160:163], v3 offset:32768
  ds_read_b128 v[164:167], v3 offset:36864
  v_mfma_f32_32x32x16_bf16 v[96:111], v[168:171], v[140:143], v[96:111]
  v_mfma_f32_32x32x16_bf16 v[112:127], v[172:175], v[140:143], v[112:127]
  s_waitcnt lgkmcnt(0)
  v_mfma_f32_32x32x16_bf16 v[64:79], v[160:163], v[128:131], v[64:79]
  ds_read_b128 v[136:139], v1 offset:4096
  ds_read_b128 v[140:143], v1 offset:4608
  v_mfma_f32_32x32x16_bf16 v[80:95], v[164:167], v[128:131], v[80:95]
  ds_read_b128 v[168:171], v3 offset:33792
  ds_read_b128 v[172:175], v3 offset:37888
  v_mfma_f32_32x32x16_bf16 v[96:111], v[160:163], v[132:135], v[96:111]
  v_mfma_f32_32x32x16_bf16 v[112:127], v[164:167], v[132:135], v[112:127]
  s_waitcnt lgkmcnt(0)
  v_mfma_f32_32x32x16_bf16 v[64:79], v[168:171], v[136:139], v[64:79]
  ds_read_b128 v[128:131], v1 offset:8192
  ds_read_b128 v[132:135], v1 offset:8704
  v_mfma_f32_32x32x16_bf16 v[80:95], v[172:175], v[136:139], v[80:95]
  ds_read_b128 v[160:163], v3 offset:34816
  ds_read_b128 v[164:167], v3 offset:38912
  v_mfma_f32_32x32x16_bf16 v[96:111], v[168:171], v[140:143], v[96:111]
  v_mfma_f32_32x32x16_bf16 v[112:127], v[172:175], v[140:143], v[112:127]
  s_waitcnt lgkmcnt(0)
  v_mfma_f32_32x32x16_bf16 v[64:79], v[160:163], v[128:131], v[64:79]
  ds_read_b128 v[136:139], v1 offset:12288
  ds_read_b128 v[140:143], v1 offset:12800
  v_mfma_f32_32x32x16_bf16 v[80:95], v[164:167], v[128:131], v[80:95]
  ds_read_b128 v[168:171], v3 offset:35840
  ds_read_b128 v[172:175], v3 offset:39936
  v_mfma_f32_32x32x16_bf16 v[96:111], v[160:163], v[132:135], v[96:111]
  v_mfma_f32_32x32x16_bf16 v[112:127], v[164:167], v[132:135], v[112:127]
  s_waitcnt lgkmcnt(0)
  s_barrier
  v_mfma_f32_32x32x16_bf16 v[64:79], v[168:171], v[136:139], v[64:79]
  ds_read_b128 v[128:131], v1 offset:16384
  ds_read_b128 v[132:135], v1 offset:16896
  v_mfma_f32_32x32x16_bf16 v[80:95], v[172:175], v[136:139], v[80:95]
  ds_read_b128 v[160:163], v4 offset:0
  ds_read_b128 v[164:167], v4 offset:4096
  v_mfma_f32_32x32x16_bf16 v[96:111], v[168:171], v[140:143], v[96:111]
  v_mfma_f32_32x32x16_bf16 v[112:127], v[172:175], v[140:143], v[112:127]
  s_waitcnt lgkmcnt(0)
  v_mfma_f32_32x32x16_bf16 v[64:79], v[160:163], v[128:131], v[64:79]
  ds_read_b128 v[136:139], v1 offset:20480
  ds_read_b128 v[140:143], v1 offset:20992
  v_mfma_f32_32x32x16_bf16 v[80:95], v[164:167], v[128:131], v[80:95]
  ds_read_b128 v[168:171], v4 offset:1024
  ds_read_b128 v[172:175], v4 offset:5120
  v_mfma_f32_32x32x16_bf16 v[96:111], v[160:163], v[132:135], v[96:111]
  v_mfma_f32_32x32x16_bf16 v[112:127], v[164:167], v[132:135], v[112:127]
  s_waitcnt lgkmcnt(0)
  v_mfma_f32_32x32x16_bf16 v[64:79], v[168:171], v[136:139], v[64:79]
  ds_read_b128 v[128:131], v1 offset:24576
  ds_read_b128 v[132:135], v1 offset:25088
  v_mfma_f32_32x32x16_bf16 v[80:95], v[172:175], v[136:139], v[80:95]
  ds_read_b128 v[160:163], v4 offset:2048
  ds_read_b128 v[164:167], v4 offset:6144
  v_mfma_f32_32x32x16_bf16 v[96:111], v[168:171], v[140:143], v[96:111]
  v_mfma_f32_32x32x16_bf16 v[112:127], v[172:175], v[140:143], v[112:127]
  s_waitcnt lgkmcnt(0)
  v_mfma_f32_32x32x16_bf16 v[64:79], v[160:163], v[128:131], v[64:79]
  ds_read_b128 v[136:139], v1 offset:28672
  ds_read_b128 v[140:143], v1 offset:29184
  v_mfma_f32_32x32x16_bf16 v[80:95], v[164:167], v[128:131], v[80:95]
  ds_read_b128 v[168:171], v4 offset:3072
  ds_read_b128 v[172:175], v4 offset:7168
  v_mfma_f32_32x32x16_bf16 v[96:111], v[160:163], v[132:135], v[96:111]
  v_mfma_f32_32x32x16_bf16 v[112:127], v[164:167], v[132:135], v[112:127]
  s_waitcnt lgkmcnt(0)
  s_barrier
  v_mfma_f32_32x32x16_bf16 v[64:79], v[168:171], v[136:139], v[64:79]
  ds_read_b128 v[128:131], v1 offset:32768
  ds_read_b128 v[132:135], v1 offset:33280
  v_mfma_f32_32x32x16_bf16 v[80:95], v[172:175], v[136:139], v[80:95]
  ds_read_b128 v[160:163], v3 offset:0
  ds_read_b128 v[164:167], v3 offset:4096
  v_mfma_f32_32x32x16_bf16 v[96:111], v[168:171], v[140:143], v[96:111]
  v_mfma_f32_32x32x16_bf16 v[112:127], v[172:175], v[140:143], v[112:127]
  s_waitcnt lgkmcnt(0)
  v_mfma_f32_32x32x16_bf16 v[64:79], v[160:163], v[128:131], v[64:79]
  ds_read_b128 v[136:139], v1 offset:36864
  ds_read_b128 v[140:143], v1 offset:37376
  v_mfma_f32_32x32x16_bf16 v[80:95], v[164:167], v[128:131], v[80:95]
  ds_read_b128 v[168:171], v3 offset:1024
  ds_read_b128 v[172:175], v3 offset:5120
  v_mfma_f32_32x32x16_bf16 v[96:111], v[160:163], v[132:135], v[96:111]
  v_mfma_f32_32x32x16_bf16 v[112:127], v[164:167], v[132:135], v[112:127]
  s_waitcnt lgkmcnt(0)
  v_mfma_f32_32x32x16_bf16 v[64:79], v[168:171], v[136:139], v[64:79]
  ds_read_b128 v[128:131], v1 offset:40960
  ds_read_b128 v[132:135], v1 offset:41472
  v_mfma_f32_32x32x16_bf16 v[80:95], v[172:175], v[136:139], v[80:95]
  ds_read_b128 v[160:163], v3 offset:2048
  ds_read_b128 v[164:167], v3 offset:6144
  v_mfma_f32_32x32x16_bf16 v[96:111], v[168:171], v[140:143], v[96:111]
  v_mfma_f32_32x32x16_bf16 v[112:127], v[172:175], v[140:143], v[112:127]
  s_waitcnt lgkmcnt(0)
  v_mfma_f32_32x32x16_bf16 v[64:79], v[160:163], v[128:131], v[64:79]
  ds_read_b128 v[136:139], v1 offset:45056
  ds_read_b128 v[140:143], v1 offset:45568
  v_mfma_f32_32x32x16_bf16 v[80:95], v[164:167], v[128:131], v[80:95]
  ds_read_b128 v[168:171], v3 offset:3072
  ds_read_b128 v[172:175], v3 offset:7168
  v_mfma_f32_32x32x16_bf16 v[96:111], v[160:163], v[132:135], v[96:111]
  v_mfma_f32_32x32x16_bf16 v[112:127], v[164:167], v[132:135], v[112:127]
  s_waitcnt lgkmcnt(0)
  s_barrier
  v_mfma_f32_32x32x16_bf16 v[64:79], v[168:171], v[136:139], v[64:79]
  ds_read_b128 v[128:131], v2 offset:0
  ds_read_b128 v[132:135], v2 offset:512
  v_mfma_f32_32x32x16_bf16 v[80:95], v[172:175], v[136:139], v[80:95]
  ds_read_b128 v[160:163], v3 offset:16384
  ds_read_b128 v[164:167], v3 offset:20480
  v_mfma_f32_32x32x16_bf16 v[96:111], v[168:171], v[140:143], v[96:111]
  v_mfma_f32_32x32x16_bf16 v[112:127], v[172:175], v[140:143], v[112:127]
  s_waitcnt lgkmcnt(0)
  v_mfma_f32_32x32x16_bf16 v[64:79], v[160:163], v[128:131], v[64:79]
  ds_read_b128 v[136:139], v2 offset:4096
  ds_read_b128 v[140:143], v2 offset:4608
  v_mfma_f32_32x32x16_bf16 v[80:95], v[164:167], v[128:131], v[80:95]
  ds_read_b128 v[168:171], v3 offset:17408
  ds_read_b128 v[172:175], v3 offset:21504
  v_mfma_f32_32x32x16_bf16 v[96:111], v[160:163], v[132:135], v[96:111]
  v_mfma_f32_32x32x16_bf16 v[112:127], v[164:167], v[132:135], v[112:127]
  s_waitcnt lgkmcnt(0)
  v_mfma_f32_32x32x16_bf16 v[64:79], v[168:171], v[136:139], v[64:79]
  ds_read_b128 v[128:131], v2 offset:8192
  ds_read_b128 v[132:135], v2 offset:8704
  v_mfma_f32_32x32x16_bf16 v[80:95], v[172:175], v[136:139], v[80:95]
  ds_read_b128 v[160:163], v3 offset:18432
  ds_read_b128 v[164:167], v3 offset:22528
  v_mfma_f32_32x32x16_bf16 v[96:111], v[168:171], v[140:143], v[96:111]
  v_mfma_f32_32x32x16_bf16 v[112:127], v[172:175], v[140:143], v[112:127]
  s_waitcnt lgkmcnt(0)
  v_mfma_f32_32x32x16_bf16 v[64:79], v[160:163], v[128:131], v[64:79]
  ds_read_b128 v[136:139], v2 offset:12288
  ds_read_b128 v[140:143], v2 offset:12800
  v_mfma_f32_32x32x16_bf16 v[80:95], v[164:167], v[128:131], v[80:95]
  ds_read_b128 v[168:171], v3 offset:19456
  ds_read_b128 v[172:175], v3 offset:23552
  v_mfma_f32_32x32x16_bf16 v[96:111], v[160:163], v[132:135], v[96:111]
  v_mfma_f32_32x32x16_bf16 v[112:127], v[164:167], v[132:135], v[112:127]
  s_waitcnt lgkmcnt(0)
  s_barrier
  v_mfma_f32_32x32x16_bf16 v[64:79], v[168:171], v[136:139], v[64:79]
  ds_read_b128 v[128:131], v1 offset:0
  ds_read_b128 v[132:135], v1 offset:512
  v_mfma_f32_32x32x16_bf16 v[80:95], v[172:175], v[136:139], v[80:95]
  ds_read_b128 v[160:163], v3 offset:32768
  ds_read_b128 v[164:167], v3 offset:36864
  v_mfma_f32_32x32x16_bf16 v[96:111], v[168:171], v[140:143], v[96:111]
  v_mfma_f32_32x32x16_bf16 v[112:127], v[172:175], v[140:143], v[112:127]
  s_waitcnt lgkmcnt(0)
  v_mfma_f32_32x32x16_bf16 v[64:79], v[160:163], v[128:131], v[64:79]
  ds_read_b128 v[136:139], v1 offset:4096
  ds_read_b128 v[140:143], v1 offset:4608
  v_mfma_f32_32x32x16_bf16 v[80:95], v[164:167], v[128:131], v[80:95]
  ds_read_b128 v[168:171], v3 offset:33792
  ds_read_b128 v[172:175], v3 offset:37888
  v_mfma_f32_32x32x16_bf16 v[96:111], v[160:163], v[132:135], v[96:111]
  v_mfma_f32_32x32x16_bf16 v[112:127], v[164:167], v[132:135], v[112:127]
  s_waitcnt lgkmcnt(0)
  v_mfma_f32_32x32x16_bf16 v[64:79], v[168:171], v[136:139], v[64:79]
  ds_read_b128 v[128:131], v1 offset:8192
  ds_read_b128 v[132:135], v1 offset:8704
  v_mfma_f32_32x32x16_bf16 v[80:95], v[172:175], v[136:139], v[80:95]
  ds_read_b128 v[160:163], v3 offset:34816
  ds_read_b128 v[164:167], v3 offset:38912
  v_mfma_f32_32x32x16_bf16 v[96:111], v[168:171], v[140:143], v[96:111]
  v_mfma_f32_32x32x16_bf16 v[112:127], v[172:175], v[140:143], v[112:127]
  s_waitcnt lgkmcnt(0)
  v_mfma_f32_32x32x16_bf16 v[64:79], v[160:163], v[128:131], v[64:79]
  ds_read_b128 v[136:139], v1 offset:12288
  ds_read_b128 v[140:143], v1 offset:12800
  v_mfma_f32_32x32x16_bf16 v[80:95], v[164:167], v[128:131], v[80:95]
  ds_read_b128 v[168:171], v3 offset:35840
  ds_read_b128 v[172:175], v3 offset:39936
  v_mfma_f32_32x32x16_bf16 v[96:111], v[160:163], v[132:135], v[96:111]
  v_mfma_f32_32x32x16_bf16 v[112:127], v[164:167], v[132:135], v[112:127]
  s_waitcnt lgkmcnt(0)
  s_barrier
  v_mfma_f32_32x32x16_bf16 v[64:79], v[168:171], v[136:139], v[64:79]
  ds_read_b128 v[128:131], v1 offset:16384
  ds_read_b128 v[132:135], v1 offset:16896
  v_mfma_f32_32x32x16_bf16 v[80:95], v[172:175], v[136:139], v[80:95]
  ds_read_b128 v[160:163], v4 offset:0
  ds_read_b128 v[164:167], v4 offset:4096
  v_mfma_f32_32x32x16_bf16 v[96:111], v[168:171], v[140:143], v[96:111]
  v_mfma_f32_32x32x16_bf16 v[112:127], v[172:175], v[140:143], v[112:127]
  s_waitcnt lgkmcnt(0)
  v_mfma_f32_32x32x16_bf16 v[64:79], v[160:163], v[128:131], v[64:79]
  ds_read_b128 v[136:139], v1 offset:20480
  ds_read_b128 v[140:143], v1 offset:20992
  v_mfma_f32_32x32x16_bf16 v[80:95], v[164:167], v[128:131], v[80:95]
  ds_read_b128 v[168:171], v4 offset:1024
  ds_read_b128 v[172:175], v4 offset:5120
  v_mfma_f32_32x32x16_bf16 v[96:111], v[160:163], v[132:135], v[96:111]
  v_mfma_f32_32x32x16_bf16 v[112:127], v[164:167], v[132:135], v[112:127]
  s_waitcnt lgkmcnt(0)
  v_mfma_f32_32x32x16_bf16 v[64:79], v[168:171], v[136:139], v[64:79]
  ds_read_b128 v[128:131], v1 offset:24576
  ds_read_b128 v[132:135], v1 offset:25088
  v_mfma_f32_32x32x16_bf16 v[80:95], v[172:175], v[136:139], v[80:95]
  ds_read_b128 v[160:163], v4 offset:2048
  ds_read_b128 v[164:167], v4 offset:6144
  v_mfma_f32_32x32x16_bf16 v[96:111], v[168:171], v[140:143], v[96:111]
  v_mfma_f32_32x32x16_bf16 v[112:127], v[172:175], v[140:143], v[112:127]
  s_waitcnt lgkmcnt(0)
  v_mfma_f32_32x32x16_bf16 v[64:79], v[160:163], v[128:131], v[64:79]
  ds_read_b128 v[136:139], v1 offset:28672
  ds_read_b128 v[140:143], v1 offset:29184
  v_mfma_f32_32x32x16_bf16 v[80:95], v[164:167], v[128:131], v[80:95]
  ds_read_b128 v[168:171], v4 offset:3072
  ds_read_b128 v[172:175], v4 offset:7168
  v_mfma_f32_32x32x16_bf16 v[96:111], v[160:163], v[132:135], v[96:111]
  v_mfma_f32_32x32x16_bf16 v[112:127], v[164:167], v[132:135], v[112:127]
  s_waitcnt lgkmcnt(0)
  v_mfma_f32_32x32x16_bf16 v[64:79], v[168:171], v[136:139], v[64:79]
  v_mfma_f32_32x32x16_bf16 v[80:95], v[172:175], v[136:139], v[80:95]
  v_mfma_f32_32x32x16_bf16 v[96:111], v[168:171], v[140:143], v[96:111]
  v_mfma_f32_32x32x16_bf16 v[112:127], v[172:175], v[140:143], v[112:127]
  s_lshl_b32 s37, s36, 8
  v_lshlrev_b32 v20, 4, v17
  v_add_u32 v20, s37, v20
  v_add_u32 v20, 131072, v20
  ds_read_b128 v[128:131], v20 offset:0
  ds_read_b128 v[132:135], v20 offset:32
  ds_read_b128 v[136:139], v20 offset:64
  ds_read_b128 v[140:143], v20 offset:96
  ds_read_b128 v[144:147], v20 offset:128
  ds_read_b128 v[148:151], v20 offset:160
  ds_read_b128 v[152:155], v20 offset:192
  ds_read_b128 v[156:159], v20 offset:224
  v_lshlrev_b32 v21, 2, v16
  s_lshl_b32 s37, s27, 8
  v_add_u32 v21, s37, v21
  v_add_u32 v21, 132096, v21
  s_waitcnt lgkmcnt(4)
  ds_read_b128 v[160:163], v20 offset:512
  ds_read_b128 v[164:167], v20 offset:544
  ds_read_b128 v[168:171], v20 offset:576
  ds_read_b128 v[172:175], v20 offset:608
  ds_read_b128 v[176:179], v20 offset:640
  ds_read_b128 v[180:183], v20 offset:672
  ds_read_b128 v[184:187], v20 offset:704
  ds_read_b128 v[188:191], v20 offset:736
  ds_read_b32 v32, v21
  ds_read_b32 v34, v21 offset:128
  s_waitcnt lgkmcnt(0)
  s_nop 7
  v_pk_mul_f32 v[36:37], v[160:161], v[32:33] op_sel_hi:[1,0]
  v_pk_mul_f32 v[38:39], v[162:163], v[32:33] op_sel_hi:[1,0]
  v_pk_fma_f32 v[36:37], v[64:65], v[128:129], v[36:37] neg_lo:[0,0,1] neg_hi:[0,0,1]
  v_pk_fma_f32 v[38:39], v[66:67], v[130:131], v[38:39] neg_lo:[0,0,1] neg_hi:[0,0,1]
  v_cvt_pk_bf16_f32 v44, v36, v37
  v_cvt_pk_bf16_f32 v45, v38, v39
  v_pk_mul_f32 v[40:41], v[164:165], v[32:33] op_sel_hi:[1,0]
  v_pk_mul_f32 v[42:43], v[166:167], v[32:33] op_sel_hi:[1,0]
  v_pk_fma_f32 v[40:41], v[68:69], v[132:133], v[40:41] neg_lo:[0,0,1] neg_hi:[0,0,1]
  v_pk_fma_f32 v[42:43], v[70:71], v[134:135], v[42:43] neg_lo:[0,0,1] neg_hi:[0,0,1]
  v_cvt_pk_bf16_f32 v46, v40, v41
  v_cvt_pk_bf16_f32 v47, v42, v43
  s_nop 1
  v_permlane32_swap_b32 v44, v46
  v_permlane32_swap_b32 v45, v47
  s_nop 1
  ds_write_b128 v24, v[44:47] offset:0
  v_pk_mul_f32 v[36:37], v[168:169], v[32:33] op_sel_hi:[1,0]
  v_pk_mul_f32 v[38:39], v[170:171], v[32:33] op_sel_hi:[1,0]
  v_pk_fma_f32 v[36:37], v[72:73], v[136:137], v[36:37] neg_lo:[0,0,1] neg_hi:[0,0,1]
  v_pk_fma_f32 v[38:39], v[74:75], v[138:139], v[38:39] neg_lo:[0,0,1] neg_hi:[0,0,1]
  v_cvt_pk_bf16_f32 v48, v36, v37
  v_cvt_pk_bf16_f32 v49, v38, v39
  v_pk_mul_f32 v[40:41], v[172:173], v[32:33] op_sel_hi:[1,0]
  v_pk_mul_f32 v[42:43], v[174:175], v[32:33] op_sel_hi:[1,0]
  v_pk_fma_f32 v[40:41], v[76:77], v[140:141], v[40:41] neg_lo:[0,0,1] neg_hi:[0,0,1]
  v_pk_fma_f32 v[42:43], v[78:79], v[142:143], v[42:43] neg_lo:[0,0,1] neg_hi:[0,0,1]
  v_cvt_pk_bf16_f32 v50, v40, v41
  v_cvt_pk_bf16_f32 v51, v42, v43
  s_nop 1
  v_permlane32_swap_b32 v48, v50
  v_permlane32_swap_b32 v49, v51
  s_nop 1
  ds_write_b128 v24, v[48:51] offset:640
  v_pk_mul_f32 v[36:37], v[176:177], v[32:33] op_sel_hi:[1,0]
  v_pk_mul_f32 v[38:39], v[178:179], v[32:33] op_sel_hi:[1,0]
  v_pk_fma_f32 v[36:37], v[80:81], v[144:145], v[36:37] neg_lo:[0,0,1] neg_hi:[0,0,1]
  v_pk_fma_f32 v[38:39], v[82:83], v[146:147], v[38:39] neg_lo:[0,0,1] neg_hi:[0,0,1]
  v_cvt_pk_bf16_f32 v44, v36, v37
  v_cvt_pk_bf16_f32 v45, v38, v39
  v_pk_mul_f32 v[40:41], v[180:181], v[32:33] op_sel_hi:[1,0]
  v_pk_mul_f32 v[42:43], v[182:183], v[32:33] op_sel_hi:[1,0]
  v_pk_fma_f32 v[40:41], v[84:85], v[148:149], v[40:41] neg_lo:[0,0,1] neg_hi:[0,0,1]
  v_pk_fma_f32 v[42:43], v[86:87], v[150:151], v[42:43] neg_lo:[0,0,1] neg_hi:[0,0,1]
  v_cvt_pk_bf16_f32 v46, v40, v41
  v_cvt_pk_bf16_f32 v47, v42, v43
  s_nop 1
  v_permlane32_swap_b32 v44, v46
  v_permlane32_swap_b32 v45, v47
  s_nop 1
  v_xor_b32 v24, 16384, v24
  ds_write_b128 v24, v[44:47] offset:0
  v_pk_mul_f32 v[36:37], v[184:185], v[32:33] op_sel_hi:[1,0]
  v_pk_mul_f32 v[38:39], v[186:187], v[32:33] op_sel_hi:[1,0]
  v_pk_fma_f32 v[36:37], v[88:89], v[152:153], v[36:37] neg_lo:[0,0,1] neg_hi:[0,0,1]
  v_pk_fma_f32 v[38:39], v[90:91], v[154:155], v[38:39] neg_lo:[0,0,1] neg_hi:[0,0,1]
  v_cvt_pk_bf16_f32 v48, v36, v37
  v_cvt_pk_bf16_f32 v49, v38, v39
  v_pk_mul_f32 v[40:41], v[188:189], v[32:33] op_sel_hi:[1,0]
  v_pk_mul_f32 v[42:43], v[190:191], v[32:33] op_sel_hi:[1,0]
  v_pk_fma_f32 v[40:41], v[92:93], v[156:157], v[40:41] neg_lo:[0,0,1] neg_hi:[0,0,1]
  v_pk_fma_f32 v[42:43], v[94:95], v[158:159], v[42:43] neg_lo:[0,0,1] neg_hi:[0,0,1]
  v_cvt_pk_bf16_f32 v50, v40, v41
  v_cvt_pk_bf16_f32 v51, v42, v43
  s_nop 1
  v_permlane32_swap_b32 v48, v50
  v_permlane32_swap_b32 v49, v51
  s_nop 1
  ds_write_b128 v24, v[48:51] offset:640
  v_pk_mul_f32 v[36:37], v[160:161], v[34:35] op_sel_hi:[1,0]
  v_pk_mul_f32 v[38:39], v[162:163], v[34:35] op_sel_hi:[1,0]
  v_pk_fma_f32 v[36:37], v[96:97], v[128:129], v[36:37] neg_lo:[0,0,1] neg_hi:[0,0,1]
  v_pk_fma_f32 v[38:39], v[98:99], v[130:131], v[38:39] neg_lo:[0,0,1] neg_hi:[0,0,1]
  v_cvt_pk_bf16_f32 v44, v36, v37
  v_cvt_pk_bf16_f32 v45, v38, v39
  v_pk_mul_f32 v[40:41], v[164:165], v[34:35] op_sel_hi:[1,0]
  v_pk_mul_f32 v[42:43], v[166:167], v[34:35] op_sel_hi:[1,0]
  v_pk_fma_f32 v[40:41], v[100:101], v[132:133], v[40:41] neg_lo:[0,0,1] neg_hi:[0,0,1]
  v_pk_fma_f32 v[42:43], v[102:103], v[134:135], v[42:43] neg_lo:[0,0,1] neg_hi:[0,0,1]
  v_cvt_pk_bf16_f32 v46, v40, v41
  v_cvt_pk_bf16_f32 v47, v42, v43
  s_nop 1
  v_permlane32_swap_b32 v44, v46
  v_permlane32_swap_b32 v45, v47
  s_nop 1
  ds_write_b128 v25, v[44:47] offset:0
  v_pk_mul_f32 v[36:37], v[168:169], v[34:35] op_sel_hi:[1,0]
  v_pk_mul_f32 v[38:39], v[170:171], v[34:35] op_sel_hi:[1,0]
  v_pk_fma_f32 v[36:37], v[104:105], v[136:137], v[36:37] neg_lo:[0,0,1] neg_hi:[0,0,1]
  v_pk_fma_f32 v[38:39], v[106:107], v[138:139], v[38:39] neg_lo:[0,0,1] neg_hi:[0,0,1]
  v_cvt_pk_bf16_f32 v48, v36, v37
  v_cvt_pk_bf16_f32 v49, v38, v39
  v_pk_mul_f32 v[40:41], v[172:173], v[34:35] op_sel_hi:[1,0]
  v_pk_mul_f32 v[42:43], v[174:175], v[34:35] op_sel_hi:[1,0]
  v_pk_fma_f32 v[40:41], v[108:109], v[140:141], v[40:41] neg_lo:[0,0,1] neg_hi:[0,0,1]
  v_pk_fma_f32 v[42:43], v[110:111], v[142:143], v[42:43] neg_lo:[0,0,1] neg_hi:[0,0,1]
  v_cvt_pk_bf16_f32 v50, v40, v41
  v_cvt_pk_bf16_f32 v51, v42, v43
  s_nop 1
  v_permlane32_swap_b32 v48, v50
  v_permlane32_swap_b32 v49, v51
  s_nop 1
  ds_write_b128 v25, v[48:51] offset:640
  v_pk_mul_f32 v[36:37], v[176:177], v[34:35] op_sel_hi:[1,0]
  v_pk_mul_f32 v[38:39], v[178:179], v[34:35] op_sel_hi:[1,0]
  v_pk_fma_f32 v[36:37], v[112:113], v[144:145], v[36:37] neg_lo:[0,0,1] neg_hi:[0,0,1]
  v_pk_fma_f32 v[38:39], v[114:115], v[146:147], v[38:39] neg_lo:[0,0,1] neg_hi:[0,0,1]
  v_cvt_pk_bf16_f32 v44, v36, v37
  v_cvt_pk_bf16_f32 v45, v38, v39
  v_pk_mul_f32 v[40:41], v[180:181], v[34:35] op_sel_hi:[1,0]
  v_pk_mul_f32 v[42:43], v[182:183], v[34:35] op_sel_hi:[1,0]
  v_pk_fma_f32 v[40:41], v[116:117], v[148:149], v[40:41] neg_lo:[0,0,1] neg_hi:[0,0,1]
  v_pk_fma_f32 v[42:43], v[118:119], v[150:151], v[42:43] neg_lo:[0,0,1] neg_hi:[0,0,1]
  v_cvt_pk_bf16_f32 v46, v40, v41
  v_cvt_pk_bf16_f32 v47, v42, v43
  s_nop 1
  v_permlane32_swap_b32 v44, v46
  v_permlane32_swap_b32 v45, v47
  s_nop 1
  v_xor_b32 v25, 16384, v25
  ds_write_b128 v25, v[44:47] offset:0
  v_pk_mul_f32 v[36:37], v[184:185], v[34:35] op_sel_hi:[1,0]
  v_pk_mul_f32 v[38:39], v[186:187], v[34:35] op_sel_hi:[1,0]
  v_pk_fma_f32 v[36:37], v[120:121], v[152:153], v[36:37] neg_lo:[0,0,1] neg_hi:[0,0,1]
  v_pk_fma_f32 v[38:39], v[122:123], v[154:155], v[38:39] neg_lo:[0,0,1] neg_hi:[0,0,1]
  v_cvt_pk_bf16_f32 v48, v36, v37
  v_cvt_pk_bf16_f32 v49, v38, v39
  v_pk_mul_f32 v[40:41], v[188:189], v[34:35] op_sel_hi:[1,0]
  v_pk_mul_f32 v[42:43], v[190:191], v[34:35] op_sel_hi:[1,0]
  v_pk_fma_f32 v[40:41], v[124:125], v[156:157], v[40:41] neg_lo:[0,0,1] neg_hi:[0,0,1]
  v_pk_fma_f32 v[42:43], v[126:127], v[158:159], v[42:43] neg_lo:[0,0,1] neg_hi:[0,0,1]
  v_cvt_pk_bf16_f32 v50, v40, v41
  v_cvt_pk_bf16_f32 v51, v42, v43
  s_nop 1
  v_permlane32_swap_b32 v48, v50
  v_permlane32_swap_b32 v49, v51
  s_nop 1
  ds_write_b128 v25, v[48:51] offset:640
  s_waitcnt lgkmcnt(0)
  s_barrier
  ds_read_b128 v[64:67], v218 offset:0
  ds_read_b128 v[68:71], v218 offset:1024
  ds_read_b128 v[72:75], v218 offset:2048
  ds_read_b128 v[76:79], v218 offset:3072
  ds_read_b128 v[80:83], v218 offset:4096
  ds_read_b128 v[84:87], v218 offset:5120
  ds_read_b128 v[88:91], v218 offset:6144
  ds_read_b128 v[92:95], v218 offset:7168
  ds_read_b128 v[96:99], v218 offset:8192
  ds_read_b128 v[100:103], v218 offset:9216
  s_waitcnt lgkmcnt(9)
  buffer_store_dwordx4 v[64:67], v208, s[48:51], s54 offen sc1
  s_waitcnt lgkmcnt(8)
  buffer_store_dwordx4 v[68:71], v209, s[48:51], s54 offen sc1
  s_waitcnt lgkmcnt(7)
  buffer_store_dwordx4 v[72:75], v210, s[48:51], s54 offen sc1
  s_waitcnt lgkmcnt(6)
  buffer_store_dwordx4 v[76:79], v211, s[48:51], s54 offen sc1
  s_waitcnt lgkmcnt(5)
  buffer_store_dwordx4 v[80:83], v212, s[48:51], s54 offen sc1
  s_waitcnt lgkmcnt(4)
  buffer_store_dwordx4 v[84:87], v213, s[48:51], s54 offen sc1
  s_waitcnt lgkmcnt(3)
  buffer_store_dwordx4 v[88:91], v214, s[48:51], s54 offen sc1
  s_waitcnt lgkmcnt(2)
  buffer_store_dwordx4 v[92:95], v215, s[48:51], s54 offen sc1
  s_waitcnt lgkmcnt(1)
  buffer_store_dwordx4 v[96:99], v216, s[48:51], s54 offen sc1
  s_waitcnt lgkmcnt(0)
  buffer_store_dwordx4 v[100:103], v217, s[48:51], s54 offen sc1
  s_waitcnt vmcnt(0)
  s_mov_b64 exec, 1
  v_mov_b32 v1, 147456
  v_mov_b32 v2, 1
  ds_add_rtn_u32 v3, v1, v2
  s_lshl_b32 s37, s24, 7
  s_lshl_b32 s38, s25, 2
  s_add_u32 s37, s37, s38
  s_add_u32 s37, s37, 9211904
  s_waitcnt lgkmcnt(0)
  v_readfirstlane_b32 s38, v3
  s_and_b32 s38, s38, 3
  s_cmp_eq_u32 s38, 3
  s_cbranch_scc0 f0_kernel_p4_nosig26
  s_and_b32 s39, s2, 7
  s_lshl_b32 s37, s39, 7
  s_add_u32 s37, s37, 9211904
  s_cmp_eq_u32 s63, 0
  s_cbranch_scc1 f0_kernel_p4_fastsig27
  buffer_wbl2 sc1
  s_waitcnt vmcnt(0)
  buffer_atomic_add v2, off, s[48:51], s37 sc0 sc1
  s_branch f0_kernel_p4_arrived28
f0_kernel_p4_fastsig27:
  buffer_atomic_add v2, off, s[48:51], s37 sc0
f0_kernel_p4_arrived28:
  s_lshl_b32 s37, s39, 2
  s_add_u32 s37, s37, 9213952
  s_add_u32 s39, s63, 1
  s_waitcnt vmcnt(0)
  v_readfirstlane_b32 s38, v2
  s_cmp_eq_u32 s38, 29
  s_cbranch_scc0 f0_kernel_p4_nosig26
  s_mov_b64 exec, 0xff
  v_lshlrev_b32 v1, 7, v0
  v_mov_b32 v2, s39
  buffer_store_dword v2, v1, s[48:51], s37 offen sc1
f0_kernel_p4_nosig26:
  s_mov_b64 exec, -1
  s_branch f0_kernel_p5_entry
f0_kernel_p5_entry:
  s_mov_b32 s26, s64
  s_and_b32 s20, s2, 7
  s_lshr_b32 s21, s2, 3
  s_mov_b32 s24, s21
  v_lshlrev_b32 v4, 4, v0
  s_and_b32 s33, s26, 3
  s_mul_i32 s50, s24, 163840
  s_add_u32 s50, s50, 46137344
  s_lshl_b32 s25, s20, 3
  s_lshl_b32 s23, s33, 1
  s_add_u32 s25, s25, s23
  s_lshl_b32 s27, s24, 6
  s_add_u32 s27, s27, s25
  s_mul_i32 s27, s27, 1280
  s_add_u32 s27, s27, 42991616
  s_add_u32 s28, s27, 1280
  s_cmp_lt_u32 s26, 4
  s_cbranch_scc1 f0_kernel_p5_compute
  s_lshl_b32 s29, s33, 12
  s_waitcnt lgkmcnt(0)
  s_mov_b32 s12, s6
  s_mov_b32 s13, s7
  s_mov_b32 s14, 0x3200000
  s_mov_b32 s15, 0x00020000
  s_add_u32 s32, s50, s29
  s_cmp_lg_u32 s33, 0
  s_cbranch_scc1 f0_kernel_p5_nogp
  s_and_b32 s66, s2, 7
  s_lshl_b32 s66, s66, 7
  s_add_u32 s66, s66, 9213952
  v_lshlrev_b32 v10, 2, v0
  s_mov_b64 exec, 0xff
  s_mov_b32 s65, 16384
f0_kernel_p5_gpoll:
  buffer_load_dword v11, v10, s[12:15], s66 offen sc1
  s_waitcnt vmcnt(0)
  v_cmp_ne_u32 vcc, 0, v11
  s_nop 1
  s_cmp_eq_u32 vcc_lo, 0xff
  s_cbranch_scc1 f0_kernel_p5_gpolled
  s_sleep 1
  s_sub_u32 s65, s65, 1
  s_cbranch_scc0 f0_kernel_p5_gpoll
f0_kernel_p5_gpolled:
  v_cmp_lt_u32 vcc, 1, v11
  s_nop 1
  s_cmp_eq_u32 vcc_lo, 0
  s_mov_b64 exec, -1
  s_cbranch_scc1 f0_kernel_p5_gnoacq
  buffer_inv sc1
  s_waitcnt vmcnt(0)
f0_kernel_p5_gnoacq:
f0_kernel_p5_nogp:
  s_barrier
  s_add_u32 m0, s29, 0
  s_add_u32 s31, s32, 0
  buffer_load_dwordx4 v4, s[12:15], s31 offen offset:0 lds
  buffer_load_dwordx4 v4, s[12:15], s31 offen offset:1024 lds
  buffer_load_dwordx4 v4, s[12:15], s31 offen offset:2048 lds
  buffer_load_dwordx4 v4, s[12:15], s31 offen offset:3072 lds
  s_waitcnt vmcnt(0)
  s_barrier
  s_add_u32 m0, s29, 16384
  s_add_u32 s31, s32, 16384
  buffer_load_dwordx4 v4, s[12:15], s31 offen offset:0 lds
  buffer_load_dwordx4 v4, s[12:15], s31 offen offset:1024 lds
  buffer_load_dwordx4 v4, s[12:15], s31 offen offset:2048 lds
  buffer_load_dwordx4 v4, s[12:15], s31 offen offset:3072 lds
  s_add_u32 m0, s29, 32768
  s_add_u32 s31, s32, 32768
  buffer_load_dwordx4 v4, s[12:15], s31 offen offset:0 lds
  buffer_load_dwordx4 v4, s[12:15], s31 offen offset:1024 lds
  buffer_load_dwordx4 v4, s[12:15], s31 offen offset:2048 lds
  buffer_load_dwordx4 v4, s[12:15], s31 offen offset:3072 lds
  s_add_u32 m0, s29, 49152
  s_add_u32 s31, s32, 49152
  buffer_load_dwordx4 v4, s[12:15], s31 offen offset:0 lds
  buffer_load_dwordx4 v4, s[12:15], s31 offen offset:1024 lds
  buffer_load_dwordx4 v4, s[12:15], s31 offen offset:2048 lds
  buffer_load_dwordx4 v4, s[12:15], s31 offen offset:3072 lds
  s_waitcnt vmcnt(8)
  s_barrier
  s_add_u32 m0, s29, 65536
  s_add_u32 s31, s32, 65536
  buffer_load_dwordx4 v4, s[12:15], s31 offen offset:0 lds
  buffer_load_dwordx4 v4, s[12:15], s31 offen offset:1024 lds
  buffer_load_dwordx4 v4, s[12:15], s31 offen offset:2048 lds
  buffer_load_dwordx4 v4, s[12:15], s31 offen offset:3072 lds
  s_add_u32 m0, s29, 81920
  s_add_u32 s31, s32, 81920
  buffer_load_dwordx4 v4, s[12:15], s31 offen offset:0 lds
  buffer_load_dwordx4 v4, s[12:15], s31 offen offset:1024 lds
  buffer_load_dwordx4 v4, s[12:15], s31 offen offset:2048 lds
  buffer_load_dwordx4 v4, s[12:15], s31 offen offset:3072 lds
  s_waitcnt vmcnt(8)
  s_barrier
  s_add_u32 m0, s29, 98304
  s_add_u32 s31, s32, 98304
  buffer_load_dwordx4 v4, s[12:15], s31 offen offset:0 lds
  buffer_load_dwordx4 v4, s[12:15], s31 offen offset:1024 lds
  buffer_load_dwordx4 v4, s[12:15], s31 offen offset:2048 lds
  buffer_load_dwordx4 v4, s[12:15], s31 offen offset:3072 lds
  s_add_u32 m0, s29, 114688
  s_add_u32 s31, s32, 114688
  buffer_load_dwordx4 v4, s[12:15], s31 offen offset:0 lds
  buffer_load_dwordx4 v4, s[12:15], s31 offen offset:1024 lds
  buffer_load_dwordx4 v4, s[12:15], s31 offen offset:2048 lds
  buffer_load_dwordx4 v4, s[12:15], s31 offen offset:3072 lds
  s_add_u32 m0, s29, 131072
  s_add_u32 s31, s32, 131072
  buffer_load_dwordx4 v4, s[12:15], s31 offen offset:0 lds
  buffer_load_dwordx4 v4, s[12:15], s31 offen offset:1024 lds
  buffer_load_dwordx4 v4, s[12:15], s31 offen offset:2048 lds
  buffer_load_dwordx4 v4, s[12:15], s31 offen offset:3072 lds
  s_add_u32 m0, s29, 147456
  s_add_u32 s31, s32, 147456
  buffer_load_dwordx4 v4, s[12:15], s31 offen offset:0 lds
  buffer_load_dwordx4 v4, s[12:15], s31 offen offset:1024 lds
  buffer_load_dwordx4 v4, s[12:15], s31 offen offset:2048 lds
  buffer_load_dwordx4 v4, s[12:15], s31 offen offset:3072 lds
  v_and_b32 v5, 31, v0
  v_lshlrev_b32 v6, 3, v5
  v_mov_b32 v12, 0
  v_mov_b32 v13, 0
  v_mov_b32 v14, 0
  v_mov_b32 v15, 0
  buffer_load_dwordx4 v[8:11], v4, s[12:15], s27 offen
  buffer_load_dwordx4 v[28:31], v4, s[12:15], s28 offen
  s_mov_b64 exec, 0xffffffff
  buffer_load_dwordx2 v[12:13], v6, s[12:15], s27 offen offset:1024
  buffer_load_dwordx2 v[14:15], v6, s[12:15], s28 offen offset:1024
  s_mov_b64 exec, -1
  v_and_b32 v5, 31, v0
  v_and_b32 v6, 0x13, v5
  v_and_b32 v7, 4, v5
  v_lshl_or_b32 v6, v7, 1, v6
  v_and_b32 v7, 8, v5
  v_lshrrev_b32 v7, 1, v7
  v_or_b32 v6, v6, v7
  v_lshrrev_b32 v7, 5, v0
  v_lshlrev_b32 v1, 9, v7
  v_lshl_add_u32 v1, v6, 4, v1
  v_lshlrev_b32 v2, 3, v6
  v_add_u32 v2, 1024, v2
  v_mul_u32_u24 v3, 320, v7
  v_lshl_add_u32 v3, v5, 4, v3
  v_add_u32 v3, 1280, v3
  v_cmp_eq_u32 vcc, 20, v5
  v_mov_b32 v7, 0x3f803f80
  s_mov_b32 s34, 0x000fffff
  s_mov_b32 s35, 0x000fffff
  v_cndmask_b32 v32, 0, v7, vcc
  v_mov_b32 v33, v32
  v_mov_b32 v34, v32
  v_mov_b32 v35, v32
  v_mov_b32 v36, v32
  v_mov_b32 v37, v32
  v_mov_b32 v38, v32
  v_mov_b32 v39, v32
  v_mov_b32 v40, v32
  v_mov_b32 v41, v32
  v_mov_b32 v42, v32
  v_mov_b32 v43, v32
  v_mov_b32 v44, v32
  v_mov_b32 v45, v32
  v_mov_b32 v46, v32
  v_mov_b32 v47, v32
  v_mov_b32 v96, 0
  v_mov_b32 v97, 0
  v_mov_b32 v98, 0
  v_mov_b32 v99, 0
  v_mov_b32 v100, 0
  v_mov_b32 v101, 0
  v_mov_b32 v102, 0
  v_mov_b32 v103, 0
  v_mov_b32 v104, 0
  v_mov_b32 v105, 0
  v_mov_b32 v106, 0
  v_mov_b32 v107, 0
  v_mov_b32 v108, 0
  v_mov_b32 v109, 0
  v_mov_b32 v110, 0
  v_mov_b32 v111, 0
  v_mov_b32 v112, 0
  v_mov_b32 v113, 0
  v_mov_b32 v114, 0
  v_mov_b32 v115, 0
  v_mov_b32 v116, 0
  v_mov_b32 v117, 0
  v_mov_b32 v118, 0
  v_mov_b32 v119, 0
  v_mov_b32 v120, 0
  v_mov_b32 v121, 0
  v_mov_b32 v122, 0
  v_mov_b32 v123, 0
  v_mov_b32 v124, 0
  v_mov_b32 v125, 0
  v_mov_b32 v126, 0
  v_mov_b32 v127, 0
  v_mov_b32 v84, 0
  v_mov_b32 v85, 0
  v_mov_b32 v86, 0
  v_mov_b32 v87, 0
  v_add_u32 v1, 143360, v1
  v_add_u32 v2, 143360, v2
  v_add_u32 v3, 143360, v3
  s_waitcnt vmcnt(0)
  s_barrier
  s_mul_i32 s40, s24, 5
  s_lshr_b32 s40, s40, 1
  s_lshl_b32 s40, s40, 9
  s_mul_i32 s41, s25, 40960
  s_add_u32 s40, s40, s41
  s_add_u32 s40, s40, 18874368
  v_lshlrev_b32 v90, 7, v0
  v_add_u32 v91, 39424, v90
  v_cmp_gt_u32 vcc, 12, v0
  s_nop 1
  v_cndmask_b32 v90, v91, v90, vcc
  s_mov_b64 exec, 0xffffff
  buffer_load_dword v91, v90, s[12:15], s40 offen
  s_mov_b64 exec, -1
  s_lshr_b32 s41, s25, 1
  s_mul_i32 s40, s41, 81920
  s_mul_i32 s42, s24, 2560
  s_add_u32 s40, s40, s42
  s_add_u32 s40, s40, 12582912
  v_lshlrev_b32 v92, 7, v0
  s_mov_b64 exec, 0xfffff
  buffer_load_dword v93, v92, s[12:15], s40 offen
  s_lshr_b32 s40, s24, 1
  s_lshl_b32 s40, s40, 14
  s_lshl_b32 s41, s41, 9
  s_add_u32 s40, s40, s41
  s_and_b32 s41, s24, 1
  s_lshl_b32 s41, s41, 8
  s_add_u32 s40, s40, s41
  s_add_u32 s40, s40, 8912896
  s_mov_b64 exec, 3
  buffer_load_dword v94, v92, s[12:15], s40 offen
  s_mov_b64 exec, -1
  ds_read_b128 v[16:19], v1 offset:0
  ds_read_b64 v[24:25], v2 offset:0
  ds_read_b128 v[20:23], v1 offset:2560
  ds_read_b64 v[26:27], v2 offset:2560
  s_mov_b64 exec, s[34:35]
  ds_read_b128 v[32:35], v3 offset:0
  ds_read_b128 v[36:39], v3 offset:640
  s_mov_b64 exec, -1
  s_waitcnt lgkmcnt(4)
  v_mfma_f32_32x32x16_bf16 v[48:63], v[16:19], v[8:11], 0
  s_mov_b32 s36, 1
  s_nop 7
  s_nop 1
  v_mfma_f32_32x32x8bf16_1k v[48:63], v[24:25], v[12:13], v[48:63]
  s_nop 7
  s_nop 3
f0_kernel_p5_looph:
  s_cmp_eq_u32 s36, 1
  s_cselect_b32 s37, 0, 20480
  s_waitcnt lgkmcnt(0)
  v_mfma_f32_32x32x16_bf16 v[64:79], v[16:19], v[28:31], 0
  v_exp_f32 v48, v48
  v_exp_f32 v49, v49
  v_exp_f32 v50, v50
  v_exp_f32 v51, v51
  v_cvt_pk_bf16_f32 v80, v48, v49
  v_cvt_pk_bf16_f32 v81, v50, v51
  v_mfma_f32_32x32x16_bf16 v[112:127], v[44:47], v[84:87], v[112:127]
  v_exp_f32 v52, v52
  s_mov_b64 exec, s[34:35]
  ds_read_b128 v[40:43], v3 offset:2560
  ds_read_b128 v[44:47], v3 offset:3200
  s_mov_b64 exec, -1
  v_exp_f32 v53, v53
  v_exp_f32 v54, v54
  v_exp_f32 v55, v55
  v_cvt_pk_bf16_f32 v82, v52, v53
  v_cvt_pk_bf16_f32 v83, v54, v55
  v_mfma_f32_32x32x8bf16_1k v[64:79], v[24:25], v[14:15], v[64:79]
  v_exp_f32 v56, v56
  ds_read_b128 v[16:19], v1 offset:5120
  v_exp_f32 v57, v57
  ds_read_b64 v[24:25], v2 offset:5120
  v_exp_f32 v58, v58
  v_exp_f32 v59, v59
  v_cvt_pk_bf16_f32 v84, v56, v57
  v_cvt_pk_bf16_f32 v85, v58, v59
  v_mfma_f32_32x32x16_bf16 v[96:111], v[32:35], v[80:83], v[96:111]
  v_exp_f32 v60, v60
  v_exp_f32 v61, v61
  v_exp_f32 v62, v62
  v_exp_f32 v63, v63
  v_cvt_pk_bf16_f32 v86, v60, v61
  v_cvt_pk_bf16_f32 v87, v62, v63
  v_mfma_f32_32x32x16_bf16 v[48:63], v[20:23], v[8:11], 0
  v_exp_f32 v64, v64
  v_exp_f32 v65, v65
  v_exp_f32 v66, v66
  v_exp_f32 v67, v67
  v_cvt_pk_bf16_f32 v80, v64, v65
  v_cvt_pk_bf16_f32 v81, v66, v67
  v_mfma_f32_32x32x16_bf16 v[96:111], v[36:39], v[84:87], v[96:111]
  v_exp_f32 v68, v68
  v_exp_f32 v69, v69
  v_exp_f32 v70, v70
  v_exp_f32 v71, v71
  v_cvt_pk_bf16_f32 v82, v68, v69
  v_cvt_pk_bf16_f32 v83, v70, v71
  v_mfma_f32_32x32x8bf16_1k v[48:63], v[26:27], v[12:13], v[48:63]
  v_exp_f32 v72, v72
  v_exp_f32 v73, v73
  v_exp_f32 v74, v74
  v_exp_f32 v75, v75
  v_cvt_pk_bf16_f32 v84, v72, v73
  v_cvt_pk_bf16_f32 v85, v74, v75
  v_mfma_f32_32x32x16_bf16 v[112:127], v[32:35], v[80:83], v[112:127]
  v_exp_f32 v76, v76
  v_exp_f32 v77, v77
  v_exp_f32 v78, v78
  v_exp_f32 v79, v79
  v_cvt_pk_bf16_f32 v86, v76, v77
  v_cvt_pk_bf16_f32 v87, v78, v79
  s_waitcnt lgkmcnt(0)
  v_mfma_f32_32x32x16_bf16 v[64:79], v[20:23], v[28:31], 0
  v_exp_f32 v48, v48
  v_exp_f32 v49, v49
  v_exp_f32 v50, v50
  v_exp_f32 v51, v51
  v_cvt_pk_bf16_f32 v80, v48, v49
  v_cvt_pk_bf16_f32 v81, v50, v51
  v_mfma_f32_32x32x16_bf16 v[112:127], v[36:39], v[84:87], v[112:127]
  v_exp_f32 v52, v52
  s_mov_b64 exec, s[34:35]
  ds_read_b128 v[32:35], v3 offset:5120
  ds_read_b128 v[36:39], v3 offset:5760
  s_mov_b64 exec, -1
  v_exp_f32 v53, v53
  v_exp_f32 v54, v54
  v_exp_f32 v55, v55
  v_cvt_pk_bf16_f32 v82, v52, v53
  v_cvt_pk_bf16_f32 v83, v54, v55
  v_mfma_f32_32x32x8bf16_1k v[64:79], v[26:27], v[14:15], v[64:79]
  v_exp_f32 v56, v56
  ds_read_b128 v[20:23], v1 offset:7680
  v_exp_f32 v57, v57
  ds_read_b64 v[26:27], v2 offset:7680
  v_exp_f32 v58, v58
  v_exp_f32 v59, v59
  v_cvt_pk_bf16_f32 v84, v56, v57
  v_cvt_pk_bf16_f32 v85, v58, v59
  v_mfma_f32_32x32x16_bf16 v[96:111], v[40:43], v[80:83], v[96:111]
  v_exp_f32 v60, v60
  v_exp_f32 v61, v61
  v_exp_f32 v62, v62
  v_exp_f32 v63, v63
  v_cvt_pk_bf16_f32 v86, v60, v61
  v_cvt_pk_bf16_f32 v87, v62, v63
  v_mfma_f32_32x32x16_bf16 v[48:63], v[16:19], v[8:11], 0
  v_exp_f32 v64, v64
  v_exp_f32 v65, v65
  v_exp_f32 v66, v66
  v_exp_f32 v67, v67
  v_cvt_pk_bf16_f32 v80, v64, v65
  v_cvt_pk_bf16_f32 v81, v66, v67
  v_mfma_f32_32x32x16_bf16 v[96:111], v[44:47], v[84:87], v[96:111]
  v_exp_f32 v68, v68
  v_exp_f32 v69, v69
  v_exp_f32 v70, v70
  v_exp_f32 v71, v71
  v_cvt_pk_bf16_f32 v82, v68, v69
  v_cvt_pk_bf16_f32 v83, v70, v71
  v_mfma_f32_32x32x8bf16_1k v[48:63], v[24:25], v[12:13], v[48:63]
  v_exp_f32 v72, v72
  v_exp_f32 v73, v73
  v_exp_f32 v74, v74
  v_exp_f32 v75, v75
  v_cvt_pk_bf16_f32 v84, v72, v73
  v_cvt_pk_bf16_f32 v85, v74, v75
  v_mfma_f32_32x32x16_bf16 v[112:127], v[40:43], v[80:83], v[112:127]
  v_exp_f32 v76, v76
  v_exp_f32 v77, v77
  v_exp_f32 v78, v78
  v_exp_f32 v79, v79
  v_cvt_pk_bf16_f32 v86, v76, v77
  v_cvt_pk_bf16_f32 v87, v78, v79
  s_waitcnt lgkmcnt(0)
  v_mfma_f32_32x32x16_bf16 v[64:79], v[16:19], v[28:31], 0
  v_exp_f32 v48, v48
  v_exp_f32 v49, v49
  v_exp_f32 v50, v50
  v_exp_f32 v51, v51
  v_cvt_pk_bf16_f32 v80, v48, v49
  v_cvt_pk_bf16_f32 v81, v50, v51
  v_mfma_f32_32x32x16_bf16 v[112:127], v[44:47], v[84:87], v[112:127]
  v_exp_f32 v52, v52
  s_mov_b64 exec, s[34:35]
  ds_read_b128 v[40:43], v3 offset:7680
  ds_read_b128 v[44:47], v3 offset:8320
  s_mov_b64 exec, -1
  v_exp_f32 v53, v53
  v_exp_f32 v54, v54
  v_exp_f32 v55, v55
  v_cvt_pk_bf16_f32 v82, v52, v53
  v_cvt_pk_bf16_f32 v83, v54, v55
  v_mfma_f32_32x32x8bf16_1k v[64:79], v[24:25], v[14:15], v[64:79]
  v_exp_f32 v56, v56
  ds_read_b128 v[16:19], v1 offset:10240
  v_exp_f32 v57, v57
  ds_read_b64 v[24:25], v2 offset:10240
  v_exp_f32 v58, v58
  v_exp_f32 v59, v59
  v_cvt_pk_bf16_f32 v84, v56, v57
  v_cvt_pk_bf16_f32 v85, v58, v59
  v_mfma_f32_32x32x16_bf16 v[96:111], v[32:35], v[80:83], v[96:111]
  v_exp_f32 v60, v60
  v_exp_f32 v61, v61
  v_exp_f32 v62, v62
  v_exp_f32 v63, v63
  v_cvt_pk_bf16_f32 v86, v60, v61
  v_cvt_pk_bf16_f32 v87, v62, v63
  v_mfma_f32_32x32x16_bf16 v[48:63], v[20:23], v[8:11], 0
  v_exp_f32 v64, v64
  v_exp_f32 v65, v65
  v_exp_f32 v66, v66
  v_exp_f32 v67, v67
  v_cvt_pk_bf16_f32 v80, v64, v65
  v_cvt_pk_bf16_f32 v81, v66, v67
  v_mfma_f32_32x32x16_bf16 v[96:111], v[36:39], v[84:87], v[96:111]
  v_exp_f32 v68, v68
  v_exp_f32 v69, v69
  v_exp_f32 v70, v70
  v_exp_f32 v71, v71
  v_cvt_pk_bf16_f32 v82, v68, v69
  v_cvt_pk_bf16_f32 v83, v70, v71
  v_mfma_f32_32x32x8bf16_1k v[48:63], v[26:27], v[12:13], v[48:63]
  v_exp_f32 v72, v72
  v_exp_f32 v73, v73
  v_exp_f32 v74, v74
  v_exp_f32 v75, v75
  v_cvt_pk_bf16_f32 v84, v72, v73
  v_cvt_pk_bf16_f32 v85, v74, v75
  v_mfma_f32_32x32x16_bf16 v[112:127], v[32:35], v[80:83], v[112:127]
  v_exp_f32 v76, v76
  v_exp_f32 v77, v77
  v_exp_f32 v78, v78
  v_exp_f32 v79, v79
  v_cvt_pk_bf16_f32 v86, v76, v77
  v_cvt_pk_bf16_f32 v87, v78, v79
  s_waitcnt lgkmcnt(0)
  v_mfma_f32_32x32x16_bf16 v[64:79], v[20:23], v[28:31], 0
  v_exp_f32 v48, v48
  v_exp_f32 v49, v49
  v_exp_f32 v50, v50
  v_exp_f32 v51, v51
  v_cvt_pk_bf16_f32 v80, v48, v49
  v_cvt_pk_bf16_f32 v81, v50, v51
  v_mfma_f32_32x32x16_bf16 v[112:127], v[36:39], v[84:87], v[112:127]
  v_exp_f32 v52, v52
  s_mov_b64 exec, s[34:35]
  ds_read_b128 v[32:35], v3 offset:10240
  ds_read_b128 v[36:39], v3 offset:10880
  s_mov_b64 exec, -1
  v_exp_f32 v53, v53
  v_exp_f32 v54, v54
  v_exp_f32 v55, v55
  v_cvt_pk_bf16_f32 v82, v52, v53
  v_cvt_pk_bf16_f32 v83, v54, v55
  v_mfma_f32_32x32x8bf16_1k v[64:79], v[26:27], v[14:15], v[64:79]
  v_exp_f32 v56, v56
  ds_read_b128 v[20:23], v1 offset:12800
  v_exp_f32 v57, v57
  ds_read_b64 v[26:27], v2 offset:12800
  v_exp_f32 v58, v58
  v_exp_f32 v59, v59
  v_cvt_pk_bf16_f32 v84, v56, v57
  v_cvt_pk_bf16_f32 v85, v58, v59
  v_mfma_f32_32x32x16_bf16 v[96:111], v[40:43], v[80:83], v[96:111]
  v_exp_f32 v60, v60
  v_exp_f32 v61, v61
  v_exp_f32 v62, v62
  v_exp_f32 v63, v63
  v_cvt_pk_bf16_f32 v86, v60, v61
  v_cvt_pk_bf16_f32 v87, v62, v63
  v_mfma_f32_32x32x16_bf16 v[48:63], v[16:19], v[8:11], 0
  v_exp_f32 v64, v64
  v_exp_f32 v65, v65
  v_exp_f32 v66, v66
  v_exp_f32 v67, v67
  v_cvt_pk_bf16_f32 v80, v64, v65
  v_cvt_pk_bf16_f32 v81, v66, v67
  v_mfma_f32_32x32x16_bf16 v[96:111], v[44:47], v[84:87], v[96:111]
  v_exp_f32 v68, v68
  v_exp_f32 v69, v69
  v_exp_f32 v70, v70
  v_exp_f32 v71, v71
  v_cvt_pk_bf16_f32 v82, v68, v69
  v_cvt_pk_bf16_f32 v83, v70, v71
  v_mfma_f32_32x32x8bf16_1k v[48:63], v[24:25], v[12:13], v[48:63]
  v_exp_f32 v72, v72
  v_exp_f32 v73, v73
  v_exp_f32 v74, v74
  v_exp_f32 v75, v75
  v_cvt_pk_bf16_f32 v84, v72, v73
  v_cvt_pk_bf16_f32 v85, v74, v75
  v_mfma_f32_32x32x16_bf16 v[112:127], v[40:43], v[80:83], v[112:127]
  v_exp_f32 v76, v76
  v_exp_f32 v77, v77
  v_exp_f32 v78, v78
  v_exp_f32 v79, v79
  v_cvt_pk_bf16_f32 v86, v76, v77
  v_cvt_pk_bf16_f32 v87, v78, v79
  s_waitcnt lgkmcnt(0)
  v_mfma_f32_32x32x16_bf16 v[64:79], v[16:19], v[28:31], 0
  v_exp_f32 v48, v48
  v_exp_f32 v49, v49
  v_exp_f32 v50, v50
  v_exp_f32 v51, v51
  v_cvt_pk_bf16_f32 v80, v48, v49
  v_cvt_pk_bf16_f32 v81, v50, v51
  v_mfma_f32_32x32x16_bf16 v[112:127], v[44:47], v[84:87], v[112:127]
  v_exp_f32 v52, v52
  s_mov_b64 exec, s[34:35]
  ds_read_b128 v[40:43], v3 offset:12800
  ds_read_b128 v[44:47], v3 offset:13440
  s_mov_b64 exec, -1
  v_exp_f32 v53, v53
  v_exp_f32 v54, v54
  v_exp_f32 v55, v55
  v_cvt_pk_bf16_f32 v82, v52, v53
  v_cvt_pk_bf16_f32 v83, v54, v55
  v_mfma_f32_32x32x8bf16_1k v[64:79], v[24:25], v[14:15], v[64:79]
  v_exp_f32 v56, v56
  ds_read_b128 v[16:19], v1 offset:15360
  v_exp_f32 v57, v57
  ds_read_b64 v[24:25], v2 offset:15360
  v_exp_f32 v58, v58
  v_exp_f32 v59, v59
  v_cvt_pk_bf16_f32 v84, v56, v57
  v_cvt_pk_bf16_f32 v85, v58, v59
  v_mfma_f32_32x32x16_bf16 v[96:111], v[32:35], v[80:83], v[96:111]
  v_exp_f32 v60, v60
  v_exp_f32 v61, v61
  v_exp_f32 v62, v62
  v_exp_f32 v63, v63
  v_cvt_pk_bf16_f32 v86, v60, v61
  v_cvt_pk_bf16_f32 v87, v62, v63
  v_mfma_f32_32x32x16_bf16 v[48:63], v[20:23], v[8:11], 0
  v_exp_f32 v64, v64
  v_exp_f32 v65, v65
  v_exp_f32 v66, v66
  v_exp_f32 v67, v67
  v_cvt_pk_bf16_f32 v80, v64, v65
  v_cvt_pk_bf16_f32 v81, v66, v67
  v_mfma_f32_32x32x16_bf16 v[96:111], v[36:39], v[84:87], v[96:111]
  v_exp_f32 v68, v68
  v_exp_f32 v69, v69
  v_exp_f32 v70, v70
  v_exp_f32 v71, v71
  v_cvt_pk_bf16_f32 v82, v68, v69
  v_cvt_pk_bf16_f32 v83, v70, v71
  v_mfma_f32_32x32x8bf16_1k v[48:63], v[26:27], v[12:13], v[48:63]
  v_exp_f32 v72, v72
  v_exp_f32 v73, v73
  v_exp_f32 v74, v74
  v_exp_f32 v75, v75
  v_cvt_pk_bf16_f32 v84, v72, v73
  v_cvt_pk_bf16_f32 v85, v74, v75
  v_mfma_f32_32x32x16_bf16 v[112:127], v[32:35], v[80:83], v[112:127]
  v_exp_f32 v76, v76
  v_exp_f32 v77, v77
  v_exp_f32 v78, v78
  v_exp_f32 v79, v79
  v_cvt_pk_bf16_f32 v86, v76, v77
  v_cvt_pk_bf16_f32 v87, v78, v79
  s_waitcnt lgkmcnt(0)
  v_mfma_f32_32x32x16_bf16 v[64:79], v[20:23], v[28:31], 0
  v_exp_f32 v48, v48
  v_exp_f32 v49, v49
  v_exp_f32 v50, v50
  v_exp_f32 v51, v51
  v_cvt_pk_bf16_f32 v80, v48, v49
  v_cvt_pk_bf16_f32 v81, v50, v51
  v_mfma_f32_32x32x16_bf16 v[112:127], v[36:39], v[84:87], v[112:127]
  v_exp_f32 v52, v52
  s_mov_b64 exec, s[34:35]
  ds_read_b128 v[32:35], v3 offset:15360
  ds_read_b128 v[36:39], v3 offset:16000
  s_mov_b64 exec, -1
  v_exp_f32 v53, v53
  v_exp_f32 v54, v54
  v_exp_f32 v55, v55
  v_cvt_pk_bf16_f32 v82, v52, v53
  v_cvt_pk_bf16_f32 v83, v54, v55
  v_mfma_f32_32x32x8bf16_1k v[64:79], v[26:27], v[14:15], v[64:79]
  v_exp_f32 v56, v56
  ds_read_b128 v[20:23], v1 offset:17920
  v_exp_f32 v57, v57
  ds_read_b64 v[26:27], v2 offset:17920
  v_exp_f32 v58, v58
  v_exp_f32 v59, v59
  v_cvt_pk_bf16_f32 v84, v56, v57
  v_cvt_pk_bf16_f32 v85, v58, v59
  v_mfma_f32_32x32x16_bf16 v[96:111], v[40:43], v[80:83], v[96:111]
  v_exp_f32 v60, v60
  v_exp_f32 v61, v61
  v_exp_f32 v62, v62
  v_exp_f32 v63, v63
  v_cvt_pk_bf16_f32 v86, v60, v61
  v_cvt_pk_bf16_f32 v87, v62, v63
  v_mfma_f32_32x32x16_bf16 v[48:63], v[16:19], v[8:11], 0
  v_exp_f32 v64, v64
  v_exp_f32 v65, v65
  v_exp_f32 v66, v66
  v_exp_f32 v67, v67
  v_cvt_pk_bf16_f32 v80, v64, v65
  v_cvt_pk_bf16_f32 v81, v66, v67
  v_mfma_f32_32x32x16_bf16 v[96:111], v[44:47], v[84:87], v[96:111]
  v_exp_f32 v68, v68
  v_exp_f32 v69, v69
  v_exp_f32 v70, v70
  v_exp_f32 v71, v71
  v_cvt_pk_bf16_f32 v82, v68, v69
  v_cvt_pk_bf16_f32 v83, v70, v71
  v_mfma_f32_32x32x8bf16_1k v[48:63], v[24:25], v[12:13], v[48:63]
  v_exp_f32 v72, v72
  v_exp_f32 v73, v73
  v_exp_f32 v74, v74
  v_exp_f32 v75, v75
  v_cvt_pk_bf16_f32 v84, v72, v73
  v_cvt_pk_bf16_f32 v85, v74, v75
  v_mfma_f32_32x32x16_bf16 v[112:127], v[40:43], v[80:83], v[112:127]
  v_exp_f32 v76, v76
  v_exp_f32 v77, v77
  v_exp_f32 v78, v78
  v_exp_f32 v79, v79
  v_cvt_pk_bf16_f32 v86, v76, v77
  v_cvt_pk_bf16_f32 v87, v78, v79
  s_waitcnt lgkmcnt(0)
  v_mfma_f32_32x32x16_bf16 v[64:79], v[16:19], v[28:31], 0
  v_exp_f32 v48, v48
  v_exp_f32 v49, v49
  v_exp_f32 v50, v50
  v_exp_f32 v51, v51
  v_cvt_pk_bf16_f32 v80, v48, v49
  v_cvt_pk_bf16_f32 v81, v50, v51
  v_mfma_f32_32x32x16_bf16 v[112:127], v[44:47], v[84:87], v[112:127]
  v_exp_f32 v52, v52
  s_mov_b64 exec, s[34:35]
  ds_read_b128 v[40:43], v3 offset:17920
  ds_read_b128 v[44:47], v3 offset:18560
  s_mov_b64 exec, -1
  v_exp_f32 v53, v53
  v_exp_f32 v54, v54
  v_exp_f32 v55, v55
  v_cvt_pk_bf16_f32 v82, v52, v53
  v_cvt_pk_bf16_f32 v83, v54, v55
  v_mfma_f32_32x32x8bf16_1k v[64:79], v[24:25], v[14:15], v[64:79]
  v_add_u32 v1, s37, v1
  v_add_u32 v2, s37, v2
  v_exp_f32 v56, v56
  ds_read_b128 v[16:19], v1 offset:0
  v_exp_f32 v57, v57
  ds_read_b64 v[24:25], v2 offset:0
  v_exp_f32 v58, v58
  v_exp_f32 v59, v59
  v_cvt_pk_bf16_f32 v84, v56, v57
  v_cvt_pk_bf16_f32 v85, v58, v59
  v_mfma_f32_32x32x16_bf16 v[96:111], v[32:35], v[80:83], v[96:111]
  v_exp_f32 v60, v60
  v_exp_f32 v61, v61
  v_exp_f32 v62, v62
  v_exp_f32 v63, v63
  v_cvt_pk_bf16_f32 v86, v60, v61
  v_cvt_pk_bf16_f32 v87, v62, v63
  v_mfma_f32_32x32x16_bf16 v[48:63], v[20:23], v[8:11], 0
  v_exp_f32 v64, v64
  v_exp_f32 v65, v65
  v_exp_f32 v66, v66
  v_exp_f32 v67, v67
  v_cvt_pk_bf16_f32 v80, v64, v65
  v_cvt_pk_bf16_f32 v81, v66, v67
  v_mfma_f32_32x32x16_bf16 v[96:111], v[36:39], v[84:87], v[96:111]
  v_exp_f32 v68, v68
  v_exp_f32 v69, v69
  v_exp_f32 v70, v70
  v_exp_f32 v71, v71
  v_cvt_pk_bf16_f32 v82, v68, v69
  v_cvt_pk_bf16_f32 v83, v70, v71
  v_mfma_f32_32x32x8bf16_1k v[48:63], v[26:27], v[12:13], v[48:63]
  v_exp_f32 v72, v72
  v_exp_f32 v73, v73
  v_exp_f32 v74, v74
  v_exp_f32 v75, v75
  v_cvt_pk_bf16_f32 v84, v72, v73
  v_cvt_pk_bf16_f32 v85, v74, v75
  v_mfma_f32_32x32x16_bf16 v[112:127], v[32:35], v[80:83], v[112:127]
  v_exp_f32 v76, v76
  v_exp_f32 v77, v77
  v_exp_f32 v78, v78
  v_exp_f32 v79, v79
  v_cvt_pk_bf16_f32 v86, v76, v77
  v_cvt_pk_bf16_f32 v87, v78, v79
  s_waitcnt lgkmcnt(0)
  v_mfma_f32_32x32x16_bf16 v[64:79], v[20:23], v[28:31], 0
  v_exp_f32 v48, v48
  v_exp_f32 v49, v49
  v_exp_f32 v50, v50
  v_exp_f32 v51, v51
  v_cvt_pk_bf16_f32 v80, v48, v49
  v_cvt_pk_bf16_f32 v81, v50, v51
  v_mfma_f32_32x32x16_bf16 v[112:127], v[36:39], v[84:87], v[112:127]
  v_add_u32 v3, s37, v3
  v_exp_f32 v52, v52
  s_mov_b64 exec, s[34:35]
  ds_read_b128 v[32:35], v3 offset:0
  ds_read_b128 v[36:39], v3 offset:640
  s_mov_b64 exec, -1
  v_exp_f32 v53, v53
  v_exp_f32 v54, v54
  v_exp_f32 v55, v55
  v_cvt_pk_bf16_f32 v82, v52, v53
  v_cvt_pk_bf16_f32 v83, v54, v55
  v_mfma_f32_32x32x8bf16_1k v[64:79], v[26:27], v[14:15], v[64:79]
  v_exp_f32 v56, v56
  ds_read_b128 v[20:23], v1 offset:2560
  v_exp_f32 v57, v57
  ds_read_b64 v[26:27], v2 offset:2560
  v_exp_f32 v58, v58
  v_exp_f32 v59, v59
  v_cvt_pk_bf16_f32 v84, v56, v57
  v_cvt_pk_bf16_f32 v85, v58, v59
  v_mfma_f32_32x32x16_bf16 v[96:111], v[40:43], v[80:83], v[96:111]
  v_exp_f32 v60, v60
  v_exp_f32 v61, v61
  v_exp_f32 v62, v62
  v_exp_f32 v63, v63
  v_cvt_pk_bf16_f32 v86, v60, v61
  v_cvt_pk_bf16_f32 v87, v62, v63
  v_mfma_f32_32x32x16_bf16 v[48:63], v[16:19], v[8:11], 0
  v_exp_f32 v64, v64
  v_exp_f32 v65, v65
  v_exp_f32 v66, v66
  v_exp_f32 v67, v67
  v_cvt_pk_bf16_f32 v80, v64, v65
  v_cvt_pk_bf16_f32 v81, v66, v67
  v_mfma_f32_32x32x16_bf16 v[96:111], v[44:47], v[84:87], v[96:111]
  v_exp_f32 v68, v68
  v_exp_f32 v69, v69
  v_exp_f32 v70, v70
  v_exp_f32 v71, v71
  v_cvt_pk_bf16_f32 v82, v68, v69
  v_cvt_pk_bf16_f32 v83, v70, v71
  v_mfma_f32_32x32x8bf16_1k v[48:63], v[24:25], v[12:13], v[48:63]
  v_exp_f32 v72, v72
  v_exp_f32 v73, v73
  v_exp_f32 v74, v74
  v_exp_f32 v75, v75
  v_cvt_pk_bf16_f32 v84, v72, v73
  v_cvt_pk_bf16_f32 v85, v74, v75
  v_mfma_f32_32x32x16_bf16 v[112:127], v[40:43], v[80:83], v[112:127]
  v_exp_f32 v76, v76
  v_exp_f32 v77, v77
  v_exp_f32 v78, v78
  v_exp_f32 v79, v79
  v_cvt_pk_bf16_f32 v86, v76, v77
  v_cvt_pk_bf16_f32 v87, v78, v79
  s_sub_u32 s36, s36, 1
  s_cmp_lg_u32 s36, 0
  s_cbranch_scc1 f0_kernel_p5_looph
  s_nop 0
  v_mfma_f32_32x32x16_bf16 v[112:127], v[44:47], v[84:87], v[112:127]
  s_and_b32 s62, s2, 7
  s_lshl_b32 s62, s62, 7
  s_add_u32 s62, s62, 9216000
  buffer_load_dword v250, off, s[12:15], s62 sc1
  s_lshl_b32 s40, s33, 1
  s_add_u32 s41, s40, 1
  s_add_u32 s40, s40, 0
  s_mul_i32 s41, s41, 2688
  s_mul_i32 s40, s40, 2688
  v_lshlrev_b32 v4, 4, v0
  v_and_b32 v5, 31, v0
  v_lshlrev_b32 v5, 2, v5
  v_add_u32 v16, s41, v4
  v_add_u32 v17, s41, v5
  v_add_u32 v18, s40, v4
  v_add_u32 v19, s40, v5
  v_mov_b32 v56, 0
  v_mov_b32 v57, 0
  v_mov_b32 v58, 0
  v_mov_b32 v59, 0
  s_waitcnt lgkmcnt(0)
  s_nop 0
  ds_write_b128 v16, v[96:99]
  ds_write_b128 v16, v[100:103] offset:1024
  s_mov_b64 exec, 0xffffffff
  ds_write_b128 v16, v[104:107] offset:2048
  s_not_b64 exec, exec
  ds_write_b32 v17, v104 offset:2560
  s_mov_b64 exec, -1
  s_mul_i32 s42, s24, 5
  v_lshrrev_b32 v21, 5, v0
  v_add_u32 v21, s42, v21
  v_lshrrev_b32 v20, 1, v21
  v_lshlrev_b32 v20, 9, v20
  v_and_b32 v21, 1, v21
  v_lshl_add_u32 v20, v21, 3, v20
  v_and_b32 v21, 31, v0
  v_lshl_add_u32 v20, v21, 4, v20
  s_add_u32 s51, s25, 1
  s_mul_i32 s51, s51, 40960
  s_add_u32 s51, s51, 18874368
  s_waitcnt lgkmcnt(0)
  s_barrier
  ds_read_b128 v[48:51], v18
  ds_read_b128 v[52:55], v18 offset:1024
  s_mov_b64 exec, 0xffffffff
  ds_read_b128 v[56:59], v18 offset:2048
  s_not_b64 exec, exec
  ds_read_b32 v56, v19 offset:2560
  s_mov_b64 exec, -1
  s_waitcnt lgkmcnt(2)
  v_add_f32 v112, v112, v48
  v_add_f32 v113, v113, v49
  v_add_f32 v114, v114, v50
  v_add_f32 v115, v115, v51
  v_add_f32 v116, v116, v52
  v_add_f32 v117, v117, v53
  v_add_f32 v118, v118, v54
  v_add_f32 v119, v119, v55
  s_waitcnt lgkmcnt(0)
  v_add_f32 v120, v120, v56
  v_add_f32 v121, v121, v57
  v_add_f32 v122, v122, v58
  v_add_f32 v123, v123, v59
  v_mov_b32 v4, v120
  v_mov_b32 v5, v120
  v_mov_b32 v16, 0
  s_nop 0
  v_permlane32_swap_b32 v4, v5
  v_fma_f32 v16, v112, 0, v16
  v_fma_f32 v16, v113, 0, v16
  v_fma_f32 v16, v114, 0, v16
  v_fma_f32 v16, v115, 0, v16
  v_fma_f32 v16, v116, 0, v16
  v_fma_f32 v16, v117, 0, v16
  v_fma_f32 v16, v118, 0, v16
  v_fma_f32 v16, v119, 0, v16
  v_fma_f32 v16, v120, 0, v16
  v_fma_f32 v16, v121, 0, v16
  v_fma_f32 v16, v122, 0, v16
  v_fma_f32 v16, v123, 0, v16
  s_mov_b32 s40, 0x53800000
  s_mov_b32 s41, 0x2b800000
  v_cmp_eq_f32 vcc, 0, v16
  v_cmp_lt_f32 s[42:43], s41, v5
  v_cmp_gt_f32 s[44:45], s40, v5
  s_nop 3
  s_and_b64 vcc, vcc, s[42:43]
  s_and_b64 vcc, vcc, s[44:45]
  s_cmp_eq_u64 vcc, -1
  s_cbranch_scc0 f0_kernel_p5_slowh
f0_kernel_p5_finh:
  v_rcp_f32 v5, v5
  s_nop 0
  v_pk_mul_f32 v[112:113], v[112:113], v[4:5] op_sel:[0,1] op_sel_hi:[1,1]
  v_pk_mul_f32 v[114:115], v[114:115], v[4:5] op_sel:[0,1] op_sel_hi:[1,1]
  v_pk_mul_f32 v[116:117], v[116:117], v[4:5] op_sel:[0,1] op_sel_hi:[1,1]
  v_pk_mul_f32 v[118:119], v[118:119], v[4:5] op_sel:[0,1] op_sel_hi:[1,1]
  v_pk_mul_f32 v[120:121], v[120:121], v[4:5] op_sel:[0,1] op_sel_hi:[1,1]
  v_pk_mul_f32 v[122:123], v[122:123], v[4:5] op_sel:[0,1] op_sel_hi:[1,1]
  v_cvt_pk_bf16_f32 v22, v112, v113
  v_cvt_pk_bf16_f32 v23, v114, v115
  v_cvt_pk_bf16_f32 v24, v116, v117
  v_cvt_pk_bf16_f32 v25, v118, v119
  v_cvt_pk_bf16_f32 v26, v120, v121
  v_cvt_pk_bf16_f32 v27, v122, v123
  buffer_store_dwordx2 v[22:23], v20, s[12:15], s51 offen
  buffer_store_dwordx2 v[24:25], v20, s[12:15], s51 offen offset:512
  s_mov_b64 exec, 0xffffffff
  buffer_store_dwordx2 v[26:27], v20, s[12:15], s51 offen offset:1024
  s_waitcnt vmcnt(0)
  s_mov_b64 exec, -1
  s_and_b32 s62, s2, 7
  s_lshl_b32 s62, s62, 7
  s_add_u32 s62, s62, 9216000
  s_mov_b32 s65, 16384
f0_kernel_p5_mpoll29:
  v_readfirstlane_b32 s67, v250
  s_and_b32 s66, s67, 63
  s_cmp_eq_u32 s66, 32
  s_cbranch_scc1 f0_kernel_p5_mpolled30
  s_sleep 2
  buffer_load_dword v250, off, s[12:15], s62 sc1
  s_waitcnt vmcnt(0)
  s_sub_u32 s65, s65, 1
  s_cbranch_scc0 f0_kernel_p5_mpoll29
f0_kernel_p5_mpolled30:
  s_getreg_b32 s66, hwreg(HW_REG_XCC_ID, 0, 4)
  s_mul_i32 s65, s66, s66
  s_lshl_b32 s65, s65, 16
  s_lshl_b32 s66, s66, 6
  s_add_u32 s65, s65, s66
  s_add_u32 s65, s65, 1
  s_lshl_b32 s65, s65, 5
  s_cmp_lg_u32 s65, s67
  s_cselect_b32 s63, 1, 0
  s_add_u32 s37, s25, 1
  s_lshl_b32 s37, s37, 7
  s_lshl_b32 s38, s24, 2
  s_add_u32 s37, s37, s38
  s_add_u32 s37, s37, 9195520
  s_mov_b64 exec, 1
  v_mov_b32 v2, 1
  s_cmp_eq_u32 s63, 0
  s_cbranch_scc1 f0_kernel_p5_afast32
  buffer_wbl2 sc1
  s_waitcnt vmcnt(0)
  buffer_store_dword v2, off, s[12:15], s37 sc1
  s_branch f0_kernel_p5_asig31
f0_kernel_p5_afast32:
  buffer_store_dword v2, off, s[12:15], s37
f0_kernel_p5_asig31:
  s_mov_b64 exec, -1
  s_setprio 0
  s_branch f0_kernel_p6_entry
f0_kernel_p5_slowh:
  v_and_b32 v5, 31, v0
  v_and_b32 v6, 0x13, v5
  v_and_b32 v7, 4, v5
  v_lshl_or_b32 v6, v7, 1, v6
  v_and_b32 v7, 8, v5
  v_lshrrev_b32 v7, 1, v7
  v_or_b32 v6, v6, v7
  v_lshrrev_b32 v7, 5, v0
  v_lshlrev_b32 v1, 9, v7
  v_lshl_add_u32 v1, v6, 4, v1
  v_lshlrev_b32 v2, 3, v6
  v_add_u32 v2, 1024, v2
  v_mul_u32_u24 v3, 320, v7
  v_lshl_add_u32 v3, v5, 4, v3
  v_add_u32 v3, 1280, v3
  v_mov_b32 v88, 0xff61b1e6
  v_mov_b32 v112, 0
  v_mov_b32 v113, 0
  v_mov_b32 v114, 0
  v_mov_b32 v115, 0
  v_mov_b32 v116, 0
  v_mov_b32 v117, 0
  v_mov_b32 v118, 0
  v_mov_b32 v119, 0
  v_mov_b32 v120, 0
  v_mov_b32 v121, 0
  v_mov_b32 v122, 0
  v_mov_b32 v123, 0
  v_mov_b32 v124, 0
  v_mov_b32 v125, 0
  v_mov_b32 v126, 0
  v_mov_b32 v127, 0
  s_mov_b32 s36, 0
f0_kernel_p5_slh:
  buffer_load_dwordx4 v[16:19], v1, s[12:15], s50 offen
  buffer_load_dwordx2 v[24:25], v2, s[12:15], s50 offen
  s_mov_b64 exec, s[34:35]
  buffer_load_dwordx4 v[32:35], v3, s[12:15], s50 offen
  buffer_load_dwordx4 v[36:39], v3, s[12:15], s50 offen offset:640
  s_mov_b64 exec, -1
  s_waitcnt vmcnt(0)
  v_mfma_f32_32x32x16_bf16 v[64:79], v[16:19], v[28:31], 0
  s_nop 7
  s_nop 1
  v_mfma_f32_32x32x8bf16_1k v[64:79], v[24:25], v[14:15], v[64:79]
  s_nop 7
  s_nop 3
  v_max3_f32 v4, v64, v65, v66
  v_max3_f32 v4, v4, v67, v68
  v_max3_f32 v4, v4, v69, v70
  v_max3_f32 v4, v4, v71, v72
  v_max3_f32 v4, v4, v73, v74
  v_max3_f32 v4, v4, v75, v76
  v_max3_f32 v4, v4, v77, v78
  v_max_f32 v4, v4, v79
  v_mov_b32 v5, v4
  s_nop 1
  v_permlane32_swap_b32 v4, v5
  s_nop 1
  v_max3_f32 v4, v4, v5, v88
  v_sub_f32 v5, v88, v4
  v_exp_f32 v5, v5
  v_mov_b32 v88, v4
  v_sub_f32 v64, v64, v4
  v_sub_f32 v65, v65, v4
  v_sub_f32 v66, v66, v4
  v_sub_f32 v67, v67, v4
  v_sub_f32 v68, v68, v4
  v_sub_f32 v69, v69, v4
  v_sub_f32 v70, v70, v4
  v_sub_f32 v71, v71, v4
  v_sub_f32 v72, v72, v4
  v_sub_f32 v73, v73, v4
  v_sub_f32 v74, v74, v4
  v_sub_f32 v75, v75, v4
  v_sub_f32 v76, v76, v4
  v_sub_f32 v77, v77, v4
  v_sub_f32 v78, v78, v4
  v_sub_f32 v79, v79, v4
  v_exp_f32 v64, v64
  v_exp_f32 v65, v65
  v_exp_f32 v66, v66
  v_exp_f32 v67, v67
  v_exp_f32 v68, v68
  v_exp_f32 v69, v69
  v_exp_f32 v70, v70
  v_exp_f32 v71, v71
  v_exp_f32 v72, v72
  v_exp_f32 v73, v73
  v_exp_f32 v74, v74
  v_exp_f32 v75, v75
  v_exp_f32 v76, v76
  v_exp_f32 v77, v77
  v_exp_f32 v78, v78
  v_exp_f32 v79, v79
  v_mul_f32 v112, v112, v5
  v_mul_f32 v113, v113, v5
  v_mul_f32 v114, v114, v5
  v_mul_f32 v115, v115, v5
  v_mul_f32 v116, v116, v5
  v_mul_f32 v117, v117, v5
  v_mul_f32 v118, v118, v5
  v_mul_f32 v119, v119, v5
  v_mul_f32 v120, v120, v5
  v_mul_f32 v121, v121, v5
  v_mul_f32 v122, v122, v5
  v_mul_f32 v123, v123, v5
  v_cvt_pk_bf16_f32 v80, v64, v65
  v_cvt_pk_bf16_f32 v81, v66, v67
  v_cvt_pk_bf16_f32 v82, v68, v69
  v_cvt_pk_bf16_f32 v83, v70, v71
  v_cvt_pk_bf16_f32 v84, v72, v73
  v_cvt_pk_bf16_f32 v85, v74, v75
  v_cvt_pk_bf16_f32 v86, v76, v77
  v_cvt_pk_bf16_f32 v87, v78, v79
  v_add_u32 v1, 2560, v1
  v_add_u32 v2, 2560, v2
  v_add_u32 v3, 2560, v3
  s_nop 4
  v_mfma_f32_32x32x16_bf16 v[112:127], v[32:35], v[80:83], v[112:127]
  v_mfma_f32_32x32x16_bf16 v[112:127], v[36:39], v[84:87], v[112:127]
  s_nop 7
  s_nop 3
  s_add_u32 s36, s36, 1
  s_cmp_lt_u32 s36, 64
  s_cbranch_scc1 f0_kernel_p5_slh
  v_mov_b32 v4, v120
  v_mov_b32 v5, v120
  s_nop 1
  v_permlane32_swap_b32 v4, v5
  s_nop 1
  s_branch f0_kernel_p5_finh
f0_kernel_p5_compute:
  s_setprio 2
  s_waitcnt lgkmcnt(0)
  s_mov_b32 s12, s6
  s_mov_b32 s13, s7
  s_mov_b32 s14, 0x3200000
  s_mov_b32 s15, 0x00020000
  v_and_b32 v5, 31, v0
  v_and_b32 v6, 0x13, v5
  v_and_b32 v7, 4, v5
  v_lshl_or_b32 v6, v7, 1, v6
  v_and_b32 v7, 8, v5
  v_lshrrev_b32 v7, 1, v7
  v_or_b32 v6, v6, v7
  v_lshrrev_b32 v7, 5, v0
  v_lshlrev_b32 v1, 9, v7
  v_lshl_add_u32 v1, v6, 4, v1
  v_lshlrev_b32 v2, 3, v6
  v_add_u32 v2, 1024, v2
  v_mul_u32_u24 v3, 320, v7
  v_lshl_add_u32 v3, v5, 4, v3
  v_add_u32 v3, 1280, v3
  v_cmp_eq_u32 vcc, 20, v5
  v_mov_b32 v7, 0x3f803f80
  s_mov_b32 s34, 0x000fffff
  s_mov_b32 s35, 0x000fffff
  v_cndmask_b32 v32, 0, v7, vcc
  v_mov_b32 v33, v32
  v_mov_b32 v34, v32
  v_mov_b32 v35, v32
  v_mov_b32 v36, v32
  v_mov_b32 v37, v32
  v_mov_b32 v38, v32
  v_mov_b32 v39, v32
  v_mov_b32 v40, v32
  v_mov_b32 v41, v32
  v_mov_b32 v42, v32
  v_mov_b32 v43, v32
  v_mov_b32 v44, v32
  v_mov_b32 v45, v32
  v_mov_b32 v46, v32
  v_mov_b32 v47, v32
  v_mov_b32 v96, 0
  v_mov_b32 v97, 0
  v_mov_b32 v98, 0
  v_mov_b32 v99, 0
  v_mov_b32 v100, 0
  v_mov_b32 v101, 0
  v_mov_b32 v102, 0
  v_mov_b32 v103, 0
  v_mov_b32 v104, 0
  v_mov_b32 v105, 0
  v_mov_b32 v106, 0
  v_mov_b32 v107, 0
  v_mov_b32 v108, 0
  v_mov_b32 v109, 0
  v_mov_b32 v110, 0
  v_mov_b32 v111, 0
  v_mov_b32 v112, 0
  v_mov_b32 v113, 0
  v_mov_b32 v114, 0
  v_mov_b32 v115, 0
  v_mov_b32 v116, 0
  v_mov_b32 v117, 0
  v_mov_b32 v118, 0
  v_mov_b32 v119, 0
  v_mov_b32 v120, 0
  v_mov_b32 v121, 0
  v_mov_b32 v122, 0
  v_mov_b32 v123, 0
  v_mov_b32 v124, 0
  v_mov_b32 v125, 0
  v_mov_b32 v126, 0
  v_mov_b32 v127, 0
  v_mov_b32 v84, 0
  v_mov_b32 v85, 0
  v_mov_b32 v86, 0
  v_mov_b32 v87, 0
  s_barrier
  v_and_b32 v5, 31, v0
  v_lshlrev_b32 v6, 3, v5
  v_mov_b32 v12, 0
  v_mov_b32 v13, 0
  v_mov_b32 v14, 0
  v_mov_b32 v15, 0
  buffer_load_dwordx4 v[8:11], v4, s[12:15], s27 offen
  buffer_load_dwordx4 v[28:31], v4, s[12:15], s28 offen
  s_mov_b64 exec, 0xffffffff
  buffer_load_dwordx2 v[12:13], v6, s[12:15], s27 offen offset:1024
  buffer_load_dwordx2 v[14:15], v6, s[12:15], s28 offen offset:1024
  s_mov_b64 exec, -1
  s_waitcnt vmcnt(0)
  s_barrier
  ds_read_b128 v[16:19], v1 offset:0
  ds_read_b64 v[24:25], v2 offset:0
  ds_read_b128 v[20:23], v1 offset:2560
  ds_read_b64 v[26:27], v2 offset:2560
  s_mov_b64 exec, s[34:35]
  ds_read_b128 v[32:35], v3 offset:0
  ds_read_b128 v[36:39], v3 offset:640
  s_mov_b64 exec, -1
  s_waitcnt lgkmcnt(4)
  v_mfma_f32_32x32x16_bf16 v[48:63], v[16:19], v[8:11], 0
  s_mov_b32 s36, 14
  s_mov_b32 s38, 0x3200
  s_nop 7
  s_nop 1
  v_mfma_f32_32x32x8bf16_1k v[48:63], v[24:25], v[12:13], v[48:63]
  s_nop 7
  s_nop 3
f0_kernel_p5_loopm:
  s_bitcmp1_b32 s38, s36
  s_cbranch_scc0 f0_kernel_p5_nosyncm
  s_barrier
f0_kernel_p5_nosyncm:
  s_cmp_eq_u32 s36, 1
  s_cselect_b32 s37, 0, 10240
  s_waitcnt lgkmcnt(0)
  v_mfma_f32_32x32x16_bf16 v[64:79], v[16:19], v[28:31], 0
  v_exp_f32 v48, v48
  v_exp_f32 v49, v49
  v_exp_f32 v50, v50
  v_exp_f32 v51, v51
  v_cvt_pk_bf16_f32 v80, v48, v49
  v_cvt_pk_bf16_f32 v81, v50, v51
  v_mfma_f32_32x32x16_bf16 v[112:127], v[44:47], v[84:87], v[112:127]
  v_exp_f32 v52, v52
  s_mov_b64 exec, s[34:35]
  ds_read_b128 v[40:43], v3 offset:2560
  ds_read_b128 v[44:47], v3 offset:3200
  s_mov_b64 exec, -1
  v_exp_f32 v53, v53
  v_exp_f32 v54, v54
  v_exp_f32 v55, v55
  v_cvt_pk_bf16_f32 v82, v52, v53
  v_cvt_pk_bf16_f32 v83, v54, v55
  v_mfma_f32_32x32x8bf16_1k v[64:79], v[24:25], v[14:15], v[64:79]
  v_exp_f32 v56, v56
  ds_read_b128 v[16:19], v1 offset:5120
  v_exp_f32 v57, v57
  ds_read_b64 v[24:25], v2 offset:5120
  v_exp_f32 v58, v58
  v_exp_f32 v59, v59
  v_cvt_pk_bf16_f32 v84, v56, v57
  v_cvt_pk_bf16_f32 v85, v58, v59
  v_mfma_f32_32x32x16_bf16 v[96:111], v[32:35], v[80:83], v[96:111]
  v_exp_f32 v60, v60
  v_exp_f32 v61, v61
  v_exp_f32 v62, v62
  v_exp_f32 v63, v63
  v_cvt_pk_bf16_f32 v86, v60, v61
  v_cvt_pk_bf16_f32 v87, v62, v63
  v_mfma_f32_32x32x16_bf16 v[48:63], v[20:23], v[8:11], 0
  v_exp_f32 v64, v64
  v_exp_f32 v65, v65
  v_exp_f32 v66, v66
  v_exp_f32 v67, v67
  v_cvt_pk_bf16_f32 v80, v64, v65
  v_cvt_pk_bf16_f32 v81, v66, v67
  v_mfma_f32_32x32x16_bf16 v[96:111], v[36:39], v[84:87], v[96:111]
  v_exp_f32 v68, v68
  v_exp_f32 v69, v69
  v_exp_f32 v70, v70
  v_exp_f32 v71, v71
  v_cvt_pk_bf16_f32 v82, v68, v69
  v_cvt_pk_bf16_f32 v83, v70, v71
  v_mfma_f32_32x32x8bf16_1k v[48:63], v[26:27], v[12:13], v[48:63]
  v_exp_f32 v72, v72
  v_exp_f32 v73, v73
  v_exp_f32 v74, v74
  v_exp_f32 v75, v75
  v_cvt_pk_bf16_f32 v84, v72, v73
  v_cvt_pk_bf16_f32 v85, v74, v75
  v_mfma_f32_32x32x16_bf16 v[112:127], v[32:35], v[80:83], v[112:127]
  v_exp_f32 v76, v76
  v_exp_f32 v77, v77
  v_exp_f32 v78, v78
  v_exp_f32 v79, v79
  v_cvt_pk_bf16_f32 v86, v76, v77
  v_cvt_pk_bf16_f32 v87, v78, v79
  s_waitcnt lgkmcnt(0)
  v_mfma_f32_32x32x16_bf16 v[64:79], v[20:23], v[28:31], 0
  v_exp_f32 v48, v48
  v_exp_f32 v49, v49
  v_exp_f32 v50, v50
  v_exp_f32 v51, v51
  v_cvt_pk_bf16_f32 v80, v48, v49
  v_cvt_pk_bf16_f32 v81, v50, v51
  v_mfma_f32_32x32x16_bf16 v[112:127], v[36:39], v[84:87], v[112:127]
  v_exp_f32 v52, v52
  s_mov_b64 exec, s[34:35]
  ds_read_b128 v[32:35], v3 offset:5120
  ds_read_b128 v[36:39], v3 offset:5760
  s_mov_b64 exec, -1
  v_exp_f32 v53, v53
  v_exp_f32 v54, v54
  v_exp_f32 v55, v55
  v_cvt_pk_bf16_f32 v82, v52, v53
  v_cvt_pk_bf16_f32 v83, v54, v55
  v_mfma_f32_32x32x8bf16_1k v[64:79], v[26:27], v[14:15], v[64:79]
  v_exp_f32 v56, v56
  ds_read_b128 v[20:23], v1 offset:7680
  v_exp_f32 v57, v57
  ds_read_b64 v[26:27], v2 offset:7680
  v_exp_f32 v58, v58
  v_exp_f32 v59, v59
  v_cvt_pk_bf16_f32 v84, v56, v57
  v_cvt_pk_bf16_f32 v85, v58, v59
  v_mfma_f32_32x32x16_bf16 v[96:111], v[40:43], v[80:83], v[96:111]
  v_exp_f32 v60, v60
  v_exp_f32 v61, v61
  v_exp_f32 v62, v62
  v_exp_f32 v63, v63
  v_cvt_pk_bf16_f32 v86, v60, v61
  v_cvt_pk_bf16_f32 v87, v62, v63
  v_mfma_f32_32x32x16_bf16 v[48:63], v[16:19], v[8:11], 0
  v_exp_f32 v64, v64
  v_exp_f32 v65, v65
  v_exp_f32 v66, v66
  v_exp_f32 v67, v67
  v_cvt_pk_bf16_f32 v80, v64, v65
  v_cvt_pk_bf16_f32 v81, v66, v67
  v_mfma_f32_32x32x16_bf16 v[96:111], v[44:47], v[84:87], v[96:111]
  v_exp_f32 v68, v68
  v_exp_f32 v69, v69
  v_exp_f32 v70, v70
  v_exp_f32 v71, v71
  v_cvt_pk_bf16_f32 v82, v68, v69
  v_cvt_pk_bf16_f32 v83, v70, v71
  v_mfma_f32_32x32x8bf16_1k v[48:63], v[24:25], v[12:13], v[48:63]
  v_exp_f32 v72, v72
  v_exp_f32 v73, v73
  v_exp_f32 v74, v74
  v_exp_f32 v75, v75
  v_cvt_pk_bf16_f32 v84, v72, v73
  v_cvt_pk_bf16_f32 v85, v74, v75
  v_mfma_f32_32x32x16_bf16 v[112:127], v[40:43], v[80:83], v[112:127]
  v_exp_f32 v76, v76
  v_exp_f32 v77, v77
  v_exp_f32 v78, v78
  v_exp_f32 v79, v79
  v_cvt_pk_bf16_f32 v86, v76, v77
  v_cvt_pk_bf16_f32 v87, v78, v79
  s_waitcnt lgkmcnt(0)
  v_mfma_f32_32x32x16_bf16 v[64:79], v[16:19], v[28:31], 0
  v_exp_f32 v48, v48
  v_exp_f32 v49, v49
  v_exp_f32 v50, v50
  v_exp_f32 v51, v51
  v_cvt_pk_bf16_f32 v80, v48, v49
  v_cvt_pk_bf16_f32 v81, v50, v51
  v_mfma_f32_32x32x16_bf16 v[112:127], v[44:47], v[84:87], v[112:127]
  v_exp_f32 v52, v52
  s_mov_b64 exec, s[34:35]
  ds_read_b128 v[40:43], v3 offset:7680
  ds_read_b128 v[44:47], v3 offset:8320
  s_mov_b64 exec, -1
  v_exp_f32 v53, v53
  v_exp_f32 v54, v54
  v_exp_f32 v55, v55
  v_cvt_pk_bf16_f32 v82, v52, v53
  v_cvt_pk_bf16_f32 v83, v54, v55
  v_mfma_f32_32x32x8bf16_1k v[64:79], v[24:25], v[14:15], v[64:79]
  v_add_u32 v1, s37, v1
  v_add_u32 v2, s37, v2
  v_exp_f32 v56, v56
  ds_read_b128 v[16:19], v1 offset:0
  v_exp_f32 v57, v57
  ds_read_b64 v[24:25], v2 offset:0
  v_exp_f32 v58, v58
  v_exp_f32 v59, v59
  v_cvt_pk_bf16_f32 v84, v56, v57
  v_cvt_pk_bf16_f32 v85, v58, v59
  v_mfma_f32_32x32x16_bf16 v[96:111], v[32:35], v[80:83], v[96:111]
  v_exp_f32 v60, v60
  v_exp_f32 v61, v61
  v_exp_f32 v62, v62
  v_exp_f32 v63, v63
  v_cvt_pk_bf16_f32 v86, v60, v61
  v_cvt_pk_bf16_f32 v87, v62, v63
  v_mfma_f32_32x32x16_bf16 v[48:63], v[20:23], v[8:11], 0
  v_exp_f32 v64, v64
  v_exp_f32 v65, v65
  v_exp_f32 v66, v66
  v_exp_f32 v67, v67
  v_cvt_pk_bf16_f32 v80, v64, v65
  v_cvt_pk_bf16_f32 v81, v66, v67
  v_mfma_f32_32x32x16_bf16 v[96:111], v[36:39], v[84:87], v[96:111]
  v_exp_f32 v68, v68
  v_exp_f32 v69, v69
  v_exp_f32 v70, v70
  v_exp_f32 v71, v71
  v_cvt_pk_bf16_f32 v82, v68, v69
  v_cvt_pk_bf16_f32 v83, v70, v71
  v_mfma_f32_32x32x8bf16_1k v[48:63], v[26:27], v[12:13], v[48:63]
  v_exp_f32 v72, v72
  v_exp_f32 v73, v73
  v_exp_f32 v74, v74
  v_exp_f32 v75, v75
  v_cvt_pk_bf16_f32 v84, v72, v73
  v_cvt_pk_bf16_f32 v85, v74, v75
  v_mfma_f32_32x32x16_bf16 v[112:127], v[32:35], v[80:83], v[112:127]
  v_exp_f32 v76, v76
  v_exp_f32 v77, v77
  v_exp_f32 v78, v78
  v_exp_f32 v79, v79
  v_cvt_pk_bf16_f32 v86, v76, v77
  v_cvt_pk_bf16_f32 v87, v78, v79
  s_waitcnt lgkmcnt(0)
  v_mfma_f32_32x32x16_bf16 v[64:79], v[20:23], v[28:31], 0
  v_exp_f32 v48, v48
  v_exp_f32 v49, v49
  v_exp_f32 v50, v50
  v_exp_f32 v51, v51
  v_cvt_pk_bf16_f32 v80, v48, v49
  v_cvt_pk_bf16_f32 v81, v50, v51
  v_mfma_f32_32x32x16_bf16 v[112:127], v[36:39], v[84:87], v[112:127]
  v_add_u32 v3, s37, v3
  v_exp_f32 v52, v52
  s_mov_b64 exec, s[34:35]
  ds_read_b128 v[32:35], v3 offset:0
  ds_read_b128 v[36:39], v3 offset:640
  s_mov_b64 exec, -1
  v_exp_f32 v53, v53
  v_exp_f32 v54, v54
  v_exp_f32 v55, v55
  v_cvt_pk_bf16_f32 v82, v52, v53
  v_cvt_pk_bf16_f32 v83, v54, v55
  v_mfma_f32_32x32x8bf16_1k v[64:79], v[26:27], v[14:15], v[64:79]
  v_exp_f32 v56, v56
  ds_read_b128 v[20:23], v1 offset:2560
  v_exp_f32 v57, v57
  ds_read_b64 v[26:27], v2 offset:2560
  v_exp_f32 v58, v58
  v_exp_f32 v59, v59
  v_cvt_pk_bf16_f32 v84, v56, v57
  v_cvt_pk_bf16_f32 v85, v58, v59
  v_mfma_f32_32x32x16_bf16 v[96:111], v[40:43], v[80:83], v[96:111]
  v_exp_f32 v60, v60
  v_exp_f32 v61, v61
  v_exp_f32 v62, v62
  v_exp_f32 v63, v63
  v_cvt_pk_bf16_f32 v86, v60, v61
  v_cvt_pk_bf16_f32 v87, v62, v63
  v_mfma_f32_32x32x16_bf16 v[48:63], v[16:19], v[8:11], 0
  v_exp_f32 v64, v64
  v_exp_f32 v65, v65
  v_exp_f32 v66, v66
  v_exp_f32 v67, v67
  v_cvt_pk_bf16_f32 v80, v64, v65
  v_cvt_pk_bf16_f32 v81, v66, v67
  v_mfma_f32_32x32x16_bf16 v[96:111], v[44:47], v[84:87], v[96:111]
  v_exp_f32 v68, v68
  v_exp_f32 v69, v69
  v_exp_f32 v70, v70
  v_exp_f32 v71, v71
  v_cvt_pk_bf16_f32 v82, v68, v69
  v_cvt_pk_bf16_f32 v83, v70, v71
  v_mfma_f32_32x32x8bf16_1k v[48:63], v[24:25], v[12:13], v[48:63]
  v_exp_f32 v72, v72
  v_exp_f32 v73, v73
  v_exp_f32 v74, v74
  v_exp_f32 v75, v75
  v_cvt_pk_bf16_f32 v84, v72, v73
  v_cvt_pk_bf16_f32 v85, v74, v75
  v_mfma_f32_32x32x16_bf16 v[112:127], v[40:43], v[80:83], v[112:127]
  v_exp_f32 v76, v76
  v_exp_f32 v77, v77
  v_exp_f32 v78, v78
  v_exp_f32 v79, v79
  v_cvt_pk_bf16_f32 v86, v76, v77
  v_cvt_pk_bf16_f32 v87, v78, v79
  s_sub_u32 s36, s36, 1
  s_cmp_lg_u32 s36, 0
  s_cbranch_scc1 f0_kernel_p5_loopm
  s_nop 0
  v_mfma_f32_32x32x16_bf16 v[112:127], v[44:47], v[84:87], v[112:127]
  s_and_b32 s62, s2, 7
  s_lshl_b32 s62, s62, 7
  s_add_u32 s62, s62, 9216000
  buffer_load_dword v250, off, s[12:15], s62 sc1
  s_lshl_b32 s40, s33, 1
  s_add_u32 s41, s40, 0
  s_add_u32 s40, s40, 1
  s_mul_i32 s41, s41, 2688
  s_mul_i32 s40, s40, 2688
  v_lshlrev_b32 v4, 4, v0
  v_and_b32 v5, 31, v0
  v_lshlrev_b32 v5, 2, v5
  v_add_u32 v16, s41, v4
  v_add_u32 v17, s41, v5
  v_add_u32 v18, s40, v4
  v_add_u32 v19, s40, v5
  v_mov_b32 v56, 0
  v_mov_b32 v57, 0
  v_mov_b32 v58, 0
  v_mov_b32 v59, 0
  s_waitcnt lgkmcnt(0)
  s_nop 7
  ds_write_b128 v16, v[112:115]
  ds_write_b128 v16, v[116:119] offset:1024
  s_mov_b64 exec, 0xffffffff
  ds_write_b128 v16, v[120:123] offset:2048
  s_not_b64 exec, exec
  ds_write_b32 v17, v120 offset:2560
  s_mov_b64 exec, -1
  s_mul_i32 s42, s24, 5
  v_lshrrev_b32 v21, 5, v0
  v_add_u32 v21, s42, v21
  v_lshrrev_b32 v20, 1, v21
  v_lshlrev_b32 v20, 9, v20
  v_and_b32 v21, 1, v21
  v_lshl_add_u32 v20, v21, 3, v20
  v_and_b32 v21, 31, v0
  v_lshl_add_u32 v20, v21, 4, v20
  s_add_u32 s51, s25, 0
  s_mul_i32 s51, s51, 40960
  s_add_u32 s51, s51, 18874368
  s_waitcnt lgkmcnt(0)
  s_barrier
  ds_read_b128 v[48:51], v18
  ds_read_b128 v[52:55], v18 offset:1024
  s_mov_b64 exec, 0xffffffff
  ds_read_b128 v[56:59], v18 offset:2048
  s_not_b64 exec, exec
  ds_read_b32 v56, v19 offset:2560
  s_mov_b64 exec, -1
  s_waitcnt lgkmcnt(2)
  v_add_f32 v96, v96, v48
  v_add_f32 v97, v97, v49
  v_add_f32 v98, v98, v50
  v_add_f32 v99, v99, v51
  v_add_f32 v100, v100, v52
  v_add_f32 v101, v101, v53
  v_add_f32 v102, v102, v54
  v_add_f32 v103, v103, v55
  s_waitcnt lgkmcnt(0)
  v_add_f32 v104, v104, v56
  v_add_f32 v105, v105, v57
  v_add_f32 v106, v106, v58
  v_add_f32 v107, v107, v59
  v_mov_b32 v4, v104
  v_mov_b32 v5, v104
  v_mov_b32 v16, 0
  s_nop 0
  v_permlane32_swap_b32 v4, v5
  v_fma_f32 v16, v96, 0, v16
  v_fma_f32 v16, v97, 0, v16
  v_fma_f32 v16, v98, 0, v16
  v_fma_f32 v16, v99, 0, v16
  v_fma_f32 v16, v100, 0, v16
  v_fma_f32 v16, v101, 0, v16
  v_fma_f32 v16, v102, 0, v16
  v_fma_f32 v16, v103, 0, v16
  v_fma_f32 v16, v104, 0, v16
  v_fma_f32 v16, v105, 0, v16
  v_fma_f32 v16, v106, 0, v16
  v_fma_f32 v16, v107, 0, v16
  s_mov_b32 s40, 0x53800000
  s_mov_b32 s41, 0x2b800000
  v_cmp_eq_f32 vcc, 0, v16
  v_cmp_lt_f32 s[42:43], s41, v5
  v_cmp_gt_f32 s[44:45], s40, v5
  s_nop 3
  s_and_b64 vcc, vcc, s[42:43]
  s_and_b64 vcc, vcc, s[44:45]
  s_cmp_eq_u64 vcc, -1
  s_cbranch_scc0 f0_kernel_p5_slowm
f0_kernel_p5_finm:
  v_rcp_f32 v5, v5
  s_nop 0
  v_pk_mul_f32 v[96:97], v[96:97], v[4:5] op_sel:[0,1] op_sel_hi:[1,1]
  v_pk_mul_f32 v[98:99], v[98:99], v[4:5] op_sel:[0,1] op_sel_hi:[1,1]
  v_pk_mul_f32 v[100:101], v[100:101], v[4:5] op_sel:[0,1] op_sel_hi:[1,1]
  v_pk_mul_f32 v[102:103], v[102:103], v[4:5] op_sel:[0,1] op_sel_hi:[1,1]
  v_pk_mul_f32 v[104:105], v[104:105], v[4:5] op_sel:[0,1] op_sel_hi:[1,1]
  v_pk_mul_f32 v[106:107], v[106:107], v[4:5] op_sel:[0,1] op_sel_hi:[1,1]
  v_cvt_pk_bf16_f32 v22, v96, v97
  v_cvt_pk_bf16_f32 v23, v98, v99
  v_cvt_pk_bf16_f32 v24, v100, v101
  v_cvt_pk_bf16_f32 v25, v102, v103
  v_cvt_pk_bf16_f32 v26, v104, v105
  v_cvt_pk_bf16_f32 v27, v106, v107
  buffer_store_dwordx2 v[22:23], v20, s[12:15], s51 offen
  buffer_store_dwordx2 v[24:25], v20, s[12:15], s51 offen offset:512
  s_mov_b64 exec, 0xffffffff
  buffer_store_dwordx2 v[26:27], v20, s[12:15], s51 offen offset:1024
  s_waitcnt vmcnt(0)
  s_mov_b64 exec, -1
  s_and_b32 s62, s2, 7
  s_lshl_b32 s62, s62, 7
  s_add_u32 s62, s62, 9216000
  s_mov_b32 s65, 16384
f0_kernel_p5_mpoll33:
  v_readfirstlane_b32 s67, v250
  s_and_b32 s66, s67, 63
  s_cmp_eq_u32 s66, 32
  s_cbranch_scc1 f0_kernel_p5_mpolled34
  s_sleep 2
  buffer_load_dword v250, off, s[12:15], s62 sc1
  s_waitcnt vmcnt(0)
  s_sub_u32 s65, s65, 1
  s_cbranch_scc0 f0_kernel_p5_mpoll33
f0_kernel_p5_mpolled34:
  s_getreg_b32 s66, hwreg(HW_REG_XCC_ID, 0, 4)
  s_mul_i32 s65, s66, s66
  s_lshl_b32 s65, s65, 16
  s_lshl_b32 s66, s66, 6
  s_add_u32 s65, s65, s66
  s_add_u32 s65, s65, 1
  s_lshl_b32 s65, s65, 5
  s_cmp_lg_u32 s65, s67
  s_cselect_b32 s63, 1, 0
  s_add_u32 s37, s25, 0
  s_lshl_b32 s37, s37, 7
  s_lshl_b32 s38, s24, 2
  s_add_u32 s37, s37, s38
  s_add_u32 s37, s37, 9195520
  s_mov_b64 exec, 1
  v_mov_b32 v2, 1
  s_cmp_eq_u32 s63, 0
  s_cbranch_scc1 f0_kernel_p5_afast36
  buffer_wbl2 sc1
  s_waitcnt vmcnt(0)
  buffer_store_dword v2, off, s[12:15], s37 sc1
  s_branch f0_kernel_p5_asig35
f0_kernel_p5_afast36:
  buffer_store_dword v2, off, s[12:15], s37
f0_kernel_p5_asig35:
  v_mov_b32 v1, 147456
  v_mov_b32 v2, 0
  ds_write_b32 v1, v2
  s_waitcnt lgkmcnt(0)
  s_mov_b64 exec, -1
  s_setprio 0
  s_branch f0_kernel_p6_entry
f0_kernel_p5_slowm:
  v_and_b32 v5, 31, v0
  v_and_b32 v6, 0x13, v5
  v_and_b32 v7, 4, v5
  v_lshl_or_b32 v6, v7, 1, v6
  v_and_b32 v7, 8, v5
  v_lshrrev_b32 v7, 1, v7
  v_or_b32 v6, v6, v7
  v_lshrrev_b32 v7, 5, v0
  v_lshlrev_b32 v1, 9, v7
  v_lshl_add_u32 v1, v6, 4, v1
  v_lshlrev_b32 v2, 3, v6
  v_add_u32 v2, 1024, v2
  v_mul_u32_u24 v3, 320, v7
  v_lshl_add_u32 v3, v5, 4, v3
  v_add_u32 v3, 1280, v3
  v_mov_b32 v88, 0xff61b1e6
  v_mov_b32 v96, 0
  v_mov_b32 v97, 0
  v_mov_b32 v98, 0
  v_mov_b32 v99, 0
  v_mov_b32 v100, 0
  v_mov_b32 v101, 0
  v_mov_b32 v102, 0
  v_mov_b32 v103, 0
  v_mov_b32 v104, 0
  v_mov_b32 v105, 0
  v_mov_b32 v106, 0
  v_mov_b32 v107, 0
  v_mov_b32 v108, 0
  v_mov_b32 v109, 0
  v_mov_b32 v110, 0
  v_mov_b32 v111, 0
  s_mov_b32 s36, 0
f0_kernel_p5_slm:
  buffer_load_dwordx4 v[16:19], v1, s[12:15], s50 offen
  buffer_load_dwordx2 v[24:25], v2, s[12:15], s50 offen
  s_mov_b64 exec, s[34:35]
  buffer_load_dwordx4 v[32:35], v3, s[12:15], s50 offen
  buffer_load_dwordx4 v[36:39], v3, s[12:15], s50 offen offset:640
  s_mov_b64 exec, -1
  s_waitcnt vmcnt(0)
  v_mfma_f32_32x32x16_bf16 v[48:63], v[16:19], v[8:11], 0
  s_nop 7
  s_nop 1
  v_mfma_f32_32x32x8bf16_1k v[48:63], v[24:25], v[12:13], v[48:63]
  s_nop 7
  s_nop 3
  v_max3_f32 v4, v48, v49, v50
  v_max3_f32 v4, v4, v51, v52
  v_max3_f32 v4, v4, v53, v54
  v_max3_f32 v4, v4, v55, v56
  v_max3_f32 v4, v4, v57, v58
  v_max3_f32 v4, v4, v59, v60
  v_max3_f32 v4, v4, v61, v62
  v_max_f32 v4, v4, v63
  v_mov_b32 v5, v4
  s_nop 1
  v_permlane32_swap_b32 v4, v5
  s_nop 1
  v_max3_f32 v4, v4, v5, v88
  v_sub_f32 v5, v88, v4
  v_exp_f32 v5, v5
  v_mov_b32 v88, v4
  v_sub_f32 v48, v48, v4
  v_sub_f32 v49, v49, v4
  v_sub_f32 v50, v50, v4
  v_sub_f32 v51, v51, v4
  v_sub_f32 v52, v52, v4
  v_sub_f32 v53, v53, v4
  v_sub_f32 v54, v54, v4
  v_sub_f32 v55, v55, v4
  v_sub_f32 v56, v56, v4
  v_sub_f32 v57, v57, v4
  v_sub_f32 v58, v58, v4
  v_sub_f32 v59, v59, v4
  v_sub_f32 v60, v60, v4
  v_sub_f32 v61, v61, v4
  v_sub_f32 v62, v62, v4
  v_sub_f32 v63, v63, v4
  v_exp_f32 v48, v48
  v_exp_f32 v49, v49
  v_exp_f32 v50, v50
  v_exp_f32 v51, v51
  v_exp_f32 v52, v52
  v_exp_f32 v53, v53
  v_exp_f32 v54, v54
  v_exp_f32 v55, v55
  v_exp_f32 v56, v56
  v_exp_f32 v57, v57
  v_exp_f32 v58, v58
  v_exp_f32 v59, v59
  v_exp_f32 v60, v60
  v_exp_f32 v61, v61
  v_exp_f32 v62, v62
  v_exp_f32 v63, v63
  v_mul_f32 v96, v96, v5
  v_mul_f32 v97, v97, v5
  v_mul_f32 v98, v98, v5
  v_mul_f32 v99, v99, v5
  v_mul_f32 v100, v100, v5
  v_mul_f32 v101, v101, v5
  v_mul_f32 v102, v102, v5
  v_mul_f32 v103, v103, v5
  v_mul_f32 v104, v104, v5
  v_mul_f32 v105, v105, v5
  v_mul_f32 v106, v106, v5
  v_mul_f32 v107, v107, v5
  v_cvt_pk_bf16_f32 v80, v48, v49
  v_cvt_pk_bf16_f32 v81, v50, v51
  v_cvt_pk_bf16_f32 v82, v52, v53
  v_cvt_pk_bf16_f32 v83, v54, v55
  v_cvt_pk_bf16_f32 v84, v56, v57
  v_cvt_pk_bf16_f32 v85, v58, v59
  v_cvt_pk_bf16_f32 v86, v60, v61
  v_cvt_pk_bf16_f32 v87, v62, v63
  v_add_u32 v1, 2560, v1
  v_add_u32 v2, 2560, v2
  v_add_u32 v3, 2560, v3
  s_nop 4
  v_mfma_f32_32x32x16_bf16 v[96:111], v[32:35], v[80:83], v[96:111]
  v_mfma_f32_32x32x16_bf16 v[96:111], v[36:39], v[84:87], v[96:111]
  s_nop 7
  s_nop 3
  s_add_u32 s36, s36, 1
  s_cmp_lt_u32 s36, 64
  s_cbranch_scc1 f0_kernel_p5_slm
  v_mov_b32 v4, v104
  v_mov_b32 v5, v104
  s_nop 1
  v_permlane32_swap_b32 v4, v5
  s_nop 1
  s_branch f0_kernel_p5_finm
f0_kernel_p6_entry:
  s_mov_b32 s26, s64
  s_and_b32 s20, s2, 7
  s_lshr_b32 s21, s2, 3
  s_and_b32 s22, s21, 3
  s_lshl_b32 s23, s20, 2
  s_add_u32 s24, s23, s22
  s_lshr_b32 s25, s21, 2
  s_cmp_lt_u32 s26, 4
  s_cbranch_scc1 f0_kernel_p6_compute
  s_sub_u32 s26, s26, 4
  v_lshlrev_b32 v1, 4, v0
  s_mul_i32 s40, s25, 102400
  s_mul_i32 s41, s26, 5120
  s_add_u32 s40, s40, s41
  s_add_u32 s40, s40, 5242880
  s_mov_b32 s42, s41
  s_lshl_b32 s43, s24, 1
  s_lshr_b32 s47, s26, 1
  s_add_u32 s43, s43, s47
  s_mul_i32 s43, s43, 40960
  s_and_b32 s47, s26, 1
  s_lshl_b32 s47, s47, 12
  s_add_u32 s43, s43, s47
  s_add_u32 s43, s43, 18874368
  s_lshl_b32 s44, s26, 12
  s_waitcnt lgkmcnt(0)
  s_mov_b32 s12, s6
  s_mov_b32 s13, s7
  s_mov_b32 s14, 0x3200000
  s_mov_b32 s15, 0x00020000
  s_add_u32 m0, s42, 32768
  s_add_u32 s45, s40, 0
  buffer_load_dwordx4 v1, s[12:15], s45 offen offset:0 lds
  buffer_load_dwordx4 v1, s[12:15], s45 offen offset:1024 lds
  buffer_load_dwordx4 v1, s[12:15], s45 offen offset:2048 lds
  buffer_load_dwordx4 v1, s[12:15], s45 offen offset:3072 lds
  s_add_u32 m0, s42, 36864
  s_add_u32 s45, s40, 4096
  buffer_load_dwordx4 v1, s[12:15], s45 offen lds
  s_add_u32 m0, s42, 53248
  s_add_u32 s45, s40, 20480
  buffer_load_dwordx4 v1, s[12:15], s45 offen offset:0 lds
  buffer_load_dwordx4 v1, s[12:15], s45 offen offset:1024 lds
  buffer_load_dwordx4 v1, s[12:15], s45 offen offset:2048 lds
  buffer_load_dwordx4 v1, s[12:15], s45 offen offset:3072 lds
  s_add_u32 m0, s42, 57344
  s_add_u32 s45, s40, 24576
  buffer_load_dwordx4 v1, s[12:15], s45 offen lds
  s_lshl_b32 s67, s24, 1
  s_lshr_b32 s47, s26, 1
  s_add_u32 s67, s67, s47
  s_lshl_b32 s66, s67, 7
  s_add_u32 s66, s66, 9195520
  v_lshlrev_b32 v10, 2, v0
  s_mov_b64 exec, 0xffffffff
  s_mov_b32 s65, 16384
f0_kernel_p6_poll:
  buffer_load_dword v11, v10, s[12:15], s66 offen sc1
  s_waitcnt vmcnt(0)
  v_cmp_ne_u32 vcc, 0, v11
  s_cmp_eq_u32 vcc_lo, 0xffffffff
  s_cbranch_scc1 f0_kernel_p6_polled
  s_sleep 1
  s_sub_u32 s65, s65, 1
  s_cbranch_scc0 f0_kernel_p6_poll
f0_kernel_p6_polled:
  s_mov_b64 exec, -1
  s_cmp_eq_u32 s63, 0
  s_cbranch_scc1 f0_kernel_p6_noacq
  buffer_inv sc1
  s_waitcnt vmcnt(0)
f0_kernel_p6_noacq:
  s_add_u32 m0, s44, 114688
  s_add_u32 s45, s43, 0
  buffer_load_dwordx4 v1, s[12:15], s45 offen offset:0 sc1 lds
  buffer_load_dwordx4 v1, s[12:15], s45 offen offset:1024 sc1 lds
  buffer_load_dwordx4 v1, s[12:15], s45 offen offset:2048 sc1 lds
  buffer_load_dwordx4 v1, s[12:15], s45 offen offset:3072 sc1 lds
  s_add_u32 m0, s44, 131072
  s_add_u32 s45, s43, 8192
  buffer_load_dwordx4 v1, s[12:15], s45 offen offset:0 sc1 lds
  buffer_load_dwordx4 v1, s[12:15], s45 offen offset:1024 sc1 lds
  buffer_load_dwordx4 v1, s[12:15], s45 offen offset:2048 sc1 lds
  buffer_load_dwordx4 v1, s[12:15], s45 offen offset:3072 sc1 lds
  s_add_u32 m0, s42, 73728
  s_add_u32 s45, s40, 40960
  buffer_load_dwordx4 v1, s[12:15], s45 offen offset:0 lds
  buffer_load_dwordx4 v1, s[12:15], s45 offen offset:1024 lds
  buffer_load_dwordx4 v1, s[12:15], s45 offen offset:2048 lds
  buffer_load_dwordx4 v1, s[12:15], s45 offen offset:3072 lds
  s_add_u32 m0, s42, 77824
  s_add_u32 s45, s40, 45056
  buffer_load_dwordx4 v1, s[12:15], s45 offen lds
  s_add_u32 m0, s42, 94208
  s_add_u32 s45, s40, 61440
  buffer_load_dwordx4 v1, s[12:15], s45 offen offset:0 lds
  buffer_load_dwordx4 v1, s[12:15], s45 offen offset:1024 lds
  buffer_load_dwordx4 v1, s[12:15], s45 offen offset:2048 lds
  buffer_load_dwordx4 v1, s[12:15], s45 offen offset:3072 lds
  s_add_u32 m0, s42, 98304
  s_add_u32 s45, s40, 65536
  buffer_load_dwordx4 v1, s[12:15], s45 offen lds
  s_waitcnt vmcnt(14)
  s_barrier
  s_add_u32 m0, s44, 0
  s_add_u32 s45, s43, 16384
  buffer_load_dwordx4 v1, s[12:15], s45 offen offset:0 sc1 lds
  buffer_load_dwordx4 v1, s[12:15], s45 offen offset:1024 sc1 lds
  buffer_load_dwordx4 v1, s[12:15], s45 offen offset:2048 sc1 lds
  buffer_load_dwordx4 v1, s[12:15], s45 offen offset:3072 sc1 lds
  s_add_u32 m0, s44, 16384
  s_add_u32 s45, s43, 24576
  buffer_load_dwordx4 v1, s[12:15], s45 offen offset:0 sc1 lds
  buffer_load_dwordx4 v1, s[12:15], s45 offen offset:1024 sc1 lds
  buffer_load_dwordx4 v1, s[12:15], s45 offen offset:2048 sc1 lds
  buffer_load_dwordx4 v1, s[12:15], s45 offen offset:3072 sc1 lds
  s_waitcnt vmcnt(18)
  s_barrier
  s_add_u32 m0, s44, 114688
  s_add_u32 s45, s43, 32768
  buffer_load_dwordx4 v1, s[12:15], s45 offen offset:0 sc1 lds
  buffer_load_dwordx4 v1, s[12:15], s45 offen offset:1024 sc1 lds
  buffer_load_dwordx4 v1, s[12:15], s45 offen offset:2048 sc1 lds
  buffer_load_dwordx4 v1, s[12:15], s45 offen offset:3072 sc1 lds
  s_add_u32 m0, s42, 32768
  s_add_u32 s45, s40, 81920
  buffer_load_dwordx4 v1, s[12:15], s45 offen offset:0 lds
  buffer_load_dwordx4 v1, s[12:15], s45 offen offset:1024 lds
  buffer_load_dwordx4 v1, s[12:15], s45 offen offset:2048 lds
  buffer_load_dwordx4 v1, s[12:15], s45 offen offset:3072 lds
  s_add_u32 m0, s42, 36864
  s_add_u32 s45, s40, 86016
  buffer_load_dwordx4 v1, s[12:15], s45 offen lds
  v_lshlrev_b32 v12, 7, v0
  s_mul_i32 s46, s24, 196608
  s_lshl_b32 s47, s25, 2
  s_add_u32 s47, s47, s26
  s_mul_i32 s47, s47, 6144
  s_add_u32 s46, s46, s47
  s_add_u32 s46, s46, 31457280
  s_mov_b32 exec_hi, 0xffff
  buffer_load_dword v13, v12, s[12:15], s46 offen
  s_mov_b32 exec_hi, -1
  s_waitcnt vmcnt(14)
  s_barrier
  s_waitcnt vmcnt(10)
  s_barrier
  s_waitcnt vmcnt(1)
  s_barrier
  s_branch f0_kernel_p7_entry
f0_kernel_p6_compute:
  s_and_b32 s27, s26, 1
  s_lshr_b32 s36, s26, 1
  v_lshrrev_b32 v17, 4, v0
  v_and_b32 v16, 15, v0
  v_mul_u32_u24 v20, 1280, v17
  v_lshl_add_u32 v20, v16, 4, v20
  s_mul_i32 s37, s27, 768
  s_add_u32 s37, s37, 32768
  v_add_u32 v1, s37, v20
  v_add_u32 v2, 61440, v1
  v_lshlrev_b32 v20, 9, v17
  v_lshl_add_u32 v20, v16, 4, v20
  s_lshl_b32 s37, s36, 13
  s_add_u32 s37, s37, 0
  v_add_u32 v3, s37, v20
  v_add_u32 v4, 114688, v3
  v_lshrrev_b32 v20, 1, v17
  v_lshlrev_b32 v20, 9, v20
  v_lshl_add_u32 v20, v16, 4, v20
  v_and_b32 v21, 1, v17
  v_lshl_add_u32 v20, v21, 3, v20
  s_lshl_b32 s38, s24, 1
  s_add_u32 s38, s38, s36
  s_mul_i32 s39, s38, 40960
  s_mul_i32 s40, s25, 5120
  s_add_u32 s39, s39, s40
  s_mul_i32 s40, s27, 3072
  s_add_u32 s39, s39, s40
  s_add_u32 s52, s39, 15728640
  s_waitcnt lgkmcnt(0)
  s_mov_b32 s48, s6
  s_mov_b32 s49, s7
  s_mov_b32 s50, 0x3200000
  s_mov_b32 s51, 0x00020000
  s_cmp_eq_u32 s27, 1
  s_cbranch_scc1 f0_kernel_p6_p2
  buffer_load_dwordx2 v[104:105], v20, s[48:51], s52 offen offset:0
  buffer_load_dwordx2 v[106:107], v20, s[48:51], s52 offen offset:256
  buffer_load_dwordx2 v[108:109], v20, s[48:51], s52 offen offset:1024
  buffer_load_dwordx2 v[110:111], v20, s[48:51], s52 offen offset:1280
  buffer_load_dwordx2 v[112:113], v20, s[48:51], s52 offen offset:2048
  buffer_load_dwordx2 v[114:115], v20, s[48:51], s52 offen offset:2304
  s_barrier
  ds_read_b128 v[88:91], v4 offset:0
  ds_read_b128 v[92:95], v4 offset:256
  ds_read_b128 v[64:67], v1 offset:0
  ds_read_b128 v[68:71], v1 offset:256
  ds_read_b128 v[72:75], v1 offset:512
  s_waitcnt lgkmcnt(0)
  v_mfma_f32_16x16x32_bf16 v[32:35], v[64:67], v[88:91], 0
  ds_read_b128 v[96:99], v4 offset:2048
  ds_read_b128 v[100:103], v4 offset:2304
  v_mfma_f32_16x16x32_bf16 v[36:39], v[64:67], v[92:95], 0
  ds_read_b128 v[76:79], v1 offset:5120
  ds_read_b128 v[80:83], v1 offset:5376
  v_mfma_f32_16x16x32_bf16 v[40:43], v[68:71], v[88:91], 0
  ds_read_b128 v[84:87], v1 offset:5632
  v_mfma_f32_16x16x32_bf16 v[44:47], v[68:71], v[92:95], 0
  v_mfma_f32_16x16x32_bf16 v[48:51], v[72:75], v[88:91], 0
  v_mfma_f32_16x16x32_bf16 v[52:55], v[72:75], v[92:95], 0
  s_waitcnt lgkmcnt(0)
  v_mfma_f32_16x16x32_bf16 v[32:35], v[76:79], v[96:99], v[32:35]
  ds_read_b128 v[88:91], v4 offset:4096
  ds_read_b128 v[92:95], v4 offset:4352
  v_mfma_f32_16x16x32_bf16 v[36:39], v[76:79], v[100:103], v[36:39]
  ds_read_b128 v[64:67], v1 offset:10240
  ds_read_b128 v[68:71], v1 offset:10496
  v_mfma_f32_16x16x32_bf16 v[40:43], v[80:83], v[96:99], v[40:43]
  ds_read_b128 v[72:75], v1 offset:10752
  v_mfma_f32_16x16x32_bf16 v[44:47], v[80:83], v[100:103], v[44:47]
  v_mfma_f32_16x16x32_bf16 v[48:51], v[84:87], v[96:99], v[48:51]
  v_mfma_f32_16x16x32_bf16 v[52:55], v[84:87], v[100:103], v[52:55]
  s_waitcnt lgkmcnt(0)
  v_mfma_f32_16x16x32_bf16 v[32:35], v[64:67], v[88:91], v[32:35]
  ds_read_b128 v[96:99], v4 offset:6144
  ds_read_b128 v[100:103], v4 offset:6400
  v_mfma_f32_16x16x32_bf16 v[36:39], v[64:67], v[92:95], v[36:39]
  ds_read_b128 v[76:79], v1 offset:15360
  ds_read_b128 v[80:83], v1 offset:15616
  v_mfma_f32_16x16x32_bf16 v[40:43], v[68:71], v[88:91], v[40:43]
  ds_read_b128 v[84:87], v1 offset:15872
  v_mfma_f32_16x16x32_bf16 v[44:47], v[68:71], v[92:95], v[44:47]
  v_mfma_f32_16x16x32_bf16 v[48:51], v[72:75], v[88:91], v[48:51]
  v_mfma_f32_16x16x32_bf16 v[52:55], v[72:75], v[92:95], v[52:55]
  s_waitcnt lgkmcnt(0)
  s_barrier
  v_mfma_f32_16x16x32_bf16 v[32:35], v[76:79], v[96:99], v[32:35]
  ds_read_b128 v[88:91], v4 offset:16384
  ds_read_b128 v[92:95], v4 offset:16640
  v_mfma_f32_16x16x32_bf16 v[36:39], v[76:79], v[100:103], v[36:39]
  ds_read_b128 v[64:67], v1 offset:20480
  ds_read_b128 v[68:71], v1 offset:20736
  v_mfma_f32_16x16x32_bf16 v[40:43], v[80:83], v[96:99], v[40:43]
  ds_read_b128 v[72:75], v1 offset:20992
  v_mfma_f32_16x16x32_bf16 v[44:47], v[80:83], v[100:103], v[44:47]
  v_mfma_f32_16x16x32_bf16 v[48:51], v[84:87], v[96:99], v[48:51]
  v_mfma_f32_16x16x32_bf16 v[52:55], v[84:87], v[100:103], v[52:55]
  s_waitcnt lgkmcnt(0)
  v_mfma_f32_16x16x32_bf16 v[32:35], v[64:67], v[88:91], v[32:35]
  ds_read_b128 v[96:99], v4 offset:18432
  ds_read_b128 v[100:103], v4 offset:18688
  v_mfma_f32_16x16x32_bf16 v[36:39], v[64:67], v[92:95], v[36:39]
  ds_read_b128 v[76:79], v1 offset:25600
  ds_read_b128 v[80:83], v1 offset:25856
  v_mfma_f32_16x16x32_bf16 v[40:43], v[68:71], v[88:91], v[40:43]
  ds_read_b128 v[84:87], v1 offset:26112
  v_mfma_f32_16x16x32_bf16 v[44:47], v[68:71], v[92:95], v[44:47]
  v_mfma_f32_16x16x32_bf16 v[48:51], v[72:75], v[88:91], v[48:51]
  v_mfma_f32_16x16x32_bf16 v[52:55], v[72:75], v[92:95], v[52:55]
  s_waitcnt lgkmcnt(0)
  v_mfma_f32_16x16x32_bf16 v[32:35], v[76:79], v[96:99], v[32:35]
  ds_read_b128 v[88:91], v4 offset:20480
  ds_read_b128 v[92:95], v4 offset:20736
  v_mfma_f32_16x16x32_bf16 v[36:39], v[76:79], v[100:103], v[36:39]
  ds_read_b128 v[64:67], v1 offset:30720
  ds_read_b128 v[68:71], v1 offset:30976
  v_mfma_f32_16x16x32_bf16 v[40:43], v[80:83], v[96:99], v[40:43]
  ds_read_b128 v[72:75], v1 offset:31232
  v_mfma_f32_16x16x32_bf16 v[44:47], v[80:83], v[100:103], v[44:47]
  v_mfma_f32_16x16x32_bf16 v[48:51], v[84:87], v[96:99], v[48:51]
  v_mfma_f32_16x16x32_bf16 v[52:55], v[84:87], v[100:103], v[52:55]
  s_waitcnt lgkmcnt(0)
  v_mfma_f32_16x16x32_bf16 v[32:35], v[64:67], v[88:91], v[32:35]
  ds_read_b128 v[96:99], v4 offset:22528
  ds_read_b128 v[100:103], v4 offset:22784
  v_mfma_f32_16x16x32_bf16 v[36:39], v[64:67], v[92:95], v[36:39]
  ds_read_b128 v[76:79], v1 offset:35840
  ds_read_b128 v[80:83], v1 offset:36096
  v_mfma_f32_16x16x32_bf16 v[40:43], v[68:71], v[88:91], v[40:43]
  ds_read_b128 v[84:87], v1 offset:36352
  v_mfma_f32_16x16x32_bf16 v[44:47], v[68:71], v[92:95], v[44:47]
  v_mfma_f32_16x16x32_bf16 v[48:51], v[72:75], v[88:91], v[48:51]
  v_mfma_f32_16x16x32_bf16 v[52:55], v[72:75], v[92:95], v[52:55]
  s_waitcnt lgkmcnt(0)
  s_barrier
  v_mfma_f32_16x16x32_bf16 v[32:35], v[76:79], v[96:99], v[32:35]
  ds_read_b128 v[88:91], v3 offset:0
  ds_read_b128 v[92:95], v3 offset:256
  v_mfma_f32_16x16x32_bf16 v[36:39], v[76:79], v[100:103], v[36:39]
  ds_read_b128 v[64:67], v1 offset:40960
  ds_read_b128 v[68:71], v1 offset:41216
  v_mfma_f32_16x16x32_bf16 v[40:43], v[80:83], v[96:99], v[40:43]
  ds_read_b128 v[72:75], v1 offset:41472
  v_mfma_f32_16x16x32_bf16 v[44:47], v[80:83], v[100:103], v[44:47]
  v_mfma_f32_16x16x32_bf16 v[48:51], v[84:87], v[96:99], v[48:51]
  v_mfma_f32_16x16x32_bf16 v[52:55], v[84:87], v[100:103], v[52:55]
  s_waitcnt lgkmcnt(0)
  v_mfma_f32_16x16x32_bf16 v[32:35], v[64:67], v[88:91], v[32:35]
  ds_read_b128 v[96:99], v3 offset:2048
  ds_read_b128 v[100:103], v3 offset:2304
  v_mfma_f32_16x16x32_bf16 v[36:39], v[64:67], v[92:95], v[36:39]
  ds_read_b128 v[76:79], v1 offset:46080
  ds_read_b128 v[80:83], v1 offset:46336
  v_mfma_f32_16x16x32_bf16 v[40:43], v[68:71], v[88:91], v[40:43]
  ds_read_b128 v[84:87], v1 offset:46592
  v_mfma_f32_16x16x32_bf16 v[44:47], v[68:71], v[92:95], v[44:47]
  v_mfma_f32_16x16x32_bf16 v[48:51], v[72:75], v[88:91], v[48:51]
  v_mfma_f32_16x16x32_bf16 v[52:55], v[72:75], v[92:95], v[52:55]
  s_waitcnt lgkmcnt(0)
  v_mfma_f32_16x16x32_bf16 v[32:35], v[76:79], v[96:99], v[32:35]
  ds_read_b128 v[88:91], v3 offset:4096
  ds_read_b128 v[92:95], v3 offset:4352
  v_mfma_f32_16x16x32_bf16 v[36:39], v[76:79], v[100:103], v[36:39]
  ds_read_b128 v[64:67], v1 offset:51200
  ds_read_b128 v[68:71], v1 offset:51456
  v_mfma_f32_16x16x32_bf16 v[40:43], v[80:83], v[96:99], v[40:43]
  ds_read_b128 v[72:75], v1 offset:51712
  v_mfma_f32_16x16x32_bf16 v[44:47], v[80:83], v[100:103], v[44:47]
  v_mfma_f32_16x16x32_bf16 v[48:51], v[84:87], v[96:99], v[48:51]
  v_mfma_f32_16x16x32_bf16 v[52:55], v[84:87], v[100:103], v[52:55]
  s_waitcnt lgkmcnt(0)
  v_mfma_f32_16x16x32_bf16 v[32:35], v[64:67], v[88:91], v[32:35]
  ds_read_b128 v[96:99], v3 offset:6144
  ds_read_b128 v[100:103], v3 offset:6400
  v_mfma_f32_16x16x32_bf16 v[36:39], v[64:67], v[92:95], v[36:39]
  ds_read_b128 v[76:79], v1 offset:56320
  ds_read_b128 v[80:83], v1 offset:56576
  v_mfma_f32_16x16x32_bf16 v[40:43], v[68:71], v[88:91], v[40:43]
  ds_read_b128 v[84:87], v1 offset:56832
  v_mfma_f32_16x16x32_bf16 v[44:47], v[68:71], v[92:95], v[44:47]
  v_mfma_f32_16x16x32_bf16 v[48:51], v[72:75], v[88:91], v[48:51]
  v_mfma_f32_16x16x32_bf16 v[52:55], v[72:75], v[92:95], v[52:55]
  s_waitcnt lgkmcnt(0)
  s_barrier
  v_mfma_f32_16x16x32_bf16 v[32:35], v[76:79], v[96:99], v[32:35]
  ds_read_b128 v[88:91], v3 offset:16384
  ds_read_b128 v[92:95], v3 offset:16640
  v_mfma_f32_16x16x32_bf16 v[36:39], v[76:79], v[100:103], v[36:39]
  ds_read_b128 v[64:67], v2 offset:0
  ds_read_b128 v[68:71], v2 offset:256
  v_mfma_f32_16x16x32_bf16 v[40:43], v[80:83], v[96:99], v[40:43]
  ds_read_b128 v[72:75], v2 offset:512
  v_mfma_f32_16x16x32_bf16 v[44:47], v[80:83], v[100:103], v[44:47]
  v_mfma_f32_16x16x32_bf16 v[48:51], v[84:87], v[96:99], v[48:51]
  v_mfma_f32_16x16x32_bf16 v[52:55], v[84:87], v[100:103], v[52:55]
  s_waitcnt lgkmcnt(0)
  v_mfma_f32_16x16x32_bf16 v[32:35], v[64:67], v[88:91], v[32:35]
  ds_read_b128 v[96:99], v3 offset:18432
  ds_read_b128 v[100:103], v3 offset:18688
  v_mfma_f32_16x16x32_bf16 v[36:39], v[64:67], v[92:95], v[36:39]
  ds_read_b128 v[76:79], v2 offset:5120
  ds_read_b128 v[80:83], v2 offset:5376
  v_mfma_f32_16x16x32_bf16 v[40:43], v[68:71], v[88:91], v[40:43]
  ds_read_b128 v[84:87], v2 offset:5632
  v_mfma_f32_16x16x32_bf16 v[44:47], v[68:71], v[92:95], v[44:47]
  v_mfma_f32_16x16x32_bf16 v[48:51], v[72:75], v[88:91], v[48:51]
  v_mfma_f32_16x16x32_bf16 v[52:55], v[72:75], v[92:95], v[52:55]
  s_waitcnt lgkmcnt(0)
  v_mfma_f32_16x16x32_bf16 v[32:35], v[76:79], v[96:99], v[32:35]
  ds_read_b128 v[88:91], v3 offset:20480
  ds_read_b128 v[92:95], v3 offset:20736
  v_mfma_f32_16x16x32_bf16 v[36:39], v[76:79], v[100:103], v[36:39]
  ds_read_b128 v[64:67], v2 offset:10240
  ds_read_b128 v[68:71], v2 offset:10496
  v_mfma_f32_16x16x32_bf16 v[40:43], v[80:83], v[96:99], v[40:43]
  ds_read_b128 v[72:75], v2 offset:10752
  v_mfma_f32_16x16x32_bf16 v[44:47], v[80:83], v[100:103], v[44:47]
  v_mfma_f32_16x16x32_bf16 v[48:51], v[84:87], v[96:99], v[48:51]
  v_mfma_f32_16x16x32_bf16 v[52:55], v[84:87], v[100:103], v[52:55]
  s_waitcnt lgkmcnt(0)
  v_mfma_f32_16x16x32_bf16 v[32:35], v[64:67], v[88:91], v[32:35]
  ds_read_b128 v[96:99], v3 offset:22528
  ds_read_b128 v[100:103], v3 offset:22784
  v_mfma_f32_16x16x32_bf16 v[36:39], v[64:67], v[92:95], v[36:39]
  ds_read_b128 v[76:79], v2 offset:15360
  ds_read_b128 v[80:83], v2 offset:15616
  v_mfma_f32_16x16x32_bf16 v[40:43], v[68:71], v[88:91], v[40:43]
  ds_read_b128 v[84:87], v2 offset:15872
  v_mfma_f32_16x16x32_bf16 v[44:47], v[68:71], v[92:95], v[44:47]
  v_mfma_f32_16x16x32_bf16 v[48:51], v[72:75], v[88:91], v[48:51]
  v_mfma_f32_16x16x32_bf16 v[52:55], v[72:75], v[92:95], v[52:55]
  s_waitcnt lgkmcnt(0)
  s_barrier
  v_mfma_f32_16x16x32_bf16 v[32:35], v[76:79], v[96:99], v[32:35]
  ds_read_b128 v[88:91], v4 offset:0
  ds_read_b128 v[92:95], v4 offset:256
  v_mfma_f32_16x16x32_bf16 v[36:39], v[76:79], v[100:103], v[36:39]
  ds_read_b128 v[64:67], v1 offset:0
  ds_read_b128 v[68:71], v1 offset:256
  v_mfma_f32_16x16x32_bf16 v[40:43], v[80:83], v[96:99], v[40:43]
  ds_read_b128 v[72:75], v1 offset:512
  v_mfma_f32_16x16x32_bf16 v[44:47], v[80:83], v[100:103], v[44:47]
  v_mfma_f32_16x16x32_bf16 v[48:51], v[84:87], v[96:99], v[48:51]
  v_mfma_f32_16x16x32_bf16 v[52:55], v[84:87], v[100:103], v[52:55]
  s_waitcnt lgkmcnt(0)
  v_mfma_f32_16x16x32_bf16 v[32:35], v[64:67], v[88:91], v[32:35]
  ds_read_b128 v[96:99], v4 offset:2048
  ds_read_b128 v[100:103], v4 offset:2304
  v_mfma_f32_16x16x32_bf16 v[36:39], v[64:67], v[92:95], v[36:39]
  ds_read_b128 v[76:79], v1 offset:5120
  ds_read_b128 v[80:83], v1 offset:5376
  v_mfma_f32_16x16x32_bf16 v[40:43], v[68:71], v[88:91], v[40:43]
  ds_read_b128 v[84:87], v1 offset:5632
  v_mfma_f32_16x16x32_bf16 v[44:47], v[68:71], v[92:95], v[44:47]
  v_mfma_f32_16x16x32_bf16 v[48:51], v[72:75], v[88:91], v[48:51]
  v_mfma_f32_16x16x32_bf16 v[52:55], v[72:75], v[92:95], v[52:55]
  s_waitcnt lgkmcnt(0)
  v_mfma_f32_16x16x32_bf16 v[32:35], v[76:79], v[96:99], v[32:35]
  ds_read_b128 v[88:91], v4 offset:4096
  ds_read_b128 v[92:95], v4 offset:4352
  v_mfma_f32_16x16x32_bf16 v[36:39], v[76:79], v[100:103], v[36:39]
  ds_read_b128 v[64:67], v1 offset:10240
  ds_read_b128 v[68:71], v1 offset:10496
  v_mfma_f32_16x16x32_bf16 v[40:43], v[80:83], v[96:99], v[40:43]
  ds_read_b128 v[72:75], v1 offset:10752
  v_mfma_f32_16x16x32_bf16 v[44:47], v[80:83], v[100:103], v[44:47]
  v_mfma_f32_16x16x32_bf16 v[48:51], v[84:87], v[96:99], v[48:51]
  v_mfma_f32_16x16x32_bf16 v[52:55], v[84:87], v[100:103], v[52:55]
  s_waitcnt lgkmcnt(0)
  v_mfma_f32_16x16x32_bf16 v[32:35], v[64:67], v[88:91], v[32:35]
  ds_read_b128 v[96:99], v4 offset:6144
  ds_read_b128 v[100:103], v4 offset:6400
  v_mfma_f32_16x16x32_bf16 v[36:39], v[64:67], v[92:95], v[36:39]
  ds_read_b128 v[76:79], v1 offset:15360
  ds_read_b128 v[80:83], v1 offset:15616
  v_mfma_f32_16x16x32_bf16 v[40:43], v[68:71], v[88:91], v[40:43]
  ds_read_b128 v[84:87], v1 offset:15872
  v_mfma_f32_16x16x32_bf16 v[44:47], v[68:71], v[92:95], v[44:47]
  v_mfma_f32_16x16x32_bf16 v[48:51], v[72:75], v[88:91], v[48:51]
  v_mfma_f32_16x16x32_bf16 v[52:55], v[72:75], v[92:95], v[52:55]
  s_waitcnt lgkmcnt(0)
  v_mfma_f32_16x16x32_bf16 v[32:35], v[76:79], v[96:99], v[32:35]
  v_mfma_f32_16x16x32_bf16 v[36:39], v[76:79], v[100:103], v[36:39]
  v_mfma_f32_16x16x32_bf16 v[40:43], v[80:83], v[96:99], v[40:43]
  v_mfma_f32_16x16x32_bf16 v[44:47], v[80:83], v[100:103], v[44:47]
  v_mfma_f32_16x16x32_bf16 v[48:51], v[84:87], v[96:99], v[48:51]
  v_mfma_f32_16x16x32_bf16 v[52:55], v[84:87], v[100:103], v[52:55]
  s_waitcnt vmcnt(0)
  v_mov_b32 v8, 0
  v_mov_b32 v9, 0
  v_mov_b32 v10, 0
  v_mov_b32 v11, 0
  v_lshlrev_b32 v22, 4, v0
  s_add_u32 s53, s39, 12582912
  s_nop 4
  v_lshlrev_b32 v12, 16, v104
  v_and_b32 v13, 0xffff0000, v104
  v_lshlrev_b32 v14, 16, v105
  v_and_b32 v15, 0xffff0000, v105
  v_pk_add_f32 v[32:33], v[32:33], v[12:13]
  v_pk_add_f32 v[34:35], v[34:35], v[14:15]
  v_add_f32 v8, v8, v32
  v_fmac_f32 v10, v32, v32
  v_add_f32 v8, v8, v33
  v_fmac_f32 v10, v33, v33
  v_add_f32 v8, v8, v34
  v_fmac_f32 v10, v34, v34
  v_add_f32 v8, v8, v35
  v_fmac_f32 v10, v35, v35
  v_cvt_pk_bf16_f32 v24, v32, v33
  v_cvt_pk_bf16_f32 v25, v34, v35
  v_lshlrev_b32 v12, 16, v106
  v_and_b32 v13, 0xffff0000, v106
  v_lshlrev_b32 v14, 16, v107
  v_and_b32 v15, 0xffff0000, v107
  v_pk_add_f32 v[36:37], v[36:37], v[12:13]
  v_pk_add_f32 v[38:39], v[38:39], v[14:15]
  v_add_f32 v9, v9, v36
  v_fmac_f32 v11, v36, v36
  v_add_f32 v9, v9, v37
  v_fmac_f32 v11, v37, v37
  v_add_f32 v9, v9, v38
  v_fmac_f32 v11, v38, v38
  v_add_f32 v9, v9, v39
  v_fmac_f32 v11, v39, v39
  v_cvt_pk_bf16_f32 v26, v36, v37
  v_cvt_pk_bf16_f32 v27, v38, v39
  s_nop 1
  v_permlane16_swap_b32 v24, v26
  v_permlane16_swap_b32 v25, v27
  s_nop 1
  buffer_store_dwordx4 v[24:27], v22, s[48:51], s53 offen offset:0
  v_lshlrev_b32 v12, 16, v108
  v_and_b32 v13, 0xffff0000, v108
  v_lshlrev_b32 v14, 16, v109
  v_and_b32 v15, 0xffff0000, v109
  v_pk_add_f32 v[40:41], v[40:41], v[12:13]
  v_pk_add_f32 v[42:43], v[42:43], v[14:15]
  v_add_f32 v8, v8, v40
  v_fmac_f32 v10, v40, v40
  v_add_f32 v8, v8, v41
  v_fmac_f32 v10, v41, v41
  v_add_f32 v8, v8, v42
  v_fmac_f32 v10, v42, v42
  v_add_f32 v8, v8, v43
  v_fmac_f32 v10, v43, v43
  v_cvt_pk_bf16_f32 v28, v40, v41
  v_cvt_pk_bf16_f32 v29, v42, v43
  v_lshlrev_b32 v12, 16, v110
  v_and_b32 v13, 0xffff0000, v110
  v_lshlrev_b32 v14, 16, v111
  v_and_b32 v15, 0xffff0000, v111
  v_pk_add_f32 v[44:45], v[44:45], v[12:13]
  v_pk_add_f32 v[46:47], v[46:47], v[14:15]
  v_add_f32 v9, v9, v44
  v_fmac_f32 v11, v44, v44
  v_add_f32 v9, v9, v45
  v_fmac_f32 v11, v45, v45
  v_add_f32 v9, v9, v46
  v_fmac_f32 v11, v46, v46
  v_add_f32 v9, v9, v47
  v_fmac_f32 v11, v47, v47
  v_cvt_pk_bf16_f32 v30, v44, v45
  v_cvt_pk_bf16_f32 v31, v46, v47
  s_nop 1
  v_permlane16_swap_b32 v28, v30
  v_permlane16_swap_b32 v29, v31
  s_nop 1
  buffer_store_dwordx4 v[28:31], v22, s[48:51], s53 offen offset:1024
  v_lshlrev_b32 v12, 16, v112
  v_and_b32 v13, 0xffff0000, v112
  v_lshlrev_b32 v14, 16, v113
  v_and_b32 v15, 0xffff0000, v113
  v_pk_add_f32 v[48:49], v[48:49], v[12:13]
  v_pk_add_f32 v[50:51], v[50:51], v[14:15]
  v_add_f32 v8, v8, v48
  v_fmac_f32 v10, v48, v48
  v_add_f32 v8, v8, v49
  v_fmac_f32 v10, v49, v49
  v_add_f32 v8, v8, v50
  v_fmac_f32 v10, v50, v50
  v_add_f32 v8, v8, v51
  v_fmac_f32 v10, v51, v51
  v_cvt_pk_bf16_f32 v24, v48, v49
  v_cvt_pk_bf16_f32 v25, v50, v51
  v_lshlrev_b32 v12, 16, v114
  v_and_b32 v13, 0xffff0000, v114
  v_lshlrev_b32 v14, 16, v115
  v_and_b32 v15, 0xffff0000, v115
  v_pk_add_f32 v[52:53], v[52:53], v[12:13]
  v_pk_add_f32 v[54:55], v[54:55], v[14:15]
  v_add_f32 v9, v9, v52
  v_fmac_f32 v11, v52, v52
  v_add_f32 v9, v9, v53
  v_fmac_f32 v11, v53, v53
  v_add_f32 v9, v9, v54
  v_fmac_f32 v11, v54, v54
  v_add_f32 v9, v9, v55
  v_fmac_f32 v11, v55, v55
  v_cvt_pk_bf16_f32 v26, v52, v53
  v_cvt_pk_bf16_f32 v27, v54, v55
  s_nop 1
  v_permlane16_swap_b32 v24, v26
  v_permlane16_swap_b32 v25, v27
  s_nop 1
  buffer_store_dwordx4 v[24:27], v22, s[48:51], s53 offen offset:2048
  v_permlane16_swap_b32 v8, v9
  v_permlane16_swap_b32 v10, v11
  s_nop 1
  v_add_f32 v8, v8, v9
  v_add_f32 v10, v10, v11
  s_nop 1
  v_permlane32_swap_b32 v8, v10
  s_nop 1
  v_add_f32 v8, v8, v10
  v_and_b32 v12, 31, v0
  v_lshlrev_b32 v12, 3, v12
  v_lshrrev_b32 v13, 5, v0
  v_lshl_add_u32 v12, v13, 2, v12
  s_lshl_b32 s40, s25, 1
  s_add_u32 s40, s40, s27
  s_lshl_b32 s40, s40, 14
  s_lshl_b32 s41, s38, 8
  s_add_u32 s40, s40, s41
  s_add_u32 s40, s40, 8912896
  buffer_store_dword v8, v12, s[48:51], s40 offen
  s_waitcnt vmcnt(0)
  s_mov_b64 exec, 1
  v_mov_b32 v1, 147456
  v_mov_b32 v2, 1
  ds_add_rtn_u32 v3, v1, v2
  s_lshl_b32 s37, s24, 7
  s_lshl_b32 s38, s25, 2
  s_add_u32 s37, s37, s38
  s_add_u32 s37, s37, 9203712
  s_waitcnt lgkmcnt(0)
  v_readfirstlane_b32 s38, v3
  s_and_b32 s38, s38, 3
  s_cmp_eq_u32 s38, 3
  s_cbranch_scc0 f0_kernel_p6_nosig37
  s_cmp_eq_u32 s63, 0
  s_cbranch_scc1 f0_kernel_p6_fastsig38
  buffer_wbl2 sc1
  s_waitcnt vmcnt(0)
  buffer_store_dword v2, off, s[48:51], s37 sc1
  s_branch f0_kernel_p6_nosig37
f0_kernel_p6_fastsig38:
  buffer_store_dword v2, off, s[48:51], s37
f0_kernel_p6_nosig37:
  s_mov_b64 exec, -1
  s_branch f0_kernel_p7_entry
f0_kernel_p6_p2:
  buffer_load_dwordx2 v[104:105], v20, s[48:51], s52 offen offset:0
  buffer_load_dwordx2 v[106:107], v20, s[48:51], s52 offen offset:256
  buffer_load_dwordx2 v[108:109], v20, s[48:51], s52 offen offset:1024
  buffer_load_dwordx2 v[110:111], v20, s[48:51], s52 offen offset:1280
  s_barrier
  ds_read_b128 v[88:91], v4 offset:0
  ds_read_b128 v[92:95], v4 offset:256
  ds_read_b128 v[64:67], v1 offset:0
  ds_read_b128 v[68:71], v1 offset:256
  s_waitcnt lgkmcnt(0)
  v_mfma_f32_16x16x32_bf16 v[32:35], v[64:67], v[88:91], 0
  ds_read_b128 v[96:99], v4 offset:2048
  ds_read_b128 v[100:103], v4 offset:2304
  v_mfma_f32_16x16x32_bf16 v[36:39], v[64:67], v[92:95], 0
  ds_read_b128 v[76:79], v1 offset:5120
  ds_read_b128 v[80:83], v1 offset:5376
  v_mfma_f32_16x16x32_bf16 v[40:43], v[68:71], v[88:91], 0
  v_mfma_f32_16x16x32_bf16 v[44:47], v[68:71], v[92:95], 0
  s_waitcnt lgkmcnt(0)
  v_mfma_f32_16x16x32_bf16 v[32:35], v[76:79], v[96:99], v[32:35]
  ds_read_b128 v[88:91], v4 offset:4096
  ds_read_b128 v[92:95], v4 offset:4352
  v_mfma_f32_16x16x32_bf16 v[36:39], v[76:79], v[100:103], v[36:39]
  ds_read_b128 v[64:67], v1 offset:10240
  ds_read_b128 v[68:71], v1 offset:10496
  v_mfma_f32_16x16x32_bf16 v[40:43], v[80:83], v[96:99], v[40:43]
  v_mfma_f32_16x16x32_bf16 v[44:47], v[80:83], v[100:103], v[44:47]
  s_waitcnt lgkmcnt(0)
  v_mfma_f32_16x16x32_bf16 v[32:35], v[64:67], v[88:91], v[32:35]
  ds_read_b128 v[96:99], v4 offset:6144
  ds_read_b128 v[100:103], v4 offset:6400
  v_mfma_f32_16x16x32_bf16 v[36:39], v[64:67], v[92:95], v[36:39]
  ds_read_b128 v[76:79], v1 offset:15360
  ds_read_b128 v[80:83], v1 offset:15616
  v_mfma_f32_16x16x32_bf16 v[40:43], v[68:71], v[88:91], v[40:43]
  v_mfma_f32_16x16x32_bf16 v[44:47], v[68:71], v[92:95], v[44:47]
  s_waitcnt lgkmcnt(0)
  s_barrier
  v_mfma_f32_16x16x32_bf16 v[32:35], v[76:79], v[96:99], v[32:35]
  ds_read_b128 v[88:91], v4 offset:16384
  ds_read_b128 v[92:95], v4 offset:16640
  v_mfma_f32_16x16x32_bf16 v[36:39], v[76:79], v[100:103], v[36:39]
  ds_read_b128 v[64:67], v1 offset:20480
  ds_read_b128 v[68:71], v1 offset:20736
  v_mfma_f32_16x16x32_bf16 v[40:43], v[80:83], v[96:99], v[40:43]
  v_mfma_f32_16x16x32_bf16 v[44:47], v[80:83], v[100:103], v[44:47]
  s_waitcnt lgkmcnt(0)
  v_mfma_f32_16x16x32_bf16 v[32:35], v[64:67], v[88:91], v[32:35]
  ds_read_b128 v[96:99], v4 offset:18432
  ds_read_b128 v[100:103], v4 offset:18688
  v_mfma_f32_16x16x32_bf16 v[36:39], v[64:67], v[92:95], v[36:39]
  ds_read_b128 v[76:79], v1 offset:25600
  ds_read_b128 v[80:83], v1 offset:25856
  v_mfma_f32_16x16x32_bf16 v[40:43], v[68:71], v[88:91], v[40:43]
  v_mfma_f32_16x16x32_bf16 v[44:47], v[68:71], v[92:95], v[44:47]
  s_waitcnt lgkmcnt(0)
  v_mfma_f32_16x16x32_bf16 v[32:35], v[76:79], v[96:99], v[32:35]
  ds_read_b128 v[88:91], v4 offset:20480
  ds_read_b128 v[92:95], v4 offset:20736
  v_mfma_f32_16x16x32_bf16 v[36:39], v[76:79], v[100:103], v[36:39]
  ds_read_b128 v[64:67], v1 offset:30720
  ds_read_b128 v[68:71], v1 offset:30976
  v_mfma_f32_16x16x32_bf16 v[40:43], v[80:83], v[96:99], v[40:43]
  v_mfma_f32_16x16x32_bf16 v[44:47], v[80:83], v[100:103], v[44:47]
  s_waitcnt lgkmcnt(0)
  v_mfma_f32_16x16x32_bf16 v[32:35], v[64:67], v[88:91], v[32:35]
  ds_read_b128 v[96:99], v4 offset:22528
  ds_read_b128 v[100:103], v4 offset:22784
  v_mfma_f32_16x16x32_bf16 v[36:39], v[64:67], v[92:95], v[36:39]
  ds_read_b128 v[76:79], v1 offset:35840
  ds_read_b128 v[80:83], v1 offset:36096
  v_mfma_f32_16x16x32_bf16 v[40:43], v[68:71], v[88:91], v[40:43]
  v_mfma_f32_16x16x32_bf16 v[44:47], v[68:71], v[92:95], v[44:47]
  s_waitcnt lgkmcnt(0)
  s_barrier
  v_mfma_f32_16x16x32_bf16 v[32:35], v[76:79], v[96:99], v[32:35]
  ds_read_b128 v[88:91], v3 offset:0
  ds_read_b128 v[92:95], v3 offset:256
  v_mfma_f32_16x16x32_bf16 v[36:39], v[76:79], v[100:103], v[36:39]
  ds_read_b128 v[64:67], v1 offset:40960
  ds_read_b128 v[68:71], v1 offset:41216
  v_mfma_f32_16x16x32_bf16 v[40:43], v[80:83], v[96:99], v[40:43]
  v_mfma_f32_16x16x32_bf16 v[44:47], v[80:83], v[100:103], v[44:47]
  s_waitcnt lgkmcnt(0)
  v_mfma_f32_16x16x32_bf16 v[32:35], v[64:67], v[88:91], v[32:35]
  ds_read_b128 v[96:99], v3 offset:2048
  ds_read_b128 v[100:103], v3 offset:2304
  v_mfma_f32_16x16x32_bf16 v[36:39], v[64:67], v[92:95], v[36:39]
  ds_read_b128 v[76:79], v1 offset:46080
  ds_read_b128 v[80:83], v1 offset:46336
  v_mfma_f32_16x16x32_bf16 v[40:43], v[68:71], v[88:91], v[40:43]
  v_mfma_f32_16x16x32_bf16 v[44:47], v[68:71], v[92:95], v[44:47]
  s_waitcnt lgkmcnt(0)
  v_mfma_f32_16x16x32_bf16 v[32:35], v[76:79], v[96:99], v[32:35]
  ds_read_b128 v[88:91], v3 offset:4096
  ds_read_b128 v[92:95], v3 offset:4352
  v_mfma_f32_16x16x32_bf16 v[36:39], v[76:79], v[100:103], v[36:39]
  ds_read_b128 v[64:67], v1 offset:51200
  ds_read_b128 v[68:71], v1 offset:51456
  v_mfma_f32_16x16x32_bf16 v[40:43], v[80:83], v[96:99], v[40:43]
  v_mfma_f32_16x16x32_bf16 v[44:47], v[80:83], v[100:103], v[44:47]
  s_waitcnt lgkmcnt(0)
  v_mfma_f32_16x16x32_bf16 v[32:35], v[64:67], v[88:91], v[32:35]
  ds_read_b128 v[96:99], v3 offset:6144
  ds_read_b128 v[100:103], v3 offset:6400
  v_mfma_f32_16x16x32_bf16 v[36:39], v[64:67], v[92:95], v[36:39]
  ds_read_b128 v[76:79], v1 offset:56320
  ds_read_b128 v[80:83], v1 offset:56576
  v_mfma_f32_16x16x32_bf16 v[40:43], v[68:71], v[88:91], v[40:43]
  v_mfma_f32_16x16x32_bf16 v[44:47], v[68:71], v[92:95], v[44:47]
  s_waitcnt lgkmcnt(0)
  s_barrier
  v_mfma_f32_16x16x32_bf16 v[32:35], v[76:79], v[96:99], v[32:35]
  ds_read_b128 v[88:91], v3 offset:16384
  ds_read_b128 v[92:95], v3 offset:16640
  v_mfma_f32_16x16x32_bf16 v[36:39], v[76:79], v[100:103], v[36:39]
  ds_read_b128 v[64:67], v2 offset:0
  ds_read_b128 v[68:71], v2 offset:256
  v_mfma_f32_16x16x32_bf16 v[40:43], v[80:83], v[96:99], v[40:43]
  v_mfma_f32_16x16x32_bf16 v[44:47], v[80:83], v[100:103], v[44:47]
  s_waitcnt lgkmcnt(0)
  v_mfma_f32_16x16x32_bf16 v[32:35], v[64:67], v[88:91], v[32:35]
  ds_read_b128 v[96:99], v3 offset:18432
  ds_read_b128 v[100:103], v3 offset:18688
  v_mfma_f32_16x16x32_bf16 v[36:39], v[64:67], v[92:95], v[36:39]
  ds_read_b128 v[76:79], v2 offset:5120
  ds_read_b128 v[80:83], v2 offset:5376
  v_mfma_f32_16x16x32_bf16 v[40:43], v[68:71], v[88:91], v[40:43]
  v_mfma_f32_16x16x32_bf16 v[44:47], v[68:71], v[92:95], v[44:47]
  s_waitcnt lgkmcnt(0)
  v_mfma_f32_16x16x32_bf16 v[32:35], v[76:79], v[96:99], v[32:35]
  ds_read_b128 v[88:91], v3 offset:20480
  ds_read_b128 v[92:95], v3 offset:20736
  v_mfma_f32_16x16x32_bf16 v[36:39], v[76:79], v[100:103], v[36:39]
  ds_read_b128 v[64:67], v2 offset:10240
  ds_read_b128 v[68:71], v2 offset:10496
  v_mfma_f32_16x16x32_bf16 v[40:43], v[80:83], v[96:99], v[40:43]
  v_mfma_f32_16x16x32_bf16 v[44:47], v[80:83], v[100:103], v[44:47]
  s_waitcnt lgkmcnt(0)
  v_mfma_f32_16x16x32_bf16 v[32:35], v[64:67], v[88:91], v[32:35]
  ds_read_b128 v[96:99], v3 offset:22528
  ds_read_b128 v[100:103], v3 offset:22784
  v_mfma_f32_16x16x32_bf16 v[36:39], v[64:67], v[92:95], v[36:39]
  ds_read_b128 v[76:79], v2 offset:15360
  ds_read_b128 v[80:83], v2 offset:15616
  v_mfma_f32_16x16x32_bf16 v[40:43], v[68:71], v[88:91], v[40:43]
  v_mfma_f32_16x16x32_bf16 v[44:47], v[68:71], v[92:95], v[44:47]
  s_waitcnt lgkmcnt(0)
  s_barrier
  v_mfma_f32_16x16x32_bf16 v[32:35], v[76:79], v[96:99], v[32:35]
  ds_read_b128 v[88:91], v4 offset:0
  ds_read_b128 v[92:95], v4 offset:256
  v_mfma_f32_16x16x32_bf16 v[36:39], v[76:79], v[100:103], v[36:39]
  ds_read_b128 v[64:67], v1 offset:0
  ds_read_b128 v[68:71], v1 offset:256
  v_mfma_f32_16x16x32_bf16 v[40:43], v[80:83], v[96:99], v[40:43]
  v_mfma_f32_16x16x32_bf16 v[44:47], v[80:83], v[100:103], v[44:47]
  s_waitcnt lgkmcnt(0)
  v_mfma_f32_16x16x32_bf16 v[32:35], v[64:67], v[88:91], v[32:35]
  ds_read_b128 v[96:99], v4 offset:2048
  ds_read_b128 v[100:103], v4 offset:2304
  v_mfma_f32_16x16x32_bf16 v[36:39], v[64:67], v[92:95], v[36:39]
  ds_read_b128 v[76:79], v1 offset:5120
  ds_read_b128 v[80:83], v1 offset:5376
  v_mfma_f32_16x16x32_bf16 v[40:43], v[68:71], v[88:91], v[40:43]
  v_mfma_f32_16x16x32_bf16 v[44:47], v[68:71], v[92:95], v[44:47]
  s_waitcnt lgkmcnt(0)
  v_mfma_f32_16x16x32_bf16 v[32:35], v[76:79], v[96:99], v[32:35]
  ds_read_b128 v[88:91], v4 offset:4096
  ds_read_b128 v[92:95], v4 offset:4352
  v_mfma_f32_16x16x32_bf16 v[36:39], v[76:79], v[100:103], v[36:39]
  ds_read_b128 v[64:67], v1 offset:10240
  ds_read_b128 v[68:71], v1 offset:10496
  v_mfma_f32_16x16x32_bf16 v[40:43], v[80:83], v[96:99], v[40:43]
  v_mfma_f32_16x16x32_bf16 v[44:47], v[80:83], v[100:103], v[44:47]
  s_waitcnt lgkmcnt(0)
  v_mfma_f32_16x16x32_bf16 v[32:35], v[64:67], v[88:91], v[32:35]
  ds_read_b128 v[96:99], v4 offset:6144
  ds_read_b128 v[100:103], v4 offset:6400
  v_mfma_f32_16x16x32_bf16 v[36:39], v[64:67], v[92:95], v[36:39]
  ds_read_b128 v[76:79], v1 offset:15360
  ds_read_b128 v[80:83], v1 offset:15616
  v_mfma_f32_16x16x32_bf16 v[40:43], v[68:71], v[88:91], v[40:43]
  v_mfma_f32_16x16x32_bf16 v[44:47], v[68:71], v[92:95], v[44:47]
  s_waitcnt lgkmcnt(0)
  v_mfma_f32_16x16x32_bf16 v[32:35], v[76:79], v[96:99], v[32:35]
  v_mfma_f32_16x16x32_bf16 v[36:39], v[76:79], v[100:103], v[36:39]
  v_mfma_f32_16x16x32_bf16 v[40:43], v[80:83], v[96:99], v[40:43]
  v_mfma_f32_16x16x32_bf16 v[44:47], v[80:83], v[100:103], v[44:47]
  s_waitcnt vmcnt(0)
  v_mov_b32 v8, 0
  v_mov_b32 v9, 0
  v_mov_b32 v10, 0
  v_mov_b32 v11, 0
  v_lshlrev_b32 v22, 4, v0
  s_add_u32 s53, s39, 12582912
  s_nop 4
  v_lshlrev_b32 v12, 16, v104
  v_and_b32 v13, 0xffff0000, v104
  v_lshlrev_b32 v14, 16, v105
  v_and_b32 v15, 0xffff0000, v105
  v_pk_add_f32 v[32:33], v[32:33], v[12:13]
  v_pk_add_f32 v[34:35], v[34:35], v[14:15]
  v_add_f32 v8, v8, v32
  v_fmac_f32 v10, v32, v32
  v_add_f32 v8, v8, v33
  v_fmac_f32 v10, v33, v33
  v_add_f32 v8, v8, v34
  v_fmac_f32 v10, v34, v34
  v_add_f32 v8, v8, v35
  v_fmac_f32 v10, v35, v35
  v_cvt_pk_bf16_f32 v24, v32, v33
  v_cvt_pk_bf16_f32 v25, v34, v35
  v_lshlrev_b32 v12, 16, v106
  v_and_b32 v13, 0xffff0000, v106
  v_lshlrev_b32 v14, 16, v107
  v_and_b32 v15, 0xffff0000, v107
  v_pk_add_f32 v[36:37], v[36:37], v[12:13]
  v_pk_add_f32 v[38:39], v[38:39], v[14:15]
  v_add_f32 v9, v9, v36
  v_fmac_f32 v11, v36, v36
  v_add_f32 v9, v9, v37
  v_fmac_f32 v11, v37, v37
  v_add_f32 v9, v9, v38
  v_fmac_f32 v11, v38, v38
  v_add_f32 v9, v9, v39
  v_fmac_f32 v11, v39, v39
  v_cvt_pk_bf16_f32 v26, v36, v37
  v_cvt_pk_bf16_f32 v27, v38, v39
  s_nop 1
  v_permlane16_swap_b32 v24, v26
  v_permlane16_swap_b32 v25, v27
  s_nop 1
  buffer_store_dwordx4 v[24:27], v22, s[48:51], s53 offen offset:0
  v_lshlrev_b32 v12, 16, v108
  v_and_b32 v13, 0xffff0000, v108
  v_lshlrev_b32 v14, 16, v109
  v_and_b32 v15, 0xffff0000, v109
  v_pk_add_f32 v[40:41], v[40:41], v[12:13]
  v_pk_add_f32 v[42:43], v[42:43], v[14:15]
  v_add_f32 v8, v8, v40
  v_fmac_f32 v10, v40, v40
  v_add_f32 v8, v8, v41
  v_fmac_f32 v10, v41, v41
  v_add_f32 v8, v8, v42
  v_fmac_f32 v10, v42, v42
  v_add_f32 v8, v8, v43
  v_fmac_f32 v10, v43, v43
  v_cvt_pk_bf16_f32 v28, v40, v41
  v_cvt_pk_bf16_f32 v29, v42, v43
  v_lshlrev_b32 v12, 16, v110
  v_and_b32 v13, 0xffff0000, v110
  v_lshlrev_b32 v14, 16, v111
  v_and_b32 v15, 0xffff0000, v111
  v_pk_add_f32 v[44:45], v[44:45], v[12:13]
  v_pk_add_f32 v[46:47], v[46:47], v[14:15]
  v_add_f32 v9, v9, v44
  v_fmac_f32 v11, v44, v44
  v_add_f32 v9, v9, v45
  v_fmac_f32 v11, v45, v45
  v_add_f32 v9, v9, v46
  v_fmac_f32 v11, v46, v46
  v_add_f32 v9, v9, v47
  v_fmac_f32 v11, v47, v47
  v_cvt_pk_bf16_f32 v30, v44, v45
  v_cvt_pk_bf16_f32 v31, v46, v47
  s_nop 1
  v_permlane16_swap_b32 v28, v30
  v_permlane16_swap_b32 v29, v31
  s_nop 1
  buffer_store_dwordx4 v[28:31], v22, s[48:51], s53 offen offset:1024
  v_permlane16_swap_b32 v8, v9
  v_permlane16_swap_b32 v10, v11
  s_nop 1
  v_add_f32 v8, v8, v9
  v_add_f32 v10, v10, v11
  s_nop 1
  v_permlane32_swap_b32 v8, v10
  s_nop 1
  v_add_f32 v8, v8, v10
  v_and_b32 v12, 31, v0
  v_lshlrev_b32 v12, 3, v12
  v_lshrrev_b32 v13, 5, v0
  v_lshl_add_u32 v12, v13, 2, v12
  s_lshl_b32 s40, s25, 1
  s_add_u32 s40, s40, s27
  s_lshl_b32 s40, s40, 14
  s_lshl_b32 s41, s38, 8
  s_add_u32 s40, s40, s41
  s_add_u32 s40, s40, 8912896
  buffer_store_dword v8, v12, s[48:51], s40 offen
  s_waitcnt vmcnt(0)
  s_mov_b64 exec, 1
  v_mov_b32 v1, 147456
  v_mov_b32 v2, 1
  ds_add_rtn_u32 v3, v1, v2
  s_lshl_b32 s37, s24, 7
  s_lshl_b32 s38, s25, 2
  s_add_u32 s37, s37, s38
  s_add_u32 s37, s37, 9203712
  s_waitcnt lgkmcnt(0)
  v_readfirstlane_b32 s38, v3
  s_and_b32 s38, s38, 3
  s_cmp_eq_u32 s38, 3
  s_cbranch_scc0 f0_kernel_p6_nosig39
  s_cmp_eq_u32 s63, 0
  s_cbranch_scc1 f0_kernel_p6_fastsig40
  buffer_wbl2 sc1
  s_waitcnt vmcnt(0)
  buffer_store_dword v2, off, s[48:51], s37 sc1
  s_branch f0_kernel_p6_nosig39
f0_kernel_p6_fastsig40:
  buffer_store_dword v2, off, s[48:51], s37
f0_kernel_p6_nosig39:
  s_mov_b64 exec, -1
  s_branch f0_kernel_p7_entry
f0_kernel_p7_entry:
  s_mov_b32 s26, s64
  s_load_dwordx2 s[8:9], s[0:1], 40
  s_and_b32 s20, s2, 7
  s_lshr_b32 s21, s2, 3
  s_and_b32 s22, s21, 1
  s_lshl_b32 s23, s20, 1
  s_add_u32 s24, s23, s22
  s_lshr_b32 s25, s21, 1
  s_cmp_lt_u32 s26, 4
  s_cbranch_scc1 f0_kernel_p7_compute
  s_sub_u32 s26, s26, 4
  v_lshlrev_b32 v1, 4, v0
  s_mul_i32 s40, s25, 122880
  s_mul_i32 s41, s26, 3072
  s_add_u32 s40, s40, s41
  s_add_u32 s40, s40, 3145728
  s_mov_b32 s42, s41
  s_lshl_b32 s43, s24, 2
  s_add_u32 s43, s43, s26
  s_mul_i32 s43, s43, 40960
  s_add_u32 s43, s43, 12582912
  s_lshl_b32 s44, s26, 12
  s_waitcnt lgkmcnt(0)
  s_mov_b32 s12, s6
  s_mov_b32 s13, s7
  s_mov_b32 s14, 0x3200000
  s_mov_b32 s15, 0x00020000
  s_add_u32 m0, s42, 0
  s_add_u32 s45, s40, 0
  buffer_load_dwordx4 v1, s[12:15], s45 offen offset:0 lds
  buffer_load_dwordx4 v1, s[12:15], s45 offen offset:1024 lds
  buffer_load_dwordx4 v1, s[12:15], s45 offen offset:2048 lds
  s_add_u32 m0, s42, 147712
  s_add_u32 s45, s40, 12288
  buffer_load_dwordx4 v1, s[12:15], s45 offen offset:0 lds
  buffer_load_dwordx4 v1, s[12:15], s45 offen offset:1024 lds
  buffer_load_dwordx4 v1, s[12:15], s45 offen offset:2048 lds
  v_and_b32 v2, 31, v0
  v_lshrrev_b32 v3, 5, v0
  s_lshl_b32 s47, s26, 5
  v_add_u32 v5, s47, v2
  s_mul_i32 s47, s25, 96
  v_add_u32 v6, s47, v5
  v_lshlrev_b32 v7, 2, v6
  v_mul_u32_u24 v8, 30720, v3
  v_add_u32 v7, v7, v8
  s_mov_b32 s47, 8519680
  buffer_load_dword v32, v7, s[12:15], s47 offen
  s_mov_b32 s47, 8525824
  buffer_load_dword v33, v7, s[12:15], s47 offen
  s_mov_b32 s47, 8531968
  buffer_load_dword v34, v7, s[12:15], s47 offen
  s_mov_b32 s47, 8538112
  buffer_load_dword v35, v7, s[12:15], s47 offen
  s_mov_b32 s47, 8544256
  buffer_load_dword v36, v7, s[12:15], s47 offen
  s_mov_b32 s16, s8
  s_mov_b32 s17, s9
  s_mov_b32 s18, 0xc00
  s_mov_b32 s19, 0x00020000
  v_lshlrev_b32 v9, 1, v6
  buffer_load_ushort v38, v9, s[16:19], 0 offen
  s_lshr_b32 s67, s26, 1
  s_lshl_b32 s46, s24, 1
  s_add_u32 s67, s67, s46
  s_lshl_b32 s66, s67, 7
  s_add_u32 s66, s66, 9203712
  v_lshlrev_b32 v10, 2, v0
  s_mov_b64 exec, 0xff
  s_mov_b32 s65, 16384
f0_kernel_p7_poll:
  buffer_load_dword v11, v10, s[12:15], s66 offen sc1
  s_waitcnt vmcnt(0)
  v_cmp_ne_u32 vcc, 0, v11
  s_cmp_eq_u32 vcc_lo, 0xff
  s_cbranch_scc1 f0_kernel_p7_polled
  s_sleep 1
  s_sub_u32 s65, s65, 1
  s_cbranch_scc0 f0_kernel_p7_poll
f0_kernel_p7_polled:
  s_mov_b64 exec, -1
  s_cmp_eq_u32 s63, 0
  s_cbranch_scc1 f0_kernel_p7_noacq
  buffer_inv sc1
  s_waitcnt vmcnt(0)
f0_kernel_p7_noacq:
  s_add_u32 m0, s44, 65536
  s_add_u32 s45, s43, 0
  buffer_load_dwordx4 v1, s[12:15], s45 offen offset:0 sc1 lds
  buffer_load_dwordx4 v1, s[12:15], s45 offen offset:1024 sc1 lds
  buffer_load_dwordx4 v1, s[12:15], s45 offen offset:2048 sc1 lds
  buffer_load_dwordx4 v1, s[12:15], s45 offen offset:3072 sc1 lds
  s_lshl_b32 s46, s24, 7
  s_lshl_b32 s47, s26, 5
  s_add_u32 s46, s46, s47
  v_add_u32 v4, s46, v2
  v_lshlrev_b32 v4, 3, v4
  v_lshl_add_u32 v4, v3, 17, v4
  s_mov_b32 s47, 8912896
  buffer_load_dwordx2 v[16:17], v4, s[12:15], s47 offen sc1
  s_mov_b32 s47, 8929280
  buffer_load_dwordx2 v[18:19], v4, s[12:15], s47 offen sc1
  s_mov_b32 s47, 8945664
  buffer_load_dwordx2 v[20:21], v4, s[12:15], s47 offen sc1
  s_mov_b32 s47, 8962048
  buffer_load_dwordx2 v[22:23], v4, s[12:15], s47 offen sc1
  s_mov_b32 s47, 8978432
  buffer_load_dwordx2 v[24:25], v4, s[12:15], s47 offen sc1
  s_mov_b32 s47, 8994816
  buffer_load_dwordx2 v[26:27], v4, s[12:15], s47 offen sc1
  s_mov_b32 s47, 9011200
  buffer_load_dwordx2 v[28:29], v4, s[12:15], s47 offen sc1
  s_mov_b32 s47, 9027584
  buffer_load_dwordx2 v[30:31], v4, s[12:15], s47 offen sc1
  s_add_u32 m0, s44, 131072
  s_add_u32 s45, s43, 4096
  buffer_load_dwordx4 v1, s[12:15], s45 offen offset:0 sc1 lds
  buffer_load_dwordx4 v1, s[12:15], s45 offen offset:1024 sc1 lds
  buffer_load_dwordx4 v1, s[12:15], s45 offen offset:2048 sc1 lds
  buffer_load_dwordx4 v1, s[12:15], s45 offen offset:3072 sc1 lds
  s_add_u32 m0, s42, 12288
  s_add_u32 s45, s40, 24576
  buffer_load_dwordx4 v1, s[12:15], s45 offen offset:0 lds
  buffer_load_dwordx4 v1, s[12:15], s45 offen offset:1024 lds
  buffer_load_dwordx4 v1, s[12:15], s45 offen offset:2048 lds
  s_add_u32 m0, s42, 53248
  s_add_u32 s45, s40, 36864
  buffer_load_dwordx4 v1, s[12:15], s45 offen offset:0 lds
  buffer_load_dwordx4 v1, s[12:15], s45 offen offset:1024 lds
  buffer_load_dwordx4 v1, s[12:15], s45 offen offset:2048 lds
  s_waitcnt vmcnt(10)
  s_barrier
  v_add_f32 v16, v16, v18
  v_add_f32 v17, v17, v19
  v_add_f32 v16, v16, v20
  v_add_f32 v17, v17, v21
  v_add_f32 v16, v16, v22
  v_add_f32 v17, v17, v23
  v_add_f32 v16, v16, v24
  v_add_f32 v17, v17, v25
  v_add_f32 v16, v16, v26
  v_add_f32 v17, v17, v27
  v_add_f32 v16, v16, v28
  v_add_f32 v17, v17, v29
  v_add_f32 v16, v16, v30
  v_add_f32 v17, v17, v31
  v_mov_b32 v18, v16
  v_mov_b32 v19, v17
  s_nop 1
  v_permlane32_swap_b32 v16, v18
  v_permlane32_swap_b32 v17, v19
  s_nop 1
  v_add_f32 v16, v16, v18
  v_add_f32 v17, v17, v19
  v_mul_f32 v16, 0x3acccccd, v16
  v_mul_f32 v17, 0x3acccccd, v17
  v_fma_f32 v17, -v16, v16, v17
  v_max_f32 v17, 0, v17
  v_add_f32 v18, 0x3727c5ac, v17
  v_rsq_f32 v18, v18
  s_nop 0
  v_mul_f32 v19, v18, v18
  v_mul_f32 v19, v19, v17
  v_add_f32 v19, 0x3727c5ac, v19
  v_rsq_f32 v19, v19
  s_nop 0
  v_mul_f32 v18, v18, v19
  s_nop 0
  v_mul_f32 v19, v18, v16
  v_add_f32 v32, v32, v33
  v_add_f32 v32, v32, v34
  v_add_f32 v32, v32, v35
  v_add_f32 v32, v32, v36
  v_mov_b32 v33, v32
  s_nop 1
  v_permlane32_swap_b32 v32, v33
  s_nop 1
  v_add_f32 v32, v32, v33
  v_cmp_eq_u32 vcc, 0, v3
  s_lshl_b32 s47, s26, 7
  v_lshlrev_b32 v2, 2, v2
  v_add_u32 v2, s47, v2
  v_add_u32 v2, 160000, v2
  v_lshl_add_u32 v2, v3, 9, v2
  v_cndmask_b32 v18, v19, v18, vcc
  v_lshlrev_b32 v38, 16, v38
  v_cndmask_b32 v32, v38, v32, vcc
  ds_write_b32 v2, v18
  ds_write_b32 v2, v32 offset:1024
  s_waitcnt lgkmcnt(0)
  s_add_u32 m0, s44, 81920
  s_add_u32 s45, s43, 8192
  buffer_load_dwordx4 v1, s[12:15], s45 offen offset:0 sc1 lds
  buffer_load_dwordx4 v1, s[12:15], s45 offen offset:1024 sc1 lds
  buffer_load_dwordx4 v1, s[12:15], s45 offen offset:2048 sc1 lds
  buffer_load_dwordx4 v1, s[12:15], s45 offen offset:3072 sc1 lds
  s_add_u32 m0, s44, 98304
  s_add_u32 s45, s43, 12288
  buffer_load_dwordx4 v1, s[12:15], s45 offen offset:0 sc1 lds
  buffer_load_dwordx4 v1, s[12:15], s45 offen offset:1024 sc1 lds
  buffer_load_dwordx4 v1, s[12:15], s45 offen offset:2048 sc1 lds
  buffer_load_dwordx4 v1, s[12:15], s45 offen offset:3072 sc1 lds
  s_waitcnt vmcnt(14)
  s_barrier
  s_add_u32 m0, s42, 0
  s_add_u32 s45, s40, 49152
  buffer_load_dwordx4 v1, s[12:15], s45 offen offset:0 lds
  buffer_load_dwordx4 v1, s[12:15], s45 offen offset:1024 lds
  buffer_load_dwordx4 v1, s[12:15], s45 offen offset:2048 lds
  s_add_u32 m0, s44, 65536
  s_add_u32 s45, s43, 16384
  buffer_load_dwordx4 v1, s[12:15], s45 offen offset:0 sc1 lds
  buffer_load_dwordx4 v1, s[12:15], s45 offen offset:1024 sc1 lds
  buffer_load_dwordx4 v1, s[12:15], s45 offen offset:2048 sc1 lds
  buffer_load_dwordx4 v1, s[12:15], s45 offen offset:3072 sc1 lds
  s_waitcnt vmcnt(11)
  s_barrier
  s_add_u32 m0, s42, 147712
  s_add_u32 s45, s40, 61440
  buffer_load_dwordx4 v1, s[12:15], s45 offen offset:0 lds
  buffer_load_dwordx4 v1, s[12:15], s45 offen offset:1024 lds
  buffer_load_dwordx4 v1, s[12:15], s45 offen offset:2048 lds
  s_add_u32 m0, s44, 131072
  s_add_u32 s45, s43, 20480
  buffer_load_dwordx4 v1, s[12:15], s45 offen offset:0 sc1 lds
  buffer_load_dwordx4 v1, s[12:15], s45 offen offset:1024 sc1 lds
  buffer_load_dwordx4 v1, s[12:15], s45 offen offset:2048 sc1 lds
  buffer_load_dwordx4 v1, s[12:15], s45 offen offset:3072 sc1 lds
  s_waitcnt vmcnt(14)
  s_barrier
  s_add_u32 m0, s42, 12288
  s_add_u32 s45, s40, 73728
  buffer_load_dwordx4 v1, s[12:15], s45 offen offset:0 lds
  buffer_load_dwordx4 v1, s[12:15], s45 offen offset:1024 lds
  buffer_load_dwordx4 v1, s[12:15], s45 offen offset:2048 lds
  s_add_u32 m0, s44, 81920
  s_add_u32 s45, s43, 24576
  buffer_load_dwordx4 v1, s[12:15], s45 offen offset:0 sc1 lds
  buffer_load_dwordx4 v1, s[12:15], s45 offen offset:1024 sc1 lds
  buffer_load_dwordx4 v1, s[12:15], s45 offen offset:2048 sc1 lds
  buffer_load_dwordx4 v1, s[12:15], s45 offen offset:3072 sc1 lds
  s_waitcnt vmcnt(14)
  s_barrier
  s_add_u32 m0, s42, 53248
  s_add_u32 s45, s40, 86016
  buffer_load_dwordx4 v1, s[12:15], s45 offen offset:0 lds
  buffer_load_dwordx4 v1, s[12:15], s45 offen offset:1024 lds
  buffer_load_dwordx4 v1, s[12:15], s45 offen offset:2048 lds
  s_add_u32 m0, s44, 98304
  s_add_u32 s45, s43, 28672
  buffer_load_dwordx4 v1, s[12:15], s45 offen offset:0 sc1 lds
  buffer_load_dwordx4 v1, s[12:15], s45 offen offset:1024 sc1 lds
  buffer_load_dwordx4 v1, s[12:15], s45 offen offset:2048 sc1 lds
  buffer_load_dwordx4 v1, s[12:15], s45 offen offset:3072 sc1 lds
  s_waitcnt vmcnt(14)
  s_barrier
  s_add_u32 m0, s42, 0
  s_add_u32 s45, s40, 98304
  buffer_load_dwordx4 v1, s[12:15], s45 offen offset:0 lds
  buffer_load_dwordx4 v1, s[12:15], s45 offen offset:1024 lds
  buffer_load_dwordx4 v1, s[12:15], s45 offen offset:2048 lds
  s_add_u32 m0, s44, 65536
  s_add_u32 s45, s43, 32768
  buffer_load_dwordx4 v1, s[12:15], s45 offen offset:0 sc1 lds
  buffer_load_dwordx4 v1, s[12:15], s45 offen offset:1024 sc1 lds
  buffer_load_dwordx4 v1, s[12:15], s45 offen offset:2048 sc1 lds
  buffer_load_dwordx4 v1, s[12:15], s45 offen offset:3072 sc1 lds
  s_waitcnt vmcnt(14)
  s_barrier
  s_add_u32 m0, s42, 147712
  s_add_u32 s45, s40, 110592
  buffer_load_dwordx4 v1, s[12:15], s45 offen offset:0 lds
  buffer_load_dwordx4 v1, s[12:15], s45 offen offset:1024 lds
  buffer_load_dwordx4 v1, s[12:15], s45 offen offset:2048 lds
  s_add_u32 m0, s44, 131072
  s_add_u32 s45, s43, 36864
  buffer_load_dwordx4 v1, s[12:15], s45 offen offset:0 sc1 lds
  buffer_load_dwordx4 v1, s[12:15], s45 offen offset:1024 sc1 lds
  buffer_load_dwordx4 v1, s[12:15], s45 offen offset:2048 sc1 lds
  buffer_load_dwordx4 v1, s[12:15], s45 offen offset:3072 sc1 lds
  v_lshlrev_b32 v12, 7, v0
  s_mul_i32 s46, s24, 163840
  s_lshl_b32 s47, s25, 2
  s_add_u32 s47, s47, s26
  s_mul_i32 s47, s47, 2560
  s_add_u32 s46, s46, s47
  s_load_dwordx2 s[56:57], s[0:1], 64
  s_waitcnt lgkmcnt(0)
  s_mov_b32 s16, s56
  s_mov_b32 s17, s57
  s_mov_b32 s18, 0x280000
  s_mov_b32 s19, 0x00020000
  s_mov_b64 exec, 0xfffff
  buffer_load_dword v13, v12, s[16:19], s46 offen
  s_mov_b64 exec, -1
  s_waitcnt vmcnt(15)
  s_barrier
  s_waitcnt vmcnt(8)
  s_barrier
  s_waitcnt vmcnt(1)
  s_barrier
  s_branch f0_kernel_p8_entry
f0_kernel_p7_compute:
  s_mov_b32 s27, 0
  s_mov_b32 s36, s26
  v_lshrrev_b32 v17, 5, v0
  v_and_b32 v16, 31, v0
  v_mul_u32_u24 v20, 1536, v17
  v_lshl_add_u32 v20, v16, 4, v20
  s_mul_i32 s37, s27, 1536
  v_add_u32 v1, s37, v20
  v_add_u32 v2, 147712, v1
  v_lshlrev_b32 v20, 4, v0
  s_mul_i32 s37, s36, 4096
  s_add_u32 s37, s37, 65536
  v_add_u32 v3, s37, v20
  v_add_u32 v4, 65536, v3
  s_waitcnt lgkmcnt(0)
  s_barrier
  ds_read_b128 v[128:131], v1 offset:0
  ds_read_b128 v[132:135], v1 offset:512
  ds_read_b128 v[136:139], v1 offset:1024
  ds_read_b128 v[160:163], v3 offset:0
  s_waitcnt lgkmcnt(0)
  v_mfma_f32_32x32x16_bf16 v[64:79], v[128:131], v[160:163], 0
  ds_read_b128 v[140:143], v1 offset:3072
  ds_read_b128 v[144:147], v1 offset:3584
  v_mfma_f32_32x32x16_bf16 v[80:95], v[132:135], v[160:163], 0
  ds_read_b128 v[148:151], v1 offset:4096
  ds_read_b128 v[164:167], v3 offset:1024
  v_mfma_f32_32x32x16_bf16 v[96:111], v[136:139], v[160:163], 0
  s_waitcnt lgkmcnt(0)
  v_mfma_f32_32x32x16_bf16 v[64:79], v[140:143], v[164:167], v[64:79]
  ds_read_b128 v[128:131], v1 offset:6144
  ds_read_b128 v[132:135], v1 offset:6656
  v_mfma_f32_32x32x16_bf16 v[80:95], v[144:147], v[164:167], v[80:95]
  ds_read_b128 v[136:139], v1 offset:7168
  ds_read_b128 v[160:163], v3 offset:2048
  v_mfma_f32_32x32x16_bf16 v[96:111], v[148:151], v[164:167], v[96:111]
  s_waitcnt lgkmcnt(0)
  v_mfma_f32_32x32x16_bf16 v[64:79], v[128:131], v[160:163], v[64:79]
  ds_read_b128 v[140:143], v1 offset:9216
  ds_read_b128 v[144:147], v1 offset:9728
  v_mfma_f32_32x32x16_bf16 v[80:95], v[132:135], v[160:163], v[80:95]
  ds_read_b128 v[148:151], v1 offset:10240
  ds_read_b128 v[164:167], v3 offset:3072
  v_mfma_f32_32x32x16_bf16 v[96:111], v[136:139], v[160:163], v[96:111]
  s_waitcnt lgkmcnt(0)
  s_barrier
  v_mfma_f32_32x32x16_bf16 v[64:79], v[140:143], v[164:167], v[64:79]
  ds_read_b128 v[128:131], v2 offset:0
  ds_read_b128 v[132:135], v2 offset:512
  v_mfma_f32_32x32x16_bf16 v[80:95], v[144:147], v[164:167], v[80:95]
  ds_read_b128 v[136:139], v2 offset:1024
  ds_read_b128 v[160:163], v4 offset:0
  v_mfma_f32_32x32x16_bf16 v[96:111], v[148:151], v[164:167], v[96:111]
  s_waitcnt lgkmcnt(0)
  v_mfma_f32_32x32x16_bf16 v[64:79], v[128:131], v[160:163], v[64:79]
  ds_read_b128 v[140:143], v2 offset:3072
  ds_read_b128 v[144:147], v2 offset:3584
  v_mfma_f32_32x32x16_bf16 v[80:95], v[132:135], v[160:163], v[80:95]
  ds_read_b128 v[148:151], v2 offset:4096
  ds_read_b128 v[164:167], v4 offset:1024
  v_mfma_f32_32x32x16_bf16 v[96:111], v[136:139], v[160:163], v[96:111]
  s_waitcnt lgkmcnt(0)
  v_mfma_f32_32x32x16_bf16 v[64:79], v[140:143], v[164:167], v[64:79]
  ds_read_b128 v[128:131], v2 offset:6144
  ds_read_b128 v[132:135], v2 offset:6656
  v_mfma_f32_32x32x16_bf16 v[80:95], v[144:147], v[164:167], v[80:95]
  ds_read_b128 v[136:139], v2 offset:7168
  ds_read_b128 v[160:163], v4 offset:2048
  v_mfma_f32_32x32x16_bf16 v[96:111], v[148:151], v[164:167], v[96:111]
  s_waitcnt lgkmcnt(0)
  v_mfma_f32_32x32x16_bf16 v[64:79], v[128:131], v[160:163], v[64:79]
  ds_read_b128 v[140:143], v2 offset:9216
  ds_read_b128 v[144:147], v2 offset:9728
  v_mfma_f32_32x32x16_bf16 v[80:95], v[132:135], v[160:163], v[80:95]
  ds_read_b128 v[148:151], v2 offset:10240
  ds_read_b128 v[164:167], v4 offset:3072
  v_mfma_f32_32x32x16_bf16 v[96:111], v[136:139], v[160:163], v[96:111]
  s_waitcnt lgkmcnt(0)
  s_barrier
  v_mfma_f32_32x32x16_bf16 v[64:79], v[140:143], v[164:167], v[64:79]
  ds_read_b128 v[128:131], v1 offset:12288
  ds_read_b128 v[132:135], v1 offset:12800
  v_mfma_f32_32x32x16_bf16 v[80:95], v[144:147], v[164:167], v[80:95]
  ds_read_b128 v[136:139], v1 offset:13312
  ds_read_b128 v[160:163], v3 offset:16384
  v_mfma_f32_32x32x16_bf16 v[96:111], v[148:151], v[164:167], v[96:111]
  s_waitcnt lgkmcnt(0)
  v_mfma_f32_32x32x16_bf16 v[64:79], v[128:131], v[160:163], v[64:79]
  ds_read_b128 v[140:143], v1 offset:15360
  ds_read_b128 v[144:147], v1 offset:15872
  v_mfma_f32_32x32x16_bf16 v[80:95], v[132:135], v[160:163], v[80:95]
  ds_read_b128 v[148:151], v1 offset:16384
  ds_read_b128 v[164:167], v3 offset:17408
  v_mfma_f32_32x32x16_bf16 v[96:111], v[136:139], v[160:163], v[96:111]
  s_waitcnt lgkmcnt(0)
  v_mfma_f32_32x32x16_bf16 v[64:79], v[140:143], v[164:167], v[64:79]
  ds_read_b128 v[128:131], v1 offset:18432
  ds_read_b128 v[132:135], v1 offset:18944
  v_mfma_f32_32x32x16_bf16 v[80:95], v[144:147], v[164:167], v[80:95]
  ds_read_b128 v[136:139], v1 offset:19456
  ds_read_b128 v[160:163], v3 offset:18432
  v_mfma_f32_32x32x16_bf16 v[96:111], v[148:151], v[164:167], v[96:111]
  s_waitcnt lgkmcnt(0)
  v_mfma_f32_32x32x16_bf16 v[64:79], v[128:131], v[160:163], v[64:79]
  ds_read_b128 v[140:143], v1 offset:21504
  ds_read_b128 v[144:147], v1 offset:22016
  v_mfma_f32_32x32x16_bf16 v[80:95], v[132:135], v[160:163], v[80:95]
  ds_read_b128 v[148:151], v1 offset:22528
  ds_read_b128 v[164:167], v3 offset:19456
  v_mfma_f32_32x32x16_bf16 v[96:111], v[136:139], v[160:163], v[96:111]
  s_waitcnt lgkmcnt(0)
  s_barrier
  v_mfma_f32_32x32x16_bf16 v[64:79], v[140:143], v[164:167], v[64:79]
  ds_read_b128 v[128:131], v1 offset:53248
  ds_read_b128 v[132:135], v1 offset:53760
  v_mfma_f32_32x32x16_bf16 v[80:95], v[144:147], v[164:167], v[80:95]
  ds_read_b128 v[136:139], v1 offset:54272
  ds_read_b128 v[160:163], v3 offset:32768
  v_mfma_f32_32x32x16_bf16 v[96:111], v[148:151], v[164:167], v[96:111]
  s_waitcnt lgkmcnt(0)
  v_mfma_f32_32x32x16_bf16 v[64:79], v[128:131], v[160:163], v[64:79]
  ds_read_b128 v[140:143], v1 offset:56320
  ds_read_b128 v[144:147], v1 offset:56832
  v_mfma_f32_32x32x16_bf16 v[80:95], v[132:135], v[160:163], v[80:95]
  ds_read_b128 v[148:151], v1 offset:57344
  ds_read_b128 v[164:167], v3 offset:33792
  v_mfma_f32_32x32x16_bf16 v[96:111], v[136:139], v[160:163], v[96:111]
  s_waitcnt lgkmcnt(0)
  v_mfma_f32_32x32x16_bf16 v[64:79], v[140:143], v[164:167], v[64:79]
  ds_read_b128 v[128:131], v1 offset:59392
  ds_read_b128 v[132:135], v1 offset:59904
  v_mfma_f32_32x32x16_bf16 v[80:95], v[144:147], v[164:167], v[80:95]
  ds_read_b128 v[136:139], v1 offset:60416
  ds_read_b128 v[160:163], v3 offset:34816
  v_mfma_f32_32x32x16_bf16 v[96:111], v[148:151], v[164:167], v[96:111]
  s_waitcnt lgkmcnt(0)
  v_mfma_f32_32x32x16_bf16 v[64:79], v[128:131], v[160:163], v[64:79]
  ds_read_b128 v[140:143], v1 offset:62464
  ds_read_b128 v[144:147], v1 offset:62976
  v_mfma_f32_32x32x16_bf16 v[80:95], v[132:135], v[160:163], v[80:95]
  ds_read_b128 v[148:151], v1 offset:63488
  ds_read_b128 v[164:167], v3 offset:35840
  v_mfma_f32_32x32x16_bf16 v[96:111], v[136:139], v[160:163], v[96:111]
  s_waitcnt lgkmcnt(0)
  s_barrier
  v_mfma_f32_32x32x16_bf16 v[64:79], v[140:143], v[164:167], v[64:79]
  ds_read_b128 v[128:131], v1 offset:0
  ds_read_b128 v[132:135], v1 offset:512
  v_mfma_f32_32x32x16_bf16 v[80:95], v[144:147], v[164:167], v[80:95]
  ds_read_b128 v[136:139], v1 offset:1024
  ds_read_b128 v[160:163], v3 offset:0
  v_mfma_f32_32x32x16_bf16 v[96:111], v[148:151], v[164:167], v[96:111]
  s_waitcnt lgkmcnt(0)
  v_mfma_f32_32x32x16_bf16 v[64:79], v[128:131], v[160:163], v[64:79]
  ds_read_b128 v[140:143], v1 offset:3072
  ds_read_b128 v[144:147], v1 offset:3584
  v_mfma_f32_32x32x16_bf16 v[80:95], v[132:135], v[160:163], v[80:95]
  ds_read_b128 v[148:151], v1 offset:4096
  ds_read_b128 v[164:167], v3 offset:1024
  v_mfma_f32_32x32x16_bf16 v[96:111], v[136:139], v[160:163], v[96:111]
  s_waitcnt lgkmcnt(0)
  v_mfma_f32_32x32x16_bf16 v[64:79], v[140:143], v[164:167], v[64:79]
  ds_read_b128 v[128:131], v1 offset:6144
  ds_read_b128 v[132:135], v1 offset:6656
  v_mfma_f32_32x32x16_bf16 v[80:95], v[144:147], v[164:167], v[80:95]
  ds_read_b128 v[136:139], v1 offset:7168
  ds_read_b128 v[160:163], v3 offset:2048
  v_mfma_f32_32x32x16_bf16 v[96:111], v[148:151], v[164:167], v[96:111]
  s_waitcnt lgkmcnt(0)
  v_mfma_f32_32x32x16_bf16 v[64:79], v[128:131], v[160:163], v[64:79]
  ds_read_b128 v[140:143], v1 offset:9216
  ds_read_b128 v[144:147], v1 offset:9728
  v_mfma_f32_32x32x16_bf16 v[80:95], v[132:135], v[160:163], v[80:95]
  ds_read_b128 v[148:151], v1 offset:10240
  ds_read_b128 v[164:167], v3 offset:3072
  v_mfma_f32_32x32x16_bf16 v[96:111], v[136:139], v[160:163], v[96:111]
  s_waitcnt lgkmcnt(0)
  s_barrier
  v_mfma_f32_32x32x16_bf16 v[64:79], v[140:143], v[164:167], v[64:79]
  ds_read_b128 v[128:131], v2 offset:0
  ds_read_b128 v[132:135], v2 offset:512
  v_mfma_f32_32x32x16_bf16 v[80:95], v[144:147], v[164:167], v[80:95]
  ds_read_b128 v[136:139], v2 offset:1024
  ds_read_b128 v[160:163], v4 offset:0
  v_mfma_f32_32x32x16_bf16 v[96:111], v[148:151], v[164:167], v[96:111]
  s_waitcnt lgkmcnt(0)
  v_mfma_f32_32x32x16_bf16 v[64:79], v[128:131], v[160:163], v[64:79]
  ds_read_b128 v[140:143], v2 offset:3072
  ds_read_b128 v[144:147], v2 offset:3584
  v_mfma_f32_32x32x16_bf16 v[80:95], v[132:135], v[160:163], v[80:95]
  ds_read_b128 v[148:151], v2 offset:4096
  ds_read_b128 v[164:167], v4 offset:1024
  v_mfma_f32_32x32x16_bf16 v[96:111], v[136:139], v[160:163], v[96:111]
  s_waitcnt lgkmcnt(0)
  v_mfma_f32_32x32x16_bf16 v[64:79], v[140:143], v[164:167], v[64:79]
  ds_read_b128 v[128:131], v2 offset:6144
  ds_read_b128 v[132:135], v2 offset:6656
  v_mfma_f32_32x32x16_bf16 v[80:95], v[144:147], v[164:167], v[80:95]
  ds_read_b128 v[136:139], v2 offset:7168
  ds_read_b128 v[160:163], v4 offset:2048
  v_mfma_f32_32x32x16_bf16 v[96:111], v[148:151], v[164:167], v[96:111]
  s_waitcnt lgkmcnt(0)
  v_mfma_f32_32x32x16_bf16 v[64:79], v[128:131], v[160:163], v[64:79]
  ds_read_b128 v[140:143], v2 offset:9216
  ds_read_b128 v[144:147], v2 offset:9728
  v_mfma_f32_32x32x16_bf16 v[80:95], v[132:135], v[160:163], v[80:95]
  ds_read_b128 v[148:151], v2 offset:10240
  ds_read_b128 v[164:167], v4 offset:3072
  v_mfma_f32_32x32x16_bf16 v[96:111], v[136:139], v[160:163], v[96:111]
  s_waitcnt lgkmcnt(0)
  s_barrier
  v_mfma_f32_32x32x16_bf16 v[64:79], v[140:143], v[164:167], v[64:79]
  ds_read_b128 v[128:131], v1 offset:12288
  ds_read_b128 v[132:135], v1 offset:12800
  v_mfma_f32_32x32x16_bf16 v[80:95], v[144:147], v[164:167], v[80:95]
  ds_read_b128 v[136:139], v1 offset:13312
  ds_read_b128 v[160:163], v3 offset:16384
  v_mfma_f32_32x32x16_bf16 v[96:111], v[148:151], v[164:167], v[96:111]
  s_waitcnt lgkmcnt(0)
  v_mfma_f32_32x32x16_bf16 v[64:79], v[128:131], v[160:163], v[64:79]
  ds_read_b128 v[140:143], v1 offset:15360
  ds_read_b128 v[144:147], v1 offset:15872
  v_mfma_f32_32x32x16_bf16 v[80:95], v[132:135], v[160:163], v[80:95]
  ds_read_b128 v[148:151], v1 offset:16384
  ds_read_b128 v[164:167], v3 offset:17408
  v_mfma_f32_32x32x16_bf16 v[96:111], v[136:139], v[160:163], v[96:111]
  s_waitcnt lgkmcnt(0)
  v_mfma_f32_32x32x16_bf16 v[64:79], v[140:143], v[164:167], v[64:79]
  ds_read_b128 v[128:131], v1 offset:18432
  ds_read_b128 v[132:135], v1 offset:18944
  v_mfma_f32_32x32x16_bf16 v[80:95], v[144:147], v[164:167], v[80:95]
  ds_read_b128 v[136:139], v1 offset:19456
  ds_read_b128 v[160:163], v3 offset:18432
  v_mfma_f32_32x32x16_bf16 v[96:111], v[148:151], v[164:167], v[96:111]
  s_waitcnt lgkmcnt(0)
  v_mfma_f32_32x32x16_bf16 v[64:79], v[128:131], v[160:163], v[64:79]
  ds_read_b128 v[140:143], v1 offset:21504
  ds_read_b128 v[144:147], v1 offset:22016
  v_mfma_f32_32x32x16_bf16 v[80:95], v[132:135], v[160:163], v[80:95]
  ds_read_b128 v[148:151], v1 offset:22528
  ds_read_b128 v[164:167], v3 offset:19456
  v_mfma_f32_32x32x16_bf16 v[96:111], v[136:139], v[160:163], v[96:111]
  s_waitcnt lgkmcnt(0)
  s_barrier
  v_mfma_f32_32x32x16_bf16 v[64:79], v[140:143], v[164:167], v[64:79]
  ds_read_b128 v[128:131], v1 offset:53248
  ds_read_b128 v[132:135], v1 offset:53760
  v_mfma_f32_32x32x16_bf16 v[80:95], v[144:147], v[164:167], v[80:95]
  ds_read_b128 v[136:139], v1 offset:54272
  ds_read_b128 v[160:163], v3 offset:32768
  v_mfma_f32_32x32x16_bf16 v[96:111], v[148:151], v[164:167], v[96:111]
  s_waitcnt lgkmcnt(0)
  v_mfma_f32_32x32x16_bf16 v[64:79], v[128:131], v[160:163], v[64:79]
  ds_read_b128 v[140:143], v1 offset:56320
  ds_read_b128 v[144:147], v1 offset:56832
  v_mfma_f32_32x32x16_bf16 v[80:95], v[132:135], v[160:163], v[80:95]
  ds_read_b128 v[148:151], v1 offset:57344
  ds_read_b128 v[164:167], v3 offset:33792
  v_mfma_f32_32x32x16_bf16 v[96:111], v[136:139], v[160:163], v[96:111]
  s_waitcnt lgkmcnt(0)
  v_mfma_f32_32x32x16_bf16 v[64:79], v[140:143], v[164:167], v[64:79]
  ds_read_b128 v[128:131], v1 offset:59392
  ds_read_b128 v[132:135], v1 offset:59904
  v_mfma_f32_32x32x16_bf16 v[80:95], v[144:147], v[164:167], v[80:95]
  ds_read_b128 v[136:139], v1 offset:60416
  ds_read_b128 v[160:163], v3 offset:34816
  v_mfma_f32_32x32x16_bf16 v[96:111], v[148:151], v[164:167], v[96:111]
  s_waitcnt lgkmcnt(0)
  v_mfma_f32_32x32x16_bf16 v[64:79], v[128:131], v[160:163], v[64:79]
  ds_read_b128 v[140:143], v1 offset:62464
  ds_read_b128 v[144:147], v1 offset:62976
  v_mfma_f32_32x32x16_bf16 v[80:95], v[132:135], v[160:163], v[80:95]
  ds_read_b128 v[148:151], v1 offset:63488
  ds_read_b128 v[164:167], v3 offset:35840
  v_mfma_f32_32x32x16_bf16 v[96:111], v[136:139], v[160:163], v[96:111]
  s_waitcnt lgkmcnt(0)
  s_barrier
  v_mfma_f32_32x32x16_bf16 v[64:79], v[140:143], v[164:167], v[64:79]
  ds_read_b128 v[128:131], v1 offset:0
  ds_read_b128 v[132:135], v1 offset:512
  v_mfma_f32_32x32x16_bf16 v[80:95], v[144:147], v[164:167], v[80:95]
  ds_read_b128 v[136:139], v1 offset:1024
  ds_read_b128 v[160:163], v3 offset:0
  v_mfma_f32_32x32x16_bf16 v[96:111], v[148:151], v[164:167], v[96:111]
  s_waitcnt lgkmcnt(0)
  v_mfma_f32_32x32x16_bf16 v[64:79], v[128:131], v[160:163], v[64:79]
  ds_read_b128 v[140:143], v1 offset:3072
  ds_read_b128 v[144:147], v1 offset:3584
  v_mfma_f32_32x32x16_bf16 v[80:95], v[132:135], v[160:163], v[80:95]
  ds_read_b128 v[148:151], v1 offset:4096
  ds_read_b128 v[164:167], v3 offset:1024
  v_mfma_f32_32x32x16_bf16 v[96:111], v[136:139], v[160:163], v[96:111]
  s_waitcnt lgkmcnt(0)
  v_mfma_f32_32x32x16_bf16 v[64:79], v[140:143], v[164:167], v[64:79]
  ds_read_b128 v[128:131], v1 offset:6144
  ds_read_b128 v[132:135], v1 offset:6656
  v_mfma_f32_32x32x16_bf16 v[80:95], v[144:147], v[164:167], v[80:95]
  ds_read_b128 v[136:139], v1 offset:7168
  ds_read_b128 v[160:163], v3 offset:2048
  v_mfma_f32_32x32x16_bf16 v[96:111], v[148:151], v[164:167], v[96:111]
  s_waitcnt lgkmcnt(0)
  v_mfma_f32_32x32x16_bf16 v[64:79], v[128:131], v[160:163], v[64:79]
  ds_read_b128 v[140:143], v1 offset:9216
  ds_read_b128 v[144:147], v1 offset:9728
  v_mfma_f32_32x32x16_bf16 v[80:95], v[132:135], v[160:163], v[80:95]
  ds_read_b128 v[148:151], v1 offset:10240
  ds_read_b128 v[164:167], v3 offset:3072
  v_mfma_f32_32x32x16_bf16 v[96:111], v[136:139], v[160:163], v[96:111]
  s_waitcnt lgkmcnt(0)
  s_barrier
  v_mfma_f32_32x32x16_bf16 v[64:79], v[140:143], v[164:167], v[64:79]
  ds_read_b128 v[128:131], v2 offset:0
  ds_read_b128 v[132:135], v2 offset:512
  v_mfma_f32_32x32x16_bf16 v[80:95], v[144:147], v[164:167], v[80:95]
  ds_read_b128 v[136:139], v2 offset:1024
  ds_read_b128 v[160:163], v4 offset:0
  v_mfma_f32_32x32x16_bf16 v[96:111], v[148:151], v[164:167], v[96:111]
  s_waitcnt lgkmcnt(0)
  v_mfma_f32_32x32x16_bf16 v[64:79], v[128:131], v[160:163], v[64:79]
  ds_read_b128 v[140:143], v2 offset:3072
  ds_read_b128 v[144:147], v2 offset:3584
  v_mfma_f32_32x32x16_bf16 v[80:95], v[132:135], v[160:163], v[80:95]
  ds_read_b128 v[148:151], v2 offset:4096
  ds_read_b128 v[164:167], v4 offset:1024
  v_mfma_f32_32x32x16_bf16 v[96:111], v[136:139], v[160:163], v[96:111]
  s_waitcnt lgkmcnt(0)
  v_mfma_f32_32x32x16_bf16 v[64:79], v[140:143], v[164:167], v[64:79]
  ds_read_b128 v[128:131], v2 offset:6144
  ds_read_b128 v[132:135], v2 offset:6656
  v_mfma_f32_32x32x16_bf16 v[80:95], v[144:147], v[164:167], v[80:95]
  ds_read_b128 v[136:139], v2 offset:7168
  ds_read_b128 v[160:163], v4 offset:2048
  v_mfma_f32_32x32x16_bf16 v[96:111], v[148:151], v[164:167], v[96:111]
  s_waitcnt lgkmcnt(0)
  v_mfma_f32_32x32x16_bf16 v[64:79], v[128:131], v[160:163], v[64:79]
  ds_read_b128 v[140:143], v2 offset:9216
  ds_read_b128 v[144:147], v2 offset:9728
  v_mfma_f32_32x32x16_bf16 v[80:95], v[132:135], v[160:163], v[80:95]
  ds_read_b128 v[148:151], v2 offset:10240
  ds_read_b128 v[164:167], v4 offset:3072
  v_mfma_f32_32x32x16_bf16 v[96:111], v[136:139], v[160:163], v[96:111]
  s_waitcnt lgkmcnt(0)
  v_mfma_f32_32x32x16_bf16 v[64:79], v[140:143], v[164:167], v[64:79]
  v_mfma_f32_32x32x16_bf16 v[80:95], v[144:147], v[164:167], v[80:95]
  v_mfma_f32_32x32x16_bf16 v[96:111], v[148:151], v[164:167], v[96:111]
  s_mov_b32 s48, s6
  s_mov_b32 s49, s7
  s_mov_b32 s50, 0x3200000
  s_mov_b32 s51, 0x00020000
  s_lshl_b32 s37, s36, 7
  v_lshlrev_b32 v20, 2, v16
  v_add_u32 v20, s37, v20
  v_add_u32 v20, 160000, v20
  ds_read_b32 v32, v20
  ds_read_b32 v33, v20 offset:512
  v_lshlrev_b32 v21, 4, v17
  v_add_u32 v21, 161024, v21
  ds_read_b128 v[128:131], v21 offset:0
  ds_read_b128 v[132:135], v21 offset:32
  ds_read_b128 v[136:139], v21 offset:64
  ds_read_b128 v[140:143], v21 offset:96
  ds_read_b128 v[144:147], v21 offset:128
  ds_read_b128 v[148:151], v21 offset:160
  ds_read_b128 v[152:155], v21 offset:192
  ds_read_b128 v[156:159], v21 offset:224
  ds_read_b128 v[160:163], v21 offset:256
  ds_read_b128 v[164:167], v21 offset:288
  ds_read_b128 v[168:171], v21 offset:320
  ds_read_b128 v[172:175], v21 offset:352
  s_waitcnt lgkmcnt(6)
  ds_read_b128 v[176:179], v21 offset:512
  ds_read_b128 v[180:183], v21 offset:544
  ds_read_b128 v[184:187], v21 offset:576
  ds_read_b128 v[188:191], v21 offset:608
  ds_read_b128 v[192:195], v21 offset:640
  ds_read_b128 v[196:199], v21 offset:672
  ds_read_b128 v[200:203], v21 offset:704
  ds_read_b128 v[204:207], v21 offset:736
  ds_read_b128 v[208:211], v21 offset:768
  ds_read_b128 v[212:215], v21 offset:800
  ds_read_b128 v[216:219], v21 offset:832
  ds_read_b128 v[220:223], v21 offset:864
  s_lshl_b32 s39, s24, 2
  s_add_u32 s39, s39, s36
  s_mul_i32 s39, s39, 98304
  s_mul_i32 s40, s25, 6144
  s_add_u32 s39, s39, s40
  s_add_u32 s52, s39, 31457280
  s_add_u32 s53, s52, 2048
  s_add_u32 s54, s52, 4096
  v_lshlrev_b32 v22, 4, v0
  v_mov_b32 v34, 0xc0135761
  v_mov_b32 v35, 0xbdd2d3e8
  s_waitcnt lgkmcnt(0)
  s_nop 7
  v_pk_fma_f32 v[36:37], v[128:129], v[32:33], v[176:177] op_sel:[0,1,0] op_sel_hi:[1,1,1] neg_lo:[1,0,0] neg_hi:[1,0,0]
  v_pk_fma_f32 v[38:39], v[130:131], v[32:33], v[178:179] op_sel:[0,1,0] op_sel_hi:[1,1,1] neg_lo:[1,0,0] neg_hi:[1,0,0]
  v_pk_fma_f32 v[36:37], v[64:65], v[32:33], v[36:37] op_sel_hi:[1,0,1]
  v_pk_fma_f32 v[38:39], v[66:67], v[32:33], v[38:39] op_sel_hi:[1,0,1]
  v_pk_mul_f32 v[40:41], v[36:37], v[36:37]
  v_pk_mul_f32 v[42:43], v[38:39], v[38:39]
  v_pk_fma_f32 v[40:41], v[40:41], v[34:35], v[34:35] op_sel:[0,1,0] op_sel_hi:[1,1,0]
  v_pk_fma_f32 v[42:43], v[42:43], v[34:35], v[34:35] op_sel:[0,1,0] op_sel_hi:[1,1,0]
  v_pk_mul_f32 v[40:41], v[40:41], v[36:37]
  v_pk_mul_f32 v[42:43], v[42:43], v[38:39]
  v_exp_f32 v40, v40
  v_exp_f32 v41, v41
  v_exp_f32 v42, v42
  v_exp_f32 v43, v43
  s_nop 0
  v_pk_add_f32 v[40:41], v[40:41], 1.0 op_sel_hi:[1,0]
  v_pk_add_f32 v[42:43], v[42:43], 1.0 op_sel_hi:[1,0]
  v_rcp_f32 v40, v40
  v_rcp_f32 v41, v41
  v_rcp_f32 v42, v42
  v_rcp_f32 v43, v43
  s_nop 0
  v_pk_mul_f32 v[36:37], v[36:37], v[40:41]
  v_pk_mul_f32 v[38:39], v[38:39], v[42:43]
  v_cvt_pk_bf16_f32 v56, v36, v37
  v_cvt_pk_bf16_f32 v57, v38, v39
  v_pk_fma_f32 v[36:37], v[132:133], v[32:33], v[180:181] op_sel:[0,1,0] op_sel_hi:[1,1,1] neg_lo:[1,0,0] neg_hi:[1,0,0]
  v_pk_fma_f32 v[38:39], v[134:135], v[32:33], v[182:183] op_sel:[0,1,0] op_sel_hi:[1,1,1] neg_lo:[1,0,0] neg_hi:[1,0,0]
  v_pk_fma_f32 v[36:37], v[68:69], v[32:33], v[36:37] op_sel_hi:[1,0,1]
  v_pk_fma_f32 v[38:39], v[70:71], v[32:33], v[38:39] op_sel_hi:[1,0,1]
  v_pk_mul_f32 v[40:41], v[36:37], v[36:37]
  v_pk_mul_f32 v[42:43], v[38:39], v[38:39]
  v_pk_fma_f32 v[40:41], v[40:41], v[34:35], v[34:35] op_sel:[0,1,0] op_sel_hi:[1,1,0]
  v_pk_fma_f32 v[42:43], v[42:43], v[34:35], v[34:35] op_sel:[0,1,0] op_sel_hi:[1,1,0]
  v_pk_mul_f32 v[40:41], v[40:41], v[36:37]
  v_pk_mul_f32 v[42:43], v[42:43], v[38:39]
  v_exp_f32 v40, v40
  v_exp_f32 v41, v41
  v_exp_f32 v42, v42
  v_exp_f32 v43, v43
  s_nop 0
  v_pk_add_f32 v[40:41], v[40:41], 1.0 op_sel_hi:[1,0]
  v_pk_add_f32 v[42:43], v[42:43], 1.0 op_sel_hi:[1,0]
  v_rcp_f32 v40, v40
  v_rcp_f32 v41, v41
  v_rcp_f32 v42, v42
  v_rcp_f32 v43, v43
  s_nop 0
  v_pk_mul_f32 v[36:37], v[36:37], v[40:41]
  v_pk_mul_f32 v[38:39], v[38:39], v[42:43]
  v_cvt_pk_bf16_f32 v58, v36, v37
  v_cvt_pk_bf16_f32 v59, v38, v39
  s_nop 1
  v_permlane32_swap_b32 v56, v58
  v_permlane32_swap_b32 v57, v59
  s_nop 1
  buffer_store_dwordx4 v[56:59], v22, s[48:51], s52 offen offset:0
  v_pk_fma_f32 v[36:37], v[136:137], v[32:33], v[184:185] op_sel:[0,1,0] op_sel_hi:[1,1,1] neg_lo:[1,0,0] neg_hi:[1,0,0]
  v_pk_fma_f32 v[38:39], v[138:139], v[32:33], v[186:187] op_sel:[0,1,0] op_sel_hi:[1,1,1] neg_lo:[1,0,0] neg_hi:[1,0,0]
  v_pk_fma_f32 v[36:37], v[72:73], v[32:33], v[36:37] op_sel_hi:[1,0,1]
  v_pk_fma_f32 v[38:39], v[74:75], v[32:33], v[38:39] op_sel_hi:[1,0,1]
  v_pk_mul_f32 v[40:41], v[36:37], v[36:37]
  v_pk_mul_f32 v[42:43], v[38:39], v[38:39]
  v_pk_fma_f32 v[40:41], v[40:41], v[34:35], v[34:35] op_sel:[0,1,0] op_sel_hi:[1,1,0]
  v_pk_fma_f32 v[42:43], v[42:43], v[34:35], v[34:35] op_sel:[0,1,0] op_sel_hi:[1,1,0]
  v_pk_mul_f32 v[40:41], v[40:41], v[36:37]
  v_pk_mul_f32 v[42:43], v[42:43], v[38:39]
  v_exp_f32 v40, v40
  v_exp_f32 v41, v41
  v_exp_f32 v42, v42
  v_exp_f32 v43, v43
  s_nop 0
  v_pk_add_f32 v[40:41], v[40:41], 1.0 op_sel_hi:[1,0]
  v_pk_add_f32 v[42:43], v[42:43], 1.0 op_sel_hi:[1,0]
  v_rcp_f32 v40, v40
  v_rcp_f32 v41, v41
  v_rcp_f32 v42, v42
  v_rcp_f32 v43, v43
  s_nop 0
  v_pk_mul_f32 v[36:37], v[36:37], v[40:41]
  v_pk_mul_f32 v[38:39], v[38:39], v[42:43]
  v_cvt_pk_bf16_f32 v60, v36, v37
  v_cvt_pk_bf16_f32 v61, v38, v39
  v_pk_fma_f32 v[36:37], v[140:141], v[32:33], v[188:189] op_sel:[0,1,0] op_sel_hi:[1,1,1] neg_lo:[1,0,0] neg_hi:[1,0,0]
  v_pk_fma_f32 v[38:39], v[142:143], v[32:33], v[190:191] op_sel:[0,1,0] op_sel_hi:[1,1,1] neg_lo:[1,0,0] neg_hi:[1,0,0]
  v_pk_fma_f32 v[36:37], v[76:77], v[32:33], v[36:37] op_sel_hi:[1,0,1]
  v_pk_fma_f32 v[38:39], v[78:79], v[32:33], v[38:39] op_sel_hi:[1,0,1]
  v_pk_mul_f32 v[40:41], v[36:37], v[36:37]
  v_pk_mul_f32 v[42:43], v[38:39], v[38:39]
  v_pk_fma_f32 v[40:41], v[40:41], v[34:35], v[34:35] op_sel:[0,1,0] op_sel_hi:[1,1,0]
  v_pk_fma_f32 v[42:43], v[42:43], v[34:35], v[34:35] op_sel:[0,1,0] op_sel_hi:[1,1,0]
  v_pk_mul_f32 v[40:41], v[40:41], v[36:37]
  v_pk_mul_f32 v[42:43], v[42:43], v[38:39]
  v_exp_f32 v40, v40
  v_exp_f32 v41, v41
  v_exp_f32 v42, v42
  v_exp_f32 v43, v43
  s_nop 0
  v_pk_add_f32 v[40:41], v[40:41], 1.0 op_sel_hi:[1,0]
  v_pk_add_f32 v[42:43], v[42:43], 1.0 op_sel_hi:[1,0]
  v_rcp_f32 v40, v40
  v_rcp_f32 v41, v41
  v_rcp_f32 v42, v42
  v_rcp_f32 v43, v43
  s_nop 0
  v_pk_mul_f32 v[36:37], v[36:37], v[40:41]
  v_pk_mul_f32 v[38:39], v[38:39], v[42:43]
  v_cvt_pk_bf16_f32 v62, v36, v37
  v_cvt_pk_bf16_f32 v63, v38, v39
  s_nop 1
  v_permlane32_swap_b32 v60, v62
  v_permlane32_swap_b32 v61, v63
  s_nop 1
  buffer_store_dwordx4 v[60:63], v22, s[48:51], s52 offen offset:1024
  v_pk_fma_f32 v[36:37], v[144:145], v[32:33], v[192:193] op_sel:[0,1,0] op_sel_hi:[1,1,1] neg_lo:[1,0,0] neg_hi:[1,0,0]
  v_pk_fma_f32 v[38:39], v[146:147], v[32:33], v[194:195] op_sel:[0,1,0] op_sel_hi:[1,1,1] neg_lo:[1,0,0] neg_hi:[1,0,0]
  v_pk_fma_f32 v[36:37], v[80:81], v[32:33], v[36:37] op_sel_hi:[1,0,1]
  v_pk_fma_f32 v[38:39], v[82:83], v[32:33], v[38:39] op_sel_hi:[1,0,1]
  v_pk_mul_f32 v[40:41], v[36:37], v[36:37]
  v_pk_mul_f32 v[42:43], v[38:39], v[38:39]
  v_pk_fma_f32 v[40:41], v[40:41], v[34:35], v[34:35] op_sel:[0,1,0] op_sel_hi:[1,1,0]
  v_pk_fma_f32 v[42:43], v[42:43], v[34:35], v[34:35] op_sel:[0,1,0] op_sel_hi:[1,1,0]
  v_pk_mul_f32 v[40:41], v[40:41], v[36:37]
  v_pk_mul_f32 v[42:43], v[42:43], v[38:39]
  v_exp_f32 v40, v40
  v_exp_f32 v41, v41
  v_exp_f32 v42, v42
  v_exp_f32 v43, v43
  s_nop 0
  v_pk_add_f32 v[40:41], v[40:41], 1.0 op_sel_hi:[1,0]
  v_pk_add_f32 v[42:43], v[42:43], 1.0 op_sel_hi:[1,0]
  v_rcp_f32 v40, v40
  v_rcp_f32 v41, v41
  v_rcp_f32 v42, v42
  v_rcp_f32 v43, v43
  s_nop 0
  v_pk_mul_f32 v[36:37], v[36:37], v[40:41]
  v_pk_mul_f32 v[38:39], v[38:39], v[42:43]
  v_cvt_pk_bf16_f32 v56, v36, v37
  v_cvt_pk_bf16_f32 v57, v38, v39
  v_pk_fma_f32 v[36:37], v[148:149], v[32:33], v[196:197] op_sel:[0,1,0] op_sel_hi:[1,1,1] neg_lo:[1,0,0] neg_hi:[1,0,0]
  v_pk_fma_f32 v[38:39], v[150:151], v[32:33], v[198:199] op_sel:[0,1,0] op_sel_hi:[1,1,1] neg_lo:[1,0,0] neg_hi:[1,0,0]
  v_pk_fma_f32 v[36:37], v[84:85], v[32:33], v[36:37] op_sel_hi:[1,0,1]
  v_pk_fma_f32 v[38:39], v[86:87], v[32:33], v[38:39] op_sel_hi:[1,0,1]
  v_pk_mul_f32 v[40:41], v[36:37], v[36:37]
  v_pk_mul_f32 v[42:43], v[38:39], v[38:39]
  v_pk_fma_f32 v[40:41], v[40:41], v[34:35], v[34:35] op_sel:[0,1,0] op_sel_hi:[1,1,0]
  v_pk_fma_f32 v[42:43], v[42:43], v[34:35], v[34:35] op_sel:[0,1,0] op_sel_hi:[1,1,0]
  v_pk_mul_f32 v[40:41], v[40:41], v[36:37]
  v_pk_mul_f32 v[42:43], v[42:43], v[38:39]
  v_exp_f32 v40, v40
  v_exp_f32 v41, v41
  v_exp_f32 v42, v42
  v_exp_f32 v43, v43
  s_nop 0
  v_pk_add_f32 v[40:41], v[40:41], 1.0 op_sel_hi:[1,0]
  v_pk_add_f32 v[42:43], v[42:43], 1.0 op_sel_hi:[1,0]
  v_rcp_f32 v40, v40
  v_rcp_f32 v41, v41
  v_rcp_f32 v42, v42
  v_rcp_f32 v43, v43
  s_nop 0
  v_pk_mul_f32 v[36:37], v[36:37], v[40:41]
  v_pk_mul_f32 v[38:39], v[38:39], v[42:43]
  v_cvt_pk_bf16_f32 v58, v36, v37
  v_cvt_pk_bf16_f32 v59, v38, v39
  s_nop 1
  v_permlane32_swap_b32 v56, v58
  v_permlane32_swap_b32 v57, v59
  s_nop 1
  buffer_store_dwordx4 v[56:59], v22, s[48:51], s53 offen offset:0
  v_pk_fma_f32 v[36:37], v[152:153], v[32:33], v[200:201] op_sel:[0,1,0] op_sel_hi:[1,1,1] neg_lo:[1,0,0] neg_hi:[1,0,0]
  v_pk_fma_f32 v[38:39], v[154:155], v[32:33], v[202:203] op_sel:[0,1,0] op_sel_hi:[1,1,1] neg_lo:[1,0,0] neg_hi:[1,0,0]
  v_pk_fma_f32 v[36:37], v[88:89], v[32:33], v[36:37] op_sel_hi:[1,0,1]
  v_pk_fma_f32 v[38:39], v[90:91], v[32:33], v[38:39] op_sel_hi:[1,0,1]
  v_pk_mul_f32 v[40:41], v[36:37], v[36:37]
  v_pk_mul_f32 v[42:43], v[38:39], v[38:39]
  v_pk_fma_f32 v[40:41], v[40:41], v[34:35], v[34:35] op_sel:[0,1,0] op_sel_hi:[1,1,0]
  v_pk_fma_f32 v[42:43], v[42:43], v[34:35], v[34:35] op_sel:[0,1,0] op_sel_hi:[1,1,0]
  v_pk_mul_f32 v[40:41], v[40:41], v[36:37]
  v_pk_mul_f32 v[42:43], v[42:43], v[38:39]
  v_exp_f32 v40, v40
  v_exp_f32 v41, v41
  v_exp_f32 v42, v42
  v_exp_f32 v43, v43
  s_nop 0
  v_pk_add_f32 v[40:41], v[40:41], 1.0 op_sel_hi:[1,0]
  v_pk_add_f32 v[42:43], v[42:43], 1.0 op_sel_hi:[1,0]
  v_rcp_f32 v40, v40
  v_rcp_f32 v41, v41
  v_rcp_f32 v42, v42
  v_rcp_f32 v43, v43
  s_nop 0
  v_pk_mul_f32 v[36:37], v[36:37], v[40:41]
  v_pk_mul_f32 v[38:39], v[38:39], v[42:43]
  v_cvt_pk_bf16_f32 v60, v36, v37
  v_cvt_pk_bf16_f32 v61, v38, v39
  v_pk_fma_f32 v[36:37], v[156:157], v[32:33], v[204:205] op_sel:[0,1,0] op_sel_hi:[1,1,1] neg_lo:[1,0,0] neg_hi:[1,0,0]
  v_pk_fma_f32 v[38:39], v[158:159], v[32:33], v[206:207] op_sel:[0,1,0] op_sel_hi:[1,1,1] neg_lo:[1,0,0] neg_hi:[1,0,0]
  v_pk_fma_f32 v[36:37], v[92:93], v[32:33], v[36:37] op_sel_hi:[1,0,1]
  v_pk_fma_f32 v[38:39], v[94:95], v[32:33], v[38:39] op_sel_hi:[1,0,1]
  v_pk_mul_f32 v[40:41], v[36:37], v[36:37]
  v_pk_mul_f32 v[42:43], v[38:39], v[38:39]
  v_pk_fma_f32 v[40:41], v[40:41], v[34:35], v[34:35] op_sel:[0,1,0] op_sel_hi:[1,1,0]
  v_pk_fma_f32 v[42:43], v[42:43], v[34:35], v[34:35] op_sel:[0,1,0] op_sel_hi:[1,1,0]
  v_pk_mul_f32 v[40:41], v[40:41], v[36:37]
  v_pk_mul_f32 v[42:43], v[42:43], v[38:39]
  v_exp_f32 v40, v40
  v_exp_f32 v41, v41
  v_exp_f32 v42, v42
  v_exp_f32 v43, v43
  s_nop 0
  v_pk_add_f32 v[40:41], v[40:41], 1.0 op_sel_hi:[1,0]
  v_pk_add_f32 v[42:43], v[42:43], 1.0 op_sel_hi:[1,0]
  v_rcp_f32 v40, v40
  v_rcp_f32 v41, v41
  v_rcp_f32 v42, v42
  v_rcp_f32 v43, v43
  s_nop 0
  v_pk_mul_f32 v[36:37], v[36:37], v[40:41]
  v_pk_mul_f32 v[38:39], v[38:39], v[42:43]
  v_cvt_pk_bf16_f32 v62, v36, v37
  v_cvt_pk_bf16_f32 v63, v38, v39
  s_nop 1
  v_permlane32_swap_b32 v60, v62
  v_permlane32_swap_b32 v61, v63
  s_nop 1
  buffer_store_dwordx4 v[60:63], v22, s[48:51], s53 offen offset:1024
  v_pk_fma_f32 v[36:37], v[160:161], v[32:33], v[208:209] op_sel:[0,1,0] op_sel_hi:[1,1,1] neg_lo:[1,0,0] neg_hi:[1,0,0]
  v_pk_fma_f32 v[38:39], v[162:163], v[32:33], v[210:211] op_sel:[0,1,0] op_sel_hi:[1,1,1] neg_lo:[1,0,0] neg_hi:[1,0,0]
  v_pk_fma_f32 v[36:37], v[96:97], v[32:33], v[36:37] op_sel_hi:[1,0,1]
  v_pk_fma_f32 v[38:39], v[98:99], v[32:33], v[38:39] op_sel_hi:[1,0,1]
  v_pk_mul_f32 v[40:41], v[36:37], v[36:37]
  v_pk_mul_f32 v[42:43], v[38:39], v[38:39]
  v_pk_fma_f32 v[40:41], v[40:41], v[34:35], v[34:35] op_sel:[0,1,0] op_sel_hi:[1,1,0]
  v_pk_fma_f32 v[42:43], v[42:43], v[34:35], v[34:35] op_sel:[0,1,0] op_sel_hi:[1,1,0]
  v_pk_mul_f32 v[40:41], v[40:41], v[36:37]
  v_pk_mul_f32 v[42:43], v[42:43], v[38:39]
  v_exp_f32 v40, v40
  v_exp_f32 v41, v41
  v_exp_f32 v42, v42
  v_exp_f32 v43, v43
  s_nop 0
  v_pk_add_f32 v[40:41], v[40:41], 1.0 op_sel_hi:[1,0]
  v_pk_add_f32 v[42:43], v[42:43], 1.0 op_sel_hi:[1,0]
  v_rcp_f32 v40, v40
  v_rcp_f32 v41, v41
  v_rcp_f32 v42, v42
  v_rcp_f32 v43, v43
  s_nop 0
  v_pk_mul_f32 v[36:37], v[36:37], v[40:41]
  v_pk_mul_f32 v[38:39], v[38:39], v[42:43]
  v_cvt_pk_bf16_f32 v56, v36, v37
  v_cvt_pk_bf16_f32 v57, v38, v39
  v_pk_fma_f32 v[36:37], v[164:165], v[32:33], v[212:213] op_sel:[0,1,0] op_sel_hi:[1,1,1] neg_lo:[1,0,0] neg_hi:[1,0,0]
  v_pk_fma_f32 v[38:39], v[166:167], v[32:33], v[214:215] op_sel:[0,1,0] op_sel_hi:[1,1,1] neg_lo:[1,0,0] neg_hi:[1,0,0]
  v_pk_fma_f32 v[36:37], v[100:101], v[32:33], v[36:37] op_sel_hi:[1,0,1]
  v_pk_fma_f32 v[38:39], v[102:103], v[32:33], v[38:39] op_sel_hi:[1,0,1]
  v_pk_mul_f32 v[40:41], v[36:37], v[36:37]
  v_pk_mul_f32 v[42:43], v[38:39], v[38:39]
  v_pk_fma_f32 v[40:41], v[40:41], v[34:35], v[34:35] op_sel:[0,1,0] op_sel_hi:[1,1,0]
  v_pk_fma_f32 v[42:43], v[42:43], v[34:35], v[34:35] op_sel:[0,1,0] op_sel_hi:[1,1,0]
  v_pk_mul_f32 v[40:41], v[40:41], v[36:37]
  v_pk_mul_f32 v[42:43], v[42:43], v[38:39]
  v_exp_f32 v40, v40
  v_exp_f32 v41, v41
  v_exp_f32 v42, v42
  v_exp_f32 v43, v43
  s_nop 0
  v_pk_add_f32 v[40:41], v[40:41], 1.0 op_sel_hi:[1,0]
  v_pk_add_f32 v[42:43], v[42:43], 1.0 op_sel_hi:[1,0]
  v_rcp_f32 v40, v40
  v_rcp_f32 v41, v41
  v_rcp_f32 v42, v42
  v_rcp_f32 v43, v43
  s_nop 0
  v_pk_mul_f32 v[36:37], v[36:37], v[40:41]
  v_pk_mul_f32 v[38:39], v[38:39], v[42:43]
  v_cvt_pk_bf16_f32 v58, v36, v37
  v_cvt_pk_bf16_f32 v59, v38, v39
  s_nop 1
  v_permlane32_swap_b32 v56, v58
  v_permlane32_swap_b32 v57, v59
  s_nop 1
  buffer_store_dwordx4 v[56:59], v22, s[48:51], s54 offen offset:0
  v_pk_fma_f32 v[36:37], v[168:169], v[32:33], v[216:217] op_sel:[0,1,0] op_sel_hi:[1,1,1] neg_lo:[1,0,0] neg_hi:[1,0,0]
  v_pk_fma_f32 v[38:39], v[170:171], v[32:33], v[218:219] op_sel:[0,1,0] op_sel_hi:[1,1,1] neg_lo:[1,0,0] neg_hi:[1,0,0]
  v_pk_fma_f32 v[36:37], v[104:105], v[32:33], v[36:37] op_sel_hi:[1,0,1]
  v_pk_fma_f32 v[38:39], v[106:107], v[32:33], v[38:39] op_sel_hi:[1,0,1]
  v_pk_mul_f32 v[40:41], v[36:37], v[36:37]
  v_pk_mul_f32 v[42:43], v[38:39], v[38:39]
  v_pk_fma_f32 v[40:41], v[40:41], v[34:35], v[34:35] op_sel:[0,1,0] op_sel_hi:[1,1,0]
  v_pk_fma_f32 v[42:43], v[42:43], v[34:35], v[34:35] op_sel:[0,1,0] op_sel_hi:[1,1,0]
  v_pk_mul_f32 v[40:41], v[40:41], v[36:37]
  v_pk_mul_f32 v[42:43], v[42:43], v[38:39]
  v_exp_f32 v40, v40
  v_exp_f32 v41, v41
  v_exp_f32 v42, v42
  v_exp_f32 v43, v43
  s_nop 0
  v_pk_add_f32 v[40:41], v[40:41], 1.0 op_sel_hi:[1,0]
  v_pk_add_f32 v[42:43], v[42:43], 1.0 op_sel_hi:[1,0]
  v_rcp_f32 v40, v40
  v_rcp_f32 v41, v41
  v_rcp_f32 v42, v42
  v_rcp_f32 v43, v43
  s_nop 0
  v_pk_mul_f32 v[36:37], v[36:37], v[40:41]
  v_pk_mul_f32 v[38:39], v[38:39], v[42:43]
  v_cvt_pk_bf16_f32 v60, v36, v37
  v_cvt_pk_bf16_f32 v61, v38, v39
  v_pk_fma_f32 v[36:37], v[172:173], v[32:33], v[220:221] op_sel:[0,1,0] op_sel_hi:[1,1,1] neg_lo:[1,0,0] neg_hi:[1,0,0]
  v_pk_fma_f32 v[38:39], v[174:175], v[32:33], v[222:223] op_sel:[0,1,0] op_sel_hi:[1,1,1] neg_lo:[1,0,0] neg_hi:[1,0,0]
  v_pk_fma_f32 v[36:37], v[108:109], v[32:33], v[36:37] op_sel_hi:[1,0,1]
  v_pk_fma_f32 v[38:39], v[110:111], v[32:33], v[38:39] op_sel_hi:[1,0,1]
  v_pk_mul_f32 v[40:41], v[36:37], v[36:37]
  v_pk_mul_f32 v[42:43], v[38:39], v[38:39]
  v_pk_fma_f32 v[40:41], v[40:41], v[34:35], v[34:35] op_sel:[0,1,0] op_sel_hi:[1,1,0]
  v_pk_fma_f32 v[42:43], v[42:43], v[34:35], v[34:35] op_sel:[0,1,0] op_sel_hi:[1,1,0]
  v_pk_mul_f32 v[40:41], v[40:41], v[36:37]
  v_pk_mul_f32 v[42:43], v[42:43], v[38:39]
  v_exp_f32 v40, v40
  v_exp_f32 v41, v41
  v_exp_f32 v42, v42
  v_exp_f32 v43, v43
  s_nop 0
  v_pk_add_f32 v[40:41], v[40:41], 1.0 op_sel_hi:[1,0]
  v_pk_add_f32 v[42:43], v[42:43], 1.0 op_sel_hi:[1,0]
  v_rcp_f32 v40, v40
  v_rcp_f32 v41, v41
  v_rcp_f32 v42, v42
  v_rcp_f32 v43, v43
  s_nop 0
  v_pk_mul_f32 v[36:37], v[36:37], v[40:41]
  v_pk_mul_f32 v[38:39], v[38:39], v[42:43]
  v_cvt_pk_bf16_f32 v62, v36, v37
  v_cvt_pk_bf16_f32 v63, v38, v39
  s_nop 1
  v_permlane32_swap_b32 v60, v62
  v_permlane32_swap_b32 v61, v63
  s_nop 1
  buffer_store_dwordx4 v[60:63], v22, s[48:51], s54 offen offset:1024
  s_waitcnt vmcnt(0)
  s_mov_b64 exec, 1
  v_mov_b32 v1, 147456
  v_mov_b32 v2, 1
  ds_add_rtn_u32 v3, v1, v2
  s_lshl_b32 s37, s24, 7
  s_lshl_b32 s38, s25, 2
  s_add_u32 s37, s37, s38
  s_add_u32 s37, s37, 9207808
  s_waitcnt lgkmcnt(0)
  v_readfirstlane_b32 s38, v3
  s_and_b32 s38, s38, 3
  s_cmp_eq_u32 s38, 3
  s_cbranch_scc0 f0_kernel_p7_nosig41
  s_cmp_eq_u32 s63, 0
  s_cbranch_scc1 f0_kernel_p7_fastsig42
  buffer_wbl2 sc1
  s_waitcnt vmcnt(0)
  buffer_store_dword v2, off, s[48:51], s37 sc1
  s_branch f0_kernel_p7_nosig41
f0_kernel_p7_fastsig42:
  buffer_store_dword v2, off, s[48:51], s37
f0_kernel_p7_nosig41:
  s_mov_b64 exec, -1
  s_branch f0_kernel_p8_entry
f0_kernel_p8_entry:
  s_mov_b32 s26, s64
  s_load_dwordx2 s[8:9], s[0:1], 56
  s_load_dwordx2 s[10:11], s[0:1], 64
  s_and_b32 s20, s2, 7
  s_lshr_b32 s21, s2, 3
  s_and_b32 s22, s21, 3
  s_lshl_b32 s23, s20, 2
  s_add_u32 s24, s23, s22
  s_lshr_b32 s25, s21, 2
  s_cmp_lt_u32 s26, 4
  s_cbranch_scc1 f0_kernel_p8_compute
  s_sub_u32 s26, s26, 4
  v_lshlrev_b32 v1, 4, v0
  s_mul_i32 s40, s25, 245760
  s_mul_i32 s41, s26, 5120
  s_add_u32 s40, s40, s41
  s_add_u32 s40, s40, 6291456
  s_mov_b32 s42, s41
  s_lshl_b32 s43, s24, 1
  s_lshr_b32 s47, s26, 1
  s_add_u32 s43, s43, s47
  s_mul_i32 s43, s43, 98304
  s_and_b32 s47, s26, 1
  s_lshl_b32 s47, s47, 12
  s_add_u32 s43, s43, s47
  s_add_u32 s43, s43, 31457280
  s_lshl_b32 s44, s26, 12
  s_waitcnt lgkmcnt(0)
  s_mov_b32 s12, s6
  s_mov_b32 s13, s7
  s_mov_b32 s14, 0x3200000
  s_mov_b32 s15, 0x00020000
  s_add_u32 m0, s42, 0
  s_add_u32 s45, s40, 0
  buffer_load_dwordx4 v1, s[12:15], s45 offen offset:0 lds
  buffer_load_dwordx4 v1, s[12:15], s45 offen offset:1024 lds
  buffer_load_dwordx4 v1, s[12:15], s45 offen offset:2048 lds
  buffer_load_dwordx4 v1, s[12:15], s45 offen offset:3072 lds
  s_add_u32 m0, s42, 4096
  s_add_u32 s45, s40, 4096
  buffer_load_dwordx4 v1, s[12:15], s45 offen lds
  s_add_u32 m0, s42, 20480
  s_add_u32 s45, s40, 20480
  buffer_load_dwordx4 v1, s[12:15], s45 offen offset:0 lds
  buffer_load_dwordx4 v1, s[12:15], s45 offen offset:1024 lds
  buffer_load_dwordx4 v1, s[12:15], s45 offen offset:2048 lds
  buffer_load_dwordx4 v1, s[12:15], s45 offen offset:3072 lds
  s_add_u32 m0, s42, 24576
  s_add_u32 s45, s40, 24576
  buffer_load_dwordx4 v1, s[12:15], s45 offen lds
  s_lshr_b32 s67, s24, 1
  s_lshl_b32 s66, s67, 7
  s_add_u32 s66, s66, 9207808
  v_lshlrev_b32 v10, 2, v0
  s_mov_b64 exec, 0xffff
  s_mov_b32 s65, 16384
f0_kernel_p8_poll:
  buffer_load_dword v11, v10, s[12:15], s66 offen sc1
  s_waitcnt vmcnt(0)
  v_cmp_ne_u32 vcc, 0, v11
  s_cmp_eq_u32 vcc_lo, 0xffff
  s_cbranch_scc1 f0_kernel_p8_polled
  s_sleep 1
  s_sub_u32 s65, s65, 1
  s_cbranch_scc0 f0_kernel_p8_poll
f0_kernel_p8_polled:
  s_mov_b64 exec, -1
  s_cmp_eq_u32 s63, 0
  s_cbranch_scc1 f0_kernel_p8_noacq
  buffer_inv sc1
  s_waitcnt vmcnt(0)
f0_kernel_p8_noacq:
  s_add_u32 m0, s44, 81920
  s_add_u32 s45, s43, 0
  buffer_load_dwordx4 v1, s[12:15], s45 offen offset:0 sc1 lds
  buffer_load_dwordx4 v1, s[12:15], s45 offen offset:1024 sc1 lds
  buffer_load_dwordx4 v1, s[12:15], s45 offen offset:2048 sc1 lds
  buffer_load_dwordx4 v1, s[12:15], s45 offen offset:3072 sc1 lds
  s_add_u32 m0, s44, 98304
  s_add_u32 s45, s43, 8192
  buffer_load_dwordx4 v1, s[12:15], s45 offen offset:0 sc1 lds
  buffer_load_dwordx4 v1, s[12:15], s45 offen offset:1024 sc1 lds
  buffer_load_dwordx4 v1, s[12:15], s45 offen offset:2048 sc1 lds
  buffer_load_dwordx4 v1, s[12:15], s45 offen offset:3072 sc1 lds
  s_add_u32 m0, s42, 40960
  s_add_u32 s45, s40, 40960
  buffer_load_dwordx4 v1, s[12:15], s45 offen offset:0 lds
  buffer_load_dwordx4 v1, s[12:15], s45 offen offset:1024 lds
  buffer_load_dwordx4 v1, s[12:15], s45 offen offset:2048 lds
  buffer_load_dwordx4 v1, s[12:15], s45 offen offset:3072 lds
  s_add_u32 m0, s42, 45056
  s_add_u32 s45, s40, 45056
  buffer_load_dwordx4 v1, s[12:15], s45 offen lds
  s_add_u32 m0, s42, 61440
  s_add_u32 s45, s40, 61440
  buffer_load_dwordx4 v1, s[12:15], s45 offen offset:0 lds
  buffer_load_dwordx4 v1, s[12:15], s45 offen offset:1024 lds
  buffer_load_dwordx4 v1, s[12:15], s45 offen offset:2048 lds
  buffer_load_dwordx4 v1, s[12:15], s45 offen offset:3072 lds
  s_add_u32 m0, s42, 65536
  s_add_u32 s45, s40, 65536
  buffer_load_dwordx4 v1, s[12:15], s45 offen lds
  s_waitcnt vmcnt(14)
  s_barrier
  s_add_u32 m0, s44, 114688
  s_add_u32 s45, s43, 16384
  buffer_load_dwordx4 v1, s[12:15], s45 offen offset:0 sc1 lds
  buffer_load_dwordx4 v1, s[12:15], s45 offen offset:1024 sc1 lds
  buffer_load_dwordx4 v1, s[12:15], s45 offen offset:2048 sc1 lds
  buffer_load_dwordx4 v1, s[12:15], s45 offen offset:3072 sc1 lds
  s_add_u32 m0, s44, 131072
  s_add_u32 s45, s43, 24576
  buffer_load_dwordx4 v1, s[12:15], s45 offen offset:0 sc1 lds
  buffer_load_dwordx4 v1, s[12:15], s45 offen offset:1024 sc1 lds
  buffer_load_dwordx4 v1, s[12:15], s45 offen offset:2048 sc1 lds
  buffer_load_dwordx4 v1, s[12:15], s45 offen offset:3072 sc1 lds
  s_waitcnt vmcnt(18)
  s_barrier
  s_add_u32 m0, s44, 81920
  s_add_u32 s45, s43, 32768
  buffer_load_dwordx4 v1, s[12:15], s45 offen offset:0 sc1 lds
  buffer_load_dwordx4 v1, s[12:15], s45 offen offset:1024 sc1 lds
  buffer_load_dwordx4 v1, s[12:15], s45 offen offset:2048 sc1 lds
  buffer_load_dwordx4 v1, s[12:15], s45 offen offset:3072 sc1 lds
  s_add_u32 m0, s42, 0
  s_add_u32 s45, s40, 81920
  buffer_load_dwordx4 v1, s[12:15], s45 offen offset:0 lds
  buffer_load_dwordx4 v1, s[12:15], s45 offen offset:1024 lds
  buffer_load_dwordx4 v1, s[12:15], s45 offen offset:2048 lds
  buffer_load_dwordx4 v1, s[12:15], s45 offen offset:3072 lds
  s_add_u32 m0, s42, 4096
  s_add_u32 s45, s40, 86016
  buffer_load_dwordx4 v1, s[12:15], s45 offen lds
  s_waitcnt vmcnt(13)
  s_barrier
  s_add_u32 m0, s44, 98304
  s_add_u32 s45, s43, 40960
  buffer_load_dwordx4 v1, s[12:15], s45 offen offset:0 sc1 lds
  buffer_load_dwordx4 v1, s[12:15], s45 offen offset:1024 sc1 lds
  buffer_load_dwordx4 v1, s[12:15], s45 offen offset:2048 sc1 lds
  buffer_load_dwordx4 v1, s[12:15], s45 offen offset:3072 sc1 lds
  s_add_u32 m0, s42, 20480
  s_add_u32 s45, s40, 102400
  buffer_load_dwordx4 v1, s[12:15], s45 offen offset:0 lds
  buffer_load_dwordx4 v1, s[12:15], s45 offen offset:1024 lds
  buffer_load_dwordx4 v1, s[12:15], s45 offen offset:2048 lds
  buffer_load_dwordx4 v1, s[12:15], s45 offen offset:3072 lds
  s_add_u32 m0, s42, 24576
  s_add_u32 s45, s40, 106496
  buffer_load_dwordx4 v1, s[12:15], s45 offen lds
  s_waitcnt vmcnt(18)
  s_barrier
  s_add_u32 m0, s44, 114688
  s_add_u32 s45, s43, 49152
  buffer_load_dwordx4 v1, s[12:15], s45 offen offset:0 sc1 lds
  buffer_load_dwordx4 v1, s[12:15], s45 offen offset:1024 sc1 lds
  buffer_load_dwordx4 v1, s[12:15], s45 offen offset:2048 sc1 lds
  buffer_load_dwordx4 v1, s[12:15], s45 offen offset:3072 sc1 lds
  s_add_u32 m0, s42, 40960
  s_add_u32 s45, s40, 122880
  buffer_load_dwordx4 v1, s[12:15], s45 offen offset:0 lds
  buffer_load_dwordx4 v1, s[12:15], s45 offen offset:1024 lds
  buffer_load_dwordx4 v1, s[12:15], s45 offen offset:2048 lds
  buffer_load_dwordx4 v1, s[12:15], s45 offen offset:3072 lds
  s_add_u32 m0, s42, 45056
  s_add_u32 s45, s40, 126976
  buffer_load_dwordx4 v1, s[12:15], s45 offen lds
  s_waitcnt vmcnt(18)
  s_barrier
  s_add_u32 m0, s44, 131072
  s_add_u32 s45, s43, 57344
  buffer_load_dwordx4 v1, s[12:15], s45 offen offset:0 sc1 lds
  buffer_load_dwordx4 v1, s[12:15], s45 offen offset:1024 sc1 lds
  buffer_load_dwordx4 v1, s[12:15], s45 offen offset:2048 sc1 lds
  buffer_load_dwordx4 v1, s[12:15], s45 offen offset:3072 sc1 lds
  s_add_u32 m0, s42, 61440
  s_add_u32 s45, s40, 143360
  buffer_load_dwordx4 v1, s[12:15], s45 offen offset:0 lds
  buffer_load_dwordx4 v1, s[12:15], s45 offen offset:1024 lds
  buffer_load_dwordx4 v1, s[12:15], s45 offen offset:2048 lds
  buffer_load_dwordx4 v1, s[12:15], s45 offen offset:3072 lds
  s_add_u32 m0, s42, 65536
  s_add_u32 s45, s40, 147456
  buffer_load_dwordx4 v1, s[12:15], s45 offen lds
  s_waitcnt vmcnt(18)
  s_barrier
  s_add_u32 m0, s44, 81920
  s_add_u32 s45, s43, 65536
  buffer_load_dwordx4 v1, s[12:15], s45 offen offset:0 sc1 lds
  buffer_load_dwordx4 v1, s[12:15], s45 offen offset:1024 sc1 lds
  buffer_load_dwordx4 v1, s[12:15], s45 offen offset:2048 sc1 lds
  buffer_load_dwordx4 v1, s[12:15], s45 offen offset:3072 sc1 lds
  s_add_u32 m0, s42, 0
  s_add_u32 s45, s40, 163840
  buffer_load_dwordx4 v1, s[12:15], s45 offen offset:0 lds
  buffer_load_dwordx4 v1, s[12:15], s45 offen offset:1024 lds
  buffer_load_dwordx4 v1, s[12:15], s45 offen offset:2048 lds
  buffer_load_dwordx4 v1, s[12:15], s45 offen offset:3072 lds
  s_add_u32 m0, s42, 4096
  s_add_u32 s45, s40, 167936
  buffer_load_dwordx4 v1, s[12:15], s45 offen lds
  s_waitcnt vmcnt(18)
  s_barrier
  s_add_u32 m0, s44, 98304
  s_add_u32 s45, s43, 73728
  buffer_load_dwordx4 v1, s[12:15], s45 offen offset:0 sc1 lds
  buffer_load_dwordx4 v1, s[12:15], s45 offen offset:1024 sc1 lds
  buffer_load_dwordx4 v1, s[12:15], s45 offen offset:2048 sc1 lds
  buffer_load_dwordx4 v1, s[12:15], s45 offen offset:3072 sc1 lds
  s_add_u32 m0, s42, 20480
  s_add_u32 s45, s40, 184320
  buffer_load_dwordx4 v1, s[12:15], s45 offen offset:0 lds
  buffer_load_dwordx4 v1, s[12:15], s45 offen offset:1024 lds
  buffer_load_dwordx4 v1, s[12:15], s45 offen offset:2048 lds
  buffer_load_dwordx4 v1, s[12:15], s45 offen offset:3072 lds
  s_add_u32 m0, s42, 24576
  s_add_u32 s45, s40, 188416
  buffer_load_dwordx4 v1, s[12:15], s45 offen lds
  s_waitcnt vmcnt(18)
  s_barrier
  s_add_u32 m0, s44, 114688
  s_add_u32 s45, s43, 81920
  buffer_load_dwordx4 v1, s[12:15], s45 offen offset:0 sc1 lds
  buffer_load_dwordx4 v1, s[12:15], s45 offen offset:1024 sc1 lds
  buffer_load_dwordx4 v1, s[12:15], s45 offen offset:2048 sc1 lds
  buffer_load_dwordx4 v1, s[12:15], s45 offen offset:3072 sc1 lds
  s_add_u32 m0, s42, 40960
  s_add_u32 s45, s40, 204800
  buffer_load_dwordx4 v1, s[12:15], s45 offen offset:0 lds
  buffer_load_dwordx4 v1, s[12:15], s45 offen offset:1024 lds
  buffer_load_dwordx4 v1, s[12:15], s45 offen offset:2048 lds
  buffer_load_dwordx4 v1, s[12:15], s45 offen offset:3072 lds
  s_add_u32 m0, s42, 45056
  s_add_u32 s45, s40, 208896
  buffer_load_dwordx4 v1, s[12:15], s45 offen lds
  s_waitcnt vmcnt(18)
  s_barrier
  s_add_u32 m0, s44, 131072
  s_add_u32 s45, s43, 90112
  buffer_load_dwordx4 v1, s[12:15], s45 offen offset:0 sc1 lds
  buffer_load_dwordx4 v1, s[12:15], s45 offen offset:1024 sc1 lds
  buffer_load_dwordx4 v1, s[12:15], s45 offen offset:2048 sc1 lds
  buffer_load_dwordx4 v1, s[12:15], s45 offen offset:3072 sc1 lds
  s_add_u32 m0, s42, 61440
  s_add_u32 s45, s40, 225280
  buffer_load_dwordx4 v1, s[12:15], s45 offen offset:0 lds
  buffer_load_dwordx4 v1, s[12:15], s45 offen offset:1024 lds
  buffer_load_dwordx4 v1, s[12:15], s45 offen offset:2048 lds
  buffer_load_dwordx4 v1, s[12:15], s45 offen offset:3072 lds
  s_add_u32 m0, s42, 65536
  s_add_u32 s45, s40, 229376
  buffer_load_dwordx4 v1, s[12:15], s45 offen lds
  s_waitcnt vmcnt(18)
  s_barrier
  s_waitcnt vmcnt(9)
  s_barrier
  s_waitcnt vmcnt(0)
  s_barrier
  s_endpgm
f0_kernel_p8_compute:
  s_and_b32 s27, s26, 1
  s_lshr_b32 s36, s26, 1
  v_lshrrev_b32 v17, 4, v0
  v_and_b32 v16, 15, v0
  v_mul_u32_u24 v20, 1280, v17
  v_lshl_add_u32 v20, v16, 4, v20
  s_mul_i32 s37, s27, 768
  v_add_u32 v1, s37, v20
  v_add_u32 v2, 61440, v1
  v_lshlrev_b32 v20, 9, v17
  v_lshl_add_u32 v20, v16, 4, v20
  s_lshl_b32 s37, s36, 13
  s_add_u32 s37, s37, 81920
  v_add_u32 v3, s37, v20
  v_add_u32 v4, 49152, v3
  v_lshrrev_b32 v20, 1, v17
  v_lshlrev_b32 v20, 9, v20
  v_lshl_add_u32 v20, v16, 4, v20
  v_and_b32 v21, 1, v17
  v_lshl_add_u32 v20, v21, 3, v20
  s_lshl_b32 s38, s24, 1
  s_add_u32 s38, s38, s36
  s_mul_i32 s39, s38, 40960
  s_mul_i32 s40, s25, 5120
  s_add_u32 s39, s39, s40
  s_mul_i32 s40, s27, 3072
  s_add_u32 s39, s39, s40
  s_add_u32 s52, s39, 12582912
  s_waitcnt lgkmcnt(0)
  s_mov_b32 s48, s6
  s_mov_b32 s49, s7
  s_mov_b32 s50, 0x3200000
  s_mov_b32 s51, 0x00020000
  s_cmp_eq_u32 s27, 1
  s_cbranch_scc1 f0_kernel_p8_p2
  buffer_load_dwordx2 v[104:105], v20, s[48:51], s52 offen offset:0 sc1
  buffer_load_dwordx2 v[106:107], v20, s[48:51], s52 offen offset:256 sc1
  buffer_load_dwordx2 v[108:109], v20, s[48:51], s52 offen offset:1024 sc1
  buffer_load_dwordx2 v[110:111], v20, s[48:51], s52 offen offset:1280 sc1
  buffer_load_dwordx2 v[112:113], v20, s[48:51], s52 offen offset:2048 sc1
  buffer_load_dwordx2 v[114:115], v20, s[48:51], s52 offen offset:2304 sc1
  s_mov_b32 s56, s8
  s_mov_b32 s57, s9
  s_mov_b32 s58, 0x500
  s_mov_b32 s59, 0x00020000
  s_mul_i32 s40, s25, 160
  s_mul_i32 s41, s27, 96
  s_add_u32 s40, s40, s41
  v_lshlrev_b32 v21, 3, v17
  buffer_load_dwordx2 v[116:117], v21, s[56:59], s40 offen offset:0
  buffer_load_dwordx2 v[118:119], v21, s[56:59], s40 offen offset:32
  buffer_load_dwordx2 v[120:121], v21, s[56:59], s40 offen offset:64
  s_barrier
  ds_read_b128 v[88:91], v3 offset:0
  ds_read_b128 v[92:95], v3 offset:256
  ds_read_b128 v[64:67], v1 offset:0
  ds_read_b128 v[68:71], v1 offset:256
  ds_read_b128 v[72:75], v1 offset:512
  s_waitcnt lgkmcnt(0)
  v_mfma_f32_16x16x32_bf16 v[32:35], v[64:67], v[88:91], 0
  ds_read_b128 v[96:99], v3 offset:2048
  ds_read_b128 v[100:103], v3 offset:2304
  v_mfma_f32_16x16x32_bf16 v[36:39], v[64:67], v[92:95], 0
  ds_read_b128 v[76:79], v1 offset:5120
  ds_read_b128 v[80:83], v1 offset:5376
  v_mfma_f32_16x16x32_bf16 v[40:43], v[68:71], v[88:91], 0
  ds_read_b128 v[84:87], v1 offset:5632
  v_mfma_f32_16x16x32_bf16 v[44:47], v[68:71], v[92:95], 0
  v_mfma_f32_16x16x32_bf16 v[48:51], v[72:75], v[88:91], 0
  v_mfma_f32_16x16x32_bf16 v[52:55], v[72:75], v[92:95], 0
  s_waitcnt lgkmcnt(0)
  v_mfma_f32_16x16x32_bf16 v[32:35], v[76:79], v[96:99], v[32:35]
  ds_read_b128 v[88:91], v3 offset:4096
  ds_read_b128 v[92:95], v3 offset:4352
  v_mfma_f32_16x16x32_bf16 v[36:39], v[76:79], v[100:103], v[36:39]
  ds_read_b128 v[64:67], v1 offset:10240
  ds_read_b128 v[68:71], v1 offset:10496
  v_mfma_f32_16x16x32_bf16 v[40:43], v[80:83], v[96:99], v[40:43]
  ds_read_b128 v[72:75], v1 offset:10752
  v_mfma_f32_16x16x32_bf16 v[44:47], v[80:83], v[100:103], v[44:47]
  v_mfma_f32_16x16x32_bf16 v[48:51], v[84:87], v[96:99], v[48:51]
  v_mfma_f32_16x16x32_bf16 v[52:55], v[84:87], v[100:103], v[52:55]
  s_waitcnt lgkmcnt(0)
  v_mfma_f32_16x16x32_bf16 v[32:35], v[64:67], v[88:91], v[32:35]
  ds_read_b128 v[96:99], v3 offset:6144
  ds_read_b128 v[100:103], v3 offset:6400
  v_mfma_f32_16x16x32_bf16 v[36:39], v[64:67], v[92:95], v[36:39]
  ds_read_b128 v[76:79], v1 offset:15360
  ds_read_b128 v[80:83], v1 offset:15616
  v_mfma_f32_16x16x32_bf16 v[40:43], v[68:71], v[88:91], v[40:43]
  ds_read_b128 v[84:87], v1 offset:15872
  v_mfma_f32_16x16x32_bf16 v[44:47], v[68:71], v[92:95], v[44:47]
  v_mfma_f32_16x16x32_bf16 v[48:51], v[72:75], v[88:91], v[48:51]
  v_mfma_f32_16x16x32_bf16 v[52:55], v[72:75], v[92:95], v[52:55]
  s_waitcnt lgkmcnt(0)
  s_barrier
  v_mfma_f32_16x16x32_bf16 v[32:35], v[76:79], v[96:99], v[32:35]
  ds_read_b128 v[88:91], v3 offset:16384
  ds_read_b128 v[92:95], v3 offset:16640
  v_mfma_f32_16x16x32_bf16 v[36:39], v[76:79], v[100:103], v[36:39]
  ds_read_b128 v[64:67], v1 offset:20480
  ds_read_b128 v[68:71], v1 offset:20736
  v_mfma_f32_16x16x32_bf16 v[40:43], v[80:83], v[96:99], v[40:43]
  ds_read_b128 v[72:75], v1 offset:20992
  v_mfma_f32_16x16x32_bf16 v[44:47], v[80:83], v[100:103], v[44:47]
  v_mfma_f32_16x16x32_bf16 v[48:51], v[84:87], v[96:99], v[48:51]
  v_mfma_f32_16x16x32_bf16 v[52:55], v[84:87], v[100:103], v[52:55]
  s_waitcnt lgkmcnt(0)
  v_mfma_f32_16x16x32_bf16 v[32:35], v[64:67], v[88:91], v[32:35]
  ds_read_b128 v[96:99], v3 offset:18432
  ds_read_b128 v[100:103], v3 offset:18688
  v_mfma_f32_16x16x32_bf16 v[36:39], v[64:67], v[92:95], v[36:39]
  ds_read_b128 v[76:79], v1 offset:25600
  ds_read_b128 v[80:83], v1 offset:25856
  v_mfma_f32_16x16x32_bf16 v[40:43], v[68:71], v[88:91], v[40:43]
  ds_read_b128 v[84:87], v1 offset:26112
  v_mfma_f32_16x16x32_bf16 v[44:47], v[68:71], v[92:95], v[44:47]
  v_mfma_f32_16x16x32_bf16 v[48:51], v[72:75], v[88:91], v[48:51]
  v_mfma_f32_16x16x32_bf16 v[52:55], v[72:75], v[92:95], v[52:55]
  s_waitcnt lgkmcnt(0)
  v_mfma_f32_16x16x32_bf16 v[32:35], v[76:79], v[96:99], v[32:35]
  ds_read_b128 v[88:91], v3 offset:20480
  ds_read_b128 v[92:95], v3 offset:20736
  v_mfma_f32_16x16x32_bf16 v[36:39], v[76:79], v[100:103], v[36:39]
  ds_read_b128 v[64:67], v1 offset:30720
  ds_read_b128 v[68:71], v1 offset:30976
  v_mfma_f32_16x16x32_bf16 v[40:43], v[80:83], v[96:99], v[40:43]
  ds_read_b128 v[72:75], v1 offset:31232
  v_mfma_f32_16x16x32_bf16 v[44:47], v[80:83], v[100:103], v[44:47]
  v_mfma_f32_16x16x32_bf16 v[48:51], v[84:87], v[96:99], v[48:51]
  v_mfma_f32_16x16x32_bf16 v[52:55], v[84:87], v[100:103], v[52:55]
  s_waitcnt lgkmcnt(0)
  v_mfma_f32_16x16x32_bf16 v[32:35], v[64:67], v[88:91], v[32:35]
  ds_read_b128 v[96:99], v3 offset:22528
  ds_read_b128 v[100:103], v3 offset:22784
  v_mfma_f32_16x16x32_bf16 v[36:39], v[64:67], v[92:95], v[36:39]
  ds_read_b128 v[76:79], v1 offset:35840
  ds_read_b128 v[80:83], v1 offset:36096
  v_mfma_f32_16x16x32_bf16 v[40:43], v[68:71], v[88:91], v[40:43]
  ds_read_b128 v[84:87], v1 offset:36352
  v_mfma_f32_16x16x32_bf16 v[44:47], v[68:71], v[92:95], v[44:47]
  v_mfma_f32_16x16x32_bf16 v[48:51], v[72:75], v[88:91], v[48:51]
  v_mfma_f32_16x16x32_bf16 v[52:55], v[72:75], v[92:95], v[52:55]
  s_waitcnt lgkmcnt(0)
  s_barrier
  v_mfma_f32_16x16x32_bf16 v[32:35], v[76:79], v[96:99], v[32:35]
  ds_read_b128 v[88:91], v3 offset:32768
  ds_read_b128 v[92:95], v3 offset:33024
  v_mfma_f32_16x16x32_bf16 v[36:39], v[76:79], v[100:103], v[36:39]
  ds_read_b128 v[64:67], v1 offset:40960
  ds_read_b128 v[68:71], v1 offset:41216
  v_mfma_f32_16x16x32_bf16 v[40:43], v[80:83], v[96:99], v[40:43]
  ds_read_b128 v[72:75], v1 offset:41472
  v_mfma_f32_16x16x32_bf16 v[44:47], v[80:83], v[100:103], v[44:47]
  v_mfma_f32_16x16x32_bf16 v[48:51], v[84:87], v[96:99], v[48:51]
  v_mfma_f32_16x16x32_bf16 v[52:55], v[84:87], v[100:103], v[52:55]
  s_waitcnt lgkmcnt(0)
  v_mfma_f32_16x16x32_bf16 v[32:35], v[64:67], v[88:91], v[32:35]
  ds_read_b128 v[96:99], v3 offset:34816
  ds_read_b128 v[100:103], v3 offset:35072
  v_mfma_f32_16x16x32_bf16 v[36:39], v[64:67], v[92:95], v[36:39]
  ds_read_b128 v[76:79], v1 offset:46080
  ds_read_b128 v[80:83], v1 offset:46336
  v_mfma_f32_16x16x32_bf16 v[40:43], v[68:71], v[88:91], v[40:43]
  ds_read_b128 v[84:87], v1 offset:46592
  v_mfma_f32_16x16x32_bf16 v[44:47], v[68:71], v[92:95], v[44:47]
  v_mfma_f32_16x16x32_bf16 v[48:51], v[72:75], v[88:91], v[48:51]
  v_mfma_f32_16x16x32_bf16 v[52:55], v[72:75], v[92:95], v[52:55]
  s_waitcnt lgkmcnt(0)
  v_mfma_f32_16x16x32_bf16 v[32:35], v[76:79], v[96:99], v[32:35]
  ds_read_b128 v[88:91], v3 offset:36864
  ds_read_b128 v[92:95], v3 offset:37120
  v_mfma_f32_16x16x32_bf16 v[36:39], v[76:79], v[100:103], v[36:39]
  ds_read_b128 v[64:67], v1 offset:51200
  ds_read_b128 v[68:71], v1 offset:51456
  v_mfma_f32_16x16x32_bf16 v[40:43], v[80:83], v[96:99], v[40:43]
  ds_read_b128 v[72:75], v1 offset:51712
  v_mfma_f32_16x16x32_bf16 v[44:47], v[80:83], v[100:103], v[44:47]
  v_mfma_f32_16x16x32_bf16 v[48:51], v[84:87], v[96:99], v[48:51]
  v_mfma_f32_16x16x32_bf16 v[52:55], v[84:87], v[100:103], v[52:55]
  s_waitcnt lgkmcnt(0)
  v_mfma_f32_16x16x32_bf16 v[32:35], v[64:67], v[88:91], v[32:35]
  ds_read_b128 v[96:99], v3 offset:38912
  ds_read_b128 v[100:103], v3 offset:39168
  v_mfma_f32_16x16x32_bf16 v[36:39], v[64:67], v[92:95], v[36:39]
  ds_read_b128 v[76:79], v1 offset:56320
  ds_read_b128 v[80:83], v1 offset:56576
  v_mfma_f32_16x16x32_bf16 v[40:43], v[68:71], v[88:91], v[40:43]
  ds_read_b128 v[84:87], v1 offset:56832
  v_mfma_f32_16x16x32_bf16 v[44:47], v[68:71], v[92:95], v[44:47]
  v_mfma_f32_16x16x32_bf16 v[48:51], v[72:75], v[88:91], v[48:51]
  v_mfma_f32_16x16x32_bf16 v[52:55], v[72:75], v[92:95], v[52:55]
  s_waitcnt lgkmcnt(0)
  s_barrier
  v_mfma_f32_16x16x32_bf16 v[32:35], v[76:79], v[96:99], v[32:35]
  ds_read_b128 v[88:91], v4 offset:0
  ds_read_b128 v[92:95], v4 offset:256
  v_mfma_f32_16x16x32_bf16 v[36:39], v[76:79], v[100:103], v[36:39]
  ds_read_b128 v[64:67], v2 offset:0
  ds_read_b128 v[68:71], v2 offset:256
  v_mfma_f32_16x16x32_bf16 v[40:43], v[80:83], v[96:99], v[40:43]
  ds_read_b128 v[72:75], v2 offset:512
  v_mfma_f32_16x16x32_bf16 v[44:47], v[80:83], v[100:103], v[44:47]
  v_mfma_f32_16x16x32_bf16 v[48:51], v[84:87], v[96:99], v[48:51]
  v_mfma_f32_16x16x32_bf16 v[52:55], v[84:87], v[100:103], v[52:55]
  s_waitcnt lgkmcnt(0)
  v_mfma_f32_16x16x32_bf16 v[32:35], v[64:67], v[88:91], v[32:35]
  ds_read_b128 v[96:99], v4 offset:2048
  ds_read_b128 v[100:103], v4 offset:2304
  v_mfma_f32_16x16x32_bf16 v[36:39], v[64:67], v[92:95], v[36:39]
  ds_read_b128 v[76:79], v2 offset:5120
  ds_read_b128 v[80:83], v2 offset:5376
  v_mfma_f32_16x16x32_bf16 v[40:43], v[68:71], v[88:91], v[40:43]
  ds_read_b128 v[84:87], v2 offset:5632
  v_mfma_f32_16x16x32_bf16 v[44:47], v[68:71], v[92:95], v[44:47]
  v_mfma_f32_16x16x32_bf16 v[48:51], v[72:75], v[88:91], v[48:51]
  v_mfma_f32_16x16x32_bf16 v[52:55], v[72:75], v[92:95], v[52:55]
  s_waitcnt lgkmcnt(0)
  v_mfma_f32_16x16x32_bf16 v[32:35], v[76:79], v[96:99], v[32:35]
  ds_read_b128 v[88:91], v4 offset:4096
  ds_read_b128 v[92:95], v4 offset:4352
  v_mfma_f32_16x16x32_bf16 v[36:39], v[76:79], v[100:103], v[36:39]
  ds_read_b128 v[64:67], v2 offset:10240
  ds_read_b128 v[68:71], v2 offset:10496
  v_mfma_f32_16x16x32_bf16 v[40:43], v[80:83], v[96:99], v[40:43]
  ds_read_b128 v[72:75], v2 offset:10752
  v_mfma_f32_16x16x32_bf16 v[44:47], v[80:83], v[100:103], v[44:47]
  v_mfma_f32_16x16x32_bf16 v[48:51], v[84:87], v[96:99], v[48:51]
  v_mfma_f32_16x16x32_bf16 v[52:55], v[84:87], v[100:103], v[52:55]
  s_waitcnt lgkmcnt(0)
  v_mfma_f32_16x16x32_bf16 v[32:35], v[64:67], v[88:91], v[32:35]
  ds_read_b128 v[96:99], v4 offset:6144
  ds_read_b128 v[100:103], v4 offset:6400
  v_mfma_f32_16x16x32_bf16 v[36:39], v[64:67], v[92:95], v[36:39]
  ds_read_b128 v[76:79], v2 offset:15360
  ds_read_b128 v[80:83], v2 offset:15616
  v_mfma_f32_16x16x32_bf16 v[40:43], v[68:71], v[88:91], v[40:43]
  ds_read_b128 v[84:87], v2 offset:15872
  v_mfma_f32_16x16x32_bf16 v[44:47], v[68:71], v[92:95], v[44:47]
  v_mfma_f32_16x16x32_bf16 v[48:51], v[72:75], v[88:91], v[48:51]
  v_mfma_f32_16x16x32_bf16 v[52:55], v[72:75], v[92:95], v[52:55]
  s_waitcnt lgkmcnt(0)
  s_barrier
  v_mfma_f32_16x16x32_bf16 v[32:35], v[76:79], v[96:99], v[32:35]
  ds_read_b128 v[88:91], v3 offset:0
  ds_read_b128 v[92:95], v3 offset:256
  v_mfma_f32_16x16x32_bf16 v[36:39], v[76:79], v[100:103], v[36:39]
  ds_read_b128 v[64:67], v1 offset:0
  ds_read_b128 v[68:71], v1 offset:256
  v_mfma_f32_16x16x32_bf16 v[40:43], v[80:83], v[96:99], v[40:43]
  ds_read_b128 v[72:75], v1 offset:512
  v_mfma_f32_16x16x32_bf16 v[44:47], v[80:83], v[100:103], v[44:47]
  v_mfma_f32_16x16x32_bf16 v[48:51], v[84:87], v[96:99], v[48:51]
  v_mfma_f32_16x16x32_bf16 v[52:55], v[84:87], v[100:103], v[52:55]
  s_waitcnt lgkmcnt(0)
  v_mfma_f32_16x16x32_bf16 v[32:35], v[64:67], v[88:91], v[32:35]
  ds_read_b128 v[96:99], v3 offset:2048
  ds_read_b128 v[100:103], v3 offset:2304
  v_mfma_f32_16x16x32_bf16 v[36:39], v[64:67], v[92:95], v[36:39]
  ds_read_b128 v[76:79], v1 offset:5120
  ds_read_b128 v[80:83], v1 offset:5376
  v_mfma_f32_16x16x32_bf16 v[40:43], v[68:71], v[88:91], v[40:43]
  ds_read_b128 v[84:87], v1 offset:5632
  v_mfma_f32_16x16x32_bf16 v[44:47], v[68:71], v[92:95], v[44:47]
  v_mfma_f32_16x16x32_bf16 v[48:51], v[72:75], v[88:91], v[48:51]
  v_mfma_f32_16x16x32_bf16 v[52:55], v[72:75], v[92:95], v[52:55]
  s_waitcnt lgkmcnt(0)
  v_mfma_f32_16x16x32_bf16 v[32:35], v[76:79], v[96:99], v[32:35]
  ds_read_b128 v[88:91], v3 offset:4096
  ds_read_b128 v[92:95], v3 offset:4352
  v_mfma_f32_16x16x32_bf16 v[36:39], v[76:79], v[100:103], v[36:39]
  ds_read_b128 v[64:67], v1 offset:10240
  ds_read_b128 v[68:71], v1 offset:10496
  v_mfma_f32_16x16x32_bf16 v[40:43], v[80:83], v[96:99], v[40:43]
  ds_read_b128 v[72:75], v1 offset:10752
  v_mfma_f32_16x16x32_bf16 v[44:47], v[80:83], v[100:103], v[44:47]
  v_mfma_f32_16x16x32_bf16 v[48:51], v[84:87], v[96:99], v[48:51]
  v_mfma_f32_16x16x32_bf16 v[52:55], v[84:87], v[100:103], v[52:55]
  s_waitcnt lgkmcnt(0)
  v_mfma_f32_16x16x32_bf16 v[32:35], v[64:67], v[88:91], v[32:35]
  ds_read_b128 v[96:99], v3 offset:6144
  ds_read_b128 v[100:103], v3 offset:6400
  v_mfma_f32_16x16x32_bf16 v[36:39], v[64:67], v[92:95], v[36:39]
  ds_read_b128 v[76:79], v1 offset:15360
  ds_read_b128 v[80:83], v1 offset:15616
  v_mfma_f32_16x16x32_bf16 v[40:43], v[68:71], v[88:91], v[40:43]
  ds_read_b128 v[84:87], v1 offset:15872
  v_mfma_f32_16x16x32_bf16 v[44:47], v[68:71], v[92:95], v[44:47]
  v_mfma_f32_16x16x32_bf16 v[48:51], v[72:75], v[88:91], v[48:51]
  v_mfma_f32_16x16x32_bf16 v[52:55], v[72:75], v[92:95], v[52:55]
  s_waitcnt lgkmcnt(0)
  s_barrier
  v_mfma_f32_16x16x32_bf16 v[32:35], v[76:79], v[96:99], v[32:35]
  ds_read_b128 v[88:91], v3 offset:16384
  ds_read_b128 v[92:95], v3 offset:16640
  v_mfma_f32_16x16x32_bf16 v[36:39], v[76:79], v[100:103], v[36:39]
  ds_read_b128 v[64:67], v1 offset:20480
  ds_read_b128 v[68:71], v1 offset:20736
  v_mfma_f32_16x16x32_bf16 v[40:43], v[80:83], v[96:99], v[40:43]
  ds_read_b128 v[72:75], v1 offset:20992
  v_mfma_f32_16x16x32_bf16 v[44:47], v[80:83], v[100:103], v[44:47]
  v_mfma_f32_16x16x32_bf16 v[48:51], v[84:87], v[96:99], v[48:51]
  v_mfma_f32_16x16x32_bf16 v[52:55], v[84:87], v[100:103], v[52:55]
  s_waitcnt lgkmcnt(0)
  v_mfma_f32_16x16x32_bf16 v[32:35], v[64:67], v[88:91], v[32:35]
  ds_read_b128 v[96:99], v3 offset:18432
  ds_read_b128 v[100:103], v3 offset:18688
  v_mfma_f32_16x16x32_bf16 v[36:39], v[64:67], v[92:95], v[36:39]
  ds_read_b128 v[76:79], v1 offset:25600
  ds_read_b128 v[80:83], v1 offset:25856
  v_mfma_f32_16x16x32_bf16 v[40:43], v[68:71], v[88:91], v[40:43]
  ds_read_b128 v[84:87], v1 offset:26112
  v_mfma_f32_16x16x32_bf16 v[44:47], v[68:71], v[92:95], v[44:47]
  v_mfma_f32_16x16x32_bf16 v[48:51], v[72:75], v[88:91], v[48:51]
  v_mfma_f32_16x16x32_bf16 v[52:55], v[72:75], v[92:95], v[52:55]
  s_waitcnt lgkmcnt(0)
  v_mfma_f32_16x16x32_bf16 v[32:35], v[76:79], v[96:99], v[32:35]
  ds_read_b128 v[88:91], v3 offset:20480
  ds_read_b128 v[92:95], v3 offset:20736
  v_mfma_f32_16x16x32_bf16 v[36:39], v[76:79], v[100:103], v[36:39]
  ds_read_b128 v[64:67], v1 offset:30720
  ds_read_b128 v[68:71], v1 offset:30976
  v_mfma_f32_16x16x32_bf16 v[40:43], v[80:83], v[96:99], v[40:43]
  ds_read_b128 v[72:75], v1 offset:31232
  v_mfma_f32_16x16x32_bf16 v[44:47], v[80:83], v[100:103], v[44:47]
  v_mfma_f32_16x16x32_bf16 v[48:51], v[84:87], v[96:99], v[48:51]
  v_mfma_f32_16x16x32_bf16 v[52:55], v[84:87], v[100:103], v[52:55]
  s_waitcnt lgkmcnt(0)
  v_mfma_f32_16x16x32_bf16 v[32:35], v[64:67], v[88:91], v[32:35]
  ds_read_b128 v[96:99], v3 offset:22528
  ds_read_b128 v[100:103], v3 offset:22784
  v_mfma_f32_16x16x32_bf16 v[36:39], v[64:67], v[92:95], v[36:39]
  ds_read_b128 v[76:79], v1 offset:35840
  ds_read_b128 v[80:83], v1 offset:36096
  v_mfma_f32_16x16x32_bf16 v[40:43], v[68:71], v[88:91], v[40:43]
  ds_read_b128 v[84:87], v1 offset:36352
  v_mfma_f32_16x16x32_bf16 v[44:47], v[68:71], v[92:95], v[44:47]
  v_mfma_f32_16x16x32_bf16 v[48:51], v[72:75], v[88:91], v[48:51]
  v_mfma_f32_16x16x32_bf16 v[52:55], v[72:75], v[92:95], v[52:55]
  s_waitcnt lgkmcnt(0)
  s_barrier
  v_mfma_f32_16x16x32_bf16 v[32:35], v[76:79], v[96:99], v[32:35]
  ds_read_b128 v[88:91], v3 offset:32768
  ds_read_b128 v[92:95], v3 offset:33024
  v_mfma_f32_16x16x32_bf16 v[36:39], v[76:79], v[100:103], v[36:39]
  ds_read_b128 v[64:67], v1 offset:40960
  ds_read_b128 v[68:71], v1 offset:41216
  v_mfma_f32_16x16x32_bf16 v[40:43], v[80:83], v[96:99], v[40:43]
  ds_read_b128 v[72:75], v1 offset:41472
  v_mfma_f32_16x16x32_bf16 v[44:47], v[80:83], v[100:103], v[44:47]
  v_mfma_f32_16x16x32_bf16 v[48:51], v[84:87], v[96:99], v[48:51]
  v_mfma_f32_16x16x32_bf16 v[52:55], v[84:87], v[100:103], v[52:55]
  s_waitcnt lgkmcnt(0)
  v_mfma_f32_16x16x32_bf16 v[32:35], v[64:67], v[88:91], v[32:35]
  ds_read_b128 v[96:99], v3 offset:34816
  ds_read_b128 v[100:103], v3 offset:35072
  v_mfma_f32_16x16x32_bf16 v[36:39], v[64:67], v[92:95], v[36:39]
  ds_read_b128 v[76:79], v1 offset:46080
  ds_read_b128 v[80:83], v1 offset:46336
  v_mfma_f32_16x16x32_bf16 v[40:43], v[68:71], v[88:91], v[40:43]
  ds_read_b128 v[84:87], v1 offset:46592
  v_mfma_f32_16x16x32_bf16 v[44:47], v[68:71], v[92:95], v[44:47]
  v_mfma_f32_16x16x32_bf16 v[48:51], v[72:75], v[88:91], v[48:51]
  v_mfma_f32_16x16x32_bf16 v[52:55], v[72:75], v[92:95], v[52:55]
  s_waitcnt lgkmcnt(0)
  v_mfma_f32_16x16x32_bf16 v[32:35], v[76:79], v[96:99], v[32:35]
  ds_read_b128 v[88:91], v3 offset:36864
  ds_read_b128 v[92:95], v3 offset:37120
  v_mfma_f32_16x16x32_bf16 v[36:39], v[76:79], v[100:103], v[36:39]
  ds_read_b128 v[64:67], v1 offset:51200
  ds_read_b128 v[68:71], v1 offset:51456
  v_mfma_f32_16x16x32_bf16 v[40:43], v[80:83], v[96:99], v[40:43]
  ds_read_b128 v[72:75], v1 offset:51712
  v_mfma_f32_16x16x32_bf16 v[44:47], v[80:83], v[100:103], v[44:47]
  v_mfma_f32_16x16x32_bf16 v[48:51], v[84:87], v[96:99], v[48:51]
  v_mfma_f32_16x16x32_bf16 v[52:55], v[84:87], v[100:103], v[52:55]
  s_waitcnt lgkmcnt(0)
  v_mfma_f32_16x16x32_bf16 v[32:35], v[64:67], v[88:91], v[32:35]
  ds_read_b128 v[96:99], v3 offset:38912
  ds_read_b128 v[100:103], v3 offset:39168
  v_mfma_f32_16x16x32_bf16 v[36:39], v[64:67], v[92:95], v[36:39]
  ds_read_b128 v[76:79], v1 offset:56320
  ds_read_b128 v[80:83], v1 offset:56576
  v_mfma_f32_16x16x32_bf16 v[40:43], v[68:71], v[88:91], v[40:43]
  ds_read_b128 v[84:87], v1 offset:56832
  v_mfma_f32_16x16x32_bf16 v[44:47], v[68:71], v[92:95], v[44:47]
  v_mfma_f32_16x16x32_bf16 v[48:51], v[72:75], v[88:91], v[48:51]
  v_mfma_f32_16x16x32_bf16 v[52:55], v[72:75], v[92:95], v[52:55]
  s_waitcnt lgkmcnt(0)
  s_barrier
  v_mfma_f32_16x16x32_bf16 v[32:35], v[76:79], v[96:99], v[32:35]
  ds_read_b128 v[88:91], v4 offset:0
  ds_read_b128 v[92:95], v4 offset:256
  v_mfma_f32_16x16x32_bf16 v[36:39], v[76:79], v[100:103], v[36:39]
  ds_read_b128 v[64:67], v2 offset:0
  ds_read_b128 v[68:71], v2 offset:256
  v_mfma_f32_16x16x32_bf16 v[40:43], v[80:83], v[96:99], v[40:43]
  ds_read_b128 v[72:75], v2 offset:512
  v_mfma_f32_16x16x32_bf16 v[44:47], v[80:83], v[100:103], v[44:47]
  v_mfma_f32_16x16x32_bf16 v[48:51], v[84:87], v[96:99], v[48:51]
  v_mfma_f32_16x16x32_bf16 v[52:55], v[84:87], v[100:103], v[52:55]
  s_waitcnt lgkmcnt(0)
  v_mfma_f32_16x16x32_bf16 v[32:35], v[64:67], v[88:91], v[32:35]
  ds_read_b128 v[96:99], v4 offset:2048
  ds_read_b128 v[100:103], v4 offset:2304
  v_mfma_f32_16x16x32_bf16 v[36:39], v[64:67], v[92:95], v[36:39]
  ds_read_b128 v[76:79], v2 offset:5120
  ds_read_b128 v[80:83], v2 offset:5376
  v_mfma_f32_16x16x32_bf16 v[40:43], v[68:71], v[88:91], v[40:43]
  ds_read_b128 v[84:87], v2 offset:5632
  v_mfma_f32_16x16x32_bf16 v[44:47], v[68:71], v[92:95], v[44:47]
  v_mfma_f32_16x16x32_bf16 v[48:51], v[72:75], v[88:91], v[48:51]
  v_mfma_f32_16x16x32_bf16 v[52:55], v[72:75], v[92:95], v[52:55]
  s_waitcnt lgkmcnt(0)
  v_mfma_f32_16x16x32_bf16 v[32:35], v[76:79], v[96:99], v[32:35]
  ds_read_b128 v[88:91], v4 offset:4096
  ds_read_b128 v[92:95], v4 offset:4352
  v_mfma_f32_16x16x32_bf16 v[36:39], v[76:79], v[100:103], v[36:39]
  ds_read_b128 v[64:67], v2 offset:10240
  ds_read_b128 v[68:71], v2 offset:10496
  v_mfma_f32_16x16x32_bf16 v[40:43], v[80:83], v[96:99], v[40:43]
  ds_read_b128 v[72:75], v2 offset:10752
  v_mfma_f32_16x16x32_bf16 v[44:47], v[80:83], v[100:103], v[44:47]
  v_mfma_f32_16x16x32_bf16 v[48:51], v[84:87], v[96:99], v[48:51]
  v_mfma_f32_16x16x32_bf16 v[52:55], v[84:87], v[100:103], v[52:55]
  s_waitcnt lgkmcnt(0)
  v_mfma_f32_16x16x32_bf16 v[32:35], v[64:67], v[88:91], v[32:35]
  ds_read_b128 v[96:99], v4 offset:6144
  ds_read_b128 v[100:103], v4 offset:6400
  v_mfma_f32_16x16x32_bf16 v[36:39], v[64:67], v[92:95], v[36:39]
  ds_read_b128 v[76:79], v2 offset:15360
  ds_read_b128 v[80:83], v2 offset:15616
  v_mfma_f32_16x16x32_bf16 v[40:43], v[68:71], v[88:91], v[40:43]
  ds_read_b128 v[84:87], v2 offset:15872
  v_mfma_f32_16x16x32_bf16 v[44:47], v[68:71], v[92:95], v[44:47]
  v_mfma_f32_16x16x32_bf16 v[48:51], v[72:75], v[88:91], v[48:51]
  v_mfma_f32_16x16x32_bf16 v[52:55], v[72:75], v[92:95], v[52:55]
  s_waitcnt lgkmcnt(0)
  s_barrier
  v_mfma_f32_16x16x32_bf16 v[32:35], v[76:79], v[96:99], v[32:35]
  ds_read_b128 v[88:91], v3 offset:0
  ds_read_b128 v[92:95], v3 offset:256
  v_mfma_f32_16x16x32_bf16 v[36:39], v[76:79], v[100:103], v[36:39]
  ds_read_b128 v[64:67], v1 offset:0
  ds_read_b128 v[68:71], v1 offset:256
  v_mfma_f32_16x16x32_bf16 v[40:43], v[80:83], v[96:99], v[40:43]
  ds_read_b128 v[72:75], v1 offset:512
  v_mfma_f32_16x16x32_bf16 v[44:47], v[80:83], v[100:103], v[44:47]
  v_mfma_f32_16x16x32_bf16 v[48:51], v[84:87], v[96:99], v[48:51]
  v_mfma_f32_16x16x32_bf16 v[52:55], v[84:87], v[100:103], v[52:55]
  s_waitcnt lgkmcnt(0)
  v_mfma_f32_16x16x32_bf16 v[32:35], v[64:67], v[88:91], v[32:35]
  ds_read_b128 v[96:99], v3 offset:2048
  ds_read_b128 v[100:103], v3 offset:2304
  v_mfma_f32_16x16x32_bf16 v[36:39], v[64:67], v[92:95], v[36:39]
  ds_read_b128 v[76:79], v1 offset:5120
  ds_read_b128 v[80:83], v1 offset:5376
  v_mfma_f32_16x16x32_bf16 v[40:43], v[68:71], v[88:91], v[40:43]
  ds_read_b128 v[84:87], v1 offset:5632
  v_mfma_f32_16x16x32_bf16 v[44:47], v[68:71], v[92:95], v[44:47]
  v_mfma_f32_16x16x32_bf16 v[48:51], v[72:75], v[88:91], v[48:51]
  v_mfma_f32_16x16x32_bf16 v[52:55], v[72:75], v[92:95], v[52:55]
  s_waitcnt lgkmcnt(0)
  v_mfma_f32_16x16x32_bf16 v[32:35], v[76:79], v[96:99], v[32:35]
  ds_read_b128 v[88:91], v3 offset:4096
  ds_read_b128 v[92:95], v3 offset:4352
  v_mfma_f32_16x16x32_bf16 v[36:39], v[76:79], v[100:103], v[36:39]
  ds_read_b128 v[64:67], v1 offset:10240
  ds_read_b128 v[68:71], v1 offset:10496
  v_mfma_f32_16x16x32_bf16 v[40:43], v[80:83], v[96:99], v[40:43]
  ds_read_b128 v[72:75], v1 offset:10752
  v_mfma_f32_16x16x32_bf16 v[44:47], v[80:83], v[100:103], v[44:47]
  v_mfma_f32_16x16x32_bf16 v[48:51], v[84:87], v[96:99], v[48:51]
  v_mfma_f32_16x16x32_bf16 v[52:55], v[84:87], v[100:103], v[52:55]
  s_waitcnt lgkmcnt(0)
  v_mfma_f32_16x16x32_bf16 v[32:35], v[64:67], v[88:91], v[32:35]
  ds_read_b128 v[96:99], v3 offset:6144
  ds_read_b128 v[100:103], v3 offset:6400
  v_mfma_f32_16x16x32_bf16 v[36:39], v[64:67], v[92:95], v[36:39]
  ds_read_b128 v[76:79], v1 offset:15360
  ds_read_b128 v[80:83], v1 offset:15616
  v_mfma_f32_16x16x32_bf16 v[40:43], v[68:71], v[88:91], v[40:43]
  ds_read_b128 v[84:87], v1 offset:15872
  v_mfma_f32_16x16x32_bf16 v[44:47], v[68:71], v[92:95], v[44:47]
  v_mfma_f32_16x16x32_bf16 v[48:51], v[72:75], v[88:91], v[48:51]
  v_mfma_f32_16x16x32_bf16 v[52:55], v[72:75], v[92:95], v[52:55]
  s_waitcnt lgkmcnt(0)
  s_barrier
  v_mfma_f32_16x16x32_bf16 v[32:35], v[76:79], v[96:99], v[32:35]
  ds_read_b128 v[88:91], v3 offset:16384
  ds_read_b128 v[92:95], v3 offset:16640
  v_mfma_f32_16x16x32_bf16 v[36:39], v[76:79], v[100:103], v[36:39]
  ds_read_b128 v[64:67], v1 offset:20480
  ds_read_b128 v[68:71], v1 offset:20736
  v_mfma_f32_16x16x32_bf16 v[40:43], v[80:83], v[96:99], v[40:43]
  ds_read_b128 v[72:75], v1 offset:20992
  v_mfma_f32_16x16x32_bf16 v[44:47], v[80:83], v[100:103], v[44:47]
  v_mfma_f32_16x16x32_bf16 v[48:51], v[84:87], v[96:99], v[48:51]
  v_mfma_f32_16x16x32_bf16 v[52:55], v[84:87], v[100:103], v[52:55]
  s_waitcnt lgkmcnt(0)
  v_mfma_f32_16x16x32_bf16 v[32:35], v[64:67], v[88:91], v[32:35]
  ds_read_b128 v[96:99], v3 offset:18432
  ds_read_b128 v[100:103], v3 offset:18688
  v_mfma_f32_16x16x32_bf16 v[36:39], v[64:67], v[92:95], v[36:39]
  ds_read_b128 v[76:79], v1 offset:25600
  ds_read_b128 v[80:83], v1 offset:25856
  v_mfma_f32_16x16x32_bf16 v[40:43], v[68:71], v[88:91], v[40:43]
  ds_read_b128 v[84:87], v1 offset:26112
  v_mfma_f32_16x16x32_bf16 v[44:47], v[68:71], v[92:95], v[44:47]
  v_mfma_f32_16x16x32_bf16 v[48:51], v[72:75], v[88:91], v[48:51]
  v_mfma_f32_16x16x32_bf16 v[52:55], v[72:75], v[92:95], v[52:55]
  s_waitcnt lgkmcnt(0)
  v_mfma_f32_16x16x32_bf16 v[32:35], v[76:79], v[96:99], v[32:35]
  ds_read_b128 v[88:91], v3 offset:20480
  ds_read_b128 v[92:95], v3 offset:20736
  v_mfma_f32_16x16x32_bf16 v[36:39], v[76:79], v[100:103], v[36:39]
  ds_read_b128 v[64:67], v1 offset:30720
  ds_read_b128 v[68:71], v1 offset:30976
  v_mfma_f32_16x16x32_bf16 v[40:43], v[80:83], v[96:99], v[40:43]
  ds_read_b128 v[72:75], v1 offset:31232
  v_mfma_f32_16x16x32_bf16 v[44:47], v[80:83], v[100:103], v[44:47]
  v_mfma_f32_16x16x32_bf16 v[48:51], v[84:87], v[96:99], v[48:51]
  v_mfma_f32_16x16x32_bf16 v[52:55], v[84:87], v[100:103], v[52:55]
  s_waitcnt lgkmcnt(0)
  v_mfma_f32_16x16x32_bf16 v[32:35], v[64:67], v[88:91], v[32:35]
  ds_read_b128 v[96:99], v3 offset:22528
  ds_read_b128 v[100:103], v3 offset:22784
  v_mfma_f32_16x16x32_bf16 v[36:39], v[64:67], v[92:95], v[36:39]
  ds_read_b128 v[76:79], v1 offset:35840
  ds_read_b128 v[80:83], v1 offset:36096
  v_mfma_f32_16x16x32_bf16 v[40:43], v[68:71], v[88:91], v[40:43]
  ds_read_b128 v[84:87], v1 offset:36352
  v_mfma_f32_16x16x32_bf16 v[44:47], v[68:71], v[92:95], v[44:47]
  v_mfma_f32_16x16x32_bf16 v[48:51], v[72:75], v[88:91], v[48:51]
  v_mfma_f32_16x16x32_bf16 v[52:55], v[72:75], v[92:95], v[52:55]
  s_waitcnt lgkmcnt(0)
  s_barrier
  v_mfma_f32_16x16x32_bf16 v[32:35], v[76:79], v[96:99], v[32:35]
  ds_read_b128 v[88:91], v3 offset:32768
  ds_read_b128 v[92:95], v3 offset:33024
  v_mfma_f32_16x16x32_bf16 v[36:39], v[76:79], v[100:103], v[36:39]
  ds_read_b128 v[64:67], v1 offset:40960
  ds_read_b128 v[68:71], v1 offset:41216
  v_mfma_f32_16x16x32_bf16 v[40:43], v[80:83], v[96:99], v[40:43]
  ds_read_b128 v[72:75], v1 offset:41472
  v_mfma_f32_16x16x32_bf16 v[44:47], v[80:83], v[100:103], v[44:47]
  v_mfma_f32_16x16x32_bf16 v[48:51], v[84:87], v[96:99], v[48:51]
  v_mfma_f32_16x16x32_bf16 v[52:55], v[84:87], v[100:103], v[52:55]
  s_waitcnt lgkmcnt(0)
  v_mfma_f32_16x16x32_bf16 v[32:35], v[64:67], v[88:91], v[32:35]
  ds_read_b128 v[96:99], v3 offset:34816
  ds_read_b128 v[100:103], v3 offset:35072
  v_mfma_f32_16x16x32_bf16 v[36:39], v[64:67], v[92:95], v[36:39]
  ds_read_b128 v[76:79], v1 offset:46080
  ds_read_b128 v[80:83], v1 offset:46336
  v_mfma_f32_16x16x32_bf16 v[40:43], v[68:71], v[88:91], v[40:43]
  ds_read_b128 v[84:87], v1 offset:46592
  v_mfma_f32_16x16x32_bf16 v[44:47], v[68:71], v[92:95], v[44:47]
  v_mfma_f32_16x16x32_bf16 v[48:51], v[72:75], v[88:91], v[48:51]
  v_mfma_f32_16x16x32_bf16 v[52:55], v[72:75], v[92:95], v[52:55]
  s_waitcnt lgkmcnt(0)
  v_mfma_f32_16x16x32_bf16 v[32:35], v[76:79], v[96:99], v[32:35]
  ds_read_b128 v[88:91], v3 offset:36864
  ds_read_b128 v[92:95], v3 offset:37120
  v_mfma_f32_16x16x32_bf16 v[36:39], v[76:79], v[100:103], v[36:39]
  ds_read_b128 v[64:67], v1 offset:51200
  ds_read_b128 v[68:71], v1 offset:51456
  v_mfma_f32_16x16x32_bf16 v[40:43], v[80:83], v[96:99], v[40:43]
  ds_read_b128 v[72:75], v1 offset:51712
  v_mfma_f32_16x16x32_bf16 v[44:47], v[80:83], v[100:103], v[44:47]
  v_mfma_f32_16x16x32_bf16 v[48:51], v[84:87], v[96:99], v[48:51]
  v_mfma_f32_16x16x32_bf16 v[52:55], v[84:87], v[100:103], v[52:55]
  s_waitcnt lgkmcnt(0)
  v_mfma_f32_16x16x32_bf16 v[32:35], v[64:67], v[88:91], v[32:35]
  ds_read_b128 v[96:99], v3 offset:38912
  ds_read_b128 v[100:103], v3 offset:39168
  v_mfma_f32_16x16x32_bf16 v[36:39], v[64:67], v[92:95], v[36:39]
  ds_read_b128 v[76:79], v1 offset:56320
  ds_read_b128 v[80:83], v1 offset:56576
  v_mfma_f32_16x16x32_bf16 v[40:43], v[68:71], v[88:91], v[40:43]
  ds_read_b128 v[84:87], v1 offset:56832
  v_mfma_f32_16x16x32_bf16 v[44:47], v[68:71], v[92:95], v[44:47]
  v_mfma_f32_16x16x32_bf16 v[48:51], v[72:75], v[88:91], v[48:51]
  v_mfma_f32_16x16x32_bf16 v[52:55], v[72:75], v[92:95], v[52:55]
  s_waitcnt lgkmcnt(0)
  s_barrier
  v_mfma_f32_16x16x32_bf16 v[32:35], v[76:79], v[96:99], v[32:35]
  ds_read_b128 v[88:91], v4 offset:0
  ds_read_b128 v[92:95], v4 offset:256
  v_mfma_f32_16x16x32_bf16 v[36:39], v[76:79], v[100:103], v[36:39]
  ds_read_b128 v[64:67], v2 offset:0
  ds_read_b128 v[68:71], v2 offset:256
  v_mfma_f32_16x16x32_bf16 v[40:43], v[80:83], v[96:99], v[40:43]
  ds_read_b128 v[72:75], v2 offset:512
  v_mfma_f32_16x16x32_bf16 v[44:47], v[80:83], v[100:103], v[44:47]
  v_mfma_f32_16x16x32_bf16 v[48:51], v[84:87], v[96:99], v[48:51]
  v_mfma_f32_16x16x32_bf16 v[52:55], v[84:87], v[100:103], v[52:55]
  s_waitcnt lgkmcnt(0)
  v_mfma_f32_16x16x32_bf16 v[32:35], v[64:67], v[88:91], v[32:35]
  ds_read_b128 v[96:99], v4 offset:2048
  ds_read_b128 v[100:103], v4 offset:2304
  v_mfma_f32_16x16x32_bf16 v[36:39], v[64:67], v[92:95], v[36:39]
  ds_read_b128 v[76:79], v2 offset:5120
  ds_read_b128 v[80:83], v2 offset:5376
  v_mfma_f32_16x16x32_bf16 v[40:43], v[68:71], v[88:91], v[40:43]
  ds_read_b128 v[84:87], v2 offset:5632
  v_mfma_f32_16x16x32_bf16 v[44:47], v[68:71], v[92:95], v[44:47]
  v_mfma_f32_16x16x32_bf16 v[48:51], v[72:75], v[88:91], v[48:51]
  v_mfma_f32_16x16x32_bf16 v[52:55], v[72:75], v[92:95], v[52:55]
  s_waitcnt lgkmcnt(0)
  v_mfma_f32_16x16x32_bf16 v[32:35], v[76:79], v[96:99], v[32:35]
  ds_read_b128 v[88:91], v4 offset:4096
  ds_read_b128 v[92:95], v4 offset:4352
  v_mfma_f32_16x16x32_bf16 v[36:39], v[76:79], v[100:103], v[36:39]
  ds_read_b128 v[64:67], v2 offset:10240
  ds_read_b128 v[68:71], v2 offset:10496
  v_mfma_f32_16x16x32_bf16 v[40:43], v[80:83], v[96:99], v[40:43]
  ds_read_b128 v[72:75], v2 offset:10752
  v_mfma_f32_16x16x32_bf16 v[44:47], v[80:83], v[100:103], v[44:47]
  v_mfma_f32_16x16x32_bf16 v[48:51], v[84:87], v[96:99], v[48:51]
  v_mfma_f32_16x16x32_bf16 v[52:55], v[84:87], v[100:103], v[52:55]
  s_waitcnt lgkmcnt(0)
  v_mfma_f32_16x16x32_bf16 v[32:35], v[64:67], v[88:91], v[32:35]
  ds_read_b128 v[96:99], v4 offset:6144
  ds_read_b128 v[100:103], v4 offset:6400
  v_mfma_f32_16x16x32_bf16 v[36:39], v[64:67], v[92:95], v[36:39]
  ds_read_b128 v[76:79], v2 offset:15360
  ds_read_b128 v[80:83], v2 offset:15616
  v_mfma_f32_16x16x32_bf16 v[40:43], v[68:71], v[88:91], v[40:43]
  ds_read_b128 v[84:87], v2 offset:15872
  v_mfma_f32_16x16x32_bf16 v[44:47], v[68:71], v[92:95], v[44:47]
  v_mfma_f32_16x16x32_bf16 v[48:51], v[72:75], v[88:91], v[48:51]
  v_mfma_f32_16x16x32_bf16 v[52:55], v[72:75], v[92:95], v[52:55]
  s_waitcnt lgkmcnt(0)
  v_mfma_f32_16x16x32_bf16 v[32:35], v[76:79], v[96:99], v[32:35]
  v_mfma_f32_16x16x32_bf16 v[36:39], v[76:79], v[100:103], v[36:39]
  v_mfma_f32_16x16x32_bf16 v[40:43], v[80:83], v[96:99], v[40:43]
  v_mfma_f32_16x16x32_bf16 v[44:47], v[80:83], v[100:103], v[44:47]
  v_mfma_f32_16x16x32_bf16 v[48:51], v[84:87], v[96:99], v[48:51]
  v_mfma_f32_16x16x32_bf16 v[52:55], v[84:87], v[100:103], v[52:55]
  s_waitcnt vmcnt(0)
  v_lshlrev_b32 v22, 4, v0
  s_mov_b32 s60, s10
  s_mov_b32 s61, s11
  s_mov_b32 s62, 0x280000
  s_mov_b32 s63, 0x00020000
  v_and_b32 v23, 31, v0
  v_mul_u32_u24 v23, 1280, v23
  v_lshrrev_b32 v24, 5, v0
  v_lshl_add_u32 v23, v24, 4, v23
  s_mul_i32 s40, s38, 40960
  s_mul_i32 s41, s25, 160
  s_add_u32 s40, s40, s41
  s_mul_i32 s41, s27, 96
  s_add_u32 s53, s40, s41
  s_nop 4
  v_lshlrev_b32 v12, 16, v104
  v_and_b32 v13, 0xffff0000, v104
  v_lshlrev_b32 v14, 16, v105
  v_and_b32 v15, 0xffff0000, v105
  v_pk_add_f32 v[32:33], v[32:33], v[12:13]
  v_pk_add_f32 v[34:35], v[34:35], v[14:15]
  v_lshlrev_b32 v16, 16, v116
  v_and_b32 v17, 0xffff0000, v116
  v_lshlrev_b32 v18, 16, v117
  v_and_b32 v19, 0xffff0000, v117
  v_pk_add_f32 v[32:33], v[32:33], v[16:17]
  v_pk_add_f32 v[34:35], v[34:35], v[18:19]
  v_cvt_pk_bf16_f32 v24, v32, v33
  v_cvt_pk_bf16_f32 v25, v34, v35
  v_lshlrev_b32 v12, 16, v106
  v_and_b32 v13, 0xffff0000, v106
  v_lshlrev_b32 v14, 16, v107
  v_and_b32 v15, 0xffff0000, v107
  v_pk_add_f32 v[36:37], v[36:37], v[12:13]
  v_pk_add_f32 v[38:39], v[38:39], v[14:15]
  v_lshlrev_b32 v16, 16, v116
  v_and_b32 v17, 0xffff0000, v116
  v_lshlrev_b32 v18, 16, v117
  v_and_b32 v19, 0xffff0000, v117
  v_pk_add_f32 v[36:37], v[36:37], v[16:17]
  v_pk_add_f32 v[38:39], v[38:39], v[18:19]
  v_cvt_pk_bf16_f32 v26, v36, v37
  v_cvt_pk_bf16_f32 v27, v38, v39
  s_nop 1
  v_permlane16_swap_b32 v24, v26
  v_permlane16_swap_b32 v25, v27
  s_nop 1
  buffer_store_dwordx4 v[24:27], v23, s[60:63], s53 offen offset:0
  v_lshlrev_b32 v12, 16, v108
  v_and_b32 v13, 0xffff0000, v108
  v_lshlrev_b32 v14, 16, v109
  v_and_b32 v15, 0xffff0000, v109
  v_pk_add_f32 v[40:41], v[40:41], v[12:13]
  v_pk_add_f32 v[42:43], v[42:43], v[14:15]
  v_lshlrev_b32 v16, 16, v118
  v_and_b32 v17, 0xffff0000, v118
  v_lshlrev_b32 v18, 16, v119
  v_and_b32 v19, 0xffff0000, v119
  v_pk_add_f32 v[40:41], v[40:41], v[16:17]
  v_pk_add_f32 v[42:43], v[42:43], v[18:19]
  v_cvt_pk_bf16_f32 v28, v40, v41
  v_cvt_pk_bf16_f32 v29, v42, v43
  v_lshlrev_b32 v12, 16, v110
  v_and_b32 v13, 0xffff0000, v110
  v_lshlrev_b32 v14, 16, v111
  v_and_b32 v15, 0xffff0000, v111
  v_pk_add_f32 v[44:45], v[44:45], v[12:13]
  v_pk_add_f32 v[46:47], v[46:47], v[14:15]
  v_lshlrev_b32 v16, 16, v118
  v_and_b32 v17, 0xffff0000, v118
  v_lshlrev_b32 v18, 16, v119
  v_and_b32 v19, 0xffff0000, v119
  v_pk_add_f32 v[44:45], v[44:45], v[16:17]
  v_pk_add_f32 v[46:47], v[46:47], v[18:19]
  v_cvt_pk_bf16_f32 v30, v44, v45
  v_cvt_pk_bf16_f32 v31, v46, v47
  s_nop 1
  v_permlane16_swap_b32 v28, v30
  v_permlane16_swap_b32 v29, v31
  s_nop 1
  buffer_store_dwordx4 v[28:31], v23, s[60:63], s53 offen offset:32
  v_lshlrev_b32 v12, 16, v112
  v_and_b32 v13, 0xffff0000, v112
  v_lshlrev_b32 v14, 16, v113
  v_and_b32 v15, 0xffff0000, v113
  v_pk_add_f32 v[48:49], v[48:49], v[12:13]
  v_pk_add_f32 v[50:51], v[50:51], v[14:15]
  v_lshlrev_b32 v16, 16, v120
  v_and_b32 v17, 0xffff0000, v120
  v_lshlrev_b32 v18, 16, v121
  v_and_b32 v19, 0xffff0000, v121
  v_pk_add_f32 v[48:49], v[48:49], v[16:17]
  v_pk_add_f32 v[50:51], v[50:51], v[18:19]
  v_cvt_pk_bf16_f32 v24, v48, v49
  v_cvt_pk_bf16_f32 v25, v50, v51
  v_lshlrev_b32 v12, 16, v114
  v_and_b32 v13, 0xffff0000, v114
  v_lshlrev_b32 v14, 16, v115
  v_and_b32 v15, 0xffff0000, v115
  v_pk_add_f32 v[52:53], v[52:53], v[12:13]
  v_pk_add_f32 v[54:55], v[54:55], v[14:15]
  v_lshlrev_b32 v16, 16, v120
  v_and_b32 v17, 0xffff0000, v120
  v_lshlrev_b32 v18, 16, v121
  v_and_b32 v19, 0xffff0000, v121
  v_pk_add_f32 v[52:53], v[52:53], v[16:17]
  v_pk_add_f32 v[54:55], v[54:55], v[18:19]
  v_cvt_pk_bf16_f32 v26, v52, v53
  v_cvt_pk_bf16_f32 v27, v54, v55
  s_nop 1
  v_permlane16_swap_b32 v24, v26
  v_permlane16_swap_b32 v25, v27
  s_nop 1
  buffer_store_dwordx4 v[24:27], v23, s[60:63], s53 offen offset:64
  s_waitcnt vmcnt(0)
  s_endpgm
f0_kernel_p8_p2:
  buffer_load_dwordx2 v[104:105], v20, s[48:51], s52 offen offset:0 sc1
  buffer_load_dwordx2 v[106:107], v20, s[48:51], s52 offen offset:256 sc1
  buffer_load_dwordx2 v[108:109], v20, s[48:51], s52 offen offset:1024 sc1
  buffer_load_dwordx2 v[110:111], v20, s[48:51], s52 offen offset:1280 sc1
  s_mov_b32 s56, s8
  s_mov_b32 s57, s9
  s_mov_b32 s58, 0x500
  s_mov_b32 s59, 0x00020000
  s_mul_i32 s40, s25, 160
  s_mul_i32 s41, s27, 96
  s_add_u32 s40, s40, s41
  v_lshlrev_b32 v21, 3, v17
  buffer_load_dwordx2 v[116:117], v21, s[56:59], s40 offen offset:0
  buffer_load_dwordx2 v[118:119], v21, s[56:59], s40 offen offset:32
  s_barrier
  ds_read_b128 v[88:91], v3 offset:0
  ds_read_b128 v[92:95], v3 offset:256
  ds_read_b128 v[64:67], v1 offset:0
  ds_read_b128 v[68:71], v1 offset:256
  s_waitcnt lgkmcnt(0)
  v_mfma_f32_16x16x32_bf16 v[32:35], v[64:67], v[88:91], 0
  ds_read_b128 v[96:99], v3 offset:2048
  ds_read_b128 v[100:103], v3 offset:2304
  v_mfma_f32_16x16x32_bf16 v[36:39], v[64:67], v[92:95], 0
  ds_read_b128 v[76:79], v1 offset:5120
  ds_read_b128 v[80:83], v1 offset:5376
  v_mfma_f32_16x16x32_bf16 v[40:43], v[68:71], v[88:91], 0
  v_mfma_f32_16x16x32_bf16 v[44:47], v[68:71], v[92:95], 0
  s_waitcnt lgkmcnt(0)
  v_mfma_f32_16x16x32_bf16 v[32:35], v[76:79], v[96:99], v[32:35]
  ds_read_b128 v[88:91], v3 offset:4096
  ds_read_b128 v[92:95], v3 offset:4352
  v_mfma_f32_16x16x32_bf16 v[36:39], v[76:79], v[100:103], v[36:39]
  ds_read_b128 v[64:67], v1 offset:10240
  ds_read_b128 v[68:71], v1 offset:10496
  v_mfma_f32_16x16x32_bf16 v[40:43], v[80:83], v[96:99], v[40:43]
  v_mfma_f32_16x16x32_bf16 v[44:47], v[80:83], v[100:103], v[44:47]
  s_waitcnt lgkmcnt(0)
  v_mfma_f32_16x16x32_bf16 v[32:35], v[64:67], v[88:91], v[32:35]
  ds_read_b128 v[96:99], v3 offset:6144
  ds_read_b128 v[100:103], v3 offset:6400
  v_mfma_f32_16x16x32_bf16 v[36:39], v[64:67], v[92:95], v[36:39]
  ds_read_b128 v[76:79], v1 offset:15360
  ds_read_b128 v[80:83], v1 offset:15616
  v_mfma_f32_16x16x32_bf16 v[40:43], v[68:71], v[88:91], v[40:43]
  v_mfma_f32_16x16x32_bf16 v[44:47], v[68:71], v[92:95], v[44:47]
  s_waitcnt lgkmcnt(0)
  s_barrier
  v_mfma_f32_16x16x32_bf16 v[32:35], v[76:79], v[96:99], v[32:35]
  ds_read_b128 v[88:91], v3 offset:16384
  ds_read_b128 v[92:95], v3 offset:16640
  v_mfma_f32_16x16x32_bf16 v[36:39], v[76:79], v[100:103], v[36:39]
  ds_read_b128 v[64:67], v1 offset:20480
  ds_read_b128 v[68:71], v1 offset:20736
  v_mfma_f32_16x16x32_bf16 v[40:43], v[80:83], v[96:99], v[40:43]
  v_mfma_f32_16x16x32_bf16 v[44:47], v[80:83], v[100:103], v[44:47]
  s_waitcnt lgkmcnt(0)
  v_mfma_f32_16x16x32_bf16 v[32:35], v[64:67], v[88:91], v[32:35]
  ds_read_b128 v[96:99], v3 offset:18432
  ds_read_b128 v[100:103], v3 offset:18688
  v_mfma_f32_16x16x32_bf16 v[36:39], v[64:67], v[92:95], v[36:39]
  ds_read_b128 v[76:79], v1 offset:25600
  ds_read_b128 v[80:83], v1 offset:25856
  v_mfma_f32_16x16x32_bf16 v[40:43], v[68:71], v[88:91], v[40:43]
  v_mfma_f32_16x16x32_bf16 v[44:47], v[68:71], v[92:95], v[44:47]
  s_waitcnt lgkmcnt(0)
  v_mfma_f32_16x16x32_bf16 v[32:35], v[76:79], v[96:99], v[32:35]
  ds_read_b128 v[88:91], v3 offset:20480
  ds_read_b128 v[92:95], v3 offset:20736
  v_mfma_f32_16x16x32_bf16 v[36:39], v[76:79], v[100:103], v[36:39]
  ds_read_b128 v[64:67], v1 offset:30720
  ds_read_b128 v[68:71], v1 offset:30976
  v_mfma_f32_16x16x32_bf16 v[40:43], v[80:83], v[96:99], v[40:43]
  v_mfma_f32_16x16x32_bf16 v[44:47], v[80:83], v[100:103], v[44:47]
  s_waitcnt lgkmcnt(0)
  v_mfma_f32_16x16x32_bf16 v[32:35], v[64:67], v[88:91], v[32:35]
  ds_read_b128 v[96:99], v3 offset:22528
  ds_read_b128 v[100:103], v3 offset:22784
  v_mfma_f32_16x16x32_bf16 v[36:39], v[64:67], v[92:95], v[36:39]
  ds_read_b128 v[76:79], v1 offset:35840
  ds_read_b128 v[80:83], v1 offset:36096
  v_mfma_f32_16x16x32_bf16 v[40:43], v[68:71], v[88:91], v[40:43]
  v_mfma_f32_16x16x32_bf16 v[44:47], v[68:71], v[92:95], v[44:47]
  s_waitcnt lgkmcnt(0)
  s_barrier
  v_mfma_f32_16x16x32_bf16 v[32:35], v[76:79], v[96:99], v[32:35]
  ds_read_b128 v[88:91], v3 offset:32768
  ds_read_b128 v[92:95], v3 offset:33024
  v_mfma_f32_16x16x32_bf16 v[36:39], v[76:79], v[100:103], v[36:39]
  ds_read_b128 v[64:67], v1 offset:40960
  ds_read_b128 v[68:71], v1 offset:41216
  v_mfma_f32_16x16x32_bf16 v[40:43], v[80:83], v[96:99], v[40:43]
  v_mfma_f32_16x16x32_bf16 v[44:47], v[80:83], v[100:103], v[44:47]
  s_waitcnt lgkmcnt(0)
  v_mfma_f32_16x16x32_bf16 v[32:35], v[64:67], v[88:91], v[32:35]
  ds_read_b128 v[96:99], v3 offset:34816
  ds_read_b128 v[100:103], v3 offset:35072
  v_mfma_f32_16x16x32_bf16 v[36:39], v[64:67], v[92:95], v[36:39]
  ds_read_b128 v[76:79], v1 offset:46080
  ds_read_b128 v[80:83], v1 offset:46336
  v_mfma_f32_16x16x32_bf16 v[40:43], v[68:71], v[88:91], v[40:43]
  v_mfma_f32_16x16x32_bf16 v[44:47], v[68:71], v[92:95], v[44:47]
  s_waitcnt lgkmcnt(0)
  v_mfma_f32_16x16x32_bf16 v[32:35], v[76:79], v[96:99], v[32:35]
  ds_read_b128 v[88:91], v3 offset:36864
  ds_read_b128 v[92:95], v3 offset:37120
  v_mfma_f32_16x16x32_bf16 v[36:39], v[76:79], v[100:103], v[36:39]
  ds_read_b128 v[64:67], v1 offset:51200
  ds_read_b128 v[68:71], v1 offset:51456
  v_mfma_f32_16x16x32_bf16 v[40:43], v[80:83], v[96:99], v[40:43]
  v_mfma_f32_16x16x32_bf16 v[44:47], v[80:83], v[100:103], v[44:47]
  s_waitcnt lgkmcnt(0)
  v_mfma_f32_16x16x32_bf16 v[32:35], v[64:67], v[88:91], v[32:35]
  ds_read_b128 v[96:99], v3 offset:38912
  ds_read_b128 v[100:103], v3 offset:39168
  v_mfma_f32_16x16x32_bf16 v[36:39], v[64:67], v[92:95], v[36:39]
  ds_read_b128 v[76:79], v1 offset:56320
  ds_read_b128 v[80:83], v1 offset:56576
  v_mfma_f32_16x16x32_bf16 v[40:43], v[68:71], v[88:91], v[40:43]
  v_mfma_f32_16x16x32_bf16 v[44:47], v[68:71], v[92:95], v[44:47]
  s_waitcnt lgkmcnt(0)
  s_barrier
  v_mfma_f32_16x16x32_bf16 v[32:35], v[76:79], v[96:99], v[32:35]
  ds_read_b128 v[88:91], v4 offset:0
  ds_read_b128 v[92:95], v4 offset:256
  v_mfma_f32_16x16x32_bf16 v[36:39], v[76:79], v[100:103], v[36:39]
  ds_read_b128 v[64:67], v2 offset:0
  ds_read_b128 v[68:71], v2 offset:256
  v_mfma_f32_16x16x32_bf16 v[40:43], v[80:83], v[96:99], v[40:43]
  v_mfma_f32_16x16x32_bf16 v[44:47], v[80:83], v[100:103], v[44:47]
  s_waitcnt lgkmcnt(0)
  v_mfma_f32_16x16x32_bf16 v[32:35], v[64:67], v[88:91], v[32:35]
  ds_read_b128 v[96:99], v4 offset:2048
  ds_read_b128 v[100:103], v4 offset:2304
  v_mfma_f32_16x16x32_bf16 v[36:39], v[64:67], v[92:95], v[36:39]
  ds_read_b128 v[76:79], v2 offset:5120
  ds_read_b128 v[80:83], v2 offset:5376
  v_mfma_f32_16x16x32_bf16 v[40:43], v[68:71], v[88:91], v[40:43]
  v_mfma_f32_16x16x32_bf16 v[44:47], v[68:71], v[92:95], v[44:47]
  s_waitcnt lgkmcnt(0)
  v_mfma_f32_16x16x32_bf16 v[32:35], v[76:79], v[96:99], v[32:35]
  ds_read_b128 v[88:91], v4 offset:4096
  ds_read_b128 v[92:95], v4 offset:4352
  v_mfma_f32_16x16x32_bf16 v[36:39], v[76:79], v[100:103], v[36:39]
  ds_read_b128 v[64:67], v2 offset:10240
  ds_read_b128 v[68:71], v2 offset:10496
  v_mfma_f32_16x16x32_bf16 v[40:43], v[80:83], v[96:99], v[40:43]
  v_mfma_f32_16x16x32_bf16 v[44:47], v[80:83], v[100:103], v[44:47]
  s_waitcnt lgkmcnt(0)
  v_mfma_f32_16x16x32_bf16 v[32:35], v[64:67], v[88:91], v[32:35]
  ds_read_b128 v[96:99], v4 offset:6144
  ds_read_b128 v[100:103], v4 offset:6400
  v_mfma_f32_16x16x32_bf16 v[36:39], v[64:67], v[92:95], v[36:39]
  ds_read_b128 v[76:79], v2 offset:15360
  ds_read_b128 v[80:83], v2 offset:15616
  v_mfma_f32_16x16x32_bf16 v[40:43], v[68:71], v[88:91], v[40:43]
  v_mfma_f32_16x16x32_bf16 v[44:47], v[68:71], v[92:95], v[44:47]
  s_waitcnt lgkmcnt(0)
  s_barrier
  v_mfma_f32_16x16x32_bf16 v[32:35], v[76:79], v[96:99], v[32:35]
  ds_read_b128 v[88:91], v3 offset:0
  ds_read_b128 v[92:95], v3 offset:256
  v_mfma_f32_16x16x32_bf16 v[36:39], v[76:79], v[100:103], v[36:39]
  ds_read_b128 v[64:67], v1 offset:0
  ds_read_b128 v[68:71], v1 offset:256
  v_mfma_f32_16x16x32_bf16 v[40:43], v[80:83], v[96:99], v[40:43]
  v_mfma_f32_16x16x32_bf16 v[44:47], v[80:83], v[100:103], v[44:47]
  s_waitcnt lgkmcnt(0)
  v_mfma_f32_16x16x32_bf16 v[32:35], v[64:67], v[88:91], v[32:35]
  ds_read_b128 v[96:99], v3 offset:2048
  ds_read_b128 v[100:103], v3 offset:2304
  v_mfma_f32_16x16x32_bf16 v[36:39], v[64:67], v[92:95], v[36:39]
  ds_read_b128 v[76:79], v1 offset:5120
  ds_read_b128 v[80:83], v1 offset:5376
  v_mfma_f32_16x16x32_bf16 v[40:43], v[68:71], v[88:91], v[40:43]
  v_mfma_f32_16x16x32_bf16 v[44:47], v[68:71], v[92:95], v[44:47]
  s_waitcnt lgkmcnt(0)
  v_mfma_f32_16x16x32_bf16 v[32:35], v[76:79], v[96:99], v[32:35]
  ds_read_b128 v[88:91], v3 offset:4096
  ds_read_b128 v[92:95], v3 offset:4352
  v_mfma_f32_16x16x32_bf16 v[36:39], v[76:79], v[100:103], v[36:39]
  ds_read_b128 v[64:67], v1 offset:10240
  ds_read_b128 v[68:71], v1 offset:10496
  v_mfma_f32_16x16x32_bf16 v[40:43], v[80:83], v[96:99], v[40:43]
  v_mfma_f32_16x16x32_bf16 v[44:47], v[80:83], v[100:103], v[44:47]
  s_waitcnt lgkmcnt(0)
  v_mfma_f32_16x16x32_bf16 v[32:35], v[64:67], v[88:91], v[32:35]
  ds_read_b128 v[96:99], v3 offset:6144
  ds_read_b128 v[100:103], v3 offset:6400
  v_mfma_f32_16x16x32_bf16 v[36:39], v[64:67], v[92:95], v[36:39]
  ds_read_b128 v[76:79], v1 offset:15360
  ds_read_b128 v[80:83], v1 offset:15616
  v_mfma_f32_16x16x32_bf16 v[40:43], v[68:71], v[88:91], v[40:43]
  v_mfma_f32_16x16x32_bf16 v[44:47], v[68:71], v[92:95], v[44:47]
  s_waitcnt lgkmcnt(0)
  s_barrier
  v_mfma_f32_16x16x32_bf16 v[32:35], v[76:79], v[96:99], v[32:35]
  ds_read_b128 v[88:91], v3 offset:16384
  ds_read_b128 v[92:95], v3 offset:16640
  v_mfma_f32_16x16x32_bf16 v[36:39], v[76:79], v[100:103], v[36:39]
  ds_read_b128 v[64:67], v1 offset:20480
  ds_read_b128 v[68:71], v1 offset:20736
  v_mfma_f32_16x16x32_bf16 v[40:43], v[80:83], v[96:99], v[40:43]
  v_mfma_f32_16x16x32_bf16 v[44:47], v[80:83], v[100:103], v[44:47]
  s_waitcnt lgkmcnt(0)
  v_mfma_f32_16x16x32_bf16 v[32:35], v[64:67], v[88:91], v[32:35]
  ds_read_b128 v[96:99], v3 offset:18432
  ds_read_b128 v[100:103], v3 offset:18688
  v_mfma_f32_16x16x32_bf16 v[36:39], v[64:67], v[92:95], v[36:39]
  ds_read_b128 v[76:79], v1 offset:25600
  ds_read_b128 v[80:83], v1 offset:25856
  v_mfma_f32_16x16x32_bf16 v[40:43], v[68:71], v[88:91], v[40:43]
  v_mfma_f32_16x16x32_bf16 v[44:47], v[68:71], v[92:95], v[44:47]
  s_waitcnt lgkmcnt(0)
  v_mfma_f32_16x16x32_bf16 v[32:35], v[76:79], v[96:99], v[32:35]
  ds_read_b128 v[88:91], v3 offset:20480
  ds_read_b128 v[92:95], v3 offset:20736
  v_mfma_f32_16x16x32_bf16 v[36:39], v[76:79], v[100:103], v[36:39]
  ds_read_b128 v[64:67], v1 offset:30720
  ds_read_b128 v[68:71], v1 offset:30976
  v_mfma_f32_16x16x32_bf16 v[40:43], v[80:83], v[96:99], v[40:43]
  v_mfma_f32_16x16x32_bf16 v[44:47], v[80:83], v[100:103], v[44:47]
  s_waitcnt lgkmcnt(0)
  v_mfma_f32_16x16x32_bf16 v[32:35], v[64:67], v[88:91], v[32:35]
  ds_read_b128 v[96:99], v3 offset:22528
  ds_read_b128 v[100:103], v3 offset:22784
  v_mfma_f32_16x16x32_bf16 v[36:39], v[64:67], v[92:95], v[36:39]
  ds_read_b128 v[76:79], v1 offset:35840
  ds_read_b128 v[80:83], v1 offset:36096
  v_mfma_f32_16x16x32_bf16 v[40:43], v[68:71], v[88:91], v[40:43]
  v_mfma_f32_16x16x32_bf16 v[44:47], v[68:71], v[92:95], v[44:47]
  s_waitcnt lgkmcnt(0)
  s_barrier
  v_mfma_f32_16x16x32_bf16 v[32:35], v[76:79], v[96:99], v[32:35]
  ds_read_b128 v[88:91], v3 offset:32768
  ds_read_b128 v[92:95], v3 offset:33024
  v_mfma_f32_16x16x32_bf16 v[36:39], v[76:79], v[100:103], v[36:39]
  ds_read_b128 v[64:67], v1 offset:40960
  ds_read_b128 v[68:71], v1 offset:41216
  v_mfma_f32_16x16x32_bf16 v[40:43], v[80:83], v[96:99], v[40:43]
  v_mfma_f32_16x16x32_bf16 v[44:47], v[80:83], v[100:103], v[44:47]
  s_waitcnt lgkmcnt(0)
  v_mfma_f32_16x16x32_bf16 v[32:35], v[64:67], v[88:91], v[32:35]
  ds_read_b128 v[96:99], v3 offset:34816
  ds_read_b128 v[100:103], v3 offset:35072
  v_mfma_f32_16x16x32_bf16 v[36:39], v[64:67], v[92:95], v[36:39]
  ds_read_b128 v[76:79], v1 offset:46080
  ds_read_b128 v[80:83], v1 offset:46336
  v_mfma_f32_16x16x32_bf16 v[40:43], v[68:71], v[88:91], v[40:43]
  v_mfma_f32_16x16x32_bf16 v[44:47], v[68:71], v[92:95], v[44:47]
  s_waitcnt lgkmcnt(0)
  v_mfma_f32_16x16x32_bf16 v[32:35], v[76:79], v[96:99], v[32:35]
  ds_read_b128 v[88:91], v3 offset:36864
  ds_read_b128 v[92:95], v3 offset:37120
  v_mfma_f32_16x16x32_bf16 v[36:39], v[76:79], v[100:103], v[36:39]
  ds_read_b128 v[64:67], v1 offset:51200
  ds_read_b128 v[68:71], v1 offset:51456
  v_mfma_f32_16x16x32_bf16 v[40:43], v[80:83], v[96:99], v[40:43]
  v_mfma_f32_16x16x32_bf16 v[44:47], v[80:83], v[100:103], v[44:47]
  s_waitcnt lgkmcnt(0)
  v_mfma_f32_16x16x32_bf16 v[32:35], v[64:67], v[88:91], v[32:35]
  ds_read_b128 v[96:99], v3 offset:38912
  ds_read_b128 v[100:103], v3 offset:39168
  v_mfma_f32_16x16x32_bf16 v[36:39], v[64:67], v[92:95], v[36:39]
  ds_read_b128 v[76:79], v1 offset:56320
  ds_read_b128 v[80:83], v1 offset:56576
  v_mfma_f32_16x16x32_bf16 v[40:43], v[68:71], v[88:91], v[40:43]
  v_mfma_f32_16x16x32_bf16 v[44:47], v[68:71], v[92:95], v[44:47]
  s_waitcnt lgkmcnt(0)
  s_barrier
  v_mfma_f32_16x16x32_bf16 v[32:35], v[76:79], v[96:99], v[32:35]
  ds_read_b128 v[88:91], v4 offset:0
  ds_read_b128 v[92:95], v4 offset:256
  v_mfma_f32_16x16x32_bf16 v[36:39], v[76:79], v[100:103], v[36:39]
  ds_read_b128 v[64:67], v2 offset:0
  ds_read_b128 v[68:71], v2 offset:256
  v_mfma_f32_16x16x32_bf16 v[40:43], v[80:83], v[96:99], v[40:43]
  v_mfma_f32_16x16x32_bf16 v[44:47], v[80:83], v[100:103], v[44:47]
  s_waitcnt lgkmcnt(0)
  v_mfma_f32_16x16x32_bf16 v[32:35], v[64:67], v[88:91], v[32:35]
  ds_read_b128 v[96:99], v4 offset:2048
  ds_read_b128 v[100:103], v4 offset:2304
  v_mfma_f32_16x16x32_bf16 v[36:39], v[64:67], v[92:95], v[36:39]
  ds_read_b128 v[76:79], v2 offset:5120
  ds_read_b128 v[80:83], v2 offset:5376
  v_mfma_f32_16x16x32_bf16 v[40:43], v[68:71], v[88:91], v[40:43]
  v_mfma_f32_16x16x32_bf16 v[44:47], v[68:71], v[92:95], v[44:47]
  s_waitcnt lgkmcnt(0)
  v_mfma_f32_16x16x32_bf16 v[32:35], v[76:79], v[96:99], v[32:35]
  ds_read_b128 v[88:91], v4 offset:4096
  ds_read_b128 v[92:95], v4 offset:4352
  v_mfma_f32_16x16x32_bf16 v[36:39], v[76:79], v[100:103], v[36:39]
  ds_read_b128 v[64:67], v2 offset:10240
  ds_read_b128 v[68:71], v2 offset:10496
  v_mfma_f32_16x16x32_bf16 v[40:43], v[80:83], v[96:99], v[40:43]
  v_mfma_f32_16x16x32_bf16 v[44:47], v[80:83], v[100:103], v[44:47]
  s_waitcnt lgkmcnt(0)
  v_mfma_f32_16x16x32_bf16 v[32:35], v[64:67], v[88:91], v[32:35]
  ds_read_b128 v[96:99], v4 offset:6144
  ds_read_b128 v[100:103], v4 offset:6400
  v_mfma_f32_16x16x32_bf16 v[36:39], v[64:67], v[92:95], v[36:39]
  ds_read_b128 v[76:79], v2 offset:15360
  ds_read_b128 v[80:83], v2 offset:15616
  v_mfma_f32_16x16x32_bf16 v[40:43], v[68:71], v[88:91], v[40:43]
  v_mfma_f32_16x16x32_bf16 v[44:47], v[68:71], v[92:95], v[44:47]
  s_waitcnt lgkmcnt(0)
  s_barrier
  v_mfma_f32_16x16x32_bf16 v[32:35], v[76:79], v[96:99], v[32:35]
  ds_read_b128 v[88:91], v3 offset:0
  ds_read_b128 v[92:95], v3 offset:256
  v_mfma_f32_16x16x32_bf16 v[36:39], v[76:79], v[100:103], v[36:39]
  ds_read_b128 v[64:67], v1 offset:0
  ds_read_b128 v[68:71], v1 offset:256
  v_mfma_f32_16x16x32_bf16 v[40:43], v[80:83], v[96:99], v[40:43]
  v_mfma_f32_16x16x32_bf16 v[44:47], v[80:83], v[100:103], v[44:47]
  s_waitcnt lgkmcnt(0)
  v_mfma_f32_16x16x32_bf16 v[32:35], v[64:67], v[88:91], v[32:35]
  ds_read_b128 v[96:99], v3 offset:2048
  ds_read_b128 v[100:103], v3 offset:2304
  v_mfma_f32_16x16x32_bf16 v[36:39], v[64:67], v[92:95], v[36:39]
  ds_read_b128 v[76:79], v1 offset:5120
  ds_read_b128 v[80:83], v1 offset:5376
  v_mfma_f32_16x16x32_bf16 v[40:43], v[68:71], v[88:91], v[40:43]
  v_mfma_f32_16x16x32_bf16 v[44:47], v[68:71], v[92:95], v[44:47]
  s_waitcnt lgkmcnt(0)
  v_mfma_f32_16x16x32_bf16 v[32:35], v[76:79], v[96:99], v[32:35]
  ds_read_b128 v[88:91], v3 offset:4096
  ds_read_b128 v[92:95], v3 offset:4352
  v_mfma_f32_16x16x32_bf16 v[36:39], v[76:79], v[100:103], v[36:39]
  ds_read_b128 v[64:67], v1 offset:10240
  ds_read_b128 v[68:71], v1 offset:10496
  v_mfma_f32_16x16x32_bf16 v[40:43], v[80:83], v[96:99], v[40:43]
  v_mfma_f32_16x16x32_bf16 v[44:47], v[80:83], v[100:103], v[44:47]
  s_waitcnt lgkmcnt(0)
  v_mfma_f32_16x16x32_bf16 v[32:35], v[64:67], v[88:91], v[32:35]
  ds_read_b128 v[96:99], v3 offset:6144
  ds_read_b128 v[100:103], v3 offset:6400
  v_mfma_f32_16x16x32_bf16 v[36:39], v[64:67], v[92:95], v[36:39]
  ds_read_b128 v[76:79], v1 offset:15360
  ds_read_b128 v[80:83], v1 offset:15616
  v_mfma_f32_16x16x32_bf16 v[40:43], v[68:71], v[88:91], v[40:43]
  v_mfma_f32_16x16x32_bf16 v[44:47], v[68:71], v[92:95], v[44:47]
  s_waitcnt lgkmcnt(0)
  s_barrier
  v_mfma_f32_16x16x32_bf16 v[32:35], v[76:79], v[96:99], v[32:35]
  ds_read_b128 v[88:91], v3 offset:16384
  ds_read_b128 v[92:95], v3 offset:16640
  v_mfma_f32_16x16x32_bf16 v[36:39], v[76:79], v[100:103], v[36:39]
  ds_read_b128 v[64:67], v1 offset:20480
  ds_read_b128 v[68:71], v1 offset:20736
  v_mfma_f32_16x16x32_bf16 v[40:43], v[80:83], v[96:99], v[40:43]
  v_mfma_f32_16x16x32_bf16 v[44:47], v[80:83], v[100:103], v[44:47]
  s_waitcnt lgkmcnt(0)
  v_mfma_f32_16x16x32_bf16 v[32:35], v[64:67], v[88:91], v[32:35]
  ds_read_b128 v[96:99], v3 offset:18432
  ds_read_b128 v[100:103], v3 offset:18688
  v_mfma_f32_16x16x32_bf16 v[36:39], v[64:67], v[92:95], v[36:39]
  ds_read_b128 v[76:79], v1 offset:25600
  ds_read_b128 v[80:83], v1 offset:25856
  v_mfma_f32_16x16x32_bf16 v[40:43], v[68:71], v[88:91], v[40:43]
  v_mfma_f32_16x16x32_bf16 v[44:47], v[68:71], v[92:95], v[44:47]
  s_waitcnt lgkmcnt(0)
  v_mfma_f32_16x16x32_bf16 v[32:35], v[76:79], v[96:99], v[32:35]
  ds_read_b128 v[88:91], v3 offset:20480
  ds_read_b128 v[92:95], v3 offset:20736
  v_mfma_f32_16x16x32_bf16 v[36:39], v[76:79], v[100:103], v[36:39]
  ds_read_b128 v[64:67], v1 offset:30720
  ds_read_b128 v[68:71], v1 offset:30976
  v_mfma_f32_16x16x32_bf16 v[40:43], v[80:83], v[96:99], v[40:43]
  v_mfma_f32_16x16x32_bf16 v[44:47], v[80:83], v[100:103], v[44:47]
  s_waitcnt lgkmcnt(0)
  v_mfma_f32_16x16x32_bf16 v[32:35], v[64:67], v[88:91], v[32:35]
  ds_read_b128 v[96:99], v3 offset:22528
  ds_read_b128 v[100:103], v3 offset:22784
  v_mfma_f32_16x16x32_bf16 v[36:39], v[64:67], v[92:95], v[36:39]
  ds_read_b128 v[76:79], v1 offset:35840
  ds_read_b128 v[80:83], v1 offset:36096
  v_mfma_f32_16x16x32_bf16 v[40:43], v[68:71], v[88:91], v[40:43]
  v_mfma_f32_16x16x32_bf16 v[44:47], v[68:71], v[92:95], v[44:47]
  s_waitcnt lgkmcnt(0)
  s_barrier
  v_mfma_f32_16x16x32_bf16 v[32:35], v[76:79], v[96:99], v[32:35]
  ds_read_b128 v[88:91], v3 offset:32768
  ds_read_b128 v[92:95], v3 offset:33024
  v_mfma_f32_16x16x32_bf16 v[36:39], v[76:79], v[100:103], v[36:39]
  ds_read_b128 v[64:67], v1 offset:40960
  ds_read_b128 v[68:71], v1 offset:41216
  v_mfma_f32_16x16x32_bf16 v[40:43], v[80:83], v[96:99], v[40:43]
  v_mfma_f32_16x16x32_bf16 v[44:47], v[80:83], v[100:103], v[44:47]
  s_waitcnt lgkmcnt(0)
  v_mfma_f32_16x16x32_bf16 v[32:35], v[64:67], v[88:91], v[32:35]
  ds_read_b128 v[96:99], v3 offset:34816
  ds_read_b128 v[100:103], v3 offset:35072
  v_mfma_f32_16x16x32_bf16 v[36:39], v[64:67], v[92:95], v[36:39]
  ds_read_b128 v[76:79], v1 offset:46080
  ds_read_b128 v[80:83], v1 offset:46336
  v_mfma_f32_16x16x32_bf16 v[40:43], v[68:71], v[88:91], v[40:43]
  v_mfma_f32_16x16x32_bf16 v[44:47], v[68:71], v[92:95], v[44:47]
  s_waitcnt lgkmcnt(0)
  v_mfma_f32_16x16x32_bf16 v[32:35], v[76:79], v[96:99], v[32:35]
  ds_read_b128 v[88:91], v3 offset:36864
  ds_read_b128 v[92:95], v3 offset:37120
  v_mfma_f32_16x16x32_bf16 v[36:39], v[76:79], v[100:103], v[36:39]
  ds_read_b128 v[64:67], v1 offset:51200
  ds_read_b128 v[68:71], v1 offset:51456
  v_mfma_f32_16x16x32_bf16 v[40:43], v[80:83], v[96:99], v[40:43]
  v_mfma_f32_16x16x32_bf16 v[44:47], v[80:83], v[100:103], v[44:47]
  s_waitcnt lgkmcnt(0)
  v_mfma_f32_16x16x32_bf16 v[32:35], v[64:67], v[88:91], v[32:35]
  ds_read_b128 v[96:99], v3 offset:38912
  ds_read_b128 v[100:103], v3 offset:39168
  v_mfma_f32_16x16x32_bf16 v[36:39], v[64:67], v[92:95], v[36:39]
  ds_read_b128 v[76:79], v1 offset:56320
  ds_read_b128 v[80:83], v1 offset:56576
  v_mfma_f32_16x16x32_bf16 v[40:43], v[68:71], v[88:91], v[40:43]
  v_mfma_f32_16x16x32_bf16 v[44:47], v[68:71], v[92:95], v[44:47]
  s_waitcnt lgkmcnt(0)
  s_barrier
  v_mfma_f32_16x16x32_bf16 v[32:35], v[76:79], v[96:99], v[32:35]
  ds_read_b128 v[88:91], v4 offset:0
  ds_read_b128 v[92:95], v4 offset:256
  v_mfma_f32_16x16x32_bf16 v[36:39], v[76:79], v[100:103], v[36:39]
  ds_read_b128 v[64:67], v2 offset:0
  ds_read_b128 v[68:71], v2 offset:256
  v_mfma_f32_16x16x32_bf16 v[40:43], v[80:83], v[96:99], v[40:43]
  v_mfma_f32_16x16x32_bf16 v[44:47], v[80:83], v[100:103], v[44:47]
  s_waitcnt lgkmcnt(0)
  v_mfma_f32_16x16x32_bf16 v[32:35], v[64:67], v[88:91], v[32:35]
  ds_read_b128 v[96:99], v4 offset:2048
  ds_read_b128 v[100:103], v4 offset:2304
  v_mfma_f32_16x16x32_bf16 v[36:39], v[64:67], v[92:95], v[36:39]
  ds_read_b128 v[76:79], v2 offset:5120
  ds_read_b128 v[80:83], v2 offset:5376
  v_mfma_f32_16x16x32_bf16 v[40:43], v[68:71], v[88:91], v[40:43]
  v_mfma_f32_16x16x32_bf16 v[44:47], v[68:71], v[92:95], v[44:47]
  s_waitcnt lgkmcnt(0)
  v_mfma_f32_16x16x32_bf16 v[32:35], v[76:79], v[96:99], v[32:35]
  ds_read_b128 v[88:91], v4 offset:4096
  ds_read_b128 v[92:95], v4 offset:4352
  v_mfma_f32_16x16x32_bf16 v[36:39], v[76:79], v[100:103], v[36:39]
  ds_read_b128 v[64:67], v2 offset:10240
  ds_read_b128 v[68:71], v2 offset:10496
  v_mfma_f32_16x16x32_bf16 v[40:43], v[80:83], v[96:99], v[40:43]
  v_mfma_f32_16x16x32_bf16 v[44:47], v[80:83], v[100:103], v[44:47]
  s_waitcnt lgkmcnt(0)
  v_mfma_f32_16x16x32_bf16 v[32:35], v[64:67], v[88:91], v[32:35]
  ds_read_b128 v[96:99], v4 offset:6144
  ds_read_b128 v[100:103], v4 offset:6400
  v_mfma_f32_16x16x32_bf16 v[36:39], v[64:67], v[92:95], v[36:39]
  ds_read_b128 v[76:79], v2 offset:15360
  ds_read_b128 v[80:83], v2 offset:15616
  v_mfma_f32_16x16x32_bf16 v[40:43], v[68:71], v[88:91], v[40:43]
  v_mfma_f32_16x16x32_bf16 v[44:47], v[68:71], v[92:95], v[44:47]
  s_waitcnt lgkmcnt(0)
  v_mfma_f32_16x16x32_bf16 v[32:35], v[76:79], v[96:99], v[32:35]
  v_mfma_f32_16x16x32_bf16 v[36:39], v[76:79], v[100:103], v[36:39]
  v_mfma_f32_16x16x32_bf16 v[40:43], v[80:83], v[96:99], v[40:43]
  v_mfma_f32_16x16x32_bf16 v[44:47], v[80:83], v[100:103], v[44:47]
  s_waitcnt vmcnt(0)
  v_lshlrev_b32 v22, 4, v0
  s_mov_b32 s60, s10
  s_mov_b32 s61, s11
  s_mov_b32 s62, 0x280000
  s_mov_b32 s63, 0x00020000
  v_and_b32 v23, 31, v0
  v_mul_u32_u24 v23, 1280, v23
  v_lshrrev_b32 v24, 5, v0
  v_lshl_add_u32 v23, v24, 4, v23
  s_mul_i32 s40, s38, 40960
  s_mul_i32 s41, s25, 160
  s_add_u32 s40, s40, s41
  s_mul_i32 s41, s27, 96
  s_add_u32 s53, s40, s41
  s_nop 4
  v_lshlrev_b32 v12, 16, v104
  v_and_b32 v13, 0xffff0000, v104
  v_lshlrev_b32 v14, 16, v105
  v_and_b32 v15, 0xffff0000, v105
  v_pk_add_f32 v[32:33], v[32:33], v[12:13]
  v_pk_add_f32 v[34:35], v[34:35], v[14:15]
  v_lshlrev_b32 v16, 16, v116
  v_and_b32 v17, 0xffff0000, v116
  v_lshlrev_b32 v18, 16, v117
  v_and_b32 v19, 0xffff0000, v117
  v_pk_add_f32 v[32:33], v[32:33], v[16:17]
  v_pk_add_f32 v[34:35], v[34:35], v[18:19]
  v_cvt_pk_bf16_f32 v24, v32, v33
  v_cvt_pk_bf16_f32 v25, v34, v35
  v_lshlrev_b32 v12, 16, v106
  v_and_b32 v13, 0xffff0000, v106
  v_lshlrev_b32 v14, 16, v107
  v_and_b32 v15, 0xffff0000, v107
  v_pk_add_f32 v[36:37], v[36:37], v[12:13]
  v_pk_add_f32 v[38:39], v[38:39], v[14:15]
  v_lshlrev_b32 v16, 16, v116
  v_and_b32 v17, 0xffff0000, v116
  v_lshlrev_b32 v18, 16, v117
  v_and_b32 v19, 0xffff0000, v117
  v_pk_add_f32 v[36:37], v[36:37], v[16:17]
  v_pk_add_f32 v[38:39], v[38:39], v[18:19]
  v_cvt_pk_bf16_f32 v26, v36, v37
  v_cvt_pk_bf16_f32 v27, v38, v39
  s_nop 1
  v_permlane16_swap_b32 v24, v26
  v_permlane16_swap_b32 v25, v27
  s_nop 1
  buffer_store_dwordx4 v[24:27], v23, s[60:63], s53 offen offset:0
  v_lshlrev_b32 v12, 16, v108
  v_and_b32 v13, 0xffff0000, v108
  v_lshlrev_b32 v14, 16, v109
  v_and_b32 v15, 0xffff0000, v109
  v_pk_add_f32 v[40:41], v[40:41], v[12:13]
  v_pk_add_f32 v[42:43], v[42:43], v[14:15]
  v_lshlrev_b32 v16, 16, v118
  v_and_b32 v17, 0xffff0000, v118
  v_lshlrev_b32 v18, 16, v119
  v_and_b32 v19, 0xffff0000, v119
  v_pk_add_f32 v[40:41], v[40:41], v[16:17]
  v_pk_add_f32 v[42:43], v[42:43], v[18:19]
  v_cvt_pk_bf16_f32 v28, v40, v41
  v_cvt_pk_bf16_f32 v29, v42, v43
  v_lshlrev_b32 v12, 16, v110
  v_and_b32 v13, 0xffff0000, v110
  v_lshlrev_b32 v14, 16, v111
  v_and_b32 v15, 0xffff0000, v111
  v_pk_add_f32 v[44:45], v[44:45], v[12:13]
  v_pk_add_f32 v[46:47], v[46:47], v[14:15]
  v_lshlrev_b32 v16, 16, v118
  v_and_b32 v17, 0xffff0000, v118
  v_lshlrev_b32 v18, 16, v119
  v_and_b32 v19, 0xffff0000, v119
  v_pk_add_f32 v[44:45], v[44:45], v[16:17]
  v_pk_add_f32 v[46:47], v[46:47], v[18:19]
  v_cvt_pk_bf16_f32 v30, v44, v45
  v_cvt_pk_bf16_f32 v31, v46, v47
  s_nop 1
  v_permlane16_swap_b32 v28, v30
  v_permlane16_swap_b32 v29, v31
  s_nop 1
  buffer_store_dwordx4 v[28:31], v23, s[60:63], s53 offen offset:32
  s_waitcnt vmcnt(0)
  s_endpgm
f0_kernel_skip:
f0_kernel_fin:
  s_endpgm
.section .rodata,"a"
.p2align 6
.amdhsa_kernel qkv0_kernel
  .amdhsa_next_free_vgpr 256
  .amdhsa_next_free_sgpr 102
  .amdhsa_accum_offset 256
  .amdhsa_group_segment_fixed_size 0
  .amdhsa_kernarg_size 88
  .amdhsa_user_sgpr_count 2
  .amdhsa_user_sgpr_kernarg_segment_ptr 1
  .amdhsa_system_sgpr_workgroup_id_x 1
.end_amdhsa_kernel
.section .rodata,"a"
.p2align 6
.amdhsa_kernel f0_kernel
  .amdhsa_next_free_vgpr 256
  .amdhsa_next_free_sgpr 102
  .amdhsa_accum_offset 256
  .amdhsa_group_segment_fixed_size 0
  .amdhsa_kernarg_size 88
  .amdhsa_user_sgpr_count 2
  .amdhsa_user_sgpr_kernarg_segment_ptr 1
  .amdhsa_system_sgpr_workgroup_id_x 1
.end_amdhsa_kernel
```
